```python
import torch

def _softmax(x, axis=-1):
    return torch.softmax(x, dim=axis)
def _gelu(x):
    return torch.nn.functional.gelu(x, approximate="tanh")
def _silu(x):
    return torch.nn.functional.silu(x)
def _sigmoid(x):
    return torch.sigmoid(x)
def _layernorm(x, axis=-1, eps=1e-5):
    m = x.mean(dim=axis, keepdim=True)
    v = x.var(dim=axis, keepdim=True, unbiased=False)
    return (x - m) / torch.sqrt(v + eps)
def _scatter_add(tgt, idx, src, axis=0):
    return tgt.clone().index_add_(axis, idx, src)
def _segment_sum(src, seg, n):
    out = torch.zeros((n,) + src.shape[1:], dtype=src.dtype)
    return out.index_add_(0, seg, src)
def _pad(x, pw):
    flat = tuple(v for pair in reversed(pw) for v in pair)
    return torch.nn.functional.pad(x, flat)

kernel_name = 'interleave_layers__sliding_local_dilated__glu_gated_swiglu__prompt'

def setup_inputs():

    _w = (lambda a: (lambda t: t.to(torch.bfloat16) if t.is_floating_point() else t)(torch.as_tensor(a)))
    def _A_setup():
        B, S, D = 1, 2048, 448
        return {
            "x": _w((lambda *s: torch.randn(*s, dtype=torch.bfloat16) * 0.05)(B, S, D)),
            "wqkv": _w((lambda *s: torch.randn(*s, dtype=torch.bfloat16) * 0.05)(D, 3 * D)),
            "wo": _w((lambda *s: torch.randn(*s, dtype=torch.bfloat16) * 0.05)(D, D)),
        }
    _A_in = _A_setup()

    def _B_setup():
        B, S, D, F = 1, 2048, 448, 1792
        return {
            "x": _w((lambda *s: torch.randn(*s, dtype=torch.bfloat16) * 0.05)(B, S, D)),
            "w1": _w((lambda *s: torch.randn(*s, dtype=torch.bfloat16) * 0.8)(D, F) * (2.0 / D) ** 0.5),
            "w3": _w((lambda *s: torch.randn(*s, dtype=torch.bfloat16) * 0.8)(D, F) * (2.0 / D) ** 0.5),
            "w2": _w((lambda *s: torch.randn(*s, dtype=torch.bfloat16) * 0.8)(F, D) * (2.0 / F) ** 0.5),
        }
    _B_in = _B_setup()

    return {
        "A_x": _A_in["x"],
        "A_wqkv": _A_in["wqkv"],
        "A_wo": _A_in["wo"],
        "B_x": _B_in["x"],
        "B_w1": _B_in["w1"],
        "B_w3": _B_in["w3"],
        "B_w2": _B_in["w2"],
    }

def reference(A_x, A_wqkv, A_wo, B_x, B_w1, B_w3, B_w2):
    def _A_ref(x, wqkv, wo):
        B, S, D = x.shape
        H = 16; Dh = D // H
        W, dil = 8, 2
        qkv = (lambda x, *d: x.permute(*d))((x @ wqkv).reshape(B, S, 3, H, Dh), 2, 0, 3, 1, 4)
        q, k, v = qkv[0], qkv[1], qkv[2]
        scale = Dh ** -0.5
        pos = torch.arange(S)
        off = torch.arange(W) * dil
        idx = pos[:, None] - off[None, :]
        mask = idx >= 0
        idx_c = torch.where(mask, idx, 0).reshape(-1)
        kg = k[:, :, idx_c, :].reshape(B, H, S, W, Dh)
        vg = v[:, :, idx_c, :].reshape(B, H, S, W, Dh)
        logits = torch.einsum("bhsd,bhswd->bhsw", q, kg) * scale
        logits = torch.where(mask[None, None, :, :], logits, -1e9)
        attn = _softmax(logits, axis=-1)
        o = torch.einsum("bhsw,bhswd->bhsd", attn, vg)
        return (lambda x, *d: x.permute(*d))(o, 0, 2, 1, 3).reshape(B, S, D) @ wo

    def _B_ref(x, w1, w3, w2):
        gate = torch.einsum("bsd,df->bsf", x, w1)
        up = torch.einsum("bsd,df->bsf", x, w3)
        h = _silu(gate) * up
        out = torch.einsum("bsf,fd->bsd", h, w2)
        return out

    x = A_x
    x = x + _A_ref(_layernorm(x, axis=-1), A_wqkv, A_wo)
    x = x + _B_ref(_layernorm(x, axis=-1), B_w1, B_w3, B_w2)
    x = x + _A_ref(_layernorm(x, axis=-1), A_wqkv, A_wo)
    x = x + _B_ref(_layernorm(x, axis=-1), B_w1, B_w3, B_w2)
    return x
```

```asm
; @launch grid=(256,1,1) block=(256,1,1) lds=163840
.amdgcn_target "amdgcn-amd-amdhsa--gfx950"
.text
.fill 64, 4, 0xbf810000
.globl interleave_layers__sliding_local_dilated__glu_gated_swiglu__prompt_kernel
.p2align 8
.type interleave_layers__sliding_local_dilated__glu_gated_swiglu__prompt_kernel,@function
interleave_layers__sliding_local_dilated__glu_gated_swiglu__prompt_kernel:

s_cmp_ge_u32 s2, 256
s_cbranch_scc1 interleave_layers__sliding_local_dilated__glu_gated_swiglu__prompt_kernel_end
s_load_dwordx2 s[8:9], s[0:1], 0
s_load_dwordx2 s[4:5], s[0:1], 72
v_lshrrev_b32 v2, 6, v0
v_and_b32 v0, 63, v0
s_lshr_b32 s13, s2, 3
v_readfirstlane_b32 s14, v2
s_getpc_b64 s[30:31]
v_lshl_add_u32 v2, s13, 2, v2
v_lshl_add_u32 v2, v0, 7, v2
v_lshlrev_b32 v2, 7, v2
v_cmp_gt_u32 vcc, (interleave_layers__sliding_local_dilated__glu_gated_swiglu__prompt_kernel_gl - interleave_layers__sliding_local_dilated__glu_gated_swiglu__prompt_kernel), v2
s_nop 0
s_mov_b64 exec, vcc
global_load_dword v192, v2, s[30:31]
s_mov_b64 exec, -1
s_lshl_b32 s26, s2, 2
s_add_u32 s26, s26, s14
s_load_dwordx4 s[60:63], s[0:1], 8
s_load_dwordx2 s[56:57], s[0:1], 48
v_lshlrev_b32 v1, 4, v0
s_and_b32 s12, s2, 7
s_mul_i32 s16, s26, 24967
s_lshr_b32 s16, s16, 20
s_mul_i32 s17, s16, 42
s_sub_u32 s17, s26, s17
s_mul_i32 s18, s17, 43
s_lshr_b32 s18, s18, 7
s_mul_i32 s19, s18, 3
s_sub_u32 s19, s17, s19
s_mul_i32 s16, s16, 56
s_mul_i32 s18, s18, 86016
s_mul_i32 s19, s19, 896
s_add_u32 s16, s16, s18
s_add_u32 s16, s16, s19
s_sub_u32 s17, s26, 784
s_bfe_u32 s18, s17, 0x40001
s_mul_i32 s18, s18, 25088
s_lshr_b32 s19, s17, 5
s_lshl_b32 s19, s19, 7
s_add_u32 s18, s18, s19
s_and_b32 s19, s17, 1
s_lshl_b32 s19, s19, 6
s_add_u32 s18, s18, s19
s_cmp_lt_u32 s17, 224
s_cselect_b32 s18, s18, 0x40000000
s_cmp_lt_u32 s26, 672
s_cselect_b32 s20, s16, s18
s_movk_i32 s16, 896
s_cselect_b32 s16, 2688, s16
s_cselect_b32 s17, 64, 48
s_cselect_b32 s19, 1, 0
s_mul_i32 s54, s16, 448
s_lshl_b32 s21, s16, 4
s_add_u32 s21, s21, s20
v_lshrrev_b32 v3, 2, v0
v_mul_u32_u24 v3, s16, v3
v_and_b32 v4, 3, v0
v_lshl_add_u32 v8, v4, 4, v3
v_cmp_gt_u32 vcc, s17, v0
v_bfrev_b32 v9, 1
s_nop 0
v_cndmask_b32 v9, v9, v8, vcc
s_lshl_b32 s22, s14, 11
s_lshl_b32 s16, s13, 2
s_add_u32 s16, s16, s14
s_mul_i32 s17, s16, 15
v_add_u32 v3, s17, v0
v_mul_u32_u24 v4, 9363, v3
v_lshrrev_b32 v4, 16, v4
v_mul_u32_u24 v6, 7, v4
v_sub_u32 v6, v3, v6
s_and_b32 s17, s12, 3
s_lshl_b32 s17, s17, 8
s_sub_i32 s17, s17, 16
v_add_u32 v4, s17, v4
v_max_i32 v4, 0, v4
v_mul_u32_u24 v4, 1792, v4
v_lshl_add_u32 v189, v6, 7, v4
s_lshr_b32 s17, s12, 2
s_mul_i32 s17, s17, 896
s_mov_b32 s55, 0x20000
s_mov_b32 s6, 17309696
s_mov_b32 s7, 0x20000
s_mov_b32 m0, s22
s_mov_b32 s18, 17043456
s_mov_b32 s10, 1835008
s_mov_b32 s11, 0x20000
s_mov_b32 s58, 1605632
s_mov_b32 s59, 0x20000
s_waitcnt lgkmcnt(0)
s_cmp_eq_u32 s19, 1
s_cselect_b32 s52, s60, s62
s_cselect_b32 s53, s61, s63
s_and_b32 s53, s53, 0xffff
s_and_b32 s9, s9, 0xffff
buffer_load_dwordx4 v8, s[52:55], s20 offen lds
s_add_u32 m0, s22, 1024
s_and_b32 s5, s5, 0xffff
buffer_load_dwordx4 v9, s[52:55], s21 offen lds
s_mov_b64 exec, 1
buffer_load_dword v193, off, s[4:7], s18 sc1
s_mov_b64 exec, 0x7fff
buffer_load_dword v194, v189, s[8:11], s17 offen
s_mov_b64 exec, -1
s_and_b32 s57, s57, 0xffff
s_cmp_lt_u32 s26, 672
s_cselect_b64 vcc, -1, 0
s_movk_i32 s3, 512
s_cselect_b32 s3, s3, 1024
v_lshrrev_b32 v16, 5, v0
v_bfe_u32 v17, v0, 4, 1
v_lshlrev_b32 v16, 2, v16
v_add_u32 v16, v16, v17
v_lshrrev_b32 v17, 4, v0
v_cndmask_b32 v16, v17, v16, vcc
v_bfe_u32 v18, v0, 2, 2
v_lshl_add_u32 v18, v16, 2, v18
v_lshlrev_b32 v18, 6, v18
v_and_b32 v16, 3, v0
v_lshl_add_u32 v18, v16, 3, v18
v_add_u32 v168, s22, v18
v_add_u32 v169, s3, v168
s_lshl_b32 s66, s26, 11
s_add_u32 s66, s66, 2064384
s_add_u32 s67, s66, 1024
s_sub_u32 s3, s26, 784
s_lshr_b32 s16, s3, 5
s_lshl_b32 s16, s16, 16
s_and_b32 s17, s3, 1
s_lshl_b32 s17, s17, 15
s_add_u32 s16, s16, s17
s_bfe_u32 s17, s3, 0x40001
s_lshl_b32 s17, s17, 10
s_add_u32 s16, s16, s17
s_add_u32 s16, s16, 1605632
s_cmp_lt_u32 s3, 224
s_cselect_b32 s16, s16, 0x40000000
s_add_u32 s17, s16, 16384
s_cmp_lt_u32 s26, 672
s_cselect_b32 s66, s66, s16
s_cselect_b32 s67, s67, s17
s_cselect_b32 s68, 0x0fff0fff, -1
s_mul_i32 s27, s26, 9363
s_lshr_b32 s27, s27, 20
s_mul_i32 s16, s27, 112
s_sub_u32 s16, s26, s16
s_lshr_b32 s17, s16, 1
s_and_b32 s16, s16, 1
s_mul_i32 s36, s17, 28672
s_lshl_b32 s17, s27, 7
s_add_u32 s36, s36, s17
s_lshl_b32 s16, s16, 6
s_add_u32 s36, s36, s16
s_lshl_b32 s27, s26, 11
s_add_u32 s27, s27, 0
s_cmp_lt_u32 s26, 784
s_cselect_b32 s36, s36, 0x40000000
s_cselect_b32 s27, s27, 0x40000000
s_add_u32 s37, s36, 14336
v_lshrrev_b32 v18, 2, v0
v_mul_u32_u24 v18, 896, v18
v_and_b32 v19, 3, v0
v_lshl_add_u32 v209, v19, 4, v18
s_lshl_b32 s34, s14, 11
s_add_u32 s34, s34, 147456
v_lshrrev_b32 v18, 5, v0
v_bfe_u32 v20, v0, 2, 3
v_lshl_add_u32 v18, v18, 4, v20
v_lshlrev_b32 v18, 6, v18
v_lshl_add_u32 v18, v19, 3, v18
v_add_u32 v211, s34, v18
s_getreg_b32 s44, hwreg(HW_REG_XCC_ID)
s_and_b32 s44, s44, 15
s_lshl_b32 s44, s44, 4
s_min_u32 s47, s13, 27
s_mul_i32 s41, s47, 9363
s_lshr_b32 s41, s41, 16
s_mul_i32 s16, s41, 7
s_sub_u32 s40, s47, s16
s_lshl_b32 s42, s12, 3
s_add_u32 s42, s42, s41
s_mov_b32 s48, 0x0fffffff
s_mov_b32 s49, 0
s_sub_u32 s45, s13, 28
s_lshl_b32 s45, s45, 2
s_add_u32 s45, s45, s14
s_lshl_b32 s43, s12, 8
s_add_u32 s43, s43, 16809984
s_lshl_b32 s16, s13, 2
s_add_u32 s46, s43, s16
s_cmp_eq_u32 s14, 0
s_cselect_b32 s50, 0, 0x80000000
s_lshl_b32 s51, s12, 5
s_add_u32 s51, s51, s13
s_lshl_b32 s51, s51, 7
s_add_u32 s51, s51, 16879616
s_and_b32 s16, s42, 31
s_lshl_b32 s16, s16, 6
s_lshr_b32 s17, s42, 5
s_add_u32 s16, s16, s17
s_mul_i32 s16, s16, 896
s_lshl_b32 s17, s40, 7
s_add_u32 s35, s16, s17
s_lshl_b32 s17, s14, 5
s_add_u32 s35, s35, s17
v_and_b32 v18, 15, v0
v_mul_u32_u24 v18, 1792, v18
v_lshrrev_b32 v19, 4, v0
v_lshl_add_u32 v165, v19, 3, v18
s_lshl_b32 s20, s12, 4
s_lshr_b32 s16, s13, 4
s_lshl_b32 s16, s16, 3
s_add_u32 s20, s20, s16
s_lshl_b32 s16, s14, 1
s_add_u32 s20, s20, s16
s_and_b32 s16, s20, 63
s_cmp_eq_u32 s16, 0
s_cselect_b32 s21, 0, 1
s_sub_u32 s22, s20, s21
s_lshl_b32 s16, s14, 1
s_sub_u32 s17, s20, s16
s_and_b32 s16, s17, 63
s_lshl_b32 s16, s16, 5
s_lshr_b32 s23, s17, 6
s_add_u32 s16, s16, s23
s_mul_i32 s23, s16, 896
s_mul_i32 s16, s14, 14336
s_add_u32 s23, s23, s16
s_add_u32 s25, s23, 28672
s_sub_u32 s24, s23, 28672
s_and_b32 s16, s17, 63
s_cmp_eq_u32 s16, 0
s_cselect_b32 s16, 1, 0
s_cmp_lt_u32 s14, 2
s_cselect_b32 s16, s16, 0
s_cmp_eq_u32 s16, 1
s_cselect_b32 s24, s23, s24
s_add_u32 s23, s25, 172032
s_cmp_lt_u32 s14, 2
s_cselect_b32 s23, s23, 0x40000000
s_lshl_b32 s22, s14, 10
s_add_u32 s22, s22, 86016
v_lshrrev_b32 v59, 3, v0
v_and_b32 v60, 7, v0
v_lshrrev_b32 v61, 1, v59
s_and_b32 s16, s14, 1
s_lshl_b32 s16, s16, 2
v_add_u32 v61, s16, v61
v_xor_b32 v60, v60, v61
v_mul_u32_u24 v59, 1792, v59
v_lshl_add_u32 v212, v60, 4, v59
v_and_b32 v59, 15, v0
v_lshrrev_b32 v60, 5, v0
v_lshlrev_b32 v60, 1, v60
v_lshrrev_b32 v61, 1, v59
v_xor_b32 v60, v60, v61
v_lshlrev_b32 v59, 7, v59
v_lshl_add_u32 v59, v60, 4, v59
v_bfe_u32 v60, v0, 4, 1
v_lshl_add_u32 v59, v60, 3, v59
s_lshl_b32 s16, s14, 12
s_add_u32 s16, s16, 86016
v_add_u32 v152, s16, v59
v_xor_b32 v153, 16, v152
v_xor_b32 v154, 64, v152
v_xor_b32 v155, 80, v152
s_and_b32 s18, s13, 15
s_mul_i32 s18, s18, 86016
s_mul_i32 s19, s14, 3072
s_add_u32 s18, s18, s19
s_add_u32 s18, s18, 2064384
s_lshl_b32 s28, s20, 14
s_and_b32 s17, s13, 15
s_lshl_b32 s17, s17, 10
s_add_u32 s28, s28, s17
s_add_u32 s28, s28, 5275648
s_lshr_b32 s16, s14, 1
v_lshrrev_b32 v16, 3, v0
v_bfe_u32 v255, v0, 1, 2
v_bfe_u32 v17, v0, 4, 1
v_sub_u32 v255, v255, v17
s_lshl_b32 s16, s16, 1
v_subrev_u32 v255, s16, v255
v_and_b32 v255, 3, v255
v_lshlrev_b32 v255, 5, v255
v_and_b32 v17, 1, v0
v_lshl_add_u32 v255, v17, 4, v255
v_mul_u32_u24 v16, 3584, v16
v_add_u32 v255, v255, v16
s_lshr_b32 s16, s14, 1
s_lshl_b32 s16, s16, 3
s_add_u32 s16, s16, 32
s_load_dwordx2 s[52:53], s[0:1], s16
s_mov_b32 s54, 1605632
s_and_b32 s16, s14, 1
s_mul_i32 s16, s16, 28672
s_lshl_b32 s47, s47, 7
s_add_u32 s47, s47, s16
s_cmp_ge_u32 s13, 28
s_cselect_b32 s47, 0x40000000, s47
v_lshrrev_b32 v59, 4, v0
v_and_b32 v61, 15, v0
v_lshlrev_b32 v60, 2, v59
v_sub_u32 v60, v60, v61
v_mov_b32 v62, 0xf149f2ca
v_cmp_le_i32 vcc, 9, v60
s_nop 1
v_cndmask_b32 v216, v62, 0, vcc
v_add_u32 v63, 7, v60
v_cmp_gt_u32 vcc, 8, v63
s_nop 1
v_cndmask_b32 v220, v62, 0, vcc
v_cmp_le_i32 vcc, 8, v60
s_nop 1
v_cndmask_b32 v217, v62, 0, vcc
v_add_u32 v63, 8, v60
v_cmp_gt_u32 vcc, 8, v63
s_nop 1
v_cndmask_b32 v221, v62, 0, vcc
v_cmp_le_i32 vcc, 7, v60
s_nop 1
v_cndmask_b32 v218, v62, 0, vcc
v_add_u32 v63, 9, v60
v_cmp_gt_u32 vcc, 8, v63
s_nop 1
v_cndmask_b32 v222, v62, 0, vcc
v_cmp_le_i32 vcc, 6, v60
s_nop 1
v_cndmask_b32 v219, v62, 0, vcc
v_add_u32 v63, 10, v60
v_cmp_gt_u32 vcc, 8, v63
s_nop 1
v_cndmask_b32 v223, v62, 0, vcc
v_add_u32 v252, 49152, v1
s_waitcnt lgkmcnt(0)
s_and_b32 s53, s53, 0xffff
v_bfrev_b32 v254, 1
v_writelane_b32 v254, s50, 0
s_mov_b64 exec, 0
s_cmp_eq_u32 s14, 0
s_cbranch_scc1 PG_A_0
s_cmp_eq_u32 s14, 1
s_cbranch_scc1 PG_A_1
s_cmp_eq_u32 s14, 2
s_cbranch_scc1 PG_A_2
s_cmp_eq_u32 s14, 3
s_cbranch_scc1 PG_A_3
PG_A_ret:
s_mov_b64 exec, -1
s_add_u32 m0, s22, 0
s_add_u32 s31, s24, 0
buffer_load_dwordx4 v212, s[8:11], s31 offen lds
s_add_u32 m0, s22, 4096
s_add_u32 s31, s25, 0
buffer_load_dwordx4 v212, s[8:11], s31 offen lds
s_add_u32 m0, s22, 8192
s_add_u32 s31, s25, 57344
buffer_load_dwordx4 v212, s[8:11], s31 offen lds
s_add_u32 m0, s22, 12288
s_add_u32 s31, s25, 114688
buffer_load_dwordx4 v212, s[8:11], s31 offen lds
s_add_u32 m0, s22, 16384
s_add_u32 s31, s23, 0
buffer_load_dwordx4 v212, s[8:11], s31 offen lds
s_add_u32 m0, s22, 20480
s_add_u32 s31, s24, 128
buffer_load_dwordx4 v212, s[8:11], s31 offen lds
s_add_u32 m0, s22, 24576
s_add_u32 s31, s25, 128
buffer_load_dwordx4 v212, s[8:11], s31 offen lds
s_add_u32 m0, s22, 28672
s_add_u32 s31, s25, 57472
buffer_load_dwordx4 v212, s[8:11], s31 offen lds
s_add_u32 m0, s22, 32768
s_add_u32 s31, s25, 114816
buffer_load_dwordx4 v212, s[8:11], s31 offen lds
s_add_u32 m0, s22, 36864
s_add_u32 s31, s23, 128
buffer_load_dwordx4 v212, s[8:11], s31 offen lds
s_add_u32 m0, s22, 40960
s_add_u32 s31, s24, 256
buffer_load_dwordx4 v212, s[8:11], s31 offen lds
s_add_u32 m0, s22, 45056
s_add_u32 s31, s25, 256
buffer_load_dwordx4 v212, s[8:11], s31 offen lds
s_add_u32 m0, s22, 49152
s_add_u32 s31, s25, 57600
buffer_load_dwordx4 v212, s[8:11], s31 offen lds
s_add_u32 m0, s22, 53248
s_add_u32 s31, s25, 114944
buffer_load_dwordx4 v212, s[8:11], s31 offen lds
s_add_u32 m0, s22, 57344
s_add_u32 s31, s23, 256
buffer_load_dwordx4 v212, s[8:11], s31 offen lds
s_waitcnt vmcnt(17)
ds_read_b64_tr_b16 v[172:173], v168 offset:0
ds_read_b64_tr_b16 v[174:175], v169 offset:0
ds_read_b64_tr_b16 v[176:177], v168 offset:32
ds_read_b64_tr_b16 v[178:179], v169 offset:32
s_waitcnt lgkmcnt(2)
buffer_store_dwordx4 v[172:175], v1, s[4:7], s66 offen sc1
s_mov_b32 vcc_lo, s68
s_mov_b32 vcc_hi, s68
s_waitcnt lgkmcnt(1)
v_cndmask_b32 v176, 0, v176, vcc
v_cndmask_b32 v177, 0, v177, vcc
s_waitcnt lgkmcnt(0)
v_cndmask_b32 v178, 0, v178, vcc
v_cndmask_b32 v179, 0, v179, vcc
buffer_store_dwordx4 v[176:179], v1, s[4:7], s67 offen sc1
s_waitcnt vmcnt(18)
v_readfirstlane_b32 s33, v193
s_nop 0
s_and_b32 s33, s33, 0xffffff00
s_add_u32 s33, s33, 256
s_add_u32 s32, s33, s44
v_mov_b32 v240, 0x3f803f80
v_mov_b32 v241, 0x3f803f80
v_mov_b32 v242, 0x3f803f80
v_mov_b32 v243, 0x3f803f80
s_waitcnt vmcnt(12)
s_waitcnt lgkmcnt(0)
s_barrier
ds_read_b64 v[128:129], v152 offset:0
ds_read_b64 v[130:131], v153 offset:0
ds_read_b64 v[132:133], v152 offset:2048
ds_read_b64 v[134:135], v153 offset:2048
ds_read_b64 v[136:137], v152 offset:4096
ds_read_b64 v[138:139], v153 offset:4096
ds_read_b64 v[140:141], v154 offset:0
ds_read_b64 v[142:143], v155 offset:0
ds_read_b64 v[144:145], v154 offset:2048
ds_read_b64 v[146:147], v155 offset:2048
ds_read_b64 v[148:149], v154 offset:4096
ds_read_b64 v[150:151], v155 offset:4096
s_waitcnt vmcnt(7)
s_waitcnt lgkmcnt(0)
s_barrier
v_mfma_f32_16x16x32_bf16 v[224:227], v[240:243], v[128:131], 0
ds_read_b64 a[112:113], v152 offset:20480
s_add_u32 m0, s22, 0
v_mfma_f32_16x16x32_bf16 v[236:239], v[128:131], v[128:131], 0
ds_read_b64 a[114:115], v153 offset:20480
s_add_u32 s31, s24, 384
v_mfma_f32_16x16x32_bf16 v[228:231], v[240:243], v[132:135], 0
ds_read_b64 a[116:117], v152 offset:22528
buffer_load_dwordx4 v212, s[8:11], s31 offen lds
v_mfma_f32_16x16x32_bf16 v[244:247], v[132:135], v[132:135], 0
ds_read_b64 a[118:119], v153 offset:22528
s_add_u32 m0, s22, 4096
s_add_u32 s31, s25, 384
v_mfma_f32_16x16x32_bf16 v[232:235], v[240:243], v[136:139], 0
ds_read_b64 a[120:121], v152 offset:24576
buffer_load_dwordx4 v212, s[8:11], s31 offen lds
v_mfma_f32_16x16x32_bf16 v[248:251], v[136:139], v[136:139], 0
ds_read_b64 a[122:123], v153 offset:24576
s_add_u32 m0, s22, 8192
v_mfma_f32_16x16x32_bf16 v[224:227], v[240:243], v[140:143], v[224:227]
ds_read_b64 a[124:125], v154 offset:20480
s_add_u32 s31, s25, 57728
v_mfma_f32_16x16x32_bf16 v[236:239], v[140:143], v[140:143], v[236:239]
ds_read_b64 a[126:127], v155 offset:20480
buffer_load_dwordx4 v212, s[8:11], s31 offen lds
s_add_u32 m0, s22, 12288
v_mfma_f32_16x16x32_bf16 v[228:231], v[240:243], v[144:147], v[228:231]
ds_read_b64 a[128:129], v154 offset:22528
s_add_u32 s31, s25, 115072
v_mfma_f32_16x16x32_bf16 v[244:247], v[144:147], v[144:147], v[244:247]
ds_read_b64 a[130:131], v155 offset:22528
buffer_load_dwordx4 v212, s[8:11], s31 offen lds
v_mfma_f32_16x16x32_bf16 v[232:235], v[240:243], v[148:151], v[232:235]
ds_read_b64 a[132:133], v154 offset:24576
s_add_u32 m0, s22, 16384
v_mfma_f32_16x16x32_bf16 v[248:251], v[148:151], v[148:151], v[248:251]
ds_read_b64 a[134:135], v155 offset:24576
s_add_u32 s31, s23, 384
buffer_load_dwordx4 v212, s[8:11], s31 offen lds
s_lshl_b32 s16, s26, 7
s_add_u32 s16, s16, 16912384
v_mov_b32 v6, s33
s_waitcnt vmcnt(5)
s_mov_b64 exec, 1
buffer_store_dword v6, off, s[4:7], s16 sc1
s_mov_b64 exec, -1
s_waitcnt lgkmcnt(0)
s_barrier
v_mfma_f32_16x16x32_bf16 v[224:227], v[240:243], a[112:115], v[224:227]
ds_read_b64 a[136:137], v152 offset:40960
s_add_u32 m0, s22, 20480
v_mfma_f32_16x16x32_bf16 v[236:239], a[112:115], a[112:115], v[236:239]
ds_read_b64 a[138:139], v153 offset:40960
s_add_u32 s31, s24, 512
v_mfma_f32_16x16x32_bf16 v[228:231], v[240:243], a[116:119], v[228:231]
ds_read_b64 a[140:141], v152 offset:43008
buffer_load_dwordx4 v212, s[8:11], s31 offen lds
v_mfma_f32_16x16x32_bf16 v[244:247], a[116:119], a[116:119], v[244:247]
ds_read_b64 a[142:143], v153 offset:43008
s_add_u32 m0, s22, 24576
s_add_u32 s31, s25, 512
v_mfma_f32_16x16x32_bf16 v[232:235], v[240:243], a[120:123], v[232:235]
ds_read_b64 a[144:145], v152 offset:45056
buffer_load_dwordx4 v212, s[8:11], s31 offen lds
v_mfma_f32_16x16x32_bf16 v[248:251], a[120:123], a[120:123], v[248:251]
ds_read_b64 a[146:147], v153 offset:45056
s_add_u32 m0, s22, 28672
v_mfma_f32_16x16x32_bf16 v[224:227], v[240:243], a[124:127], v[224:227]
ds_read_b64 a[148:149], v154 offset:40960
s_add_u32 s31, s25, 57856
v_mfma_f32_16x16x32_bf16 v[236:239], a[124:127], a[124:127], v[236:239]
ds_read_b64 a[150:151], v155 offset:40960
buffer_load_dwordx4 v212, s[8:11], s31 offen lds
s_add_u32 m0, s22, 32768
v_mfma_f32_16x16x32_bf16 v[228:231], v[240:243], a[128:131], v[228:231]
ds_read_b64 a[152:153], v154 offset:43008
s_add_u32 s31, s25, 115200
v_mfma_f32_16x16x32_bf16 v[244:247], a[128:131], a[128:131], v[244:247]
ds_read_b64 a[154:155], v155 offset:43008
buffer_load_dwordx4 v212, s[8:11], s31 offen lds
v_mfma_f32_16x16x32_bf16 v[232:235], v[240:243], a[132:135], v[232:235]
ds_read_b64 a[156:157], v154 offset:45056
s_add_u32 m0, s22, 36864
v_mfma_f32_16x16x32_bf16 v[248:251], a[132:135], a[132:135], v[248:251]
ds_read_b64 a[158:159], v155 offset:45056
s_add_u32 s31, s23, 512
buffer_load_dwordx4 v212, s[8:11], s31 offen lds
s_waitcnt vmcnt(6)
s_waitcnt lgkmcnt(0)
s_barrier
v_mfma_f32_16x16x32_bf16 v[224:227], v[240:243], a[136:139], v[224:227]
ds_read_b64 a[160:161], v152 offset:0
s_add_u32 m0, s22, 40960
v_mfma_f32_16x16x32_bf16 v[236:239], a[136:139], a[136:139], v[236:239]
ds_read_b64 a[162:163], v153 offset:0
s_add_u32 s31, s24, 640
v_mfma_f32_16x16x32_bf16 v[228:231], v[240:243], a[140:143], v[228:231]
ds_read_b64 a[164:165], v152 offset:2048
buffer_load_dwordx4 v212, s[8:11], s31 offen lds
v_mfma_f32_16x16x32_bf16 v[244:247], a[140:143], a[140:143], v[244:247]
ds_read_b64 a[166:167], v153 offset:2048
s_add_u32 m0, s22, 45056
s_add_u32 s31, s25, 640
v_mfma_f32_16x16x32_bf16 v[232:235], v[240:243], a[144:147], v[232:235]
ds_read_b64 a[168:169], v152 offset:4096
buffer_load_dwordx4 v212, s[8:11], s31 offen lds
v_mfma_f32_16x16x32_bf16 v[248:251], a[144:147], a[144:147], v[248:251]
ds_read_b64 a[170:171], v153 offset:4096
s_add_u32 m0, s22, 49152
v_mfma_f32_16x16x32_bf16 v[224:227], v[240:243], a[148:151], v[224:227]
ds_read_b64 a[172:173], v154 offset:0
s_add_u32 s31, s25, 57984
v_mfma_f32_16x16x32_bf16 v[236:239], a[148:151], a[148:151], v[236:239]
ds_read_b64 a[174:175], v155 offset:0
buffer_load_dwordx4 v212, s[8:11], s31 offen lds
s_add_u32 m0, s22, 53248
v_mfma_f32_16x16x32_bf16 v[228:231], v[240:243], a[152:155], v[228:231]
ds_read_b64 a[176:177], v154 offset:2048
s_add_u32 s31, s25, 115328
v_mfma_f32_16x16x32_bf16 v[244:247], a[152:155], a[152:155], v[244:247]
ds_read_b64 a[178:179], v155 offset:2048
buffer_load_dwordx4 v212, s[8:11], s31 offen lds
v_mfma_f32_16x16x32_bf16 v[232:235], v[240:243], a[156:159], v[232:235]
ds_read_b64 a[180:181], v154 offset:4096
s_add_u32 m0, s22, 57344
v_mfma_f32_16x16x32_bf16 v[248:251], a[156:159], a[156:159], v[248:251]
ds_read_b64 a[182:183], v155 offset:4096
s_add_u32 s31, s23, 640
buffer_load_dwordx4 v212, s[8:11], s31 offen lds
s_waitcnt vmcnt(5)
s_waitcnt lgkmcnt(0)
s_barrier
v_mfma_f32_16x16x32_bf16 v[224:227], v[240:243], a[160:163], v[224:227]
ds_read_b64 a[184:185], v152 offset:20480
s_add_u32 m0, s22, 0
v_mfma_f32_16x16x32_bf16 v[236:239], a[160:163], a[160:163], v[236:239]
ds_read_b64 a[186:187], v153 offset:20480
s_add_u32 s31, s24, 768
v_mfma_f32_16x16x32_bf16 v[228:231], v[240:243], a[164:167], v[228:231]
ds_read_b64 a[188:189], v152 offset:22528
buffer_load_dwordx4 v212, s[8:11], s31 offen lds
v_mfma_f32_16x16x32_bf16 v[244:247], a[164:167], a[164:167], v[244:247]
ds_read_b64 a[190:191], v153 offset:22528
s_add_u32 m0, s22, 4096
s_add_u32 s31, s25, 768
v_mfma_f32_16x16x32_bf16 v[232:235], v[240:243], a[168:171], v[232:235]
ds_read_b64 a[192:193], v152 offset:24576
buffer_load_dwordx4 v212, s[8:11], s31 offen lds
v_mfma_f32_16x16x32_bf16 v[248:251], a[168:171], a[168:171], v[248:251]
ds_read_b64 a[194:195], v153 offset:24576
s_add_u32 m0, s22, 8192
v_mfma_f32_16x16x32_bf16 v[224:227], v[240:243], a[172:175], v[224:227]
ds_read_b64 a[196:197], v154 offset:20480
s_add_u32 s31, s25, 58112
v_mfma_f32_16x16x32_bf16 v[236:239], a[172:175], a[172:175], v[236:239]
ds_read_b64 a[198:199], v155 offset:20480
buffer_load_dwordx4 v212, s[8:11], s31 offen lds
s_add_u32 m0, s22, 12288
v_mfma_f32_16x16x32_bf16 v[228:231], v[240:243], a[176:179], v[228:231]
ds_read_b64 a[200:201], v154 offset:22528
s_add_u32 s31, s25, 115456
v_mfma_f32_16x16x32_bf16 v[244:247], a[176:179], a[176:179], v[244:247]
ds_read_b64 a[202:203], v155 offset:22528
buffer_load_dwordx4 v212, s[8:11], s31 offen lds
v_mfma_f32_16x16x32_bf16 v[232:235], v[240:243], a[180:183], v[232:235]
ds_read_b64 a[204:205], v154 offset:24576
s_add_u32 m0, s22, 16384
v_mfma_f32_16x16x32_bf16 v[248:251], a[180:183], a[180:183], v[248:251]
ds_read_b64 a[206:207], v155 offset:24576
s_add_u32 s31, s23, 768
buffer_load_dwordx4 v212, s[8:11], s31 offen lds
s_and_b32 s15, s13, 15
s_mul_i32 s15, s15, 5376
s_add_u32 s15, s15, 16912384
v_min_u32 v180, 41, v0
v_lshlrev_b32 v180, 7, v180
buffer_load_dword v182, v180, s[4:7], s15 offen sc1
s_waitcnt vmcnt(6)
s_waitcnt lgkmcnt(0)
s_barrier
v_mfma_f32_16x16x32_bf16 v[224:227], v[240:243], a[184:187], v[224:227]
ds_read_b64 a[208:209], v152 offset:40960
v_mfma_f32_16x16x32_bf16 v[236:239], a[184:187], a[184:187], v[236:239]
ds_read_b64 a[210:211], v153 offset:40960
v_mfma_f32_16x16x32_bf16 v[228:231], v[240:243], a[188:191], v[228:231]
ds_read_b64 a[212:213], v152 offset:43008
v_mfma_f32_16x16x32_bf16 v[244:247], a[188:191], a[188:191], v[244:247]
ds_read_b64 a[214:215], v153 offset:43008
v_mfma_f32_16x16x32_bf16 v[232:235], v[240:243], a[192:195], v[232:235]
ds_read_b64 a[216:217], v152 offset:45056
v_mfma_f32_16x16x32_bf16 v[248:251], a[192:195], a[192:195], v[248:251]
ds_read_b64 a[218:219], v153 offset:45056
v_mfma_f32_16x16x32_bf16 v[224:227], v[240:243], a[196:199], v[224:227]
ds_read_b64 a[220:221], v154 offset:40960
v_mfma_f32_16x16x32_bf16 v[236:239], a[196:199], a[196:199], v[236:239]
ds_read_b64 a[222:223], v155 offset:40960
v_mfma_f32_16x16x32_bf16 v[228:231], v[240:243], a[200:203], v[228:231]
ds_read_b64 a[224:225], v154 offset:43008
v_mfma_f32_16x16x32_bf16 v[244:247], a[200:203], a[200:203], v[244:247]
ds_read_b64 a[226:227], v155 offset:43008
v_mfma_f32_16x16x32_bf16 v[232:235], v[240:243], a[204:207], v[232:235]
ds_read_b64 a[228:229], v154 offset:45056
v_mfma_f32_16x16x32_bf16 v[248:251], a[204:207], a[204:207], v[248:251]
ds_read_b64 a[230:231], v155 offset:45056
s_mov_b64 s[16:17], -1
s_add_u32 s3, s33, 0
s_waitcnt vmcnt(0)
v_subrev_u32 v182, s3, v182
v_cmp_le_u32 vcc, 16, v182
s_nop 0
s_and_b64 vcc, vcc, s[16:17]
s_cbranch_scc0 L_chk_1_ok
s_mov_b32 s31, 0
L_chk_1:
buffer_load_dword v182, v180, s[4:7], s15 offen sc1
s_waitcnt vmcnt(0)
s_add_u32 s3, s33, 0
v_subrev_u32 v182, s3, v182
v_cmp_le_u32 vcc, 16, v182
s_nop 0
s_and_b64 vcc, vcc, s[16:17]
s_cbranch_scc0 L_chk_1_ok
s_add_u32 s31, s31, 1
s_cmp_lt_u32 s31, 131072
PG_A_0:
s_cbranch_execz PG_A_4
s_cbranch_scc1 L_chk_1
L_chk_1_ok:
s_add_u32 m0, s19, 0
s_add_u32 s31, s18, 0
buffer_load_dwordx4 v1, s[4:7], s31 offen offset:0 sc1 lds
buffer_load_dwordx4 v1, s[4:7], s31 offen offset:1024 sc1 lds
buffer_load_dwordx4 v1, s[4:7], s31 offen offset:2048 sc1 lds
s_add_u32 m0, s19, 12288
s_add_u32 s31, s18, 12288
buffer_load_dwordx4 v1, s[4:7], s31 offen offset:0 sc1 lds
buffer_load_dwordx4 v1, s[4:7], s31 offen offset:1024 sc1 lds
buffer_load_dwordx4 v1, s[4:7], s31 offen offset:2048 sc1 lds
s_add_u32 m0, s19, 24576
s_add_u32 s31, s18, 24576
buffer_load_dwordx4 v1, s[4:7], s31 offen offset:0 sc1 lds
buffer_load_dwordx4 v1, s[4:7], s31 offen offset:1024 sc1 lds
buffer_load_dwordx4 v1, s[4:7], s31 offen offset:2048 sc1 lds
s_waitcnt lgkmcnt(0)
s_barrier
v_mfma_f32_16x16x32_bf16 v[224:227], v[240:243], a[208:211], v[224:227]
ds_read_b64 a[232:233], v152 offset:0
v_mfma_f32_16x16x32_bf16 v[236:239], a[208:211], a[208:211], v[236:239]
ds_read_b64 a[234:235], v153 offset:0
v_mfma_f32_16x16x32_bf16 v[228:231], v[240:243], a[212:215], v[228:231]
ds_read_b64 a[236:237], v152 offset:2048
v_mfma_f32_16x16x32_bf16 v[244:247], a[212:215], a[212:215], v[244:247]
ds_read_b64 a[238:239], v153 offset:2048
v_mfma_f32_16x16x32_bf16 v[232:235], v[240:243], a[216:219], v[232:235]
ds_read_b64 a[240:241], v152 offset:4096
v_mfma_f32_16x16x32_bf16 v[248:251], a[216:219], a[216:219], v[248:251]
ds_read_b64 a[242:243], v153 offset:4096
v_mfma_f32_16x16x32_bf16 v[224:227], v[240:243], a[220:223], v[224:227]
ds_read_b64 a[244:245], v154 offset:0
v_mfma_f32_16x16x32_bf16 v[236:239], a[220:223], a[220:223], v[236:239]
ds_read_b64 a[246:247], v155 offset:0
v_mfma_f32_16x16x32_bf16 v[228:231], v[240:243], a[224:227], v[228:231]
ds_read_b64 a[248:249], v154 offset:2048
v_mfma_f32_16x16x32_bf16 v[244:247], a[224:227], a[224:227], v[244:247]
ds_read_b64 a[250:251], v155 offset:2048
v_mfma_f32_16x16x32_bf16 v[232:235], v[240:243], a[228:231], v[232:235]
ds_read_b64 a[252:253], v154 offset:4096
v_mfma_f32_16x16x32_bf16 v[248:251], a[228:231], a[228:231], v[248:251]
ds_read_b64 a[254:255], v155 offset:4096
s_lshl_b32 s39, s40, 12
s_add_u32 s39, s39, 17012736
v_and_b32 v183, 31, v0
v_lshlrev_b32 v183, 7, v183
buffer_load_dword v185, v183, s[4:7], s39 offen sc1
s_mov_b32 m0, s34
s_nop 0
buffer_load_dwordx4 v209, s[56:59], s36 offen lds
s_add_u32 m0, s34, 1024
s_nop 0
buffer_load_dwordx4 v209, s[56:59], s37 offen lds
v_mov_b32 v7, s32
s_sub_u32 s16, s51, 65536
buffer_store_dword v7, v254, s[4:7], s46 offen
buffer_store_dword v7, v254, s[4:7], s16 offen sc1
s_waitcnt lgkmcnt(10)
v_mfma_f32_16x16x32_bf16 v[224:227], v[240:243], a[232:235], v[224:227]
v_mfma_f32_16x16x32_bf16 v[236:239], a[232:235], a[232:235], v[236:239]
s_waitcnt lgkmcnt(8)
v_mfma_f32_16x16x32_bf16 v[228:231], v[240:243], a[236:239], v[228:231]
v_mfma_f32_16x16x32_bf16 v[244:247], a[236:239], a[236:239], v[244:247]
s_waitcnt lgkmcnt(6)
v_mfma_f32_16x16x32_bf16 v[232:235], v[240:243], a[240:243], v[232:235]
v_mfma_f32_16x16x32_bf16 v[248:251], a[240:243], a[240:243], v[248:251]
s_waitcnt lgkmcnt(4)
v_mfma_f32_16x16x32_bf16 v[224:227], v[240:243], a[244:247], v[224:227]
v_mfma_f32_16x16x32_bf16 v[236:239], a[244:247], a[244:247], v[236:239]
s_waitcnt lgkmcnt(2)
v_mfma_f32_16x16x32_bf16 v[228:231], v[240:243], a[248:251], v[228:231]
v_mfma_f32_16x16x32_bf16 v[244:247], a[248:251], a[248:251], v[244:247]
s_waitcnt lgkmcnt(0)
v_mfma_f32_16x16x32_bf16 v[232:235], v[240:243], a[252:255], v[232:235]
v_mfma_f32_16x16x32_bf16 v[248:251], a[252:255], a[252:255], v[248:251]
s_lshl_b32 s16, s14, 9
s_add_u32 s16, s16, 160768
v_and_b32 v116, 15, v0
v_lshl_add_u32 v116, v116, 2, s16
s_mov_b32 vcc_lo, 0x100001
s_mov_b32 vcc_hi, 0x10000100
v_cndmask_b32 v112, 0, v236, vcc
v_cndmask_b32 v113, 0, v244, vcc
v_cndmask_b32 v114, 0, v248, vcc
s_mov_b32 vcc_lo, 0x200002
s_mov_b32 vcc_hi, 0x20000200
v_cndmask_b32 v112, v112, v237, vcc
v_cndmask_b32 v113, v113, v245, vcc
v_cndmask_b32 v114, v114, v249, vcc
s_mov_b32 vcc_lo, 0x400004
s_mov_b32 vcc_hi, 0x40000400
v_cndmask_b32 v112, v112, v238, vcc
v_cndmask_b32 v113, v113, v246, vcc
v_cndmask_b32 v114, v114, v250, vcc
s_mov_b32 vcc_lo, 0x800008
s_mov_b32 vcc_hi, 0x80000800
v_cndmask_b32 v112, v112, v239, vcc
v_cndmask_b32 v113, v113, v247, vcc
v_cndmask_b32 v114, v114, v251, vcc
v_mul_f32 v2, 0x3b124925, v224
v_mul_f32 v3, 0x3b124925, v228
v_mul_f32 v4, 0x3b124925, v232
v_mov_b32 v120, v112
v_mov_b32 v121, v113
v_mov_b32 v122, v114
v_permlane16_swap_b32 v112, v120
v_permlane16_swap_b32 v113, v121
v_permlane16_swap_b32 v114, v122
v_add_f32 v112, v112, v120
v_add_f32 v113, v113, v121
v_add_f32 v114, v114, v122
v_mov_b32 v120, v112
v_mov_b32 v121, v113
v_mov_b32 v122, v114
v_permlane32_swap_b32 v112, v120
v_permlane32_swap_b32 v113, v121
v_permlane32_swap_b32 v114, v122
v_add_f32 v112, v112, v120
v_add_f32 v113, v113, v121
v_add_f32 v114, v114, v122
v_mul_f32 v112, 0x3b124925, v112
v_mul_f32 v113, 0x3b124925, v113
v_mul_f32 v114, 0x3b124925, v114
v_fma_f32 v112, -v2, v2, v112
v_fma_f32 v113, -v3, v3, v113
v_fma_f32 v114, -v4, v4, v114
v_max_f32 v112, 0, v112
v_max_f32 v113, 0, v113
v_max_f32 v114, 0, v114
v_add_f32 v112, 0x3727c5ac, v112
v_add_f32 v113, 0x3727c5ac, v113
v_add_f32 v114, 0x3727c5ac, v114
v_rsq_f32 v112, v112
v_rsq_f32 v113, v113
v_rsq_f32 v114, v114
ds_write2_b32 v116, v2, v112 offset0:16 offset1:80
ds_write2_b32 v116, v3, v113 offset0:32 offset1:96
ds_write2_b32 v116, v4, v114 offset0:48 offset1:112
v_lshrrev_b32 v116, 4, v0
v_lshl_add_u32 v116, v116, 4, s16
s_waitcnt lgkmcnt(0)
v_mov_b32 v212, 0x3f803f80
v_mov_b32 v213, v212
v_mov_b32 v214, v212
v_mov_b32 v215, v212
ds_read_b128 v[240:243], v116 offset:64
ds_read_b128 v[244:247], v116 offset:128
ds_read_b128 v[248:251], v116 offset:192
s_waitcnt vmcnt(11)
s_barrier
ds_read_b128 v[88:91], v1 offset:2048
ds_read_b128 v[92:95], v1 offset:3072
ds_read_b128 v[80:83], v1 offset:0
ds_read_b128 v[84:87], v1 offset:1024
ds_read_b128 v[96:99], v1 offset:4096
ds_read_b128 v[100:103], v1 offset:5120
s_waitcnt lgkmcnt(0)
v_mfma_f32_16x16x32_bf16 v[48:51], v[88:91], v[136:139], 0
ds_read_b128 v[112:115], v1 offset:8192
v_mfma_f32_16x16x32_bf16 v[40:43], v[88:91], v[132:135], 0
ds_read_b128 v[116:119], v1 offset:9216
v_mfma_f32_16x16x32_bf16 v[32:35], v[88:91], v[128:131], 0
ds_read_b128 v[104:107], v1 offset:6144
v_mfma_f32_16x16x32_bf16 v[52:55], v[92:95], v[136:139], 0
ds_read_b128 v[108:111], v1 offset:7168
v_mfma_f32_16x16x32_bf16 v[44:47], v[92:95], v[132:135], 0
ds_read_b128 v[120:123], v1 offset:10240
v_mfma_f32_16x16x32_bf16 v[36:39], v[92:95], v[128:131], 0
ds_read_b128 v[124:127], v1 offset:11264
v_mfma_f32_16x16x32_bf16 v[16:19], v[80:83], v[132:135], 0
v_mfma_f32_16x16x32_bf16 v[24:27], v[80:83], v[136:139], 0
v_mfma_f32_16x16x32_bf16 v[20:23], v[84:87], v[132:135], 0
buffer_load_dwordx2 v[8:9], v165, s[8:11], s35 offen
v_mfma_f32_16x16x32_bf16 v[28:31], v[84:87], v[136:139], 0
v_mfma_f32_16x16x32_bf16 v[56:59], v[128:131], v[96:99], 0
v_mfma_f32_16x16x32_bf16 v[64:67], v[132:135], v[96:99], 0
v_mfma_f32_16x16x32_bf16 v[72:75], v[136:139], v[96:99], 0
s_add_u32 s35, s35, 28672
buffer_load_dwordx2 v[10:11], v165, s[8:11], s35 offen
v_mfma_f32_16x16x32_bf16 v[60:63], v[128:131], v[100:103], 0
v_mfma_f32_16x16x32_bf16 v[68:71], v[132:135], v[100:103], 0
v_mfma_f32_16x16x32_bf16 v[76:79], v[136:139], v[100:103], 0
v_mfma_f32_16x16x32_bf16 a[88:91], v[80:83], v[212:215], 0
s_add_u32 s35, s35, 200704
buffer_load_dwordx2 v[12:13], v165, s[8:11], s35 offen
v_mfma_f32_16x16x32_bf16 a[92:95], v[84:87], v[212:215], 0
v_mfma_f32_16x16x32_bf16 a[96:99], v[88:91], v[212:215], 0
v_mfma_f32_16x16x32_bf16 a[100:103], v[92:95], v[212:215], 0
v_mfma_f32_16x16x32_bf16 a[104:107], v[212:215], v[96:99], 0
s_add_u32 s35, s35, 28672
buffer_load_dwordx2 v[14:15], v165, s[8:11], s35 offen
v_mfma_f32_16x16x32_bf16 a[108:111], v[212:215], v[100:103], 0
s_waitcnt lgkmcnt(0)
v_mfma_f32_16x16x32_bf16 v[48:51], v[112:115], v[148:151], v[48:51]
s_waitcnt vmcnt(12)
s_barrier
v_mfma_f32_16x16x32_bf16 v[40:43], v[112:115], v[144:147], v[40:43]
ds_read_b128 v[88:91], v1 offset:14336
s_add_u32 m0, s19, 36864
v_mfma_f32_16x16x32_bf16 v[32:35], v[112:115], v[140:143], v[32:35]
ds_read_b128 v[92:95], v1 offset:15360
s_add_u32 s31, s18, 36864
v_mfma_f32_16x16x32_bf16 v[52:55], v[116:119], v[148:151], v[52:55]
ds_read_b128 v[80:83], v1 offset:12288
buffer_load_dwordx4 v1, s[4:7], s31 offen offset:0 sc1 lds
v_mfma_f32_16x16x32_bf16 v[44:47], v[116:119], v[144:147], v[44:47]
ds_read_b128 v[84:87], v1 offset:13312
v_mfma_f32_16x16x32_bf16 v[36:39], v[116:119], v[140:143], v[36:39]
ds_read_b128 v[96:99], v1 offset:16384
v_mfma_f32_16x16x32_bf16 v[16:19], v[104:107], v[144:147], v[16:19]
ds_read_b128 v[100:103], v1 offset:17408
v_mfma_f32_16x16x32_bf16 v[24:27], v[104:107], v[148:151], v[24:27]
buffer_load_dwordx4 v1, s[4:7], s31 offen offset:1024 sc1 lds
v_mfma_f32_16x16x32_bf16 v[20:23], v[108:111], v[144:147], v[20:23]
s_mov_b64 s[16:17], -1
s_add_u32 s3, s33, 0
s_waitcnt vmcnt(10)
v_subrev_u32 v185, s3, v185
v_cmp_le_u32 vcc, 16, v185
s_nop 0
s_and_b64 vcc, vcc, s[16:17]
s_cbranch_scc0 L_chk_2_ok
s_mov_b32 s15, 0
L_chk_2:
buffer_load_dword v185, v183, s[4:7], s39 offen sc1
s_waitcnt vmcnt(0)
s_add_u32 s3, s33, 0
v_subrev_u32 v185, s3, v185
v_cmp_le_u32 vcc, 16, v185
s_nop 0
s_and_b64 vcc, vcc, s[16:17]
s_cbranch_scc0 L_chk_2_ok
s_add_u32 s15, s15, 1
s_cmp_lt_u32 s15, 131072
s_cbranch_scc1 L_chk_2
L_chk_2_ok:
v_mfma_f32_16x16x32_bf16 v[28:31], v[108:111], v[148:151], v[28:31]
v_mfma_f32_16x16x32_bf16 v[56:59], v[140:143], v[120:123], v[56:59]
v_mfma_f32_16x16x32_bf16 v[64:67], v[144:147], v[120:123], v[64:67]
buffer_load_dwordx4 v1, s[4:7], s31 offen offset:2048 sc1 lds
v_mfma_f32_16x16x32_bf16 v[72:75], v[148:151], v[120:123], v[72:75]
v_mfma_f32_16x16x32_bf16 v[60:63], v[140:143], v[124:127], v[60:63]
v_mfma_f32_16x16x32_bf16 v[68:71], v[144:147], v[124:127], v[68:71]
v_mfma_f32_16x16x32_bf16 v[76:79], v[148:151], v[124:127], v[76:79]
v_mfma_f32_16x16x32_bf16 a[88:91], v[104:107], v[212:215], a[88:91]
v_mfma_f32_16x16x32_bf16 a[92:95], v[108:111], v[212:215], a[92:95]
v_mfma_f32_16x16x32_bf16 a[96:99], v[112:115], v[212:215], a[96:99]
v_mfma_f32_16x16x32_bf16 a[100:103], v[116:119], v[212:215], a[100:103]
v_mfma_f32_16x16x32_bf16 a[104:107], v[212:215], v[120:123], a[104:107]
v_mfma_f32_16x16x32_bf16 a[108:111], v[212:215], v[124:127], a[108:111]
s_waitcnt lgkmcnt(0)
v_mfma_f32_16x16x32_bf16 v[48:51], v[88:91], a[120:123], v[48:51]
ds_read_b128 v[112:115], v1 offset:20480
v_mfma_f32_16x16x32_bf16 v[40:43], v[88:91], a[116:119], v[40:43]
ds_read_b128 v[116:119], v1 offset:21504
s_add_u32 m0, s19, 49152
v_mfma_f32_16x16x32_bf16 v[32:35], v[88:91], a[112:115], v[32:35]
ds_read_b128 v[104:107], v1 offset:18432
s_add_u32 s31, s18, 49152
v_mfma_f32_16x16x32_bf16 v[52:55], v[92:95], a[120:123], v[52:55]
ds_read_b128 v[108:111], v1 offset:19456
buffer_load_dwordx4 v1, s[4:7], s31 offen offset:0 sc1 lds
v_mfma_f32_16x16x32_bf16 v[44:47], v[92:95], a[116:119], v[44:47]
ds_read_b128 v[120:123], v1 offset:22528
v_mfma_f32_16x16x32_bf16 v[36:39], v[92:95], a[112:115], v[36:39]
ds_read_b128 v[124:127], v1 offset:23552
v_mfma_f32_16x16x32_bf16 v[16:19], v[80:83], a[116:119], v[16:19]
v_mfma_f32_16x16x32_bf16 v[24:27], v[80:83], a[120:123], v[24:27]
buffer_load_dwordx4 v1, s[4:7], s31 offen offset:1024 sc1 lds
v_mfma_f32_16x16x32_bf16 v[20:23], v[84:87], a[116:119], v[20:23]
v_mfma_f32_16x16x32_bf16 v[28:31], v[84:87], a[120:123], v[28:31]
v_mfma_f32_16x16x32_bf16 v[56:59], a[112:115], v[96:99], v[56:59]
v_mfma_f32_16x16x32_bf16 v[64:67], a[116:119], v[96:99], v[64:67]
buffer_load_dwordx4 v1, s[4:7], s31 offen offset:2048 sc1 lds
v_mfma_f32_16x16x32_bf16 v[72:75], a[120:123], v[96:99], v[72:75]
v_mfma_f32_16x16x32_bf16 v[60:63], a[112:115], v[100:103], v[60:63]
v_mfma_f32_16x16x32_bf16 v[68:71], a[116:119], v[100:103], v[68:71]
v_mfma_f32_16x16x32_bf16 v[76:79], a[120:123], v[100:103], v[76:79]
v_mfma_f32_16x16x32_bf16 a[88:91], v[80:83], v[212:215], a[88:91]
v_mfma_f32_16x16x32_bf16 a[92:95], v[84:87], v[212:215], a[92:95]
v_mfma_f32_16x16x32_bf16 a[96:99], v[88:91], v[212:215], a[96:99]
v_mfma_f32_16x16x32_bf16 a[100:103], v[92:95], v[212:215], a[100:103]
v_mfma_f32_16x16x32_bf16 a[104:107], v[212:215], v[96:99], a[104:107]
v_mfma_f32_16x16x32_bf16 a[108:111], v[212:215], v[100:103], a[108:111]
s_waitcnt lgkmcnt(0)
v_mfma_f32_16x16x32_bf16 v[48:51], v[112:115], a[132:135], v[48:51]
s_barrier
v_mfma_f32_16x16x32_bf16 v[40:43], v[112:115], a[128:131], v[40:43]
ds_read_b128 v[88:91], v1 offset:26624
s_add_u32 m0, s19, 61440
v_mfma_f32_16x16x32_bf16 v[32:35], v[112:115], a[124:127], v[32:35]
ds_read_b128 v[92:95], v1 offset:27648
s_add_u32 s31, s18, 61440
v_mfma_f32_16x16x32_bf16 v[52:55], v[116:119], a[132:135], v[52:55]
ds_read_b128 v[80:83], v1 offset:24576
buffer_load_dwordx4 v1, s[4:7], s31 offen offset:0 sc1 lds
v_mfma_f32_16x16x32_bf16 v[44:47], v[116:119], a[128:131], v[44:47]
ds_read_b128 v[84:87], v1 offset:25600
v_mfma_f32_16x16x32_bf16 v[36:39], v[116:119], a[124:127], v[36:39]
ds_read_b128 v[96:99], v1 offset:28672
v_mfma_f32_16x16x32_bf16 v[16:19], v[104:107], a[128:131], v[16:19]
ds_read_b128 v[100:103], v1 offset:29696
v_mfma_f32_16x16x32_bf16 v[24:27], v[104:107], a[132:135], v[24:27]
buffer_load_dwordx4 v1, s[4:7], s31 offen offset:1024 sc1 lds
v_mfma_f32_16x16x32_bf16 v[20:23], v[108:111], a[128:131], v[20:23]
v_mfma_f32_16x16x32_bf16 v[28:31], v[108:111], a[132:135], v[28:31]
s_waitcnt vmcnt(14)
ds_read_b64_tr_b16 v[224:225], v211 offset:0
ds_read_b64_tr_b16 v[226:227], v211 offset:512
ds_read_b64_tr_b16 v[228:229], v211 offset:32
ds_read_b64_tr_b16 v[230:231], v211 offset:544
v_mfma_f32_16x16x32_bf16 v[56:59], a[124:127], v[120:123], v[56:59]
v_mfma_f32_16x16x32_bf16 v[64:67], a[128:131], v[120:123], v[64:67]
buffer_load_dwordx4 v1, s[4:7], s31 offen offset:2048 sc1 lds
v_mfma_f32_16x16x32_bf16 v[72:75], a[132:135], v[120:123], v[72:75]
v_mfma_f32_16x16x32_bf16 v[60:63], a[124:127], v[124:127], v[60:63]
v_mfma_f32_16x16x32_bf16 v[68:71], a[128:131], v[124:127], v[68:71]
s_waitcnt lgkmcnt(2)
buffer_store_dwordx4 v[224:227], v1, s[4:7], s27 offen sc1
s_waitcnt lgkmcnt(0)
buffer_store_dwordx4 v[228:231], v1, s[4:7], s27 offen offset:1024 sc1
v_mfma_f32_16x16x32_bf16 v[76:79], a[132:135], v[124:127], v[76:79]
v_mfma_f32_16x16x32_bf16 a[88:91], v[104:107], v[212:215], a[88:91]
v_mfma_f32_16x16x32_bf16 a[92:95], v[108:111], v[212:215], a[92:95]
v_mfma_f32_16x16x32_bf16 a[96:99], v[112:115], v[212:215], a[96:99]
v_mfma_f32_16x16x32_bf16 a[100:103], v[116:119], v[212:215], a[100:103]
v_mfma_f32_16x16x32_bf16 a[104:107], v[212:215], v[120:123], a[104:107]
v_mfma_f32_16x16x32_bf16 a[108:111], v[212:215], v[124:127], a[108:111]
s_waitcnt lgkmcnt(0)
v_mfma_f32_16x16x32_bf16 v[48:51], v[88:91], a[144:147], v[48:51]
ds_read_b128 v[112:115], v1 offset:32768
v_mfma_f32_16x16x32_bf16 v[40:43], v[88:91], a[140:143], v[40:43]
ds_read_b128 v[116:119], v1 offset:33792
s_add_u32 m0, s19, 73728
v_mfma_f32_16x16x32_bf16 v[32:35], v[88:91], a[136:139], v[32:35]
ds_read_b128 v[104:107], v1 offset:30720
s_add_u32 s31, s18, 73728
v_mfma_f32_16x16x32_bf16 v[52:55], v[92:95], a[144:147], v[52:55]
ds_read_b128 v[108:111], v1 offset:31744
buffer_load_dwordx4 v1, s[4:7], s31 offen offset:0 sc1 lds
v_mfma_f32_16x16x32_bf16 v[44:47], v[92:95], a[140:143], v[44:47]
ds_read_b128 v[120:123], v1 offset:34816
v_mfma_f32_16x16x32_bf16 v[36:39], v[92:95], a[136:139], v[36:39]
ds_read_b128 v[124:127], v1 offset:35840
v_mfma_f32_16x16x32_bf16 v[16:19], v[80:83], a[140:143], v[16:19]
v_mfma_f32_16x16x32_bf16 v[24:27], v[80:83], a[144:147], v[24:27]
buffer_load_dwordx4 v1, s[4:7], s31 offen offset:1024 sc1 lds
v_mfma_f32_16x16x32_bf16 v[20:23], v[84:87], a[140:143], v[20:23]
v_mfma_f32_16x16x32_bf16 v[28:31], v[84:87], a[144:147], v[28:31]
v_mfma_f32_16x16x32_bf16 v[56:59], a[136:139], v[96:99], v[56:59]
v_mfma_f32_16x16x32_bf16 v[64:67], a[140:143], v[96:99], v[64:67]
buffer_load_dwordx4 v1, s[4:7], s31 offen offset:2048 sc1 lds
v_mfma_f32_16x16x32_bf16 v[72:75], a[144:147], v[96:99], v[72:75]
v_lshlrev_b32 v208, 2, v0
buffer_load_dword v210, v208, s[4:7], s43 offen sc1
v_mfma_f32_16x16x32_bf16 v[60:63], a[136:139], v[100:103], v[60:63]
v_mfma_f32_16x16x32_bf16 v[68:71], a[140:143], v[100:103], v[68:71]
v_mfma_f32_16x16x32_bf16 v[76:79], a[144:147], v[100:103], v[76:79]
v_mfma_f32_16x16x32_bf16 a[88:91], v[80:83], v[212:215], a[88:91]
v_mfma_f32_16x16x32_bf16 a[92:95], v[84:87], v[212:215], a[92:95]
v_mfma_f32_16x16x32_bf16 a[96:99], v[88:91], v[212:215], a[96:99]
v_mfma_f32_16x16x32_bf16 a[100:103], v[92:95], v[212:215], a[100:103]
v_mfma_f32_16x16x32_bf16 a[104:107], v[212:215], v[96:99], a[104:107]
v_mfma_f32_16x16x32_bf16 a[108:111], v[212:215], v[100:103], a[108:111]
s_waitcnt lgkmcnt(0)
v_mfma_f32_16x16x32_bf16 v[48:51], v[112:115], a[156:159], v[48:51]
s_waitcnt vmcnt(12)
s_barrier
v_mfma_f32_16x16x32_bf16 v[40:43], v[112:115], a[152:155], v[40:43]
ds_read_b128 v[88:91], v1 offset:38912
v_mfma_f32_16x16x32_bf16 v[32:35], v[112:115], a[148:151], v[32:35]
ds_read_b128 v[92:95], v1 offset:39936
s_lshl_b32 s30, s40, 16
v_mfma_f32_16x16x32_bf16 v[52:55], v[116:119], a[156:159], v[52:55]
ds_read_b128 v[80:83], v1 offset:36864
s_lshl_b32 s29, s14, 14
v_mfma_f32_16x16x32_bf16 v[44:47], v[116:119], a[152:155], v[44:47]
ds_read_b128 v[84:87], v1 offset:37888
s_add_u32 s30, s30, s29
v_mfma_f32_16x16x32_bf16 v[36:39], v[116:119], a[148:151], v[36:39]
ds_read_b128 v[96:99], v1 offset:40960
s_add_u32 s30, s30, 1605632
v_mfma_f32_16x16x32_bf16 v[16:19], v[104:107], a[152:155], v[16:19]
ds_read_b128 v[100:103], v1 offset:41984
s_add_u32 s29, s30, 0
v_mfma_f32_16x16x32_bf16 v[24:27], v[104:107], a[156:159], v[24:27]
buffer_load_dwordx4 v[144:147], v1, s[4:7], s29 offen offset:0 sc1
v_mfma_f32_16x16x32_bf16 v[20:23], v[108:111], a[152:155], v[20:23]
v_mfma_f32_16x16x32_bf16 v[28:31], v[108:111], a[156:159], v[28:31]
buffer_load_dwordx4 v[148:151], v1, s[4:7], s29 offen offset:1024 sc1
v_mfma_f32_16x16x32_bf16 v[56:59], a[148:151], v[120:123], v[56:59]
v_mfma_f32_16x16x32_bf16 v[64:67], a[152:155], v[120:123], v[64:67]
buffer_load_dwordx4 v[152:155], v1, s[4:7], s29 offen offset:2048 sc1
v_mfma_f32_16x16x32_bf16 v[72:75], a[156:159], v[120:123], v[72:75]
v_mfma_f32_16x16x32_bf16 v[60:63], a[148:151], v[124:127], v[60:63]
buffer_load_dwordx4 v[156:159], v1, s[4:7], s29 offen offset:3072 sc1
v_mfma_f32_16x16x32_bf16 v[68:71], a[152:155], v[124:127], v[68:71]
v_mfma_f32_16x16x32_bf16 v[76:79], a[156:159], v[124:127], v[76:79]
s_add_u32 s29, s30, 4096
buffer_load_dwordx4 v[160:163], v1, s[4:7], s29 offen offset:0 sc1
v_mfma_f32_16x16x32_bf16 a[88:91], v[104:107], v[212:215], a[88:91]
v_mfma_f32_16x16x32_bf16 a[92:95], v[108:111], v[212:215], a[92:95]
buffer_load_dwordx4 v[164:167], v1, s[4:7], s29 offen offset:1024 sc1
v_mfma_f32_16x16x32_bf16 a[96:99], v[112:115], v[212:215], a[96:99]
v_mfma_f32_16x16x32_bf16 a[100:103], v[116:119], v[212:215], a[100:103]
v_mfma_f32_16x16x32_bf16 a[104:107], v[212:215], v[120:123], a[104:107]
v_mfma_f32_16x16x32_bf16 a[108:111], v[212:215], v[124:127], a[108:111]
s_waitcnt lgkmcnt(0)
v_mfma_f32_16x16x32_bf16 v[48:51], v[88:91], a[168:171], v[48:51]
ds_read_b128 v[112:115], v1 offset:45056
v_mfma_f32_16x16x32_bf16 v[40:43], v[88:91], a[164:167], v[40:43]
ds_read_b128 v[116:119], v1 offset:46080
v_mfma_f32_16x16x32_bf16 v[32:35], v[88:91], a[160:163], v[32:35]
ds_read_b128 v[104:107], v1 offset:43008
buffer_load_dwordx4 v[168:171], v1, s[4:7], s29 offen offset:2048 sc1
v_mfma_f32_16x16x32_bf16 v[52:55], v[92:95], a[168:171], v[52:55]
ds_read_b128 v[108:111], v1 offset:44032
v_mfma_f32_16x16x32_bf16 v[44:47], v[92:95], a[164:167], v[44:47]
ds_read_b128 v[120:123], v1 offset:47104
buffer_load_dwordx4 v[172:175], v1, s[4:7], s29 offen offset:3072 sc1
v_mfma_f32_16x16x32_bf16 v[36:39], v[92:95], a[160:163], v[36:39]
ds_read_b128 v[124:127], v1 offset:48128
v_mfma_f32_16x16x32_bf16 v[16:19], v[80:83], a[164:167], v[16:19]
s_add_u32 s29, s30, 8192
buffer_load_dwordx4 v[176:179], v1, s[4:7], s29 offen offset:0 sc1
v_mfma_f32_16x16x32_bf16 v[24:27], v[80:83], a[168:171], v[24:27]
v_mfma_f32_16x16x32_bf16 v[20:23], v[84:87], a[164:167], v[20:23]
buffer_load_dwordx4 v[180:183], v1, s[4:7], s29 offen offset:1024 sc1
v_mfma_f32_16x16x32_bf16 v[28:31], v[84:87], a[168:171], v[28:31]
v_mfma_f32_16x16x32_bf16 v[56:59], a[160:163], v[96:99], v[56:59]
buffer_load_dwordx4 v[184:187], v1, s[4:7], s29 offen offset:2048 sc1
v_mfma_f32_16x16x32_bf16 v[64:67], a[164:167], v[96:99], v[64:67]
v_mfma_f32_16x16x32_bf16 v[72:75], a[168:171], v[96:99], v[72:75]
buffer_load_dwordx4 v[188:191], v1, s[4:7], s29 offen offset:3072 sc1
v_mfma_f32_16x16x32_bf16 v[60:63], a[160:163], v[100:103], v[60:63]
v_mfma_f32_16x16x32_bf16 v[68:71], a[164:167], v[100:103], v[68:71]
v_mfma_f32_16x16x32_bf16 v[76:79], a[168:171], v[100:103], v[76:79]
v_mfma_f32_16x16x32_bf16 a[88:91], v[80:83], v[212:215], a[88:91]
v_mfma_f32_16x16x32_bf16 a[92:95], v[84:87], v[212:215], a[92:95]
v_mfma_f32_16x16x32_bf16 a[96:99], v[88:91], v[212:215], a[96:99]
v_mfma_f32_16x16x32_bf16 a[100:103], v[92:95], v[212:215], a[100:103]
v_mfma_f32_16x16x32_bf16 a[104:107], v[212:215], v[96:99], a[104:107]
v_mfma_f32_16x16x32_bf16 a[108:111], v[212:215], v[100:103], a[108:111]
s_waitcnt vmcnt(16)
s_waitcnt lgkmcnt(0)
v_mfma_f32_16x16x32_bf16 v[48:51], v[112:115], a[180:183], v[48:51]
s_barrier
v_mov_b32 v7, s33
s_lshl_b32 s16, s2, 7
s_add_u32 s16, s16, 16846848
buffer_store_dword v7, v254, s[4:7], s16 offen sc1
v_mfma_f32_16x16x32_bf16 v[40:43], v[112:115], a[176:179], v[40:43]
ds_read_b128 v[88:91], v252 offset:2048
v_mfma_f32_16x16x32_bf16 v[32:35], v[112:115], a[172:175], v[32:35]
ds_read_b128 v[92:95], v252 offset:3072
s_add_u32 s29, s30, 12288
v_mfma_f32_16x16x32_bf16 v[52:55], v[116:119], a[180:183], v[52:55]
ds_read_b128 v[80:83], v252 offset:0
buffer_load_dwordx4 v[192:195], v1, s[4:7], s29 offen offset:0 sc1
v_mfma_f32_16x16x32_bf16 v[44:47], v[116:119], a[176:179], v[44:47]
ds_read_b128 v[84:87], v252 offset:1024
v_mfma_f32_16x16x32_bf16 v[36:39], v[116:119], a[172:175], v[36:39]
ds_read_b128 v[96:99], v252 offset:4096
v_mfma_f32_16x16x32_bf16 v[16:19], v[104:107], a[176:179], v[16:19]
ds_read_b128 v[100:103], v252 offset:5120
buffer_load_dwordx4 v[196:199], v1, s[4:7], s29 offen offset:1024 sc1
v_mfma_f32_16x16x32_bf16 v[24:27], v[104:107], a[180:183], v[24:27]
v_mfma_f32_16x16x32_bf16 v[20:23], v[108:111], a[176:179], v[20:23]
v_mfma_f32_16x16x32_bf16 v[28:31], v[108:111], a[180:183], v[28:31]
buffer_load_dwordx4 v[200:203], v1, s[4:7], s29 offen offset:2048 sc1
v_mfma_f32_16x16x32_bf16 v[56:59], a[172:175], v[120:123], v[56:59]
v_mfma_f32_16x16x32_bf16 v[64:67], a[176:179], v[120:123], v[64:67]
v_mfma_f32_16x16x32_bf16 v[72:75], a[180:183], v[120:123], v[72:75]
buffer_load_dwordx4 v[204:207], v1, s[4:7], s29 offen offset:3072 sc1
v_mfma_f32_16x16x32_bf16 v[60:63], a[172:175], v[124:127], v[60:63]
v_mfma_f32_16x16x32_bf16 v[68:71], a[176:179], v[124:127], v[68:71]
v_mfma_f32_16x16x32_bf16 v[76:79], a[180:183], v[124:127], v[76:79]
v_mfma_f32_16x16x32_bf16 a[88:91], v[104:107], v[212:215], a[88:91]
v_mfma_f32_16x16x32_bf16 a[92:95], v[108:111], v[212:215], a[92:95]
v_mfma_f32_16x16x32_bf16 a[96:99], v[112:115], v[212:215], a[96:99]
v_mfma_f32_16x16x32_bf16 a[100:103], v[116:119], v[212:215], a[100:103]
v_mfma_f32_16x16x32_bf16 a[104:107], v[212:215], v[120:123], a[104:107]
v_mfma_f32_16x16x32_bf16 a[108:111], v[212:215], v[124:127], a[108:111]
s_waitcnt lgkmcnt(0)
v_mfma_f32_16x16x32_bf16 v[48:51], v[88:91], a[192:195], v[48:51]
ds_read_b128 v[112:115], v252 offset:8192
v_mfma_f32_16x16x32_bf16 v[40:43], v[88:91], a[188:191], v[40:43]
ds_read_b128 v[116:119], v252 offset:9216
v_mfma_f32_16x16x32_bf16 v[32:35], v[88:91], a[184:187], v[32:35]
ds_read_b128 v[104:107], v252 offset:6144
s_add_u32 m0, s22, 0x8000
v_mfma_f32_16x16x32_bf16 v[52:55], v[92:95], a[192:195], v[52:55]
ds_read_b128 v[108:111], v252 offset:7168
s_add_u32 s29, s47, 0
v_mfma_f32_16x16x32_bf16 v[44:47], v[92:95], a[188:191], v[44:47]
ds_read_b128 v[120:123], v252 offset:10240
buffer_load_dwordx4 v255, s[52:55], s29 offen lds
v_mfma_f32_16x16x32_bf16 v[36:39], v[92:95], a[184:187], v[36:39]
ds_read_b128 v[124:127], v252 offset:11264
v_mfma_f32_16x16x32_bf16 v[16:19], v[80:83], a[188:191], v[16:19]
v_mfma_f32_16x16x32_bf16 v[24:27], v[80:83], a[192:195], v[24:27]
v_mfma_f32_16x16x32_bf16 v[20:23], v[84:87], a[188:191], v[20:23]
v_mfma_f32_16x16x32_bf16 v[28:31], v[84:87], a[192:195], v[28:31]
s_add_u32 m0, s22, 0x9000
s_add_u32 s29, s47, 57344
v_mfma_f32_16x16x32_bf16 v[56:59], a[184:187], v[96:99], v[56:59]
buffer_load_dwordx4 v255, s[52:55], s29 offen lds
v_mfma_f32_16x16x32_bf16 v[64:67], a[188:191], v[96:99], v[64:67]
v_mfma_f32_16x16x32_bf16 v[72:75], a[192:195], v[96:99], v[72:75]
v_mfma_f32_16x16x32_bf16 v[60:63], a[184:187], v[100:103], v[60:63]
v_mfma_f32_16x16x32_bf16 v[68:71], a[188:191], v[100:103], v[68:71]
v_mfma_f32_16x16x32_bf16 v[76:79], a[192:195], v[100:103], v[76:79]
s_add_u32 m0, s22, 0xa000
s_add_u32 s29, s47, 114688
v_mfma_f32_16x16x32_bf16 a[88:91], v[80:83], v[212:215], a[88:91]
buffer_load_dwordx4 v255, s[52:55], s29 offen lds
v_mfma_f32_16x16x32_bf16 a[92:95], v[84:87], v[212:215], a[92:95]
v_mfma_f32_16x16x32_bf16 a[96:99], v[88:91], v[212:215], a[96:99]
v_mfma_f32_16x16x32_bf16 a[100:103], v[92:95], v[212:215], a[100:103]
v_mfma_f32_16x16x32_bf16 a[104:107], v[212:215], v[96:99], a[104:107]
v_mfma_f32_16x16x32_bf16 a[108:111], v[212:215], v[100:103], a[108:111]
s_waitcnt lgkmcnt(0)
v_mfma_f32_16x16x32_bf16 v[48:51], v[112:115], a[204:207], v[48:51]
s_barrier
v_mfma_f32_16x16x32_bf16 v[40:43], v[112:115], a[200:203], v[40:43]
ds_read_b128 v[88:91], v252 offset:14336
v_mfma_f32_16x16x32_bf16 v[32:35], v[112:115], a[196:199], v[32:35]
ds_read_b128 v[92:95], v252 offset:15360
s_add_u32 m0, s22, 0xb000
v_mfma_f32_16x16x32_bf16 v[52:55], v[116:119], a[204:207], v[52:55]
ds_read_b128 v[80:83], v252 offset:12288
s_add_u32 s29, s47, 172032
v_mfma_f32_16x16x32_bf16 v[44:47], v[116:119], a[200:203], v[44:47]
ds_read_b128 v[84:87], v252 offset:13312
buffer_load_dwordx4 v255, s[52:55], s29 offen lds
v_mfma_f32_16x16x32_bf16 v[36:39], v[116:119], a[196:199], v[36:39]
ds_read_b128 v[96:99], v252 offset:16384
v_mfma_f32_16x16x32_bf16 v[16:19], v[104:107], a[200:203], v[16:19]
ds_read_b128 v[100:103], v252 offset:17408
v_mfma_f32_16x16x32_bf16 v[24:27], v[104:107], a[204:207], v[24:27]
v_mfma_f32_16x16x32_bf16 v[20:23], v[108:111], a[200:203], v[20:23]
v_mfma_f32_16x16x32_bf16 v[28:31], v[108:111], a[204:207], v[28:31]
s_add_u32 m0, s22, 0xc000
s_add_u32 s29, s47, 229376
v_mfma_f32_16x16x32_bf16 v[56:59], a[196:199], v[120:123], v[56:59]
buffer_load_dwordx4 v255, s[52:55], s29 offen lds
v_mfma_f32_16x16x32_bf16 v[64:67], a[200:203], v[120:123], v[64:67]
v_mfma_f32_16x16x32_bf16 v[72:75], a[204:207], v[120:123], v[72:75]
v_mfma_f32_16x16x32_bf16 v[60:63], a[196:199], v[124:127], v[60:63]
v_mfma_f32_16x16x32_bf16 v[68:71], a[200:203], v[124:127], v[68:71]
v_mfma_f32_16x16x32_bf16 v[76:79], a[204:207], v[124:127], v[76:79]
s_add_u32 m0, s22, 0xd000
s_add_u32 s29, s47, 286720
v_mfma_f32_16x16x32_bf16 a[88:91], v[104:107], v[212:215], a[88:91]
buffer_load_dwordx4 v255, s[52:55], s29 offen lds
v_mfma_f32_16x16x32_bf16 a[92:95], v[108:111], v[212:215], a[92:95]
v_mfma_f32_16x16x32_bf16 a[96:99], v[112:115], v[212:215], a[96:99]
v_mfma_f32_16x16x32_bf16 a[100:103], v[116:119], v[212:215], a[100:103]
v_mfma_f32_16x16x32_bf16 a[104:107], v[212:215], v[120:123], a[104:107]
v_mfma_f32_16x16x32_bf16 a[108:111], v[212:215], v[124:127], a[108:111]
s_waitcnt lgkmcnt(0)
v_mfma_f32_16x16x32_bf16 v[48:51], v[88:91], a[216:219], v[48:51]
ds_read_b128 v[112:115], v252 offset:20480
v_mfma_f32_16x16x32_bf16 v[40:43], v[88:91], a[212:215], v[40:43]
ds_read_b128 v[116:119], v252 offset:21504
v_mfma_f32_16x16x32_bf16 v[32:35], v[88:91], a[208:211], v[32:35]
ds_read_b128 v[104:107], v252 offset:18432
s_add_u32 m0, s22, 0xe000
v_mfma_f32_16x16x32_bf16 v[52:55], v[92:95], a[216:219], v[52:55]
PG_A_1:
s_cbranch_execz PG_A_5
ds_read_b128 v[108:111], v252 offset:19456
s_add_u32 s29, s47, 344064
v_mfma_f32_16x16x32_bf16 v[44:47], v[92:95], a[212:215], v[44:47]
ds_read_b128 v[120:123], v252 offset:22528
buffer_load_dwordx4 v255, s[52:55], s29 offen lds
v_mfma_f32_16x16x32_bf16 v[36:39], v[92:95], a[208:211], v[36:39]
ds_read_b128 v[124:127], v252 offset:23552
v_mfma_f32_16x16x32_bf16 v[16:19], v[80:83], a[212:215], v[16:19]
v_mfma_f32_16x16x32_bf16 v[24:27], v[80:83], a[216:219], v[24:27]
v_mfma_f32_16x16x32_bf16 v[20:23], v[84:87], a[212:215], v[20:23]
v_mfma_f32_16x16x32_bf16 v[28:31], v[84:87], a[216:219], v[28:31]
s_add_u32 m0, s22, 0x0
s_add_u32 s29, s47, 401408
v_mfma_f32_16x16x32_bf16 v[56:59], a[208:211], v[96:99], v[56:59]
buffer_load_dwordx4 v255, s[52:55], s29 offen lds
v_mfma_f32_16x16x32_bf16 v[64:67], a[212:215], v[96:99], v[64:67]
v_mfma_f32_16x16x32_bf16 v[72:75], a[216:219], v[96:99], v[72:75]
v_mfma_f32_16x16x32_bf16 v[60:63], a[208:211], v[100:103], v[60:63]
v_mfma_f32_16x16x32_bf16 v[68:71], a[212:215], v[100:103], v[68:71]
v_mfma_f32_16x16x32_bf16 v[76:79], a[216:219], v[100:103], v[76:79]
s_add_u32 m0, s22, 0x1000
s_add_u32 s29, s47, 458752
v_mfma_f32_16x16x32_bf16 a[88:91], v[80:83], v[212:215], a[88:91]
buffer_load_dwordx4 v255, s[52:55], s29 offen lds
v_mfma_f32_16x16x32_bf16 a[92:95], v[84:87], v[212:215], a[92:95]
v_mfma_f32_16x16x32_bf16 a[96:99], v[88:91], v[212:215], a[96:99]
v_mfma_f32_16x16x32_bf16 a[100:103], v[92:95], v[212:215], a[100:103]
v_mfma_f32_16x16x32_bf16 a[104:107], v[212:215], v[96:99], a[104:107]
v_mfma_f32_16x16x32_bf16 a[108:111], v[212:215], v[100:103], a[108:111]
s_waitcnt lgkmcnt(0)
v_mfma_f32_16x16x32_bf16 v[48:51], v[112:115], a[228:231], v[48:51]
s_waitcnt vmcnt(27)
s_barrier
v_mfma_f32_16x16x32_bf16 v[40:43], v[112:115], a[224:227], v[40:43]
ds_read_b128 v[88:91], v252 offset:26624
v_mfma_f32_16x16x32_bf16 v[32:35], v[112:115], a[220:223], v[32:35]
ds_read_b128 v[92:95], v252 offset:27648
s_add_u32 m0, s22, 0x2000
v_mfma_f32_16x16x32_bf16 v[52:55], v[116:119], a[228:231], v[52:55]
ds_read_b128 v[80:83], v252 offset:24576
s_add_u32 s29, s47, 516096
v_mfma_f32_16x16x32_bf16 v[44:47], v[116:119], a[224:227], v[44:47]
ds_read_b128 v[84:87], v252 offset:25600
buffer_load_dwordx4 v255, s[52:55], s29 offen lds
v_mfma_f32_16x16x32_bf16 v[36:39], v[116:119], a[220:223], v[36:39]
ds_read_b128 v[96:99], v252 offset:28672
v_mfma_f32_16x16x32_bf16 v[16:19], v[104:107], a[224:227], v[16:19]
ds_read_b128 v[100:103], v252 offset:29696
v_mfma_f32_16x16x32_bf16 v[24:27], v[104:107], a[228:231], v[24:27]
v_mfma_f32_16x16x32_bf16 v[20:23], v[108:111], a[224:227], v[20:23]
v_mfma_f32_16x16x32_bf16 v[28:31], v[108:111], a[228:231], v[28:31]
s_add_u32 m0, s22, 0x3000
s_add_u32 s29, s47, 573440
v_mfma_f32_16x16x32_bf16 v[56:59], a[220:223], v[120:123], v[56:59]
buffer_load_dwordx4 v255, s[52:55], s29 offen lds
v_mfma_f32_16x16x32_bf16 v[64:67], a[224:227], v[120:123], v[64:67]
v_mfma_f32_16x16x32_bf16 v[72:75], a[228:231], v[120:123], v[72:75]
v_mfma_f32_16x16x32_bf16 v[60:63], a[220:223], v[124:127], v[60:63]
v_mfma_f32_16x16x32_bf16 v[68:71], a[224:227], v[124:127], v[68:71]
v_mfma_f32_16x16x32_bf16 v[76:79], a[228:231], v[124:127], v[76:79]
s_add_u32 m0, s22, 0x4000
s_add_u32 s29, s47, 630784
v_mfma_f32_16x16x32_bf16 a[88:91], v[104:107], v[212:215], a[88:91]
s_lshl_b32 s16, s13, 2
s_add_u32 s16, s16, s14
s_mul_i32 s16, s16, 2048
s_mul_i32 s17, s12, 262144
s_add_u32 s16, s16, s17
s_add_u32 s16, s16, 5275648
v_lshlrev_b32 v253, 7, v0
s_mov_b64 exec, 0xffff
buffer_load_dword v253, v253, s[4:7], s16 offen
s_mov_b64 exec, -1
v_mfma_f32_16x16x32_bf16 a[92:95], v[108:111], v[212:215], a[92:95]
buffer_load_dwordx4 v255, s[52:55], s29 offen lds
v_mfma_f32_16x16x32_bf16 a[96:99], v[112:115], v[212:215], a[96:99]
v_mfma_f32_16x16x32_bf16 a[100:103], v[116:119], v[212:215], a[100:103]
v_mfma_f32_16x16x32_bf16 a[104:107], v[212:215], v[120:123], a[104:107]
v_mfma_f32_16x16x32_bf16 a[108:111], v[212:215], v[124:127], a[108:111]
s_waitcnt lgkmcnt(0)
v_mfma_f32_16x16x32_bf16 v[48:51], v[88:91], a[240:243], v[48:51]
ds_read_b128 v[112:115], v252 offset:32768
v_mfma_f32_16x16x32_bf16 v[40:43], v[88:91], a[236:239], v[40:43]
ds_read_b128 v[116:119], v252 offset:33792
v_mfma_f32_16x16x32_bf16 v[32:35], v[88:91], a[232:235], v[32:35]
ds_read_b128 v[104:107], v252 offset:30720
s_add_u32 m0, s22, 0x5000
v_mfma_f32_16x16x32_bf16 v[52:55], v[92:95], a[240:243], v[52:55]
ds_read_b128 v[108:111], v252 offset:31744
s_add_u32 s29, s47, 688128
v_mfma_f32_16x16x32_bf16 v[44:47], v[92:95], a[236:239], v[44:47]
ds_read_b128 v[120:123], v252 offset:34816
buffer_load_dwordx4 v255, s[52:55], s29 offen lds
v_mfma_f32_16x16x32_bf16 v[36:39], v[92:95], a[232:235], v[36:39]
ds_read_b128 v[124:127], v252 offset:35840
v_mfma_f32_16x16x32_bf16 v[16:19], v[80:83], a[236:239], v[16:19]
v_mfma_f32_16x16x32_bf16 v[24:27], v[80:83], a[240:243], v[24:27]
v_mfma_f32_16x16x32_bf16 v[20:23], v[84:87], a[236:239], v[20:23]
v_mfma_f32_16x16x32_bf16 v[28:31], v[84:87], a[240:243], v[28:31]
s_add_u32 m0, s22, 0x6000
s_add_u32 s29, s47, 745472
v_mfma_f32_16x16x32_bf16 v[56:59], a[232:235], v[96:99], v[56:59]
s_mul_i32 s67, s40, 3584
s_add_u32 s67, s67, 16846848
v_min_u32 v252, 27, v0
v_lshlrev_b32 v252, 7, v252
buffer_load_dword v254, v252, s[4:7], s67 offen sc1
v_mfma_f32_16x16x32_bf16 v[64:67], a[236:239], v[96:99], v[64:67]
buffer_load_dwordx4 v255, s[52:55], s29 offen lds
v_mfma_f32_16x16x32_bf16 v[72:75], a[240:243], v[96:99], v[72:75]
v_mfma_f32_16x16x32_bf16 v[60:63], a[232:235], v[100:103], v[60:63]
v_mfma_f32_16x16x32_bf16 v[68:71], a[236:239], v[100:103], v[68:71]
v_mfma_f32_16x16x32_bf16 v[76:79], a[240:243], v[100:103], v[76:79]
v_mfma_f32_16x16x32_bf16 a[88:91], v[80:83], v[212:215], a[88:91]
s_add_u32 m0, s22, 0x7000
s_add_u32 s29, s47, 802816
v_mfma_f32_16x16x32_bf16 a[92:95], v[84:87], v[212:215], a[92:95]
buffer_load_dwordx4 v255, s[52:55], s29 offen lds
v_mfma_f32_16x16x32_bf16 a[96:99], v[88:91], v[212:215], a[96:99]
v_mfma_f32_16x16x32_bf16 a[100:103], v[92:95], v[212:215], a[100:103]
v_mfma_f32_16x16x32_bf16 a[104:107], v[212:215], v[96:99], a[104:107]
v_mfma_f32_16x16x32_bf16 a[108:111], v[212:215], v[100:103], a[108:111]
s_waitcnt lgkmcnt(0)
v_mfma_f32_16x16x32_bf16 v[48:51], v[112:115], a[252:255], v[48:51]
v_mfma_f32_16x16x32_bf16 v[40:43], v[112:115], a[248:251], v[40:43]
v_mfma_f32_16x16x32_bf16 v[32:35], v[112:115], a[244:247], v[32:35]
s_add_u32 m0, s22, 0x11000
s_add_u32 s29, s47, 860160
v_mfma_f32_16x16x32_bf16 v[52:55], v[116:119], a[252:255], v[52:55]
buffer_load_dwordx4 v255, s[52:55], s29 offen lds
v_mfma_f32_16x16x32_bf16 v[44:47], v[116:119], a[248:251], v[44:47]
v_mfma_f32_16x16x32_bf16 v[36:39], v[116:119], a[244:247], v[36:39]
v_mfma_f32_16x16x32_bf16 v[16:19], v[104:107], a[248:251], v[16:19]
v_mfma_f32_16x16x32_bf16 v[24:27], v[104:107], a[252:255], v[24:27]
v_mfma_f32_16x16x32_bf16 v[20:23], v[108:111], a[248:251], v[20:23]
s_add_u32 m0, s22, 0xf000
s_add_u32 s29, s47, 917504
v_mfma_f32_16x16x32_bf16 v[28:31], v[108:111], a[252:255], v[28:31]
buffer_load_dwordx4 v255, s[52:55], s29 offen lds
v_mfma_f32_16x16x32_bf16 v[56:59], a[244:247], v[120:123], v[56:59]
v_mfma_f32_16x16x32_bf16 v[64:67], a[248:251], v[120:123], v[64:67]
v_mfma_f32_16x16x32_bf16 v[72:75], a[252:255], v[120:123], v[72:75]
v_mfma_f32_16x16x32_bf16 v[60:63], a[244:247], v[124:127], v[60:63]
v_mfma_f32_16x16x32_bf16 v[68:71], a[248:251], v[124:127], v[68:71]
s_add_u32 m0, s22, 0x10000
s_add_u32 s29, s47, 974848
v_mfma_f32_16x16x32_bf16 v[76:79], a[252:255], v[124:127], v[76:79]
buffer_load_dwordx4 v255, s[52:55], s29 offen lds
v_mfma_f32_16x16x32_bf16 a[88:91], v[104:107], v[212:215], a[88:91]
v_mfma_f32_16x16x32_bf16 a[92:95], v[108:111], v[212:215], a[92:95]
v_mfma_f32_16x16x32_bf16 a[96:99], v[112:115], v[212:215], a[96:99]
v_mfma_f32_16x16x32_bf16 a[100:103], v[116:119], v[212:215], a[100:103]
v_mfma_f32_16x16x32_bf16 a[104:107], v[212:215], v[120:123], a[104:107]
v_mfma_f32_16x16x32_bf16 a[108:111], v[212:215], v[124:127], a[108:111]
s_mov_b32 s38, -1
s_mov_b32 s39, 0
s_add_u32 s3, s32, 0
s_waitcnt vmcnt(37)
v_subrev_u32 v210, s3, v210
v_cmp_le_u32 vcc, 16, v210
s_nop 0
s_and_b64 vcc, vcc, s[38:39]
s_cbranch_scc0 L_md_ok
s_mov_b32 s15, 0
s_lshl_b32 s17, s12, 12
s_add_u32 s17, s17, 16814080
v_lshlrev_b32 v209, 7, v0
L_md:
buffer_load_dword v210, v208, s[4:7], s43 offen sc1
buffer_load_dword v211, v209, s[4:7], s17 offen sc1
s_waitcnt vmcnt(0)
s_add_u32 s3, s32, 0
v_subrev_u32 v210, s3, v210
v_cmp_le_u32 vcc, 16, v210
s_nop 0
s_and_b64 vcc, vcc, s[38:39]
s_cbranch_scc0 L_md_ok
v_subrev_u32 v210, s33, v211
v_cmp_lt_u32 vcc, 255, v210
s_nop 0
s_and_b32 s16, vcc_lo, -1
s_cbranch_scc1 L_md_nx
v_cmp_ne_u32 vcc, s32, v211
s_nop 0
s_and_b32 s16, vcc_lo, -1
s_cbranch_scc1 interleave_layers__sliding_local_dilated__glu_gated_swiglu__prompt_kernel_gl
L_md_nx:
s_add_u32 s15, s15, 1
s_cmp_lt_u32 s15, 131072
s_cbranch_scc1 L_md
s_branch interleave_layers__sliding_local_dilated__glu_gated_swiglu__prompt_kernel_gl
L_md_ok:
s_lshl_b32 s16, s14, 9
s_add_u32 s16, s16, 160768
v_and_b32 v130, 15, v0
v_lshrrev_b32 v131, 4, v0
v_lshl_add_u32 v132, v130, 2, s16
v_lshl_add_u32 v133, v131, 4, s16
ds_read_b32 v112, v132 offset:320
ds_read_b32 v113, v132 offset:384
ds_read_b32 v114, v132 offset:448
ds_read_b128 v[116:119], v133 offset:320
ds_read_b128 v[120:123], v133 offset:384
ds_read_b128 v[124:127], v133 offset:448
v_lshlrev_b32 v134, 4, v131
v_lshlrev_b32 v135, 2, v130
v_add_u32 v134, 159744, v134
v_add_u32 v135, 159744, v135
v_accvgpr_read_b32 v224, a88
v_accvgpr_read_b32 v225, a89
v_accvgpr_read_b32 v226, a90
v_accvgpr_read_b32 v227, a91
v_accvgpr_read_b32 v228, a92
v_accvgpr_read_b32 v229, a93
v_accvgpr_read_b32 v230, a94
v_accvgpr_read_b32 v231, a95
v_accvgpr_read_b32 v232, a96
v_accvgpr_read_b32 v233, a97
v_accvgpr_read_b32 v234, a98
v_accvgpr_read_b32 v235, a99
v_accvgpr_read_b32 v236, a100
v_accvgpr_read_b32 v237, a101
v_accvgpr_read_b32 v238, a102
v_accvgpr_read_b32 v239, a103
v_accvgpr_read_b32 v5, a104
v_accvgpr_read_b32 v6, a108
v_fma_f32 v16, -v3, v224, v16
v_fma_f32 v17, -v3, v225, v17
v_fma_f32 v18, -v3, v226, v18
v_fma_f32 v19, -v3, v227, v19
v_fma_f32 v20, -v3, v228, v20
v_fma_f32 v21, -v3, v229, v21
v_fma_f32 v22, -v3, v230, v22
v_fma_f32 v23, -v3, v231, v23
v_fma_f32 v24, -v4, v224, v24
v_fma_f32 v25, -v4, v225, v25
v_fma_f32 v26, -v4, v226, v26
v_fma_f32 v27, -v4, v227, v27
v_fma_f32 v28, -v4, v228, v28
v_fma_f32 v29, -v4, v229, v29
v_fma_f32 v30, -v4, v230, v30
v_fma_f32 v31, -v4, v231, v31
v_fma_f32 v32, -v2, v232, v32
v_fma_f32 v33, -v2, v233, v33
v_fma_f32 v34, -v2, v234, v34
v_fma_f32 v35, -v2, v235, v35
v_fma_f32 v36, -v2, v236, v36
v_fma_f32 v37, -v2, v237, v37
v_fma_f32 v38, -v2, v238, v38
v_fma_f32 v39, -v2, v239, v39
v_fma_f32 v40, -v3, v232, v40
v_fma_f32 v41, -v3, v233, v41
v_fma_f32 v42, -v3, v234, v42
v_fma_f32 v43, -v3, v235, v43
v_fma_f32 v44, -v3, v236, v44
v_fma_f32 v45, -v3, v237, v45
v_fma_f32 v46, -v3, v238, v46
v_fma_f32 v47, -v3, v239, v47
v_fma_f32 v48, -v4, v232, v48
v_fma_f32 v49, -v4, v233, v49
v_fma_f32 v50, -v4, v234, v50
v_fma_f32 v51, -v4, v235, v51
v_fma_f32 v52, -v4, v236, v52
v_fma_f32 v53, -v4, v237, v53
v_fma_f32 v54, -v4, v238, v54
v_fma_f32 v55, -v4, v239, v55
ds_write_b128 v134, v[224:227] offset:0
ds_write_b128 v134, v[228:231] offset:64
ds_write_b128 v134, v[232:235] offset:128
ds_write_b128 v134, v[236:239] offset:192
ds_write_b32 v135, v5 offset:256
ds_write_b32 v135, v6 offset:320
v_fma_f32 v56, -v240, v5, v56
v_fma_f32 v57, -v241, v5, v57
v_fma_f32 v58, -v242, v5, v58
v_fma_f32 v59, -v243, v5, v59
v_fma_f32 v60, -v240, v6, v60
v_fma_f32 v61, -v241, v6, v61
v_fma_f32 v62, -v242, v6, v62
v_fma_f32 v63, -v243, v6, v63
v_fma_f32 v64, -v244, v5, v64
v_fma_f32 v65, -v245, v5, v65
v_fma_f32 v66, -v246, v5, v66
v_fma_f32 v67, -v247, v5, v67
v_fma_f32 v68, -v244, v6, v68
v_fma_f32 v69, -v245, v6, v69
v_fma_f32 v70, -v246, v6, v70
v_fma_f32 v71, -v247, v6, v71
v_fma_f32 v72, -v248, v5, v72
v_fma_f32 v73, -v249, v5, v73
v_fma_f32 v74, -v250, v5, v74
v_fma_f32 v75, -v251, v5, v75
v_fma_f32 v76, -v248, v6, v76
v_fma_f32 v77, -v249, v6, v77
v_fma_f32 v78, -v250, v6, v78
v_fma_f32 v79, -v251, v6, v79
v_cvt_pk_bf16_f32 v92, v16, v17
v_cvt_pk_bf16_f32 v93, v18, v19
v_cvt_pk_bf16_f32 v94, v20, v21
v_cvt_pk_bf16_f32 v95, v22, v23
v_cvt_pk_bf16_f32 v96, v24, v25
v_cvt_pk_bf16_f32 v97, v26, v27
v_cvt_pk_bf16_f32 v98, v28, v29
v_cvt_pk_bf16_f32 v99, v30, v31
s_cmp_eq_u32 s21, 1
s_cselect_b64 vcc, -1, 0
v_mov_b32 v140, 0xf149f2ca
s_waitcnt lgkmcnt(11)
v_mul_f32 v32, v32, v112
v_mul_f32 v33, v33, v112
v_mul_f32 v34, v34, v112
v_mul_f32 v35, v35, v112
v_cvt_pk_bf16_f32 v80, v32, v33
v_cvt_pk_bf16_f32 v81, v34, v35
v_mul_f32 v36, v36, v112
v_mul_f32 v37, v37, v112
v_mul_f32 v38, v38, v112
v_mul_f32 v39, v39, v112
v_cvt_pk_bf16_f32 v82, v36, v37
v_cvt_pk_bf16_f32 v83, v38, v39
s_waitcnt lgkmcnt(10)
v_mul_f32 v40, v40, v113
v_mul_f32 v41, v41, v113
v_mul_f32 v42, v42, v113
v_mul_f32 v43, v43, v113
v_cvt_pk_bf16_f32 v84, v40, v41
v_cvt_pk_bf16_f32 v85, v42, v43
v_mul_f32 v44, v44, v113
v_mul_f32 v45, v45, v113
v_mul_f32 v46, v46, v113
v_mul_f32 v47, v47, v113
v_cvt_pk_bf16_f32 v86, v44, v45
v_cvt_pk_bf16_f32 v87, v46, v47
s_waitcnt lgkmcnt(9)
v_mul_f32 v48, v48, v114
v_mul_f32 v49, v49, v114
v_mul_f32 v50, v50, v114
v_mul_f32 v51, v51, v114
v_cvt_pk_bf16_f32 v88, v48, v49
v_cvt_pk_bf16_f32 v89, v50, v51
v_mul_f32 v52, v52, v114
v_mul_f32 v53, v53, v114
v_mul_f32 v54, v54, v114
v_mul_f32 v55, v55, v114
v_cvt_pk_bf16_f32 v90, v52, v53
v_cvt_pk_bf16_f32 v91, v54, v55
v_cndmask_b32 v136, v140, v216, vcc
v_cndmask_b32 v137, v140, v217, vcc
v_cndmask_b32 v138, v140, v218, vcc
v_cndmask_b32 v139, v140, v219, vcc
v_mul_f32 v141, 0x3e8b97f6, v113
v_mul_f32 v142, 0x3e8b97f6, v114
v_mfma_f32_16x16x32_bf16 v[16:19], v[80:83], v[92:95], v[136:139]
v_mfma_f32_16x16x32_bf16 v[20:23], v[84:87], v[92:95], v[220:223]
v_mfma_f32_16x16x32_bf16 v[24:27], v[84:87], v[96:99], v[216:219]
v_mfma_f32_16x16x32_bf16 v[28:31], v[88:91], v[96:99], v[220:223]
s_waitcnt lgkmcnt(8)
v_mul_f32 v56, v56, v116
v_mul_f32 v57, v57, v117
v_mul_f32 v58, v58, v118
v_mul_f32 v59, v59, v119
v_cvt_pk_bf16_f32 v100, v56, v57
v_cvt_pk_bf16_f32 v101, v58, v59
v_mul_f32 v60, v60, v116
v_mul_f32 v61, v61, v117
v_max3_f32 v40, v16, v17, v18
v_max3_f32 v41, v19, v20, v21
v_max3_f32 v40, v40, v22, v23
v_max_f32 v40, v40, v41
v_max3_f32 v44, v24, v25, v26
v_max3_f32 v45, v27, v28, v29
v_max3_f32 v44, v44, v30, v31
v_max_f32 v44, v44, v45
v_mov_b32 v41, v40
v_mov_b32 v45, v44
v_mul_f32 v62, v62, v118
v_mul_f32 v63, v63, v119
v_permlane16_swap_b32 v40, v41
v_permlane16_swap_b32 v44, v45
v_max_f32 v40, v40, v41
v_max_f32 v44, v44, v45
v_mov_b32 v41, v40
v_mov_b32 v45, v44
v_cvt_pk_bf16_f32 v106, v60, v61
v_cvt_pk_bf16_f32 v107, v62, v63
v_permlane32_swap_b32 v40, v41
v_permlane32_swap_b32 v44, v45
v_max_f32 v40, v40, v41
v_max_f32 v44, v44, v45
v_mul_f32 v40, v40, v141
v_mul_f32 v44, v44, v142
v_fma_f32 v16, v16, v141, -v40
v_fma_f32 v17, v17, v141, -v40
v_fma_f32 v18, v18, v141, -v40
v_fma_f32 v19, v19, v141, -v40
v_fma_f32 v20, v20, v141, -v40
v_fma_f32 v21, v21, v141, -v40
v_fma_f32 v22, v22, v141, -v40
v_fma_f32 v23, v23, v141, -v40
v_fma_f32 v24, v24, v142, -v44
v_fma_f32 v25, v25, v142, -v44
v_fma_f32 v26, v26, v142, -v44
v_fma_f32 v27, v27, v142, -v44
v_fma_f32 v28, v28, v142, -v44
v_fma_f32 v29, v29, v142, -v44
v_fma_f32 v30, v30, v142, -v44
v_fma_f32 v31, v31, v142, -v44
v_exp_f32 v16, v16
v_exp_f32 v17, v17
v_exp_f32 v18, v18
v_exp_f32 v19, v19
v_exp_f32 v20, v20
v_exp_f32 v21, v21
v_exp_f32 v22, v22
v_exp_f32 v23, v23
v_exp_f32 v24, v24
v_exp_f32 v25, v25
v_exp_f32 v26, v26
v_exp_f32 v27, v27
v_exp_f32 v28, v28
v_exp_f32 v29, v29
v_exp_f32 v30, v30
v_exp_f32 v31, v31
s_waitcnt lgkmcnt(7)
v_mul_f32 v64, v64, v120
v_add_f32 v40, v16, v17
v_add_f32 v41, v18, v19
v_add_f32 v42, v20, v21
v_add_f32 v43, v22, v23
v_add_f32 v40, v40, v41
v_add_f32 v42, v42, v43
v_add_f32 v40, v40, v42
v_add_f32 v44, v24, v25
v_add_f32 v45, v26, v27
v_add_f32 v46, v28, v29
v_add_f32 v47, v30, v31
v_add_f32 v44, v44, v45
v_add_f32 v46, v46, v47
v_add_f32 v44, v44, v46
v_mov_b32 v41, v40
v_mov_b32 v45, v44
v_mul_f32 v65, v65, v121
v_mul_f32 v66, v66, v122
v_permlane16_swap_b32 v40, v41
v_permlane16_swap_b32 v44, v45
v_add_f32 v40, v40, v41
v_add_f32 v44, v44, v45
v_mov_b32 v41, v40
v_mov_b32 v45, v44
v_mul_f32 v67, v67, v123
v_cvt_pk_bf16_f32 v102, v64, v65
v_permlane32_swap_b32 v40, v41
v_permlane32_swap_b32 v44, v45
v_add_f32 v40, v40, v41
v_add_f32 v44, v44, v45
v_rcp_f32 v40, v40
v_rcp_f32 v44, v44
v_cvt_pk_bf16_f32 v103, v66, v67
v_mul_f32 v68, v68, v120
v_mul_f32 v69, v69, v121
v_mul_f32 v70, v70, v122
v_mul_f32 v71, v71, v123
v_cvt_pk_bf16_f32 v108, v68, v69
v_cvt_pk_bf16_f32 v109, v70, v71
s_waitcnt lgkmcnt(6)
v_mul_f32 v72, v72, v124
v_mul_f32 v73, v73, v125
v_mul_f32 v74, v74, v126
v_mul_f32 v75, v75, v127
v_cvt_pk_bf16_f32 v104, v72, v73
v_cvt_pk_bf16_f32 v105, v74, v75
v_mul_f32 v76, v76, v124
v_mul_f32 v77, v77, v125
v_mul_f32 v78, v78, v126
v_mul_f32 v79, v79, v127
v_cvt_pk_bf16_f32 v110, v76, v77
v_cvt_pk_bf16_f32 v111, v78, v79
v_mul_f32 v16, v16, v40
v_mul_f32 v17, v17, v40
v_mul_f32 v18, v18, v40
v_mul_f32 v19, v19, v40
v_mul_f32 v20, v20, v40
v_mul_f32 v21, v21, v40
v_mul_f32 v22, v22, v40
v_mul_f32 v23, v23, v40
v_cvt_pk_bf16_f32 v32, v16, v17
v_cvt_pk_bf16_f32 v33, v18, v19
v_cvt_pk_bf16_f32 v34, v20, v21
v_cvt_pk_bf16_f32 v35, v22, v23
s_nop 1
v_mfma_f32_16x16x32_bf16 v[48:51], v[100:103], v[32:35], 0
v_mfma_f32_16x16x32_bf16 v[52:55], v[106:109], v[32:35], 0
v_mul_f32 v24, v24, v44
v_mul_f32 v25, v25, v44
v_mul_f32 v26, v26, v44
v_mul_f32 v27, v27, v44
v_mul_f32 v28, v28, v44
v_mul_f32 v29, v29, v44
v_mul_f32 v30, v30, v44
v_mul_f32 v31, v31, v44
v_cvt_pk_bf16_f32 v36, v24, v25
v_cvt_pk_bf16_f32 v37, v26, v27
v_cvt_pk_bf16_f32 v38, v28, v29
v_cvt_pk_bf16_f32 v39, v30, v31
s_nop 1
v_mfma_f32_16x16x32_bf16 v[56:59], v[102:105], v[36:39], 0
v_mfma_f32_16x16x32_bf16 v[60:63], v[108:111], v[36:39], 0
v_cvt_pk_bf16_f32 v64, v48, v49
v_cvt_pk_bf16_f32 v65, v50, v51
v_cvt_pk_bf16_f32 v66, v52, v53
v_cvt_pk_bf16_f32 v67, v54, v55
buffer_store_dwordx4 v[64:67], v1, s[4:7], s28 offen
s_nop 1
v_cvt_pk_bf16_f32 v68, v56, v57
v_cvt_pk_bf16_f32 v69, v58, v59
v_cvt_pk_bf16_f32 v70, v60, v61
v_cvt_pk_bf16_f32 v71, v62, v63
s_add_u32 s28, s28, 16384
buffer_store_dwordx4 v[68:71], v1, s[4:7], s28 offen
s_add_u32 s16, s42, 4
s_lshl_b32 s19, s16, 11
s_mul_i32 s18, s16, 28
s_lshl_b32 s16, s16, 1
s_lshr_b32 s17, s14, 1
s_add_u32 s16, s16, s17
s_lshl_b32 s20, s16, 14
s_and_b32 s17, s14, 1
s_lshl_b32 s17, s17, 12
s_add_u32 s20, s20, s17
s_add_u32 s20, s20, 5275648
s_lshl_b32 s17, s40, 8
s_add_u32 s19, s19, s17
s_add_u32 s19, s19, 16547840
s_lshr_b32 s17, s50, 1
s_add_u32 s19, s19, s17
s_lshl_b32 s21, s14, 12
s_add_u32 s21, s21, 86016
s_lshl_b32 s16, s40, 2
s_add_u32 s18, s18, s16
s_add_u32 s18, s18, s14
s_lshl_b32 s18, s18, 10
s_add_u32 s18, s18, 7372800
v_add_u32 v2, 86016, v1
v_and_b32 v3, 15, v0
v_lshrrev_b32 v4, 5, v0
v_lshl_add_u32 v3, v4, 4, v3
v_lshlrev_b32 v3, 4, v3
v_bfe_u32 v4, v0, 4, 1
v_lshl_add_u32 v3, v4, 9, v3
v_lshlrev_b32 v6, 2, v0
v_add_u32 v5, 160768, v6
s_lshl_b32 s16, s14, 8
v_add_u32 v4, s16, v5
s_waitcnt vmcnt(0)
s_barrier
s_add_u32 s3, s32, 1
v_bfrev_b32 v76, 1
v_mov_b32 v77, s3
v_writelane_b32 v76, s50, 0
buffer_store_dword v77, v76, s[4:7], s46 offen
s_cmp_lt_u32 s13, 28
s_cbranch_scc1 L_hx_3
s_lshr_b32 s16, s45, 2
s_lshl_b32 s16, s16, 1
s_and_b32 s17, s45, 1
s_add_u32 s16, s16, s17
s_mul_i32 s16, s16, 140
s_mov_b32 s17, 1032576
v_add_u32 v16, s16, v0
v_mul_u32_u24 v17, 9363, v16
v_lshrrev_b32 v17, 16, v17
v_mul_u32_u24 v18, 7, v17
v_sub_u32 v18, v16, v18
v_mul_u32_u24 v17, 3584, v17
v_lshl_add_u32 v17, v18, 9, v17
buffer_load_dword v40, v17, s[52:55], s17 offen
s_add_u32 s16, s16, 64
v_add_u32 v16, s16, v0
v_mul_u32_u24 v17, 9363, v16
v_lshrrev_b32 v17, 16, v17
v_mul_u32_u24 v18, 7, v17
v_sub_u32 v18, v16, v18
v_mul_u32_u24 v17, 3584, v17
v_lshl_add_u32 v17, v18, 9, v17
buffer_load_dword v41, v17, s[52:55], s17 offen
s_add_u32 s16, s16, 64
v_add_u32 v16, s16, v0
v_mul_u32_u24 v17, 9363, v16
v_lshrrev_b32 v17, 16, v17
v_mul_u32_u24 v18, 7, v17
v_sub_u32 v18, v16, v18
v_mul_u32_u24 v17, 3584, v17
v_lshl_add_u32 v17, v18, 9, v17
buffer_load_dword v42, v17, s[52:55], s17 offen
s_add_u32 s16, s16, 64
s_mul_i32 s17, s12, 229376
s_mul_i32 s16, s45, 14336
s_add_u32 s16, s16, 7372800
s_add_u32 s16, s16, s17
v_lshlrev_b32 v2, 7, v0
buffer_load_dword v16, v2, s[4:7], s16 offen
s_add_u32 s16, s16, 8192
buffer_load_dword v17, v2, s[4:7], s16 offen
s_add_u32 s16, s16, 8192
s_mul_i32 s17, s12, 16384
s_mul_i32 s16, s45, 1024
s_add_u32 s16, s16, 16547840
s_add_u32 s16, s16, s17
v_lshlrev_b32 v2, 7, v0
buffer_load_dword v30, v2, s[4:7], s16 offen
s_add_u32 s16, s16, 8192
s_waitcnt vmcnt(0)
s_waitcnt vmcnt(0)
L_hx_3:
s_cmp_ge_u32 s13, 28
s_cbranch_scc1 interleave_layers__sliding_local_dilated__glu_gated_swiglu__prompt_kernel_h0L
s_mov_b64 s[16:17], -1
s_add_u32 s3, s33, 0
v_subrev_u32 v254, s3, v254
v_cmp_le_u32 vcc, 16, v254
s_nop 0
s_and_b64 vcc, vcc, s[16:17]
s_cbranch_scc0 L_pk_4_ok
s_mov_b32 s15, 0
L_pk_4:
buffer_load_dword v254, v252, s[4:7], s67 offen sc1
s_waitcnt vmcnt(0)
s_add_u32 s3, s33, 0
v_subrev_u32 v254, s3, v254
v_cmp_le_u32 vcc, 16, v254
s_nop 0
s_and_b64 vcc, vcc, s[16:17]
s_cbranch_scc0 L_pk_4_ok
s_add_u32 s15, s15, 1
s_cmp_lt_u32 s15, 131072
s_cbranch_scc1 L_pk_4
L_pk_4_ok:
s_mul_i32 s30, s40, 229376
s_mul_i32 s29, s14, 57344
s_add_u32 s30, s30, s29
s_add_u32 s30, s30, 0
s_add_u32 s29, s30, 0
buffer_load_dwordx4 a[112:115], v1, s[4:7], s29 offen offset:0 sc1
buffer_load_dwordx4 a[116:119], v1, s[4:7], s29 offen offset:1024 sc1
buffer_load_dwordx4 a[120:123], v1, s[4:7], s29 offen offset:2048 sc1
buffer_load_dwordx4 a[124:127], v1, s[4:7], s29 offen offset:3072 sc1
s_add_u32 s29, s30, 4096
buffer_load_dwordx4 a[128:131], v1, s[4:7], s29 offen offset:0 sc1
buffer_load_dwordx4 a[132:135], v1, s[4:7], s29 offen offset:1024 sc1
buffer_load_dwordx4 a[136:139], v1, s[4:7], s29 offen offset:2048 sc1
buffer_load_dwordx4 a[140:143], v1, s[4:7], s29 offen offset:3072 sc1
PG_A_2:
s_cbranch_execz PG_A_6
s_add_u32 s29, s30, 8192
buffer_load_dwordx4 a[144:147], v1, s[4:7], s29 offen offset:0 sc1
buffer_load_dwordx4 a[148:151], v1, s[4:7], s29 offen offset:1024 sc1
buffer_load_dwordx4 a[152:155], v1, s[4:7], s29 offen offset:2048 sc1
buffer_load_dwordx4 a[156:159], v1, s[4:7], s29 offen offset:3072 sc1
s_add_u32 s29, s30, 12288
buffer_load_dwordx4 a[160:163], v1, s[4:7], s29 offen offset:0 sc1
buffer_load_dwordx4 a[164:167], v1, s[4:7], s29 offen offset:1024 sc1
L_xb_5:
v_bfe_u32 v80, v0, 4, 1
v_bfe_u32 v81, v0, 2, 2
v_lshrrev_b32 v82, 5, v0
v_lshl_add_u32 v82, v82, 2, v81
v_lshlrev_b32 v82, 7, v82
v_lshl_add_u32 v82, v80, 11, v82
v_lshrrev_b32 v81, 1, v81
v_lshl_add_u32 v80, v80, 1, v81
v_add_u32 v80, s14, v80
v_and_b32 v80, 3, v80
v_lshl_add_u32 v82, v80, 5, v82
v_and_b32 v80, 3, v0
v_lshl_add_u32 v82, v80, 3, v82
v_add_u32 v82, 86016, v82
v_add_u32 v81, 32768, v82
ds_read_b64_tr_b16 a[28:29], v82 offset:0
ds_read_b64_tr_b16 a[30:31], v82 offset:1024
ds_read_b64_tr_b16 a[32:33], v82 offset:4096
ds_read_b64_tr_b16 a[34:35], v82 offset:5120
ds_read_b64_tr_b16 a[36:37], v82 offset:8192
ds_read_b64_tr_b16 a[38:39], v82 offset:9216
ds_read_b64_tr_b16 a[40:41], v82 offset:12288
ds_read_b64_tr_b16 a[42:43], v82 offset:13312
ds_read_b64_tr_b16 a[44:45], v82 offset:16384
ds_read_b64_tr_b16 a[46:47], v82 offset:17408
ds_read_b64_tr_b16 a[48:49], v82 offset:20480
ds_read_b64_tr_b16 a[50:51], v82 offset:21504
ds_read_b64_tr_b16 a[52:53], v82 offset:24576
ds_read_b64_tr_b16 a[54:55], v82 offset:25600
ds_read_b64_tr_b16 a[56:57], v82 offset:28672
ds_read_b64_tr_b16 a[58:59], v82 offset:29696
ds_read_b64_tr_b16 a[0:1], v81 offset:0
ds_read_b64_tr_b16 a[2:3], v81 offset:1024
ds_read_b64_tr_b16 a[4:5], v81 offset:4096
ds_read_b64_tr_b16 a[6:7], v81 offset:5120
ds_read_b64_tr_b16 a[8:9], v81 offset:8192
ds_read_b64_tr_b16 a[10:11], v81 offset:9216
ds_read_b64_tr_b16 a[12:13], v81 offset:12288
ds_read_b64_tr_b16 a[14:15], v81 offset:13312
ds_read_b64_tr_b16 a[16:17], v81 offset:16384
ds_read_b64_tr_b16 a[18:19], v81 offset:17408
ds_read_b64_tr_b16 a[20:21], v81 offset:20480
ds_read_b64_tr_b16 a[22:23], v81 offset:21504
ds_read_b64_tr_b16 a[24:25], v81 offset:24576
ds_read_b64_tr_b16 a[26:27], v81 offset:25600
ds_read_b64_tr_b16 a[60:61], v81 offset:36864
ds_read_b64_tr_b16 a[62:63], v81 offset:37888
ds_read_b64_tr_b16 a[64:65], v81 offset:28672
ds_read_b64_tr_b16 a[66:67], v81 offset:29696
ds_read_b64_tr_b16 a[68:69], v81 offset:32768
ds_read_b64_tr_b16 a[70:71], v81 offset:33792
s_waitcnt lgkmcnt(0)
v_mov_b32 v120, 0x3f803f80
v_mov_b32 v121, 0x3f803f80
v_mov_b32 v122, 0x3f803f80
v_mov_b32 v123, 0x3f803f80
s_nop 1
v_mfma_f32_32x32x16_bf16 a[240:255], a[0:3], v[120:123], 0
v_mfma_f32_32x32x16_bf16 a[240:255], a[4:7], v[120:123], a[240:255]
v_mfma_f32_32x32x16_bf16 a[240:255], a[8:11], v[120:123], a[240:255]
v_mfma_f32_32x32x16_bf16 a[240:255], a[12:15], v[120:123], a[240:255]
v_mfma_f32_32x32x16_bf16 a[240:255], a[16:19], v[120:123], a[240:255]
v_mfma_f32_32x32x16_bf16 a[240:255], a[20:23], v[120:123], a[240:255]
v_mfma_f32_32x32x16_bf16 a[240:255], a[24:27], v[120:123], a[240:255]
v_mfma_f32_32x32x16_bf16 a[240:255], a[28:31], v[120:123], a[240:255]
v_mfma_f32_32x32x16_bf16 a[240:255], a[32:35], v[120:123], a[240:255]
v_mfma_f32_32x32x16_bf16 a[240:255], a[36:39], v[120:123], a[240:255]
v_mfma_f32_32x32x16_bf16 a[240:255], a[40:43], v[120:123], a[240:255]
v_mfma_f32_32x32x16_bf16 a[240:255], a[44:47], v[120:123], a[240:255]
s_cmp_lg_u32 s14, 0
s_cbranch_scc1 L_wt_6
v_lshlrev_b32 v72, 2, v0
s_add_u32 s3, s32, 1
s_mov_b32 s15, 0
buffer_load_dword v73, v72, s[4:7], s43 offen sc1
s_sleep 1
buffer_load_dword v74, v72, s[4:7], s43 offen sc1
s_sleep 1
L_wt_6_p:
buffer_load_dword v75, v72, s[4:7], s43 offen sc1
s_waitcnt vmcnt(2)
v_subrev_u32 v73, s3, v73
v_cmp_le_u32 vcc, 15, v73
s_nop 0
s_and_b64 vcc, vcc, s[38:39]
s_cbranch_scc0 L_wt_6
buffer_load_dword v73, v72, s[4:7], s43 offen sc1
s_waitcnt vmcnt(2)
v_subrev_u32 v74, s3, v74
v_cmp_le_u32 vcc, 15, v74
s_nop 0
s_and_b64 vcc, vcc, s[38:39]
s_cbranch_scc0 L_wt_6
buffer_load_dword v74, v72, s[4:7], s43 offen sc1
s_waitcnt vmcnt(2)
v_subrev_u32 v75, s3, v75
v_cmp_le_u32 vcc, 15, v75
s_nop 0
s_and_b64 vcc, vcc, s[38:39]
s_cbranch_scc0 L_wt_6
s_add_u32 s15, s15, 1
s_cmp_lt_u32 s15, 131072
s_cbranch_scc1 L_wt_6_p
L_wt_6:
s_barrier
s_add_u32 m0, s21, 0
s_add_u32 s31, s20, 0x0
buffer_load_dwordx4 v1, s[4:7], s31 offen offset:0 sc1 lds
buffer_load_dwordx4 v1, s[4:7], s31 offen offset:1024 sc1 lds
buffer_load_dwordx4 v1, s[4:7], s31 offen offset:2048 sc1 lds
buffer_load_dwordx4 v1, s[4:7], s31 offen offset:3072 sc1 lds
s_add_u32 m0, s21, 16384
s_add_u32 s31, s20, 0x2000
buffer_load_dwordx4 v1, s[4:7], s31 offen offset:0 sc1 lds
buffer_load_dwordx4 v1, s[4:7], s31 offen offset:1024 sc1 lds
buffer_load_dwordx4 v1, s[4:7], s31 offen offset:2048 sc1 lds
buffer_load_dwordx4 v1, s[4:7], s31 offen offset:3072 sc1 lds
v_lshlrev_b32 v32, 16, v8
v_and_b32 v33, 0xffff0000, v8
v_lshlrev_b32 v34, 16, v9
v_and_b32 v35, 0xffff0000, v9
v_lshlrev_b32 v36, 16, v10
v_and_b32 v37, 0xffff0000, v10
v_lshlrev_b32 v38, 16, v11
v_and_b32 v39, 0xffff0000, v11
v_lshlrev_b32 v40, 16, v12
v_and_b32 v41, 0xffff0000, v12
v_lshlrev_b32 v42, 16, v13
v_and_b32 v43, 0xffff0000, v13
v_lshlrev_b32 v44, 16, v14
v_and_b32 v45, 0xffff0000, v14
v_lshlrev_b32 v46, 16, v15
v_and_b32 v47, 0xffff0000, v15
v_mov_b32 v120, 0x3f803f80
v_mov_b32 v121, 0x3f803f80
v_mov_b32 v122, 0x3f803f80
v_mov_b32 v123, 0x3f803f80
s_nop 1
v_mfma_f32_32x32x16_bf16 a[240:255], a[48:51], v[120:123], a[240:255]
v_mfma_f32_32x32x16_bf16 a[240:255], a[52:55], v[120:123], a[240:255]
v_mfma_f32_32x32x16_bf16 a[240:255], a[56:59], v[120:123], a[240:255]
v_mfma_f32_32x32x16_bf16 a[240:255], a[60:63], v[120:123], a[240:255]
v_mfma_f32_32x32x16_bf16 a[240:255], a[64:67], v[120:123], a[240:255]
v_mfma_f32_32x32x16_bf16 a[240:255], a[68:71], v[120:123], a[240:255]
s_waitcnt vmcnt(4)
s_barrier
ds_read_b128 v[48:51], v2 offset:0
ds_read_b128 v[52:55], v2 offset:8192
ds_read_b128 v[56:59], v2 offset:1024
ds_read_b128 v[60:63], v2 offset:9216
ds_read_b128 v[64:67], v2 offset:2048
ds_read_b128 v[68:71], v2 offset:10240
ds_read_b128 v[72:75], v2 offset:3072
ds_read_b128 v[76:79], v2 offset:11264
s_waitcnt lgkmcnt(7)
v_mfma_f32_16x16x32_bf16 v[24:27], v[144:147], v[48:51], v[40:43]
ds_read_b128 v[80:83], v2 offset:4096
s_waitcnt lgkmcnt(7)
v_mfma_f32_16x16x32_bf16 v[28:31], v[144:147], v[52:55], v[44:47]
ds_read_b128 v[84:87], v2 offset:12288
s_waitcnt lgkmcnt(7)
v_mfma_f32_16x16x32_bf16 v[24:27], v[148:151], v[56:59], v[24:27]
ds_read_b128 v[88:91], v2 offset:5120
s_waitcnt lgkmcnt(7)
v_mfma_f32_16x16x32_bf16 v[28:31], v[148:151], v[60:63], v[28:31]
ds_read_b128 v[92:95], v2 offset:13312
s_waitcnt lgkmcnt(7)
v_mfma_f32_16x16x32_bf16 v[24:27], v[152:155], v[64:67], v[24:27]
ds_read_b128 v[96:99], v2 offset:6144
s_waitcnt lgkmcnt(7)
v_mfma_f32_16x16x32_bf16 v[28:31], v[152:155], v[68:71], v[28:31]
ds_read_b128 v[100:103], v2 offset:14336
s_waitcnt lgkmcnt(7)
v_mfma_f32_16x16x32_bf16 v[24:27], v[156:159], v[72:75], v[24:27]
ds_read_b128 v[104:107], v2 offset:7168
s_waitcnt lgkmcnt(7)
v_mfma_f32_16x16x32_bf16 v[28:31], v[156:159], v[76:79], v[28:31]
ds_read_b128 v[108:111], v2 offset:15360
s_waitcnt vmcnt(0)
s_waitcnt lgkmcnt(0)
s_barrier
v_mfma_f32_16x16x32_bf16 v[24:27], v[160:163], v[80:83], v[24:27]
ds_read_b128 v[48:51], v2 offset:16384
s_add_u32 m0, s21, 0
v_mfma_f32_16x16x32_bf16 v[28:31], v[160:163], v[84:87], v[28:31]
ds_read_b128 v[52:55], v2 offset:24576
s_add_u32 s31, s20, 0xfffe0000
v_mfma_f32_16x16x32_bf16 v[24:27], v[164:167], v[88:91], v[24:27]
ds_read_b128 v[56:59], v2 offset:17408
buffer_load_dwordx4 v1, s[4:7], s31 offen offset:0 sc1 lds
v_mfma_f32_16x16x32_bf16 v[28:31], v[164:167], v[92:95], v[28:31]
ds_read_b128 v[60:63], v2 offset:25600
buffer_load_dwordx4 v1, s[4:7], s31 offen offset:1024 sc1 lds
v_mfma_f32_16x16x32_bf16 v[24:27], v[168:171], v[96:99], v[24:27]
ds_read_b128 v[64:67], v2 offset:18432
buffer_load_dwordx4 v1, s[4:7], s31 offen offset:2048 sc1 lds
v_mfma_f32_16x16x32_bf16 v[28:31], v[168:171], v[100:103], v[28:31]
ds_read_b128 v[68:71], v2 offset:26624
buffer_load_dwordx4 v1, s[4:7], s31 offen offset:3072 sc1 lds
v_mfma_f32_16x16x32_bf16 v[24:27], v[172:175], v[104:107], v[24:27]
ds_read_b128 v[72:75], v2 offset:19456
v_mfma_f32_16x16x32_bf16 v[28:31], v[172:175], v[108:111], v[28:31]
ds_read_b128 v[76:79], v2 offset:27648
s_waitcnt lgkmcnt(7)
v_mfma_f32_16x16x32_bf16 v[24:27], v[176:179], v[48:51], v[24:27]
ds_read_b128 v[80:83], v2 offset:20480
s_waitcnt lgkmcnt(7)
v_mfma_f32_16x16x32_bf16 v[28:31], v[176:179], v[52:55], v[28:31]
ds_read_b128 v[84:87], v2 offset:28672
s_waitcnt lgkmcnt(7)
v_mfma_f32_16x16x32_bf16 v[24:27], v[180:183], v[56:59], v[24:27]
ds_read_b128 v[88:91], v2 offset:21504
s_waitcnt lgkmcnt(7)
v_mfma_f32_16x16x32_bf16 v[28:31], v[180:183], v[60:63], v[28:31]
ds_read_b128 v[92:95], v2 offset:29696
s_waitcnt lgkmcnt(7)
v_mfma_f32_16x16x32_bf16 v[24:27], v[184:187], v[64:67], v[24:27]
ds_read_b128 v[96:99], v2 offset:22528
s_waitcnt lgkmcnt(7)
v_mfma_f32_16x16x32_bf16 v[28:31], v[184:187], v[68:71], v[28:31]
ds_read_b128 v[100:103], v2 offset:30720
s_waitcnt lgkmcnt(7)
v_mfma_f32_16x16x32_bf16 v[24:27], v[188:191], v[72:75], v[24:27]
ds_read_b128 v[104:107], v2 offset:23552
s_waitcnt lgkmcnt(7)
v_mfma_f32_16x16x32_bf16 v[28:31], v[188:191], v[76:79], v[28:31]
ds_read_b128 v[108:111], v2 offset:31744
s_waitcnt vmcnt(0)
s_waitcnt lgkmcnt(0)
s_barrier
v_mfma_f32_16x16x32_bf16 v[24:27], v[192:195], v[80:83], v[24:27]
ds_read_b128 v[48:51], v2 offset:0
s_add_u32 m0, s21, 16384
v_mfma_f32_16x16x32_bf16 v[28:31], v[192:195], v[84:87], v[28:31]
ds_read_b128 v[52:55], v2 offset:8192
s_add_u32 s31, s20, 0xfffe2000
v_mfma_f32_16x16x32_bf16 v[24:27], v[196:199], v[88:91], v[24:27]
ds_read_b128 v[56:59], v2 offset:1024
buffer_load_dwordx4 v1, s[4:7], s31 offen offset:0 sc1 lds
v_mfma_f32_16x16x32_bf16 v[28:31], v[196:199], v[92:95], v[28:31]
ds_read_b128 v[60:63], v2 offset:9216
buffer_load_dwordx4 v1, s[4:7], s31 offen offset:1024 sc1 lds
v_mfma_f32_16x16x32_bf16 v[24:27], v[200:203], v[96:99], v[24:27]
ds_read_b128 v[64:67], v2 offset:2048
buffer_load_dwordx4 v1, s[4:7], s31 offen offset:2048 sc1 lds
v_mfma_f32_16x16x32_bf16 v[28:31], v[200:203], v[100:103], v[28:31]
ds_read_b128 v[68:71], v2 offset:10240
buffer_load_dwordx4 v1, s[4:7], s31 offen offset:3072 sc1 lds
v_mfma_f32_16x16x32_bf16 v[24:27], v[204:207], v[104:107], v[24:27]
ds_read_b128 v[72:75], v2 offset:3072
s_add_u32 m0, s22, 0x8000
v_mfma_f32_16x16x32_bf16 v[28:31], v[204:207], v[108:111], v[28:31]
ds_read_b128 v[76:79], v2 offset:11264
s_add_u32 s29, s47, 1032192
s_waitcnt lgkmcnt(7)
v_mfma_f32_16x16x32_bf16 v[16:19], v[144:147], v[48:51], v[32:35]
ds_read_b128 v[80:83], v2 offset:4096
buffer_load_dwordx4 v255, s[52:55], s29 offen lds
s_waitcnt lgkmcnt(7)
v_mfma_f32_16x16x32_bf16 v[20:23], v[144:147], v[52:55], v[36:39]
ds_read_b128 v[84:87], v2 offset:12288
s_add_u32 m0, s22, 0x9000
s_waitcnt lgkmcnt(7)
v_mfma_f32_16x16x32_bf16 v[16:19], v[148:151], v[56:59], v[16:19]
ds_read_b128 v[88:91], v2 offset:5120
v_cvt_pk_bf16_f32 v112, v24, v25
s_add_u32 s29, s47, 1089536
s_waitcnt lgkmcnt(7)
v_mfma_f32_16x16x32_bf16 v[20:23], v[148:151], v[60:63], v[20:23]
ds_read_b128 v[92:95], v2 offset:13312
v_cvt_pk_bf16_f32 v113, v26, v27
v_cvt_pk_bf16_f32 v114, v28, v29
s_waitcnt lgkmcnt(7)
v_mfma_f32_16x16x32_bf16 v[16:19], v[152:155], v[64:67], v[16:19]
ds_read_b128 v[96:99], v2 offset:6144
v_cvt_pk_bf16_f32 v115, v30, v31
buffer_load_dwordx4 v255, s[52:55], s29 offen lds
s_waitcnt lgkmcnt(7)
v_mfma_f32_16x16x32_bf16 v[20:23], v[152:155], v[68:71], v[20:23]
ds_read_b128 v[100:103], v2 offset:14336
v_add_f32 v116, v24, v25
v_mul_f32 v117, v24, v24
s_waitcnt lgkmcnt(7)
v_mfma_f32_16x16x32_bf16 v[16:19], v[156:159], v[72:75], v[16:19]
ds_read_b128 v[104:107], v2 offset:7168
v_add_f32 v118, v28, v29
s_add_u32 m0, s22, 0xa000
s_waitcnt lgkmcnt(7)
v_mfma_f32_16x16x32_bf16 v[20:23], v[156:159], v[76:79], v[20:23]
ds_read_b128 v[108:111], v2 offset:15360
v_mul_f32 v119, v28, v28
v_permlane32_swap_b32 v112, v114
s_waitcnt vmcnt(2)
s_waitcnt lgkmcnt(0)
s_barrier
v_mfma_f32_16x16x32_bf16 v[16:19], v[160:163], v[80:83], v[16:19]
ds_read_b128 v[48:51], v2 offset:16384
v_permlane32_swap_b32 v113, v115
s_add_u32 s29, s47, 1146880
v_mfma_f32_16x16x32_bf16 v[20:23], v[160:163], v[84:87], v[20:23]
ds_read_b128 v[52:55], v2 offset:24576
buffer_store_dwordx4 v[112:115], v3, s[4:7], s18 offen
v_fmac_f32 v117, v25, v25
v_mfma_f32_16x16x32_bf16 v[16:19], v[164:167], v[88:91], v[16:19]
ds_read_b128 v[56:59], v2 offset:17408
v_fmac_f32 v119, v29, v29
buffer_load_dwordx4 v255, s[52:55], s29 offen lds
v_mfma_f32_16x16x32_bf16 v[20:23], v[164:167], v[92:95], v[20:23]
ds_read_b128 v[60:63], v2 offset:25600
v_add_f32 v116, v116, v26
v_fmac_f32 v117, v26, v26
v_mfma_f32_16x16x32_bf16 v[16:19], v[168:171], v[96:99], v[16:19]
ds_read_b128 v[64:67], v2 offset:18432
v_add_f32 v118, v118, v30
s_add_u32 m0, s22, 0xb000
v_mfma_f32_16x16x32_bf16 v[20:23], v[168:171], v[100:103], v[20:23]
ds_read_b128 v[68:71], v2 offset:26624
v_fmac_f32 v119, v30, v30
v_add_f32 v116, v116, v27
v_mfma_f32_16x16x32_bf16 v[16:19], v[172:175], v[104:107], v[16:19]
ds_read_b128 v[72:75], v2 offset:19456
v_fmac_f32 v117, v27, v27
s_add_u32 s29, s47, 1204224
v_mfma_f32_16x16x32_bf16 v[20:23], v[172:175], v[108:111], v[20:23]
ds_read_b128 v[76:79], v2 offset:27648
v_add_f32 v118, v118, v31
v_fmac_f32 v119, v31, v31
s_waitcnt lgkmcnt(7)
v_mfma_f32_16x16x32_bf16 v[16:19], v[176:179], v[48:51], v[16:19]
ds_read_b128 v[80:83], v2 offset:20480
v_permlane32_swap_b32 v116, v117
buffer_load_dwordx4 v255, s[52:55], s29 offen lds
s_waitcnt lgkmcnt(7)
v_mfma_f32_16x16x32_bf16 v[20:23], v[176:179], v[52:55], v[20:23]
ds_read_b128 v[84:87], v2 offset:28672
v_permlane32_swap_b32 v118, v119
v_add_f32 v116, v116, v117
s_waitcnt lgkmcnt(7)
v_mfma_f32_16x16x32_bf16 v[16:19], v[180:183], v[56:59], v[16:19]
ds_read_b128 v[88:91], v2 offset:21504
v_add_f32 v118, v118, v119
s_add_u32 m0, s22, 0xc000
s_waitcnt lgkmcnt(7)
v_mfma_f32_16x16x32_bf16 v[20:23], v[180:183], v[60:63], v[20:23]
ds_read_b128 v[92:95], v2 offset:29696
v_permlane16_swap_b32 v116, v118
v_add_f32 v116, v116, v118
s_waitcnt lgkmcnt(7)
v_mfma_f32_16x16x32_bf16 v[16:19], v[184:187], v[64:67], v[16:19]
ds_read_b128 v[96:99], v2 offset:22528
ds_write_b32 v4, v116 offset:1024
s_add_u32 s29, s47, 1261568
s_waitcnt lgkmcnt(8)
v_mfma_f32_16x16x32_bf16 v[20:23], v[184:187], v[68:71], v[20:23]
ds_read_b128 v[100:103], v2 offset:30720
buffer_load_dwordx4 v255, s[52:55], s29 offen lds
s_waitcnt lgkmcnt(8)
v_mfma_f32_16x16x32_bf16 v[16:19], v[188:191], v[72:75], v[16:19]
ds_read_b128 v[104:107], v2 offset:23552
s_add_u32 m0, s22, 0xd000
s_waitcnt lgkmcnt(8)
v_mfma_f32_16x16x32_bf16 v[20:23], v[188:191], v[76:79], v[20:23]
ds_read_b128 v[108:111], v2 offset:31744
s_add_u32 s29, s47, 1318912
s_waitcnt lgkmcnt(3)
s_barrier
v_mfma_f32_16x16x32_bf16 v[16:19], v[192:195], v[80:83], v[16:19]
ds_read2st64_b32 v[120:121], v5 offset0:4 offset1:5
ds_read2st64_b32 v[122:123], v5 offset0:6 offset1:7
buffer_load_dwordx4 v255, s[52:55], s29 offen lds
v_mfma_f32_16x16x32_bf16 v[20:23], v[192:195], v[84:87], v[20:23]
s_waitcnt lgkmcnt(1)
v_add_f32 v120, v120, v121
s_waitcnt lgkmcnt(0)
v_add_f32 v122, v122, v123
v_mfma_f32_16x16x32_bf16 v[16:19], v[196:199], v[88:91], v[16:19]
v_add_f32 v120, v120, v122
buffer_store_dword v120, v6, s[4:7], s19 offen
s_add_u32 m0, s22, 0xe000
v_mfma_f32_16x16x32_bf16 v[20:23], v[196:199], v[92:95], v[20:23]
s_add_u32 s29, s47, 1376256
v_mfma_f32_16x16x32_bf16 v[16:19], v[200:203], v[96:99], v[16:19]
buffer_load_dwordx4 v255, s[52:55], s29 offen lds
v_mfma_f32_16x16x32_bf16 v[20:23], v[200:203], v[100:103], v[20:23]
s_add_u32 m0, s22, 0xf000
v_mfma_f32_16x16x32_bf16 v[16:19], v[204:207], v[104:107], v[16:19]
s_add_u32 s29, s47, 1433600
v_mfma_f32_16x16x32_bf16 v[20:23], v[204:207], v[108:111], v[20:23]
buffer_load_dwordx4 v255, s[52:55], s29 offen lds
s_add_u32 m0, s22, 0x10000
s_add_u32 s29, s47, 1490944
buffer_load_dwordx4 v255, s[52:55], s29 offen lds
s_add_u32 m0, s22, 0x11000
s_add_u32 s29, s47, 1548288
buffer_load_dwordx4 v255, s[52:55], s29 offen lds
v_cvt_pk_bf16_f32 v124, v16, v17
v_cvt_pk_bf16_f32 v125, v18, v19
v_cvt_pk_bf16_f32 v126, v20, v21
v_cvt_pk_bf16_f32 v127, v22, v23
v_add_f32 v48, v16, v17
v_mul_f32 v49, v16, v16
v_add_f32 v50, v20, v21
v_mul_f32 v51, v20, v20
v_permlane32_swap_b32 v124, v126
v_permlane32_swap_b32 v125, v127
s_sub_u32 s18, s18, 114688
buffer_store_dwordx4 v[124:127], v3, s[4:7], s18 offen
v_fmac_f32 v49, v17, v17
v_fmac_f32 v51, v21, v21
v_add_f32 v48, v48, v18
v_fmac_f32 v49, v18, v18
v_add_f32 v50, v50, v22
v_fmac_f32 v51, v22, v22
v_add_f32 v48, v48, v19
v_fmac_f32 v49, v19, v19
v_add_f32 v50, v50, v23
v_fmac_f32 v51, v23, v23
v_permlane32_swap_b32 v48, v49
s_nop 0
v_permlane32_swap_b32 v50, v51
v_add_f32 v48, v48, v49
v_add_f32 v50, v50, v51
s_nop 1
v_permlane16_swap_b32 v48, v50
v_add_f32 v48, v48, v50
ds_write_b32 v4, v48 offset:0
s_waitcnt vmcnt(5)
s_waitcnt lgkmcnt(0)
s_barrier
ds_read2st64_b32 v[60:61], v5 offset0:0 offset1:1
ds_read2st64_b32 v[62:63], v5 offset0:2 offset1:3
s_add_u32 s3, s32, 2
v_bfrev_b32 v128, 1
v_mov_b32 v129, s3
v_writelane_b32 v128, s50, 0
buffer_store_dword v129, v128, s[4:7], s46 offen
s_waitcnt lgkmcnt(1)
v_add_f32 v60, v60, v61
s_waitcnt lgkmcnt(0)
v_add_f32 v62, v62, v63
v_add_f32 v60, v60, v62
s_sub_u32 s19, s19, 8192
buffer_store_dword v60, v6, s[4:7], s19 offen
s_lshl_b32 s16, s14, 7
s_add_u32 s16, s16, 160256
v_lshrrev_b32 v148, 5, v0
v_lshl_add_u32 v148, v148, 6, s16
s_lshl_b32 s16, s13, 2
s_add_u32 s16, s16, s14
s_lshl_b32 s20, s12, 3
s_mul_i32 s26, s20, 224
s_add_u32 s26, s26, s16
s_lshl_b32 s26, s26, 9
s_add_u32 s26, s26, 9666560
v_bfe_u32 v119, v0, 4, 1
v_mul_u32_u24 v119, 57344, v119
v_lshrrev_b32 v6, 5, v0
v_lshl_add_u32 v119, v6, 8, v119
v_and_b32 v6, 15, v0
v_lshl_add_u32 v119, v6, 4, v119
s_add_u32 s16, s14, s20
s_lshl_b32 s25, s16, 11
s_add_u32 s25, s25, 16547840
s_add_u32 s24, s25, 8192
s_mul_i32 s22, s20, 28672
s_mul_i32 s16, s14, 7168
s_add_u32 s22, s22, s16
s_add_u32 s22, s22, 7372800
s_mul_i32 s23, s14, 17408
s_add_u32 s23, s23, 86016
v_add_u32 v4, 86016, v1
v_add_u32 v5, 151552, v1
v_and_b32 v6, 31, v0
v_lshlrev_b32 v6, 4, v6
v_add_u32 v6, 155648, v6
v_and_b32 v145, 7, v0
v_lshrrev_b32 v144, 4, v0
v_lshl_add_u32 v145, v145, 2, v144
s_lshl_b32 s16, s14, 9
s_add_u32 s16, s16, 155648
v_lshl_add_u32 v145, v145, 4, s16
v_cmp_gt_u32 vcc, 48, v0
v_bfrev_b32 v144, 1
s_nop 0
v_cndmask_b32 v144, v144, v1, vcc
s_waitcnt lgkmcnt(0)
s_add_u32 s44, s42, 4
s_mul_i32 s16, s14, 14
s_mul_i32 s20, s44, 112
s_add_u32 s20, s20, s16
s_lshl_b32 s20, s20, 10
s_add_u32 s20, s20, 9207808
s_sub_u32 s21, s20, 458752
s_add_u32 s68, s20, 57344
s_add_u32 s69, s21, 57344
s_lshl_b32 s65, s14, 13
s_add_u32 s65, s65, 86016
v_and_b32 v3, 7, v0
v_lshlrev_b32 v3, 4, v3
s_and_b32 s16, s14, 1
s_lshl_b32 s16, s16, 7
s_lshr_b32 s17, s14, 1
s_lshl_b32 s17, s17, 10
s_add_u32 s16, s16, s17
v_add_u32 v2, s16, v3
v_bfe_u32 v146, v0, 3, 1
v_lshl_add_u32 v2, v146, 8, v2
v_bfe_u32 v7, v0, 4, 1
v_lshlrev_b32 v7, 7, v7
v_xor_b32 v2, v2, v7
v_lshrrev_b32 v7, 4, v0
v_lshl_add_u32 v2, v7, 11, v2
v_add_u32 v2, 86016, v2
s_mul_i32 s18, s44, 28
s_lshr_b32 s16, s14, 1
s_mul_i32 s16, s16, 14
s_add_u32 s18, s18, s16
s_lshl_b32 s16, s40, 1
s_add_u32 s18, s18, s16
s_lshl_b32 s18, s18, 10
s_and_b32 s16, s14, 1
s_lshl_b32 s16, s16, 7
s_add_u32 s18, s18, s16
s_add_u32 s18, s18, 3440640
v_lshl_add_u32 v3, v7, 9, v3
v_lshl_add_u32 v3, v146, 8, v3
s_lshl_b32 s19, s44, 11
s_lshl_b32 s16, s40, 8
s_add_u32 s19, s19, s16
s_lshl_b32 s16, s14, 5
s_add_u32 s19, s19, s16
s_add_u32 s19, s19, 16678912
v_and_b32 v7, 7, v0
v_lshrrev_b32 v146, 5, v0
v_lshlrev_b32 v7, 2, v7
v_lshl_add_u32 v7, v146, 7, v7
s_mov_b32 vcc_lo, 0xff
s_mov_b32 vcc_hi, 0xff
v_bfrev_b32 v146, 1
v_cndmask_b32 v7, v146, v7, vcc
s_mul_i32 s64, s44, 28
s_lshl_b32 s16, s40, 2
s_add_u32 s64, s64, s16
s_lshl_b32 s64, s64, 10
s_lshl_b32 s16, s14, 7
s_add_u32 s64, s64, s16
s_add_u32 s64, s64, 7372800
v_and_b32 v147, 7, v0
v_lshrrev_b32 v146, 3, v0
v_lshlrev_b32 v147, 4, v147
v_lshl_add_u32 v147, v146, 9, v147
s_sub_u32 s27, s23, 4096
s_sub_u32 s66, s64, 114688
s_mov_b64 exec, 0
s_cmp_eq_u32 s14, 0
s_cbranch_scc1 PG_B_0
s_cmp_eq_u32 s14, 1
s_cbranch_scc1 PG_B_1
s_cmp_eq_u32 s14, 2
s_cbranch_scc1 PG_B_2
s_cmp_eq_u32 s14, 3
s_cbranch_scc1 PG_B_3
PG_B_ret:
s_mov_b64 exec, -1
s_waitcnt vmcnt(0)
s_barrier
s_add_u32 s3, s32, 3
v_bfrev_b32 v76, 1
v_mov_b32 v77, s3
v_writelane_b32 v76, s50, 0
buffer_store_dword v77, v76, s[4:7], s46 offen
v_bfe_u32 v100, v0, 4, 1
v_bfe_u32 v101, v0, 2, 2
v_lshrrev_b32 v102, 5, v0
v_lshl_add_u32 v102, v102, 2, v101
v_lshlrev_b32 v102, 7, v102
v_lshl_add_u32 v102, v100, 11, v102
v_lshrrev_b32 v101, 1, v101
v_lshl_add_u32 v100, v100, 1, v101
v_add_u32 v100, s14, v100
v_and_b32 v100, 3, v100
v_lshl_add_u32 v102, v100, 5, v102
v_and_b32 v100, 3, v0
v_lshl_add_u32 v102, v100, 3, v102
v_add_u32 v102, 86016, v102
v_add_u32 v101, 32768, v102
ds_read_b64_tr_b16 a[72:73], v101 offset:0
ds_read_b64_tr_b16 a[74:75], v101 offset:1024
ds_read_b64_tr_b16 a[76:77], v101 offset:4096
ds_read_b64_tr_b16 a[78:79], v101 offset:5120
ds_read_b64_tr_b16 a[80:81], v101 offset:8192
ds_read_b64_tr_b16 a[82:83], v101 offset:9216
ds_read_b64_tr_b16 a[84:85], v101 offset:12288
ds_read_b64_tr_b16 a[86:87], v101 offset:13312
ds_read_b64_tr_b16 a[88:89], v101 offset:16384
ds_read_b64_tr_b16 a[90:91], v101 offset:17408
ds_read_b64_tr_b16 a[92:93], v101 offset:20480
ds_read_b64_tr_b16 a[94:95], v101 offset:21504
ds_read_b64_tr_b16 a[96:97], v101 offset:24576
ds_read_b64_tr_b16 a[98:99], v101 offset:25600
ds_read_b64_tr_b16 a[100:101], v101 offset:28672
ds_read_b64_tr_b16 a[102:103], v101 offset:29696
ds_read_b64_tr_b16 a[104:105], v101 offset:32768
ds_read_b64_tr_b16 a[106:107], v101 offset:33792
ds_read_b64_tr_b16 a[108:109], v101 offset:36864
ds_read_b64_tr_b16 a[110:111], v101 offset:37888
s_waitcnt lgkmcnt(0)
s_cmp_lg_u32 s14, 0
s_cbranch_scc1 L_wt_7
v_lshlrev_b32 v72, 2, v0
s_add_u32 s3, s32, 2
s_mov_b32 s15, 0
buffer_load_dword v73, v72, s[4:7], s43 offen sc1
s_sleep 1
buffer_load_dword v74, v72, s[4:7], s43 offen sc1
s_sleep 1
L_wt_7_p:
buffer_load_dword v75, v72, s[4:7], s43 offen sc1
s_waitcnt vmcnt(2)
v_subrev_u32 v73, s3, v73
v_cmp_le_u32 vcc, 14, v73
s_nop 0
s_and_b64 vcc, vcc, s[48:49]
s_cbranch_scc0 L_wt_7
buffer_load_dword v73, v72, s[4:7], s43 offen sc1
s_waitcnt vmcnt(2)
v_subrev_u32 v74, s3, v74
v_cmp_le_u32 vcc, 14, v74
s_nop 0
s_and_b64 vcc, vcc, s[48:49]
s_cbranch_scc0 L_wt_7
buffer_load_dword v74, v72, s[4:7], s43 offen sc1
s_waitcnt vmcnt(2)
v_subrev_u32 v75, s3, v75
v_cmp_le_u32 vcc, 14, v75
s_nop 0
s_and_b64 vcc, vcc, s[48:49]
s_cbranch_scc0 L_wt_7
s_add_u32 s15, s15, 1
s_cmp_lt_u32 s15, 131072
s_cbranch_scc1 L_wt_7_p
L_wt_7:
s_barrier
s_add_u32 m0, s23, 0
s_add_u32 s31, s22, 114688
PG_A_3:
s_cbranch_execz PG_A_ret
buffer_load_dwordx4 v1, s[4:7], s31 offen offset:0 sc1 lds
buffer_load_dwordx4 v1, s[4:7], s31 offen offset:1024 sc1 lds
buffer_load_dwordx4 v1, s[4:7], s31 offen offset:2048 sc1 lds
buffer_load_dwordx4 v1, s[4:7], s31 offen offset:3072 sc1 lds
s_add_u32 m0, s23, 4096
s_add_u32 s31, s22, 118784
buffer_load_dwordx4 v1, s[4:7], s31 offen offset:0 sc1 lds
buffer_load_dwordx4 v1, s[4:7], s31 offen offset:1024 sc1 lds
buffer_load_dwordx4 v1, s[4:7], s31 offen offset:2048 sc1 lds
v_mov_b32 v96, 0x3f803f80
v_mov_b32 v97, 0x3f803f80
v_mov_b32 v98, 0x3f803f80
v_mov_b32 v99, 0x3f803f80
s_nop 1
v_mfma_f32_32x32x16_bf16 a[240:255], a[72:75], v[96:99], a[240:255]
v_mfma_f32_32x32x16_bf16 a[240:255], a[76:79], v[96:99], a[240:255]
v_mfma_f32_32x32x16_bf16 a[240:255], a[80:83], v[96:99], a[240:255]
v_mfma_f32_32x32x16_bf16 a[240:255], a[84:87], v[96:99], a[240:255]
v_mfma_f32_32x32x16_bf16 a[240:255], a[88:91], v[96:99], a[240:255]
v_mfma_f32_32x32x16_bf16 a[240:255], a[92:95], v[96:99], a[240:255]
s_waitcnt vmcnt(3)
s_barrier
ds_read_b128 v[48:51], v4 offset:0
ds_read_b128 v[52:55], v4 offset:17408
ds_read_b128 v[56:59], v4 offset:34816
ds_read_b128 v[60:63], v4 offset:52224
s_waitcnt lgkmcnt(2)
v_mfma_f32_32x32x16_bf16 v[16:31], a[0:3], v[48:51], 0
ds_read_b128 v[64:67], v4 offset:1024
buffer_load_dwordx4 v[128:131], v1, s[4:7], s24 offen sc1
v_mfma_f32_32x32x16_bf16 v[16:31], a[28:31], v[52:55], v[16:31]
ds_read_b128 v[68:71], v4 offset:18432
s_waitcnt lgkmcnt(2)
v_mfma_f32_32x32x16_bf16 v[16:31], a[56:59], v[56:59], v[16:31]
ds_read_b128 v[72:75], v4 offset:35840
buffer_load_dwordx4 v[132:135], v144, s[4:7], s24 offen offset:1024 sc1
v_mfma_f32_32x32x16_bf16 v[16:31], a[84:87], v[60:63], v[16:31]
ds_read_b128 v[76:79], v4 offset:53248
s_waitcnt lgkmcnt(2)
v_mfma_f32_32x32x16_bf16 v[16:31], a[4:7], v[64:67], v[16:31]
ds_read_b128 v[48:51], v4 offset:2048
s_add_u32 m0, s23, 7168
s_add_u32 s31, s22, 143360
buffer_load_dwordx4 v1, s[4:7], s31 offen offset:0 sc1 lds
v_mfma_f32_32x32x16_bf16 v[16:31], a[32:35], v[68:71], v[16:31]
ds_read_b128 v[52:55], v4 offset:19456
s_waitcnt lgkmcnt(2)
v_mfma_f32_32x32x16_bf16 v[16:31], a[60:63], v[72:75], v[16:31]
ds_read_b128 v[56:59], v4 offset:36864
buffer_load_dwordx4 v1, s[4:7], s31 offen offset:1024 sc1 lds
v_mfma_f32_32x32x16_bf16 v[16:31], a[88:91], v[76:79], v[16:31]
ds_read_b128 v[60:63], v4 offset:54272
s_waitcnt lgkmcnt(2)
v_mfma_f32_32x32x16_bf16 v[16:31], a[8:11], v[48:51], v[16:31]
ds_read_b128 v[64:67], v4 offset:3072
buffer_load_dwordx4 v1, s[4:7], s31 offen offset:2048 sc1 lds
v_mfma_f32_32x32x16_bf16 v[16:31], a[36:39], v[52:55], v[16:31]
s_waitcnt vmcnt(5)
s_barrier
ds_read_b128 v[68:71], v4 offset:20480
s_waitcnt lgkmcnt(2)
v_mfma_f32_32x32x16_bf16 v[16:31], a[64:67], v[56:59], v[16:31]
ds_read_b128 v[72:75], v4 offset:37888
buffer_load_dwordx4 v1, s[4:7], s31 offen offset:3072 sc1 lds
v_mfma_f32_32x32x16_bf16 v[16:31], a[92:95], v[60:63], v[16:31]
ds_read_b128 v[76:79], v4 offset:55296
s_waitcnt lgkmcnt(2)
v_mfma_f32_32x32x16_bf16 v[16:31], a[12:15], v[64:67], v[16:31]
ds_read_b128 v[48:51], v4 offset:4096
v_mfma_f32_32x32x16_bf16 a[240:255], a[96:99], v[96:99], a[240:255]
s_add_u32 m0, s23, 11264
s_add_u32 s31, s22, 147456
buffer_load_dwordx4 v1, s[4:7], s31 offen offset:0 sc1 lds
s_waitcnt vmcnt(5)
v_add_f32 v128, v128, v132
v_mfma_f32_32x32x16_bf16 v[16:31], a[40:43], v[68:71], v[16:31]
ds_read_b128 v[52:55], v4 offset:21504
v_add_f32 v129, v129, v133
v_add_f32 v130, v130, v134
v_add_f32 v131, v131, v135
s_nop 0
v_permlane32_swap_b32 v128, v130
s_waitcnt lgkmcnt(2)
v_mfma_f32_32x32x16_bf16 v[16:31], a[68:71], v[72:75], v[16:31]
ds_read_b128 v[56:59], v4 offset:38912
v_mfma_f32_32x32x16_bf16 a[240:255], a[100:103], v[96:99], a[240:255]
buffer_load_dwordx4 v1, s[4:7], s31 offen offset:1024 sc1 lds
v_permlane32_swap_b32 v129, v131
v_add_f32 v128, v128, v130
v_add_f32 v129, v129, v131
s_mul_i32 s30, s40, 229376
s_mul_i32 s29, s14, 57344
s_add_u32 s30, s30, s29
s_add_u32 s30, s30, 0
s_add_u32 s29, s30, 12288
buffer_load_dwordx4 a[168:171], v1, s[4:7], s29 offen offset:2048 sc1
v_mfma_f32_32x32x16_bf16 v[16:31], a[96:99], v[76:79], v[16:31]
ds_read_b128 v[60:63], v4 offset:56320
v_permlane16_swap_b32 v128, v129
v_add_f32 v128, v128, v129
v_mul_f32 v128, 0x3b124925, v128
s_nop 1
v_mov_b32_dpp v129, v128 row_ror:8 row_mask:0xf bank_mask:0xf
buffer_load_dwordx4 a[172:175], v1, s[4:7], s29 offen offset:3072 sc1
s_waitcnt lgkmcnt(2)
v_mfma_f32_32x32x16_bf16 v[16:31], a[16:19], v[48:51], v[16:31]
ds_read_b128 v[64:67], v4 offset:5120
v_mfma_f32_32x32x16_bf16 a[240:255], a[104:107], v[96:99], a[240:255]
buffer_load_dwordx4 v1, s[4:7], s31 offen offset:2048 sc1 lds
v_fma_f32 v129, -v128, v128, v129
v_max_f32 v129, 0, v129
v_add_f32 v129, 0x3727c5ac, v129
v_mfma_f32_32x32x16_bf16 v[16:31], a[44:47], v[52:55], v[16:31]
ds_read_b128 v[68:71], v4 offset:22528
v_rsq_f32 v131, v129
v_mov_b32 v130, v129
v_mul_f32 v129, 0xbfb8aa3b, v131
s_waitcnt lgkmcnt(2)
v_mfma_f32_32x32x16_bf16 v[16:31], a[72:75], v[56:59], v[16:31]
ds_read_b128 v[72:75], v4 offset:39936
s_add_u32 m0, s23, 14336
s_add_u32 s31, s22, 172032
buffer_load_dwordx4 v1, s[4:7], s31 offen offset:0 sc1 lds
v_mfma_f32_32x32x16_bf16 a[240:255], a[108:111], v[96:99], a[240:255]
s_mov_b32 exec_lo, 0x00ff00ff
s_mov_b32 exec_hi, 0x00ff00ff
ds_write_b96 v145, v[128:130] offset:0
s_mov_b64 exec, -1
v_mfma_f32_32x32x16_bf16 v[16:31], a[100:103], v[60:63], v[16:31]
ds_read_b128 v[76:79], v4 offset:57344
s_waitcnt lgkmcnt(3)
v_mfma_f32_32x32x16_bf16 v[16:31], a[20:23], v[64:67], v[16:31]
ds_read_b128 v[48:51], v4 offset:6144
buffer_load_dwordx4 v1, s[4:7], s31 offen offset:1024 sc1 lds
v_lshlrev_b32 v168, 2, v0
buffer_load_dword v170, v168, s[4:7], s43 offen sc1
s_add_u32 s29, s30, 16384
buffer_load_dwordx4 a[176:179], v1, s[4:7], s29 offen offset:0 sc1
v_mfma_f32_32x32x16_bf16 v[16:31], a[48:51], v[68:71], v[16:31]
ds_read_b128 v[52:55], v4 offset:23552
s_waitcnt lgkmcnt(2)
v_mfma_f32_32x32x16_bf16 v[16:31], a[76:79], v[72:75], v[16:31]
ds_read_b128 v[56:59], v4 offset:40960
buffer_load_dwordx4 v1, s[4:7], s31 offen offset:2048 sc1 lds
v_mfma_f32_32x32x16_bf16 v[16:31], a[104:107], v[76:79], v[16:31]
s_waitcnt vmcnt(10)
s_barrier
ds_read_b128 v[60:63], v4 offset:58368
s_waitcnt lgkmcnt(2)
v_mfma_f32_32x32x16_bf16 v[16:31], a[24:27], v[48:51], v[16:31]
ds_read_b128 v[64:67], v4 offset:7168
s_add_u32 m0, s23, 0
s_add_u32 s31, s22, 175104
buffer_load_dwordx4 v1, s[4:7], s31 offen offset:0 sc1 lds
v_accvgpr_read_b32 v80, a240
v_accvgpr_read_b32 v81, a241
v_mfma_f32_32x32x16_bf16 v[16:31], a[52:55], v[52:55], v[16:31]
ds_read_b128 v[68:71], v4 offset:24576
v_accvgpr_read_b32 v82, a242
v_accvgpr_read_b32 v83, a243
v_accvgpr_read_b32 v84, a244
v_accvgpr_read_b32 v85, a245
ds_read_b96 v[120:122], v6 offset:0
s_waitcnt lgkmcnt(3)
v_mfma_f32_32x32x16_bf16 v[16:31], a[80:83], v[56:59], v[16:31]
ds_read_b128 v[72:75], v4 offset:41984
s_add_u32 m0, s23, 1024
s_add_u32 s31, s22, 176128
buffer_load_dwordx4 v1, s[4:7], s31 offen offset:0 sc1 lds
v_accvgpr_read_b32 v86, a246
v_accvgpr_read_b32 v87, a247
buffer_load_dwordx4 a[180:183], v1, s[4:7], s29 offen offset:1024 sc1
v_mfma_f32_32x32x16_bf16 v[16:31], a[108:111], v[60:63], v[16:31]
ds_read_b128 v[76:79], v4 offset:59392
v_accvgpr_read_b32 v88, a248
v_accvgpr_read_b32 v89, a249
v_accvgpr_read_b32 v90, a250
v_accvgpr_read_b32 v91, a251
s_add_u32 s3, s32, 3
s_waitcnt vmcnt(5)
v_subrev_u32 v170, s3, v170
v_cmp_le_u32 vcc, 13, v170
s_nop 0
s_and_b64 vcc, vcc, s[48:49]
s_cbranch_scc0 L_chk_8_ok
s_mov_b32 s15, 0
L_chk_8:
buffer_load_dword v170, v168, s[4:7], s43 offen sc1
s_waitcnt vmcnt(0)
s_add_u32 s3, s32, 3
v_subrev_u32 v170, s3, v170
v_cmp_le_u32 vcc, 13, v170
s_nop 0
s_and_b64 vcc, vcc, s[48:49]
s_cbranch_scc0 L_chk_8_ok
s_add_u32 s15, s15, 1
s_cmp_lt_u32 s15, 131072
s_cbranch_scc1 L_chk_8
L_chk_8_ok:
s_waitcnt lgkmcnt(3)
v_mfma_f32_32x32x16_bf16 v[32:47], a[0:3], v[64:67], 0
ds_read_b128 v[48:51], v4 offset:8192
v_accvgpr_read_b32 v92, a252
v_accvgpr_read_b32 v93, a253
v_accvgpr_read_b32 v94, a254
v_accvgpr_read_b32 v95, a255
buffer_load_dwordx4 v[136:139], v1, s[4:7], s25 offen sc1
buffer_load_dwordx4 a[184:187], v1, s[4:7], s29 offen offset:2048 sc1
v_mfma_f32_32x32x16_bf16 v[32:47], a[28:31], v[68:71], v[32:47]
ds_read_b128 v[52:55], v4 offset:25600
buffer_load_dwordx4 v1, s[4:7], s31 offen offset:1024 sc1 lds
s_waitcnt lgkmcnt(2)
v_mfma_f32_32x32x16_bf16 v[32:47], a[56:59], v[72:75], v[32:47]
ds_read_b128 v[56:59], v4 offset:43008
buffer_load_dwordx4 v[140:143], v144, s[4:7], s25 offen offset:1024 sc1
v_fma_f32 v16, -v120, v80, v16
v_fma_f32 v17, -v120, v81, v17
v_fma_f32 v18, -v120, v82, v18
v_fma_f32 v19, -v120, v83, v19
v_mfma_f32_32x32x16_bf16 v[32:47], a[84:87], v[76:79], v[32:47]
ds_read_b128 v[60:63], v4 offset:60416
v_fma_f32 v20, -v120, v84, v20
v_fma_f32 v21, -v120, v85, v21
v_fma_f32 v22, -v120, v86, v22
v_fma_f32 v23, -v120, v87, v23
s_waitcnt lgkmcnt(2)
v_mfma_f32_32x32x16_bf16 v[32:47], a[4:7], v[48:51], v[32:47]
ds_read_b128 v[64:67], v4 offset:9216
buffer_load_dwordx4 v1, s[4:7], s31 offen offset:2048 sc1 lds
v_fma_f32 v24, -v120, v88, v24
v_fma_f32 v25, -v120, v89, v25
v_fma_f32 v26, -v120, v90, v26
v_fma_f32 v27, -v120, v91, v27
v_mfma_f32_32x32x16_bf16 v[32:47], a[32:35], v[52:55], v[32:47]
ds_read_b128 v[68:71], v4 offset:26624
buffer_load_dwordx4 a[188:191], v1, s[4:7], s29 offen offset:3072 sc1
v_fma_f32 v28, -v120, v92, v28
v_fma_f32 v29, -v120, v93, v29
v_fma_f32 v30, -v120, v94, v30
s_waitcnt lgkmcnt(2)
v_mfma_f32_32x32x16_bf16 v[32:47], a[60:63], v[56:59], v[32:47]
ds_read_b128 v[72:75], v4 offset:44032
v_fma_f32 v31, -v120, v95, v31
v_mul_f32 v96, v16, v121
v_mul_f32 v97, v17, v121
v_mul_f32 v98, v18, v121
v_mul_f32 v99, v19, v121
v_mfma_f32_32x32x16_bf16 v[32:47], a[88:91], v[60:63], v[32:47]
ds_read_b128 v[76:79], v4 offset:61440
v_mul_f32 v100, v20, v121
v_mul_f32 v101, v21, v121
v_mul_f32 v102, v22, v121
v_mul_f32 v103, v23, v121
s_waitcnt lgkmcnt(2)
v_mfma_f32_32x32x16_bf16 v[32:47], a[8:11], v[64:67], v[32:47]
ds_read_b128 v[48:51], v4 offset:10240
v_exp_f32 v96, v96
v_mul_f32 v16, v16, v24
v_exp_f32 v97, v97
v_mfma_f32_32x32x16_bf16 v[32:47], a[36:39], v[68:71], v[32:47]
s_barrier
ds_read_b128 v[52:55], v4 offset:27648
v_mul_f32 v17, v17, v25
v_exp_f32 v98, v98
s_waitcnt lgkmcnt(2)
v_mfma_f32_32x32x16_bf16 v[32:47], a[64:67], v[72:75], v[32:47]
ds_read_b128 v[56:59], v4 offset:45056
s_add_u32 m0, s23, 4096
s_add_u32 s31, s22, 200704
buffer_load_dwordx4 v1, s[4:7], s31 offen offset:0 sc1 lds
v_mul_f32 v18, v18, v26
v_mfma_f32_32x32x16_bf16 v[32:47], a[92:95], v[76:79], v[32:47]
ds_read_b128 v[60:63], v4 offset:62464
s_add_u32 s29, s30, 20480
buffer_load_dwordx4 a[192:195], v1, s[4:7], s29 offen offset:0 sc1
v_exp_f32 v99, v99
s_waitcnt lgkmcnt(2)
v_mfma_f32_32x32x16_bf16 v[32:47], a[12:15], v[48:51], v[32:47]
ds_read_b128 v[64:67], v4 offset:11264
ds_write_b128 v148, v[80:83] offset:0
v_mul_f32 v19, v19, v27
v_exp_f32 v100, v100
v_mul_f32 v20, v20, v28
v_mfma_f32_32x32x16_bf16 v[32:47], a[40:43], v[52:55], v[32:47]
ds_read_b128 v[68:71], v4 offset:28672
buffer_load_dwordx4 v1, s[4:7], s31 offen offset:1024 sc1 lds
v_exp_f32 v101, v101
v_mul_f32 v21, v21, v29
s_waitcnt lgkmcnt(3)
v_mfma_f32_32x32x16_bf16 v[32:47], a[68:71], v[56:59], v[32:47]
ds_read_b128 v[72:75], v4 offset:46080
ds_write_b128 v148, v[84:87] offset:16
buffer_load_dwordx4 a[196:199], v1, s[4:7], s29 offen offset:1024 sc1
v_exp_f32 v102, v102
v_mul_f32 v22, v22, v30
v_mfma_f32_32x32x16_bf16 v[32:47], a[96:99], v[60:63], v[32:47]
ds_read_b128 v[76:79], v4 offset:63488
v_exp_f32 v103, v103
v_mul_f32 v23, v23, v31
v_fma_f32 v96, v96, v122, v122
s_waitcnt lgkmcnt(3)
v_mfma_f32_32x32x16_bf16 v[32:47], a[16:19], v[64:67], v[32:47]
ds_read_b128 v[48:51], v4 offset:12288
buffer_load_dwordx4 v1, s[4:7], s31 offen offset:2048 sc1 lds
ds_write_b128 v148, v[88:91] offset:32
v_fma_f32 v97, v97, v122, v122
v_fma_f32 v98, v98, v122, v122
v_fma_f32 v99, v99, v122, v122
v_mfma_f32_32x32x16_bf16 v[32:47], a[44:47], v[68:71], v[32:47]
ds_read_b128 v[52:55], v4 offset:29696
buffer_load_dwordx4 a[200:203], v1, s[4:7], s29 offen offset:2048 sc1
v_fma_f32 v100, v100, v122, v122
v_fma_f32 v101, v101, v122, v122
v_fma_f32 v102, v102, v122, v122
s_waitcnt lgkmcnt(3)
v_mfma_f32_32x32x16_bf16 v[32:47], a[72:75], v[72:75], v[32:47]
ds_read_b128 v[56:59], v4 offset:47104
ds_write_b128 v148, v[92:95] offset:48
v_fma_f32 v103, v103, v122, v122
v_rcp_f32 v96, v96
v_mfma_f32_32x32x16_bf16 v[32:47], a[100:103], v[76:79], v[32:47]
ds_read_b128 v[60:63], v4 offset:64512
buffer_load_dwordx4 v1, s[4:7], s31 offen offset:3072 sc1 lds
v_rcp_f32 v97, v97
s_waitcnt lgkmcnt(3)
v_mfma_f32_32x32x16_bf16 v[32:47], a[20:23], v[48:51], v[32:47]
ds_read_b128 v[64:67], v4 offset:13312
v_rcp_f32 v98, v98
v_mul_f32 v16, v16, v96
v_rcp_f32 v99, v99
v_mfma_f32_32x32x16_bf16 v[32:47], a[48:51], v[52:55], v[32:47]
ds_read_b128 v[68:71], v4 offset:30720
buffer_load_dwordx4 a[204:207], v1, s[4:7], s29 offen offset:3072 sc1
v_mul_f32 v17, v17, v97
v_rcp_f32 v100, v100
s_waitcnt lgkmcnt(2)
v_mfma_f32_32x32x16_bf16 v[32:47], a[76:79], v[56:59], v[32:47]
ds_read_b128 v[72:75], v4 offset:48128
v_mul_f32 v18, v18, v98
v_rcp_f32 v101, v101
v_mul_f32 v19, v19, v99
v_mfma_f32_32x32x16_bf16 v[32:47], a[104:107], v[60:63], v[32:47]
s_waitcnt vmcnt(16)
s_barrier
ds_read_b128 v[76:79], v5 offset:0
v_rcp_f32 v102, v102
v_mul_f32 v20, v20, v100
s_waitcnt lgkmcnt(2)
v_mfma_f32_32x32x16_bf16 v[32:47], a[24:27], v[64:67], v[32:47]
ds_read_b128 v[48:51], v4 offset:14336
s_add_u32 m0, s23, 8192
s_add_u32 s31, s22, 204800
buffer_load_dwordx4 v1, s[4:7], s31 offen offset:0 sc1 lds
v_rcp_f32 v103, v103
v_mfma_f32_32x32x16_bf16 v[32:47], a[52:55], v[68:71], v[32:47]
ds_read_b128 v[52:55], v4 offset:31744
v_mul_f32 v21, v21, v101
v_mul_f32 v22, v22, v102
v_mul_f32 v23, v23, v103
v_cvt_pk_bf16_f32 v112, v16, v17
ds_read_b96 v[124:126], v6 offset:512
s_waitcnt lgkmcnt(3)
v_mfma_f32_32x32x16_bf16 v[32:47], a[80:83], v[72:75], v[32:47]
ds_read_b128 v[56:59], v4 offset:49152
s_add_u32 s29, s30, 24576
buffer_load_dwordx4 a[208:211], v1, s[4:7], s29 offen offset:0 sc1
v_cvt_pk_bf16_f32 v113, v18, v19
v_cvt_pk_bf16_f32 v114, v20, v21
v_cvt_pk_bf16_f32 v115, v22, v23
v_mfma_f32_32x32x16_bf16 v[32:47], a[108:111], v[76:79], v[32:47]
ds_read_b128 v[60:63], v5 offset:1024
buffer_load_dwordx4 v1, s[4:7], s31 offen offset:1024 sc1 lds
buffer_store_dwordx4 v[112:115], v119, s[4:7], s26 offen
s_add_u32 s26, s26, 114688
s_waitcnt lgkmcnt(3)
v_mfma_f32_32x32x16_bf16 v[16:31], a[0:3], v[48:51], 0
ds_read_b128 v[64:67], v4 offset:15360
v_mfma_f32_32x32x16_bf16 v[16:31], a[28:31], v[52:55], v[16:31]
ds_read_b128 v[68:71], v4 offset:32768
s_waitcnt lgkmcnt(2)
v_mfma_f32_32x32x16_bf16 v[16:31], a[56:59], v[56:59], v[16:31]
ds_read_b128 v[72:75], v4 offset:50176
buffer_load_dwordx4 v1, s[4:7], s31 offen offset:2048 sc1 lds
buffer_load_dwordx4 a[212:215], v1, s[4:7], s29 offen offset:1024 sc1
v_fma_f32 v32, -v124, v80, v32
v_fma_f32 v33, -v124, v81, v33
v_fma_f32 v34, -v124, v82, v34
v_fma_f32 v35, -v124, v83, v35
v_mfma_f32_32x32x16_bf16 v[16:31], a[84:87], v[60:63], v[16:31]
ds_read_b128 v[76:79], v5 offset:2048
v_fma_f32 v36, -v124, v84, v36
v_fma_f32 v37, -v124, v85, v37
v_fma_f32 v38, -v124, v86, v38
v_fma_f32 v39, -v124, v87, v39
v_fma_f32 v40, -v124, v88, v40
s_waitcnt lgkmcnt(2)
v_mfma_f32_32x32x16_bf16 v[16:31], a[4:7], v[64:67], v[16:31]
ds_read_b128 v[48:51], v4 offset:16384
v_fma_f32 v41, -v124, v89, v41
v_fma_f32 v42, -v124, v90, v42
v_fma_f32 v43, -v124, v91, v43
v_fma_f32 v44, -v124, v92, v44
v_fma_f32 v45, -v124, v93, v45
v_fma_f32 v46, -v124, v94, v46
v_mfma_f32_32x32x16_bf16 v[16:31], a[32:35], v[68:71], v[16:31]
ds_read_b128 v[52:55], v4 offset:33792
v_fma_f32 v47, -v124, v95, v47
v_mul_f32 v96, v32, v125
v_mul_f32 v97, v33, v125
v_mul_f32 v98, v34, v125
v_mul_f32 v99, v35, v125
s_waitcnt lgkmcnt(2)
v_mfma_f32_32x32x16_bf16 v[16:31], a[60:63], v[72:75], v[16:31]
ds_read_b128 v[56:59], v4 offset:51200
v_mul_f32 v100, v36, v125
v_mul_f32 v101, v37, v125
v_mul_f32 v102, v38, v125
v_mul_f32 v103, v39, v125
v_exp_f32 v96, v96
v_mfma_f32_32x32x16_bf16 v[16:31], a[88:91], v[76:79], v[16:31]
ds_read_b128 v[60:63], v5 offset:3072
v_mul_f32 v32, v32, v40
v_exp_f32 v97, v97
v_mul_f32 v33, v33, v41
s_waitcnt lgkmcnt(2)
v_mfma_f32_32x32x16_bf16 v[16:31], a[8:11], v[48:51], v[16:31]
ds_read_b128 v[64:67], v4 offset:0
buffer_load_dwordx4 a[216:219], v1, s[4:7], s29 offen offset:2048 sc1
v_exp_f32 v98, v98
v_mul_f32 v34, v34, v42
v_exp_f32 v99, v99
v_mfma_f32_32x32x16_bf16 v[16:31], a[36:39], v[52:55], v[16:31]
s_waitcnt vmcnt(16)
s_barrier
ds_read_b128 v[68:71], v4 offset:17408
v_mul_f32 v35, v35, v43
v_exp_f32 v100, v100
v_mul_f32 v36, v36, v44
s_waitcnt lgkmcnt(2)
v_mfma_f32_32x32x16_bf16 v[16:31], a[64:67], v[56:59], v[16:31]
ds_read_b128 v[72:75], v4 offset:34816
s_add_u32 m0, s23, 11264
s_add_u32 s31, s22, 0
buffer_load_dwordx4 v1, s[4:7], s31 offen offset:0 sc1 lds
v_exp_f32 v101, v101
v_mul_f32 v37, v37, v45
v_mfma_f32_32x32x16_bf16 v[16:31], a[92:95], v[60:63], v[16:31]
ds_read_b128 v[76:79], v4 offset:52224
buffer_load_dwordx4 a[220:223], v1, s[4:7], s29 offen offset:3072 sc1
v_exp_f32 v102, v102
v_mul_f32 v38, v38, v46
s_waitcnt lgkmcnt(2)
v_mfma_f32_32x32x16_bf16 v[16:31], a[12:15], v[64:67], v[16:31]
ds_read_b128 v[48:51], v4 offset:1024
v_exp_f32 v103, v103
v_mul_f32 v39, v39, v47
v_fma_f32 v96, v96, v126, v126
v_fma_f32 v97, v97, v126, v126
v_fma_f32 v98, v98, v126, v126
v_mfma_f32_32x32x16_bf16 v[16:31], a[40:43], v[68:71], v[16:31]
ds_read_b128 v[52:55], v4 offset:18432
buffer_load_dwordx4 v1, s[4:7], s31 offen offset:1024 sc1 lds
v_fma_f32 v99, v99, v126, v126
v_fma_f32 v100, v100, v126, v126
v_fma_f32 v101, v101, v126, v126
v_fma_f32 v102, v102, v126, v126
s_waitcnt lgkmcnt(2)
v_mfma_f32_32x32x16_bf16 v[16:31], a[68:71], v[72:75], v[16:31]
ds_read_b128 v[56:59], v4 offset:35840
v_fma_f32 v103, v103, v126, v126
v_rcp_f32 v96, v96
v_rcp_f32 v97, v97
v_mfma_f32_32x32x16_bf16 v[16:31], a[96:99], v[76:79], v[16:31]
ds_read_b128 v[60:63], v4 offset:53248
s_add_u32 s29, s30, 28672
buffer_load_dwordx4 a[224:227], v1, s[4:7], s29 offen offset:0 sc1
v_rcp_f32 v98, v98
v_mul_f32 v32, v32, v96
s_waitcnt lgkmcnt(2)
v_mfma_f32_32x32x16_bf16 v[16:31], a[16:19], v[48:51], v[16:31]
ds_read_b128 v[64:67], v4 offset:2048
buffer_load_dwordx4 v1, s[4:7], s31 offen offset:2048 sc1 lds
v_rcp_f32 v99, v99
v_mul_f32 v33, v33, v97
v_rcp_f32 v100, v100
v_mfma_f32_32x32x16_bf16 v[16:31], a[44:47], v[52:55], v[16:31]
ds_read_b128 v[68:71], v4 offset:19456
v_mul_f32 v34, v34, v98
v_rcp_f32 v101, v101
v_mul_f32 v35, v35, v99
s_waitcnt lgkmcnt(2)
v_mfma_f32_32x32x16_bf16 v[16:31], a[72:75], v[56:59], v[16:31]
ds_read_b128 v[72:75], v4 offset:36864
v_rcp_f32 v102, v102
v_mul_f32 v36, v36, v100
v_rcp_f32 v103, v103
v_mul_f32 v37, v37, v101
v_mfma_f32_32x32x16_bf16 v[16:31], a[100:103], v[60:63], v[16:31]
ds_read_b128 v[76:79], v4 offset:54272
buffer_load_dwordx4 v1, s[4:7], s31 offen offset:3072 sc1 lds
v_mul_f32 v38, v38, v102
v_mul_f32 v39, v39, v103
v_cvt_pk_bf16_f32 v112, v32, v33
v_cvt_pk_bf16_f32 v113, v34, v35
s_waitcnt lgkmcnt(2)
v_mfma_f32_32x32x16_bf16 v[16:31], a[20:23], v[64:67], v[16:31]
ds_read_b128 v[48:51], v4 offset:3072
buffer_load_dwordx4 a[228:231], v1, s[4:7], s29 offen offset:1024 sc1
v_cvt_pk_bf16_f32 v114, v36, v37
v_cvt_pk_bf16_f32 v115, v38, v39
buffer_store_dwordx4 v[112:115], v119, s[4:7], s26 offen
s_add_u32 s26, s26, 114688
v_add_f32 v136, v136, v140
v_mfma_f32_32x32x16_bf16 v[16:31], a[48:51], v[68:71], v[16:31]
ds_read_b128 v[52:55], v4 offset:20480
v_add_f32 v137, v137, v141
v_add_f32 v138, v138, v142
v_add_f32 v139, v139, v143
s_nop 0
v_permlane32_swap_b32 v136, v138
v_permlane32_swap_b32 v137, v139
s_waitcnt lgkmcnt(2)
v_mfma_f32_32x32x16_bf16 v[16:31], a[76:79], v[72:75], v[16:31]
ds_read_b128 v[56:59], v4 offset:37888
v_add_f32 v136, v136, v138
v_add_f32 v137, v137, v139
s_nop 1
v_permlane16_swap_b32 v136, v137
v_mfma_f32_32x32x16_bf16 v[16:31], a[104:107], v[76:79], v[16:31]
s_waitcnt vmcnt(16)
s_barrier
ds_read_b128 v[60:63], v4 offset:55296
s_waitcnt lgkmcnt(2)
v_mfma_f32_32x32x16_bf16 v[16:31], a[24:27], v[48:51], v[16:31]
ds_read_b128 v[64:67], v4 offset:4096
s_add_u32 m0, s23, 15360
s_add_u32 s31, s22, 4096
buffer_load_dwordx4 v1, s[4:7], s31 offen offset:0 sc1 lds
v_mfma_f32_32x32x16_bf16 v[16:31], a[52:55], v[52:55], v[16:31]
ds_read_b128 v[68:71], v4 offset:21504
ds_read_b96 v[120:122], v6 offset:1024
s_waitcnt lgkmcnt(3)
v_mfma_f32_32x32x16_bf16 v[16:31], a[80:83], v[56:59], v[16:31]
ds_read_b128 v[72:75], v4 offset:38912
buffer_load_dwordx4 a[232:235], v1, s[4:7], s29 offen offset:2048 sc1
v_mfma_f32_32x32x16_bf16 v[16:31], a[108:111], v[60:63], v[16:31]
ds_read_b128 v[76:79], v4 offset:56320
buffer_load_dwordx4 v1, s[4:7], s31 offen offset:1024 sc1 lds
s_waitcnt lgkmcnt(3)
v_mfma_f32_32x32x16_bf16 v[32:47], a[0:3], v[64:67], 0
ds_read_b128 v[48:51], v4 offset:5120
buffer_load_dwordx4 a[236:239], v1, s[4:7], s29 offen offset:3072 sc1
v_mfma_f32_32x32x16_bf16 v[32:47], a[28:31], v[68:71], v[32:47]
ds_read_b128 v[52:55], v4 offset:22528
s_waitcnt lgkmcnt(2)
v_mfma_f32_32x32x16_bf16 v[32:47], a[56:59], v[72:75], v[32:47]
ds_read_b128 v[56:59], v4 offset:39936
s_add_u32 m0, s23, 0
s_add_u32 s31, s22, 6144
buffer_load_dwordx4 v1, s[4:7], s31 offen offset:0 sc1 lds
v_fma_f32 v16, -v120, v80, v16
v_fma_f32 v17, -v120, v81, v17
v_fma_f32 v18, -v120, v82, v18
v_mfma_f32_32x32x16_bf16 v[32:47], a[84:87], v[76:79], v[32:47]
ds_read_b128 v[60:63], v4 offset:57344
v_fma_f32 v19, -v120, v83, v19
v_fma_f32 v20, -v120, v84, v20
v_fma_f32 v21, -v120, v85, v21
v_fma_f32 v22, -v120, v86, v22
v_fma_f32 v23, -v120, v87, v23
s_waitcnt lgkmcnt(2)
v_mfma_f32_32x32x16_bf16 v[32:47], a[4:7], v[48:51], v[32:47]
ds_read_b128 v[64:67], v4 offset:6144
v_fma_f32 v24, -v120, v88, v24
v_fma_f32 v25, -v120, v89, v25
v_fma_f32 v26, -v120, v90, v26
v_fma_f32 v27, -v120, v91, v27
v_fma_f32 v28, -v120, v92, v28
v_fma_f32 v29, -v120, v93, v29
v_mfma_f32_32x32x16_bf16 v[32:47], a[32:35], v[52:55], v[32:47]
ds_read_b128 v[68:71], v4 offset:23552
s_add_u32 s29, s30, 32768
buffer_load_dwordx4 a[240:243], v1, s[4:7], s29 offen offset:0 sc1
v_fma_f32 v30, -v120, v94, v30
v_fma_f32 v31, -v120, v95, v31
v_mul_f32 v96, v16, v121
s_waitcnt lgkmcnt(2)
v_mfma_f32_32x32x16_bf16 v[32:47], a[60:63], v[56:59], v[32:47]
ds_read_b128 v[72:75], v4 offset:40960
v_mul_f32 v97, v17, v121
v_mul_f32 v98, v18, v121
v_mul_f32 v99, v19, v121
v_mul_f32 v100, v20, v121
v_mul_f32 v101, v21, v121
v_mul_f32 v102, v22, v121
v_mfma_f32_32x32x16_bf16 v[32:47], a[88:91], v[60:63], v[32:47]
ds_read_b128 v[76:79], v4 offset:58368
v_mul_f32 v103, v23, v121
v_exp_f32 v96, v96
v_mul_f32 v16, v16, v24
s_waitcnt lgkmcnt(2)
v_mfma_f32_32x32x16_bf16 v[32:47], a[8:11], v[64:67], v[32:47]
ds_read_b128 v[48:51], v4 offset:7168
v_exp_f32 v97, v97
v_mul_f32 v17, v17, v25
v_exp_f32 v98, v98
v_mul_f32 v18, v18, v26
v_mfma_f32_32x32x16_bf16 v[32:47], a[36:39], v[68:71], v[32:47]
s_waitcnt vmcnt(16)
s_barrier
ds_read_b128 v[52:55], v4 offset:24576
v_exp_f32 v99, v99
v_mul_f32 v19, v19, v27
s_waitcnt lgkmcnt(2)
v_mfma_f32_32x32x16_bf16 v[32:47], a[64:67], v[72:75], v[32:47]
ds_read_b128 v[56:59], v4 offset:41984
s_add_u32 m0, s23, 1024
s_add_u32 s31, s22, 28672
buffer_load_dwordx4 v1, s[4:7], s31 offen offset:0 sc1 lds
PG_A_4:
s_cbranch_execz PG_A_ret
v_exp_f32 v100, v100
v_mul_f32 v20, v20, v28
v_mfma_f32_32x32x16_bf16 v[32:47], a[92:95], v[76:79], v[32:47]
ds_read_b128 v[60:63], v4 offset:59392
buffer_load_dwordx4 a[244:247], v1, s[4:7], s29 offen offset:1024 sc1
v_exp_f32 v101, v101
v_mul_f32 v21, v21, v29
s_waitcnt lgkmcnt(2)
v_mfma_f32_32x32x16_bf16 v[32:47], a[12:15], v[48:51], v[32:47]
ds_read_b128 v[64:67], v4 offset:8192
v_exp_f32 v102, v102
v_mul_f32 v22, v22, v30
v_exp_f32 v103, v103
v_mul_f32 v23, v23, v31
v_mfma_f32_32x32x16_bf16 v[32:47], a[40:43], v[52:55], v[32:47]
ds_read_b128 v[68:71], v4 offset:25600
buffer_load_dwordx4 v1, s[4:7], s31 offen offset:1024 sc1 lds
v_fma_f32 v96, v96, v122, v122
v_fma_f32 v97, v97, v122, v122
v_fma_f32 v98, v98, v122, v122
v_fma_f32 v99, v99, v122, v122
s_waitcnt lgkmcnt(2)
v_mfma_f32_32x32x16_bf16 v[32:47], a[68:71], v[56:59], v[32:47]
ds_read_b128 v[72:75], v4 offset:43008
buffer_load_dwordx4 a[248:251], v1, s[4:7], s29 offen offset:2048 sc1
v_fma_f32 v100, v100, v122, v122
v_fma_f32 v101, v101, v122, v122
v_fma_f32 v102, v102, v122, v122
v_fma_f32 v103, v103, v122, v122
v_mfma_f32_32x32x16_bf16 v[32:47], a[96:99], v[60:63], v[32:47]
ds_read_b128 v[76:79], v4 offset:60416
v_rcp_f32 v96, v96
v_rcp_f32 v97, v97
s_waitcnt lgkmcnt(2)
v_mfma_f32_32x32x16_bf16 v[32:47], a[16:19], v[64:67], v[32:47]
ds_read_b128 v[48:51], v4 offset:9216
buffer_load_dwordx4 v1, s[4:7], s31 offen offset:2048 sc1 lds
v_rcp_f32 v98, v98
v_mul_f32 v16, v16, v96
v_rcp_f32 v99, v99
v_mfma_f32_32x32x16_bf16 v[32:47], a[44:47], v[68:71], v[32:47]
ds_read_b128 v[52:55], v4 offset:26624
buffer_load_dwordx4 a[252:255], v1, s[4:7], s29 offen offset:3072 sc1
v_mul_f32 v17, v17, v97
v_rcp_f32 v100, v100
v_mul_f32 v18, v18, v98
s_waitcnt lgkmcnt(2)
v_mfma_f32_32x32x16_bf16 v[32:47], a[72:75], v[72:75], v[32:47]
ds_read_b128 v[56:59], v4 offset:44032
v_rcp_f32 v101, v101
v_mul_f32 v19, v19, v99
v_rcp_f32 v102, v102
v_mul_f32 v20, v20, v100
v_mfma_f32_32x32x16_bf16 v[32:47], a[100:103], v[76:79], v[32:47]
ds_read_b128 v[60:63], v4 offset:61440
buffer_load_dwordx4 v1, s[4:7], s31 offen offset:3072 sc1 lds
v_rcp_f32 v103, v103
v_mul_f32 v21, v21, v101
v_mul_f32 v22, v22, v102
s_waitcnt lgkmcnt(2)
v_mfma_f32_32x32x16_bf16 v[32:47], a[20:23], v[48:51], v[32:47]
ds_read_b128 v[64:67], v4 offset:10240
v_mul_f32 v23, v23, v103
v_cvt_pk_bf16_f32 v112, v16, v17
v_cvt_pk_bf16_f32 v113, v18, v19
v_cvt_pk_bf16_f32 v114, v20, v21
v_cvt_pk_bf16_f32 v115, v22, v23
buffer_store_dwordx4 v[112:115], v119, s[4:7], s26 offen
v_mfma_f32_32x32x16_bf16 v[32:47], a[48:51], v[52:55], v[32:47]
ds_read_b128 v[68:71], v4 offset:27648
s_add_u32 s29, s30, 36864
buffer_load_dwordx4 v[176:179], v1, s[4:7], s29 offen offset:0 sc1
s_add_u32 s26, s26, 114688
v_add_f32 v136, v136, v137
v_mul_f32 v136, 0x3b124925, v136
s_waitcnt lgkmcnt(2)
v_mfma_f32_32x32x16_bf16 v[32:47], a[76:79], v[56:59], v[32:47]
ds_read_b128 v[72:75], v4 offset:45056
v_mov_b32_dpp v137, v136 row_ror:8 row_mask:0xf bank_mask:0xf
v_fma_f32 v137, -v136, v136, v137
v_max_f32 v137, 0, v137
v_add_f32 v137, 0x3727c5ac, v137
v_rsq_f32 v139, v137
v_mfma_f32_32x32x16_bf16 v[32:47], a[104:107], v[60:63], v[32:47]
s_waitcnt vmcnt(17)
s_barrier
ds_read_b128 v[76:79], v4 offset:62464
v_mov_b32 v138, v137
v_mul_f32 v137, 0xbfb8aa3b, v139
s_waitcnt lgkmcnt(2)
v_mfma_f32_32x32x16_bf16 v[32:47], a[24:27], v[64:67], v[32:47]
ds_read_b128 v[48:51], v4 offset:11264
s_add_u32 m0, s23, 5120
s_add_u32 s31, s22, 32768
buffer_load_dwordx4 v1, s[4:7], s31 offen offset:0 sc1 lds
s_mov_b32 exec_lo, 0x00ff00ff
s_mov_b32 exec_hi, 0x00ff00ff
ds_write_b96 v145, v[136:138] offset:2048
s_mov_b64 exec, -1
v_mfma_f32_32x32x16_bf16 v[32:47], a[52:55], v[68:71], v[32:47]
ds_read_b128 v[52:55], v4 offset:28672
ds_read_b96 v[124:126], v6 offset:1536
s_waitcnt lgkmcnt(4)
v_mfma_f32_32x32x16_bf16 v[32:47], a[80:83], v[72:75], v[32:47]
ds_read_b128 v[56:59], v4 offset:46080
buffer_load_dwordx4 v[180:183], v1, s[4:7], s29 offen offset:1024 sc1
v_mfma_f32_32x32x16_bf16 v[32:47], a[108:111], v[76:79], v[32:47]
ds_read_b128 v[60:63], v4 offset:63488
buffer_load_dwordx4 v1, s[4:7], s31 offen offset:1024 sc1 lds
s_waitcnt lgkmcnt(3)
v_mfma_f32_32x32x16_bf16 v[16:31], a[0:3], v[48:51], 0
ds_read_b128 v[64:67], v4 offset:12288
v_mfma_f32_32x32x16_bf16 v[16:31], a[28:31], v[52:55], v[16:31]
ds_read_b128 v[68:71], v4 offset:29696
s_waitcnt lgkmcnt(2)
v_mfma_f32_32x32x16_bf16 v[16:31], a[56:59], v[56:59], v[16:31]
ds_read_b128 v[72:75], v4 offset:47104
buffer_load_dwordx4 v1, s[4:7], s31 offen offset:2048 sc1 lds
buffer_load_dwordx4 v[184:187], v1, s[4:7], s29 offen offset:2048 sc1
v_fma_f32 v32, -v124, v80, v32
v_fma_f32 v33, -v124, v81, v33
v_fma_f32 v34, -v124, v82, v34
v_mfma_f32_32x32x16_bf16 v[16:31], a[84:87], v[60:63], v[16:31]
ds_read_b128 v[76:79], v4 offset:64512
v_fma_f32 v35, -v124, v83, v35
v_fma_f32 v36, -v124, v84, v36
v_fma_f32 v37, -v124, v85, v37
v_fma_f32 v38, -v124, v86, v38
s_waitcnt lgkmcnt(2)
v_mfma_f32_32x32x16_bf16 v[16:31], a[4:7], v[64:67], v[16:31]
ds_read_b128 v[48:51], v4 offset:13312
v_fma_f32 v39, -v124, v87, v39
v_fma_f32 v40, -v124, v88, v40
v_fma_f32 v41, -v124, v89, v41
v_fma_f32 v42, -v124, v90, v42
v_fma_f32 v43, -v124, v91, v43
v_mfma_f32_32x32x16_bf16 v[16:31], a[32:35], v[68:71], v[16:31]
ds_read_b128 v[52:55], v4 offset:30720
v_fma_f32 v44, -v124, v92, v44
v_fma_f32 v45, -v124, v93, v45
v_fma_f32 v46, -v124, v94, v46
v_fma_f32 v47, -v124, v95, v47
s_waitcnt lgkmcnt(2)
v_mfma_f32_32x32x16_bf16 v[16:31], a[60:63], v[72:75], v[16:31]
ds_read_b128 v[56:59], v4 offset:48128
v_mul_f32 v96, v32, v125
v_mul_f32 v97, v33, v125
v_mul_f32 v98, v34, v125
v_mul_f32 v99, v35, v125
v_mul_f32 v100, v36, v125
v_mfma_f32_32x32x16_bf16 v[16:31], a[88:91], v[76:79], v[16:31]
ds_read_b128 v[60:63], v5 offset:0
v_mul_f32 v101, v37, v125
v_mul_f32 v102, v38, v125
v_mul_f32 v103, v39, v125
s_waitcnt lgkmcnt(2)
v_mfma_f32_32x32x16_bf16 v[16:31], a[8:11], v[48:51], v[16:31]
ds_read_b128 v[64:67], v4 offset:14336
buffer_load_dwordx4 v[188:191], v1, s[4:7], s29 offen offset:3072 sc1
v_exp_f32 v96, v96
v_mul_f32 v32, v32, v40
v_mfma_f32_32x32x16_bf16 v[16:31], a[36:39], v[52:55], v[16:31]
s_waitcnt vmcnt(16)
s_barrier
ds_read_b128 v[68:71], v4 offset:31744
v_exp_f32 v97, v97
v_mul_f32 v33, v33, v41
s_waitcnt lgkmcnt(2)
v_mfma_f32_32x32x16_bf16 v[16:31], a[64:67], v[56:59], v[16:31]
ds_read_b128 v[72:75], v4 offset:49152
s_add_u32 m0, s23, 8192
s_add_u32 s31, s22, 57344
buffer_load_dwordx4 v1, s[4:7], s31 offen offset:0 sc1 lds
v_exp_f32 v98, v98
v_mfma_f32_32x32x16_bf16 v[16:31], a[92:95], v[60:63], v[16:31]
ds_read_b128 v[76:79], v5 offset:1024
s_add_u32 s29, s30, 40960
buffer_load_dwordx4 v[192:195], v1, s[4:7], s29 offen offset:0 sc1
v_mul_f32 v34, v34, v42
s_waitcnt lgkmcnt(2)
v_mfma_f32_32x32x16_bf16 v[16:31], a[12:15], v[64:67], v[16:31]
ds_read_b128 v[48:51], v4 offset:15360
v_exp_f32 v99, v99
v_mul_f32 v35, v35, v43
v_exp_f32 v100, v100
v_mfma_f32_32x32x16_bf16 v[16:31], a[40:43], v[68:71], v[16:31]
ds_read_b128 v[52:55], v4 offset:32768
buffer_load_dwordx4 v1, s[4:7], s31 offen offset:1024 sc1 lds
v_mul_f32 v36, v36, v44
v_exp_f32 v101, v101
s_waitcnt lgkmcnt(2)
v_mfma_f32_32x32x16_bf16 v[16:31], a[68:71], v[72:75], v[16:31]
ds_read_b128 v[56:59], v4 offset:50176
buffer_load_dwordx4 v[8:11], v147, s[4:7], s64 offen sc1
v_mul_f32 v37, v37, v45
v_exp_f32 v102, v102
v_mul_f32 v38, v38, v46
v_mfma_f32_32x32x16_bf16 v[16:31], a[96:99], v[76:79], v[16:31]
ds_read_b128 v[60:63], v5 offset:2048
buffer_load_dwordx4 v[196:199], v1, s[4:7], s29 offen offset:1024 sc1
v_exp_f32 v103, v103
v_mul_f32 v39, v39, v47
s_waitcnt lgkmcnt(2)
v_mfma_f32_32x32x16_bf16 v[16:31], a[16:19], v[48:51], v[16:31]
ds_read_b128 v[64:67], v4 offset:16384
buffer_load_dwordx4 v1, s[4:7], s31 offen offset:2048 sc1 lds
v_fma_f32 v96, v96, v126, v126
v_fma_f32 v97, v97, v126, v126
v_fma_f32 v98, v98, v126, v126
v_fma_f32 v99, v99, v126, v126
v_mfma_f32_32x32x16_bf16 v[16:31], a[44:47], v[52:55], v[16:31]
ds_read_b128 v[68:71], v4 offset:33792
v_fma_f32 v100, v100, v126, v126
v_fma_f32 v101, v101, v126, v126
v_fma_f32 v102, v102, v126, v126
v_fma_f32 v103, v103, v126, v126
s_waitcnt lgkmcnt(2)
v_mfma_f32_32x32x16_bf16 v[16:31], a[72:75], v[56:59], v[16:31]
ds_read_b128 v[72:75], v4 offset:51200
buffer_load_dwordx4 v[12:15], v147, s[4:7], s66 offen sc1
v_rcp_f32 v96, v96
v_rcp_f32 v97, v97
v_mfma_f32_32x32x16_bf16 v[16:31], a[100:103], v[60:63], v[16:31]
ds_read_b128 v[76:79], v5 offset:3072
buffer_load_dwordx4 v1, s[4:7], s31 offen offset:3072 sc1 lds
v_rcp_f32 v98, v98
v_mul_f32 v32, v32, v96
s_waitcnt lgkmcnt(2)
v_mfma_f32_32x32x16_bf16 v[16:31], a[20:23], v[64:67], v[16:31]
ds_read_b128 v[48:51], v4 offset:0
buffer_load_dwordx4 v[200:203], v1, s[4:7], s29 offen offset:2048 sc1
v_rcp_f32 v99, v99
v_mul_f32 v33, v33, v97
v_mfma_f32_32x32x16_bf16 v[16:31], a[48:51], v[68:71], v[16:31]
ds_read_b128 v[52:55], v4 offset:17408
buffer_load_dwordx4 v[204:207], v1, s[4:7], s29 offen offset:3072 sc1
v_rcp_f32 v100, v100
v_mul_f32 v34, v34, v98
s_waitcnt lgkmcnt(2)
v_mfma_f32_32x32x16_bf16 v[16:31], a[76:79], v[72:75], v[16:31]
ds_read_b128 v[56:59], v4 offset:34816
v_rcp_f32 v101, v101
v_mul_f32 v35, v35, v99
v_rcp_f32 v102, v102
v_mfma_f32_32x32x16_bf16 v[16:31], a[104:107], v[76:79], v[16:31]
s_waitcnt vmcnt(18)
s_barrier
ds_read_b128 v[60:63], v4 offset:52224
v_mul_f32 v36, v36, v100
v_rcp_f32 v103, v103
s_waitcnt lgkmcnt(2)
v_mfma_f32_32x32x16_bf16 v[16:31], a[24:27], v[48:51], v[16:31]
ds_read_b128 v[64:67], v4 offset:1024
s_add_u32 m0, s23, 12288
s_add_u32 s31, s22, 61440
buffer_load_dwordx4 v1, s[4:7], s31 offen offset:0 sc1 lds
v_mul_f32 v37, v37, v101
v_mul_f32 v38, v38, v102
v_mfma_f32_32x32x16_bf16 v[16:31], a[52:55], v[52:55], v[16:31]
ds_read_b128 v[68:71], v4 offset:18432
v_mul_f32 v39, v39, v103
v_cvt_pk_bf16_f32 v112, v32, v33
v_cvt_pk_bf16_f32 v113, v34, v35
v_cvt_pk_bf16_f32 v114, v36, v37
ds_read_b96 v[120:122], v6 offset:2048
s_waitcnt lgkmcnt(3)
v_mfma_f32_32x32x16_bf16 v[16:31], a[80:83], v[56:59], v[16:31]
ds_read_b128 v[72:75], v4 offset:35840
v_cvt_pk_bf16_f32 v115, v38, v39
buffer_store_dwordx4 v[112:115], v119, s[4:7], s26 offen
s_sub_u32 s26, s26, 802816
v_mfma_f32_32x32x16_bf16 v[16:31], a[108:111], v[60:63], v[16:31]
ds_read_b128 v[76:79], v4 offset:53248
buffer_load_dwordx4 v1, s[4:7], s31 offen offset:1024 sc1 lds
s_waitcnt lgkmcnt(3)
v_mfma_f32_32x32x16_bf16 v[32:47], a[0:3], v[64:67], 0
ds_read_b128 v[48:51], v4 offset:2048
s_add_u32 s29, s30, 45056
buffer_load_dwordx4 v[208:211], v1, s[4:7], s29 offen offset:0 sc1
v_mfma_f32_32x32x16_bf16 v[32:47], a[28:31], v[68:71], v[32:47]
ds_read_b128 v[52:55], v4 offset:19456
s_waitcnt lgkmcnt(2)
v_mfma_f32_32x32x16_bf16 v[32:47], a[56:59], v[72:75], v[32:47]
ds_read_b128 v[56:59], v4 offset:36864
buffer_load_dwordx4 v1, s[4:7], s31 offen offset:2048 sc1 lds
v_fma_f32 v16, -v120, v80, v16
v_fma_f32 v17, -v120, v81, v17
v_fma_f32 v18, -v120, v82, v18
v_fma_f32 v19, -v120, v83, v19
v_mfma_f32_32x32x16_bf16 v[32:47], a[84:87], v[76:79], v[32:47]
ds_read_b128 v[60:63], v4 offset:54272
v_fma_f32 v20, -v120, v84, v20
v_fma_f32 v21, -v120, v85, v21
v_fma_f32 v22, -v120, v86, v22
v_fma_f32 v23, -v120, v87, v23
s_waitcnt lgkmcnt(2)
v_mfma_f32_32x32x16_bf16 v[32:47], a[4:7], v[48:51], v[32:47]
ds_read_b128 v[64:67], v4 offset:3072
v_fma_f32 v24, -v120, v88, v24
v_fma_f32 v25, -v120, v89, v25
v_fma_f32 v26, -v120, v90, v26
v_fma_f32 v27, -v120, v91, v27
v_fma_f32 v28, -v120, v92, v28
v_mfma_f32_32x32x16_bf16 v[32:47], a[32:35], v[52:55], v[32:47]
ds_read_b128 v[68:71], v4 offset:20480
buffer_load_dwordx4 v[212:215], v1, s[4:7], s29 offen offset:1024 sc1
v_fma_f32 v29, -v120, v93, v29
v_fma_f32 v30, -v120, v94, v30
v_fma_f32 v31, -v120, v95, v31
s_waitcnt lgkmcnt(2)
v_mfma_f32_32x32x16_bf16 v[32:47], a[60:63], v[56:59], v[32:47]
ds_read_b128 v[72:75], v4 offset:37888
v_mul_f32 v96, v16, v121
v_mul_f32 v97, v17, v121
v_mul_f32 v98, v18, v121
v_mul_f32 v99, v19, v121
v_mul_f32 v100, v20, v121
v_mfma_f32_32x32x16_bf16 v[32:47], a[88:91], v[60:63], v[32:47]
ds_read_b128 v[76:79], v4 offset:55296
v_mul_f32 v101, v21, v121
v_mul_f32 v102, v22, v121
v_mul_f32 v103, v23, v121
s_waitcnt lgkmcnt(2)
v_mfma_f32_32x32x16_bf16 v[32:47], a[8:11], v[64:67], v[32:47]
ds_read_b128 v[48:51], v4 offset:4096
v_exp_f32 v96, v96
v_mul_f32 v16, v16, v24
v_exp_f32 v97, v97
v_mfma_f32_32x32x16_bf16 v[32:47], a[36:39], v[68:71], v[32:47]
s_waitcnt vmcnt(4)
s_barrier
ds_read_b128 v[52:55], v4 offset:21504
v_mul_f32 v17, v17, v25
v_exp_f32 v98, v98
s_waitcnt lgkmcnt(2)
v_mfma_f32_32x32x16_bf16 v[32:47], a[64:67], v[72:75], v[32:47]
ds_read_b128 v[56:59], v4 offset:38912
s_add_u32 m0, s23, 15360
s_add_u32 s31, s22, 86016
buffer_load_dwordx4 v1, s[4:7], s31 offen offset:0 sc1 lds
v_mul_f32 v18, v18, v26
v_mfma_f32_32x32x16_bf16 v[32:47], a[92:95], v[76:79], v[32:47]
ds_read_b128 v[60:63], v4 offset:56320
s_add_u32 s3, s32, 4
v_bfrev_b32 v116, 1
v_mov_b32 v117, s3
v_writelane_b32 v116, s50, 0
buffer_store_dword v117, v116, s[4:7], s46 offen
s_waitcnt lgkmcnt(2)
v_mfma_f32_32x32x16_bf16 v[32:47], a[12:15], v[48:51], v[32:47]
ds_read_b128 v[64:67], v4 offset:5120
v_exp_f32 v99, v99
v_mul_f32 v19, v19, v27
v_exp_f32 v100, v100
v_mfma_f32_32x32x16_bf16 v[32:47], a[40:43], v[52:55], v[32:47]
ds_read_b128 v[68:71], v4 offset:22528
buffer_load_dwordx4 v1, s[4:7], s31 offen offset:1024 sc1 lds
v_mul_f32 v20, v20, v28
v_exp_f32 v101, v101
s_waitcnt lgkmcnt(2)
v_mfma_f32_32x32x16_bf16 v[32:47], a[68:71], v[56:59], v[32:47]
ds_read_b128 v[72:75], v4 offset:39936
v_mul_f32 v21, v21, v29
v_exp_f32 v102, v102
v_mul_f32 v22, v22, v30
v_mfma_f32_32x32x16_bf16 v[32:47], a[96:99], v[60:63], v[32:47]
ds_read_b128 v[76:79], v4 offset:57344
v_exp_f32 v103, v103
v_mul_f32 v23, v23, v31
v_fma_f32 v96, v96, v122, v122
s_waitcnt lgkmcnt(2)
v_mfma_f32_32x32x16_bf16 v[32:47], a[16:19], v[64:67], v[32:47]
ds_read_b128 v[48:51], v4 offset:6144
s_add_u32 m0, s23, 0
s_add_u32 s31, s22, 88064
buffer_load_dwordx4 v1, s[4:7], s31 offen offset:0 sc1 lds
v_fma_f32 v97, v97, v122, v122
v_fma_f32 v98, v98, v122, v122
v_mfma_f32_32x32x16_bf16 v[32:47], a[44:47], v[68:71], v[32:47]
ds_read_b128 v[52:55], v4 offset:23552
v_fma_f32 v99, v99, v122, v122
v_fma_f32 v100, v100, v122, v122
v_fma_f32 v101, v101, v122, v122
v_fma_f32 v102, v102, v122, v122
s_waitcnt lgkmcnt(2)
v_mfma_f32_32x32x16_bf16 v[32:47], a[72:75], v[72:75], v[32:47]
ds_read_b128 v[56:59], v4 offset:40960
v_fma_f32 v103, v103, v122, v122
v_rcp_f32 v96, v96
v_rcp_f32 v97, v97
v_mfma_f32_32x32x16_bf16 v[32:47], a[100:103], v[76:79], v[32:47]
ds_read_b128 v[60:63], v4 offset:58368
buffer_load_dwordx4 v1, s[4:7], s31 offen offset:1024 sc1 lds
v_rcp_f32 v98, v98
v_mul_f32 v16, v16, v96
s_waitcnt lgkmcnt(2)
v_mfma_f32_32x32x16_bf16 v[32:47], a[20:23], v[48:51], v[32:47]
ds_read_b128 v[64:67], v4 offset:7168
v_rcp_f32 v99, v99
v_mul_f32 v17, v17, v97
v_rcp_f32 v100, v100
v_mfma_f32_32x32x16_bf16 v[32:47], a[48:51], v[52:55], v[32:47]
ds_read_b128 v[68:71], v4 offset:24576
v_mul_f32 v18, v18, v98
v_rcp_f32 v101, v101
v_mul_f32 v19, v19, v99
s_waitcnt lgkmcnt(2)
v_mfma_f32_32x32x16_bf16 v[32:47], a[76:79], v[56:59], v[32:47]
ds_read_b128 v[72:75], v4 offset:41984
v_rcp_f32 v102, v102
v_mul_f32 v20, v20, v100
v_rcp_f32 v103, v103
v_mfma_f32_32x32x16_bf16 v[32:47], a[104:107], v[60:63], v[32:47]
s_barrier
ds_read_b128 v[76:79], v4 offset:59392
v_mul_f32 v21, v21, v101
v_mul_f32 v22, v22, v102
v_mul_f32 v23, v23, v103
s_waitcnt lgkmcnt(2)
v_mfma_f32_32x32x16_bf16 v[32:47], a[24:27], v[64:67], v[32:47]
ds_read_b128 v[48:51], v4 offset:8192
s_add_u32 m0, s23, 2048
s_add_u32 s31, s22, 90112
buffer_load_dwordx4 v1, s[4:7], s31 offen offset:0 sc1 lds
v_lshlrev_b32 v172, 2, v0
buffer_load_dword v174, v172, s[4:7], s43 offen sc1
v_mfma_f32_32x32x16_bf16 v[32:47], a[52:55], v[68:71], v[32:47]
ds_read_b128 v[52:55], v4 offset:25600
v_cvt_pk_bf16_f32 v112, v16, v17
v_cvt_pk_bf16_f32 v113, v18, v19
v_cvt_pk_bf16_f32 v114, v20, v21
v_cvt_pk_bf16_f32 v115, v22, v23
ds_read_b96 v[124:126], v6 offset:2560
s_waitcnt lgkmcnt(3)
v_mfma_f32_32x32x16_bf16 v[32:47], a[80:83], v[72:75], v[32:47]
ds_read_b128 v[56:59], v4 offset:43008
buffer_store_dwordx4 v[112:115], v119, s[4:7], s26 offen
s_add_u32 s26, s26, 114688
v_mfma_f32_32x32x16_bf16 v[32:47], a[108:111], v[76:79], v[32:47]
ds_read_b128 v[60:63], v4 offset:60416
buffer_load_dwordx4 v1, s[4:7], s31 offen offset:1024 sc1 lds
s_waitcnt lgkmcnt(3)
v_mfma_f32_32x32x16_bf16 v[16:31], a[0:3], v[48:51], 0
ds_read_b128 v[64:67], v4 offset:9216
v_mfma_f32_32x32x16_bf16 v[16:31], a[28:31], v[52:55], v[16:31]
ds_read_b128 v[68:71], v4 offset:26624
s_waitcnt lgkmcnt(2)
v_mfma_f32_32x32x16_bf16 v[16:31], a[56:59], v[56:59], v[16:31]
ds_read_b128 v[72:75], v4 offset:44032
buffer_load_dwordx4 v1, s[4:7], s31 offen offset:2048 sc1 lds
s_nop 0
v_fma_f32 v32, -v124, v80, v32
v_fma_f32 v33, -v124, v81, v33
v_fma_f32 v34, -v124, v82, v34
v_fma_f32 v35, -v124, v83, v35
v_mfma_f32_32x32x16_bf16 v[16:31], a[84:87], v[60:63], v[16:31]
ds_read_b128 v[76:79], v4 offset:61440
s_add_u32 s3, s32, 4
s_waitcnt vmcnt(3)
v_subrev_u32 v174, s3, v174
v_cmp_le_u32 vcc, 12, v174
s_nop 0
s_and_b64 vcc, vcc, s[48:49]
s_cbranch_scc0 L_chk_9_ok
s_mov_b32 s15, 0
L_chk_9:
buffer_load_dword v174, v172, s[4:7], s43 offen sc1
s_waitcnt vmcnt(0)
s_add_u32 s3, s32, 4
v_subrev_u32 v174, s3, v174
v_cmp_le_u32 vcc, 12, v174
s_nop 0
s_and_b64 vcc, vcc, s[48:49]
s_cbranch_scc0 L_chk_9_ok
s_add_u32 s15, s15, 1
s_cmp_lt_u32 s15, 131072
s_cbranch_scc1 L_chk_9
L_chk_9_ok:
s_waitcnt lgkmcnt(2)
v_mfma_f32_32x32x16_bf16 v[16:31], a[4:7], v[64:67], v[16:31]
ds_read_b128 v[48:51], v4 offset:10240
buffer_load_dwordx4 v[128:131], v1, s[4:7], s20 offen offset:0 sc1
v_fma_f32 v36, -v124, v84, v36
v_fma_f32 v37, -v124, v85, v37
v_fma_f32 v38, -v124, v86, v38
v_fma_f32 v39, -v124, v87, v39
v_mfma_f32_32x32x16_bf16 v[16:31], a[32:35], v[68:71], v[16:31]
ds_read_b128 v[52:55], v4 offset:27648
v_fma_f32 v40, -v124, v88, v40
v_fma_f32 v41, -v124, v89, v41
v_fma_f32 v42, -v124, v90, v42
v_fma_f32 v43, -v124, v91, v43
s_waitcnt lgkmcnt(2)
v_mfma_f32_32x32x16_bf16 v[16:31], a[60:63], v[72:75], v[16:31]
ds_read_b128 v[56:59], v4 offset:45056
buffer_load_dwordx4 v[132:135], v1, s[4:7], s68 offen offset:0 sc1
v_fma_f32 v44, -v124, v92, v44
v_fma_f32 v45, -v124, v93, v45
v_fma_f32 v46, -v124, v94, v46
v_fma_f32 v47, -v124, v95, v47
v_mfma_f32_32x32x16_bf16 v[16:31], a[88:91], v[76:79], v[16:31]
ds_read_b128 v[60:63], v4 offset:62464
v_mul_f32 v96, v32, v125
v_mul_f32 v97, v33, v125
v_mul_f32 v98, v34, v125
v_mul_f32 v99, v35, v125
s_waitcnt lgkmcnt(2)
v_mfma_f32_32x32x16_bf16 v[16:31], a[8:11], v[48:51], v[16:31]
ds_read_b128 v[64:67], v4 offset:11264
buffer_load_dwordx4 v[136:139], v1, s[4:7], s20 offen offset:1024 sc1
v_mul_f32 v100, v36, v125
v_mul_f32 v101, v37, v125
v_mul_f32 v102, v38, v125
v_mul_f32 v103, v39, v125
v_mfma_f32_32x32x16_bf16 v[16:31], a[36:39], v[52:55], v[16:31]
s_barrier
ds_read_b128 v[68:71], v4 offset:28672
v_exp_f32 v96, v96
v_mul_f32 v32, v32, v40
s_waitcnt lgkmcnt(2)
v_mfma_f32_32x32x16_bf16 v[16:31], a[64:67], v[56:59], v[16:31]
ds_read_b128 v[72:75], v4 offset:46080
buffer_load_dwordx4 v[140:143], v1, s[4:7], s68 offen offset:1024 sc1
v_exp_f32 v97, v97
v_mul_f32 v33, v33, v41
v_mfma_f32_32x32x16_bf16 v[16:31], a[92:95], v[60:63], v[16:31]
ds_read_b128 v[76:79], v4 offset:63488
v_exp_f32 v98, v98
v_mul_f32 v34, v34, v42
s_waitcnt lgkmcnt(2)
v_mfma_f32_32x32x16_bf16 v[16:31], a[12:15], v[64:67], v[16:31]
ds_read_b128 v[48:51], v4 offset:12288
buffer_load_dwordx4 v[144:147], v1, s[4:7], s20 offen offset:2048 sc1
v_exp_f32 v99, v99
v_mul_f32 v35, v35, v43
v_mfma_f32_32x32x16_bf16 v[16:31], a[40:43], v[68:71], v[16:31]
ds_read_b128 v[52:55], v4 offset:29696
v_exp_f32 v100, v100
v_mul_f32 v36, v36, v44
s_waitcnt lgkmcnt(2)
v_mfma_f32_32x32x16_bf16 v[16:31], a[68:71], v[72:75], v[16:31]
ds_read_b128 v[56:59], v4 offset:47104
buffer_load_dwordx4 v[148:151], v1, s[4:7], s68 offen offset:2048 sc1
v_exp_f32 v101, v101
v_mul_f32 v37, v37, v45
v_mfma_f32_32x32x16_bf16 v[16:31], a[96:99], v[76:79], v[16:31]
ds_read_b128 v[60:63], v4 offset:64512
v_exp_f32 v102, v102
v_mul_f32 v38, v38, v46
s_waitcnt lgkmcnt(2)
v_mfma_f32_32x32x16_bf16 v[16:31], a[16:19], v[48:51], v[16:31]
ds_read_b128 v[64:67], v4 offset:13312
buffer_load_dwordx4 v[152:155], v1, s[4:7], s20 offen offset:3072 sc1
v_exp_f32 v103, v103
v_mul_f32 v39, v39, v47
v_fma_f32 v96, v96, v126, v126
v_mfma_f32_32x32x16_bf16 v[16:31], a[44:47], v[52:55], v[16:31]
ds_read_b128 v[68:71], v4 offset:30720
v_fma_f32 v97, v97, v126, v126
v_fma_f32 v98, v98, v126, v126
v_fma_f32 v99, v99, v126, v126
v_fma_f32 v100, v100, v126, v126
s_waitcnt lgkmcnt(2)
v_mfma_f32_32x32x16_bf16 v[16:31], a[72:75], v[56:59], v[16:31]
ds_read_b128 v[72:75], v4 offset:48128
buffer_load_dwordx4 v[156:159], v1, s[4:7], s68 offen offset:3072 sc1
v_fma_f32 v101, v101, v126, v126
v_fma_f32 v102, v102, v126, v126
v_fma_f32 v103, v103, v126, v126
v_mfma_f32_32x32x16_bf16 v[16:31], a[100:103], v[60:63], v[16:31]
ds_read_b128 v[76:79], v5 offset:0
v_rcp_f32 v96, v96
v_rcp_f32 v97, v97
s_waitcnt lgkmcnt(2)
v_mfma_f32_32x32x16_bf16 v[16:31], a[20:23], v[64:67], v[16:31]
ds_read_b128 v[48:51], v4 offset:14336
s_add_u32 s20, s20, 4096
buffer_load_dwordx4 v[160:163], v1, s[4:7], s20 offen offset:0 sc1
v_rcp_f32 v98, v98
v_mul_f32 v32, v32, v96
v_mfma_f32_32x32x16_bf16 v[16:31], a[48:51], v[68:71], v[16:31]
ds_read_b128 v[52:55], v4 offset:31744
v_rcp_f32 v99, v99
v_mul_f32 v33, v33, v97
s_waitcnt lgkmcnt(2)
v_mfma_f32_32x32x16_bf16 v[16:31], a[76:79], v[72:75], v[16:31]
ds_read_b128 v[56:59], v4 offset:49152
s_add_u32 s68, s68, 4096
buffer_load_dwordx4 v[164:167], v1, s[4:7], s68 offen offset:0 sc1
v_rcp_f32 v100, v100
v_mul_f32 v34, v34, v98
v_mfma_f32_32x32x16_bf16 v[16:31], a[104:107], v[76:79], v[16:31]
s_barrier
ds_read_b128 v[60:63], v5 offset:1024
v_rcp_f32 v101, v101
v_mul_f32 v35, v35, v99
s_waitcnt lgkmcnt(2)
v_mfma_f32_32x32x16_bf16 v[16:31], a[24:27], v[48:51], v[16:31]
ds_read_b128 v[64:67], v4 offset:15360
buffer_load_dwordx4 v[168:171], v1, s[4:7], s20 offen offset:1024 sc1
v_rcp_f32 v102, v102
v_mul_f32 v36, v36, v100
v_mfma_f32_32x32x16_bf16 v[16:31], a[52:55], v[52:55], v[16:31]
ds_read_b128 v[68:71], v4 offset:32768
v_rcp_f32 v103, v103
v_mul_f32 v37, v37, v101
v_mul_f32 v38, v38, v102
ds_read_b96 v[120:122], v6 offset:3072
s_waitcnt lgkmcnt(3)
v_mfma_f32_32x32x16_bf16 v[16:31], a[80:83], v[56:59], v[16:31]
ds_read_b128 v[72:75], v4 offset:50176
buffer_load_dwordx4 v[172:175], v1, s[4:7], s68 offen offset:1024 sc1
v_mul_f32 v39, v39, v103
v_cvt_pk_bf16_f32 v112, v32, v33
v_cvt_pk_bf16_f32 v113, v34, v35
v_cvt_pk_bf16_f32 v114, v36, v37
v_mfma_f32_32x32x16_bf16 v[16:31], a[108:111], v[60:63], v[16:31]
ds_read_b128 v[76:79], v5 offset:2048
v_cvt_pk_bf16_f32 v115, v38, v39
buffer_store_dwordx4 v[112:115], v119, s[4:7], s26 offen
s_add_u32 s26, s26, 114688
s_waitcnt lgkmcnt(3)
v_mfma_f32_32x32x16_bf16 v[32:47], a[0:3], v[64:67], 0
ds_read_b128 v[48:51], v4 offset:16384
s_add_u32 m0, s27, 7168
s_nop 0
buffer_load_dwordx4 v1, s[4:7], s20 offen offset:2048 sc1 lds
v_mfma_f32_32x32x16_bf16 v[32:47], a[28:31], v[68:71], v[32:47]
ds_read_b128 v[52:55], v4 offset:33792
s_waitcnt lgkmcnt(2)
v_mfma_f32_32x32x16_bf16 v[32:47], a[56:59], v[72:75], v[32:47]
PG_A_5:
s_cbranch_execz PG_A_ret
ds_read_b128 v[56:59], v4 offset:51200
s_add_u32 m0, s27, 8192
s_nop 0
buffer_load_dwordx4 v1, s[4:7], s68 offen offset:2048 sc1 lds
v_fma_f32 v16, -v120, v80, v16
v_fma_f32 v17, -v120, v81, v17
v_fma_f32 v18, -v120, v82, v18
v_mfma_f32_32x32x16_bf16 v[32:47], a[84:87], v[76:79], v[32:47]
ds_read_b128 v[60:63], v5 offset:3072
v_fma_f32 v19, -v120, v83, v19
v_fma_f32 v20, -v120, v84, v20
v_fma_f32 v21, -v120, v85, v21
v_fma_f32 v22, -v120, v86, v22
s_waitcnt lgkmcnt(2)
v_mfma_f32_32x32x16_bf16 v[32:47], a[4:7], v[48:51], v[32:47]
ds_read_b128 v[64:67], v4 offset:0
s_add_u32 m0, s27, 8192
s_nop 0
buffer_load_dwordx4 v1, s[4:7], s20 offen offset:3072 sc1 lds
v_fma_f32 v23, -v120, v87, v23
v_fma_f32 v24, -v120, v88, v24
v_fma_f32 v25, -v120, v89, v25
v_mfma_f32_32x32x16_bf16 v[32:47], a[32:35], v[52:55], v[32:47]
ds_read_b128 v[68:71], v4 offset:17408
v_fma_f32 v26, -v120, v90, v26
v_fma_f32 v27, -v120, v91, v27
v_fma_f32 v28, -v120, v92, v28
v_fma_f32 v29, -v120, v93, v29
s_waitcnt lgkmcnt(2)
v_mfma_f32_32x32x16_bf16 v[32:47], a[60:63], v[56:59], v[32:47]
ds_read_b128 v[72:75], v4 offset:34816
s_add_u32 m0, s27, 9216
s_nop 0
buffer_load_dwordx4 v1, s[4:7], s68 offen offset:3072 sc1 lds
v_fma_f32 v30, -v120, v94, v30
v_fma_f32 v31, -v120, v95, v31
v_mul_f32 v96, v16, v121
v_mfma_f32_32x32x16_bf16 v[32:47], a[88:91], v[60:63], v[32:47]
ds_read_b128 v[76:79], v4 offset:52224
v_mul_f32 v97, v17, v121
v_mul_f32 v98, v18, v121
v_mul_f32 v99, v19, v121
v_mul_f32 v100, v20, v121
s_waitcnt lgkmcnt(2)
v_mfma_f32_32x32x16_bf16 v[32:47], a[8:11], v[64:67], v[32:47]
ds_read_b128 v[48:51], v4 offset:1024
s_add_u32 s20, s20, 4096
s_add_u32 m0, s27, 13312
s_nop 0
buffer_load_dwordx4 v1, s[4:7], s20 offen offset:0 sc1 lds
v_mul_f32 v101, v21, v121
v_mul_f32 v102, v22, v121
v_mfma_f32_32x32x16_bf16 v[32:47], a[36:39], v[68:71], v[32:47]
s_waitcnt vmcnt(18)
s_barrier
ds_read_b128 v[52:55], v4 offset:18432
v_mul_f32 v103, v23, v121
v_exp_f32 v96, v96
s_waitcnt lgkmcnt(2)
v_mfma_f32_32x32x16_bf16 v[32:47], a[64:67], v[72:75], v[32:47]
ds_read_b128 v[56:59], v4 offset:35840
s_add_u32 s68, s68, 4096
s_add_u32 m0, s27, 14336
s_nop 0
buffer_load_dwordx4 v1, s[4:7], s68 offen offset:0 sc1 lds
v_mul_f32 v16, v16, v24
v_mfma_f32_32x32x16_bf16 v[32:47], a[92:95], v[76:79], v[32:47]
ds_read_b128 v[60:63], v4 offset:53248
v_exp_f32 v97, v97
v_mul_f32 v17, v17, v25
s_waitcnt lgkmcnt(2)
v_mfma_f32_32x32x16_bf16 v[32:47], a[12:15], v[48:51], v[32:47]
ds_read_b128 v[64:67], v4 offset:2048
s_add_u32 m0, s27, 14336
s_nop 0
buffer_load_dwordx4 v1, s[4:7], s20 offen offset:1024 sc1 lds
v_exp_f32 v98, v98
v_mul_f32 v18, v18, v26
v_mfma_f32_32x32x16_bf16 v[32:47], a[40:43], v[52:55], v[32:47]
ds_read_b128 v[68:71], v4 offset:19456
v_exp_f32 v99, v99
v_mul_f32 v19, v19, v27
s_waitcnt lgkmcnt(2)
v_mfma_f32_32x32x16_bf16 v[32:47], a[68:71], v[56:59], v[32:47]
ds_read_b128 v[72:75], v4 offset:36864
s_add_u32 m0, s27, 15360
s_nop 0
buffer_load_dwordx4 v1, s[4:7], s68 offen offset:1024 sc1 lds
v_exp_f32 v100, v100
v_mul_f32 v20, v20, v28
v_mfma_f32_32x32x16_bf16 v[32:47], a[96:99], v[60:63], v[32:47]
ds_read_b128 v[76:79], v4 offset:54272
v_exp_f32 v101, v101
v_mul_f32 v21, v21, v29
s_waitcnt lgkmcnt(2)
v_mfma_f32_32x32x16_bf16 v[32:47], a[16:19], v[64:67], v[32:47]
ds_read_b128 v[48:51], v4 offset:3072
s_add_u32 m0, s27, 15360
s_nop 0
buffer_load_dwordx4 v1, s[4:7], s20 offen offset:2048 sc1 lds
v_exp_f32 v102, v102
v_mul_f32 v22, v22, v30
v_mfma_f32_32x32x16_bf16 v[32:47], a[44:47], v[68:71], v[32:47]
ds_read_b128 v[52:55], v4 offset:20480
v_exp_f32 v103, v103
v_mul_f32 v23, v23, v31
v_fma_f32 v96, v96, v122, v122
s_waitcnt lgkmcnt(2)
v_mfma_f32_32x32x16_bf16 v[32:47], a[72:75], v[72:75], v[32:47]
ds_read_b128 v[56:59], v4 offset:37888
s_add_u32 m0, s27, 16384
s_nop 0
buffer_load_dwordx4 v1, s[4:7], s68 offen offset:2048 sc1 lds
v_fma_f32 v97, v97, v122, v122
v_fma_f32 v98, v98, v122, v122
v_fma_f32 v99, v99, v122, v122
v_mfma_f32_32x32x16_bf16 v[32:47], a[100:103], v[76:79], v[32:47]
ds_read_b128 v[60:63], v4 offset:55296
v_fma_f32 v100, v100, v122, v122
v_fma_f32 v101, v101, v122, v122
v_fma_f32 v102, v102, v122, v122
v_fma_f32 v103, v103, v122, v122
s_waitcnt lgkmcnt(2)
v_mfma_f32_32x32x16_bf16 v[32:47], a[20:23], v[48:51], v[32:47]
ds_read_b128 v[64:67], v4 offset:4096
v_rcp_f32 v96, v96
v_rcp_f32 v97, v97
v_mfma_f32_32x32x16_bf16 v[32:47], a[48:51], v[52:55], v[32:47]
ds_read_b128 v[68:71], v4 offset:21504
v_rcp_f32 v98, v98
v_mul_f32 v16, v16, v96
s_waitcnt lgkmcnt(2)
v_mfma_f32_32x32x16_bf16 v[32:47], a[76:79], v[56:59], v[32:47]
ds_read_b128 v[72:75], v4 offset:38912
v_rcp_f32 v99, v99
v_mul_f32 v17, v17, v97
v_rcp_f32 v100, v100
v_mfma_f32_32x32x16_bf16 v[32:47], a[104:107], v[60:63], v[32:47]
ds_read_b128 v[76:79], v4 offset:56320
v_mul_f32 v18, v18, v98
v_rcp_f32 v101, v101
v_mul_f32 v19, v19, v99
s_waitcnt lgkmcnt(2)
v_mfma_f32_32x32x16_bf16 v[32:47], a[24:27], v[64:67], v[32:47]
v_rcp_f32 v102, v102
v_mul_f32 v20, v20, v100
v_rcp_f32 v103, v103
v_mul_f32 v21, v21, v101
v_mfma_f32_32x32x16_bf16 v[32:47], a[52:55], v[68:71], v[32:47]
v_mul_f32 v22, v22, v102
v_mul_f32 v23, v23, v103
v_cvt_pk_bf16_f32 v112, v16, v17
v_cvt_pk_bf16_f32 v113, v18, v19
v_cvt_pk_bf16_f32 v114, v20, v21
ds_read_b96 v[124:126], v6 offset:3584
s_waitcnt lgkmcnt(1)
v_mfma_f32_32x32x16_bf16 v[32:47], a[80:83], v[72:75], v[32:47]
v_cvt_pk_bf16_f32 v115, v22, v23
buffer_store_dwordx4 v[112:115], v119, s[4:7], s26 offen
s_add_u32 s26, s26, 114688
v_mfma_f32_32x32x16_bf16 v[32:47], a[108:111], v[76:79], v[32:47]
s_waitcnt vmcnt(23)
v_mfma_f32_16x16x32_bf16 v[16:19], a[112:115], v[128:131], 0
buffer_load_dwordx4 v[216:219], v1, s[4:7], s29 offen offset:2048 sc1
v_mfma_f32_16x16x32_bf16 v[24:27], a[116:119], v[128:131], 0
v_mfma_f32_16x16x32_bf16 v[48:51], a[120:123], v[128:131], 0
v_mfma_f32_16x16x32_bf16 v[56:59], a[124:127], v[128:131], 0
s_waitcnt vmcnt(23)
v_mfma_f32_16x16x32_bf16 v[20:23], a[112:115], v[132:135], 0
s_waitcnt lgkmcnt(0)
s_nop 2
v_fma_f32 v32, -v124, v80, v32
v_fma_f32 v33, -v124, v81, v33
v_fma_f32 v34, -v124, v82, v34
v_fma_f32 v35, -v124, v83, v35
v_mfma_f32_16x16x32_bf16 v[28:31], a[116:119], v[132:135], 0
v_fma_f32 v36, -v124, v84, v36
v_fma_f32 v37, -v124, v85, v37
buffer_load_dwordx4 v[220:223], v1, s[4:7], s29 offen offset:3072 sc1
v_mfma_f32_16x16x32_bf16 v[52:55], a[120:123], v[132:135], 0
v_fma_f32 v38, -v124, v86, v38
v_fma_f32 v39, -v124, v87, v39
v_fma_f32 v40, -v124, v88, v40
v_mfma_f32_16x16x32_bf16 v[60:63], a[124:127], v[132:135], 0
v_fma_f32 v41, -v124, v89, v41
v_fma_f32 v42, -v124, v90, v42
v_fma_f32 v43, -v124, v91, v43
s_waitcnt vmcnt(23)
v_mfma_f32_16x16x32_bf16 v[16:19], a[128:131], v[136:139], v[16:19]
v_fma_f32 v44, -v124, v92, v44
v_fma_f32 v45, -v124, v93, v45
v_fma_f32 v46, -v124, v94, v46
v_fma_f32 v47, -v124, v95, v47
v_mfma_f32_16x16x32_bf16 v[24:27], a[132:135], v[136:139], v[24:27]
v_mul_f32 v96, v32, v125
v_mul_f32 v97, v33, v125
s_add_u32 s29, s30, 49152
buffer_load_dwordx4 v[224:227], v1, s[4:7], s29 offen offset:0 sc1
v_mfma_f32_16x16x32_bf16 v[48:51], a[136:139], v[136:139], v[48:51]
v_mul_f32 v98, v34, v125
v_mul_f32 v99, v35, v125
v_mul_f32 v100, v36, v125
v_mfma_f32_16x16x32_bf16 v[56:59], a[140:143], v[136:139], v[56:59]
v_mul_f32 v101, v37, v125
v_mul_f32 v102, v38, v125
v_mul_f32 v103, v39, v125
s_waitcnt vmcnt(23)
v_mfma_f32_16x16x32_bf16 v[20:23], a[128:131], v[140:143], v[20:23]
v_exp_f32 v96, v96
v_mul_f32 v32, v32, v40
v_mfma_f32_16x16x32_bf16 v[28:31], a[132:135], v[140:143], v[28:31]
v_exp_f32 v97, v97
v_mul_f32 v33, v33, v41
buffer_load_dwordx4 v[228:231], v1, s[4:7], s29 offen offset:1024 sc1
v_mfma_f32_16x16x32_bf16 v[52:55], a[136:139], v[140:143], v[52:55]
v_exp_f32 v98, v98
v_mul_f32 v34, v34, v42
v_mfma_f32_16x16x32_bf16 v[60:63], a[140:143], v[140:143], v[60:63]
v_exp_f32 v99, v99
v_mul_f32 v35, v35, v43
s_waitcnt vmcnt(23)
v_mfma_f32_16x16x32_bf16 v[16:19], a[144:147], v[144:147], v[16:19]
v_exp_f32 v100, v100
v_mul_f32 v36, v36, v44
v_mfma_f32_16x16x32_bf16 v[24:27], a[148:151], v[144:147], v[24:27]
v_exp_f32 v101, v101
v_mul_f32 v37, v37, v45
buffer_load_dwordx4 v[232:235], v1, s[4:7], s29 offen offset:2048 sc1
v_mfma_f32_16x16x32_bf16 v[48:51], a[152:155], v[144:147], v[48:51]
v_exp_f32 v102, v102
v_mul_f32 v38, v38, v46
v_mfma_f32_16x16x32_bf16 v[56:59], a[156:159], v[144:147], v[56:59]
v_exp_f32 v103, v103
v_mul_f32 v39, v39, v47
s_waitcnt vmcnt(23)
v_mfma_f32_16x16x32_bf16 v[20:23], a[144:147], v[148:151], v[20:23]
v_fma_f32 v96, v96, v126, v126
v_fma_f32 v97, v97, v126, v126
v_fma_f32 v98, v98, v126, v126
v_fma_f32 v99, v99, v126, v126
v_mfma_f32_16x16x32_bf16 v[28:31], a[148:151], v[148:151], v[28:31]
v_fma_f32 v100, v100, v126, v126
v_fma_f32 v101, v101, v126, v126
buffer_load_dwordx4 v[236:239], v1, s[4:7], s29 offen offset:3072 sc1
v_mfma_f32_16x16x32_bf16 v[52:55], a[152:155], v[148:151], v[52:55]
v_fma_f32 v102, v102, v126, v126
v_fma_f32 v103, v103, v126, v126
v_rcp_f32 v96, v96
v_mfma_f32_16x16x32_bf16 v[60:63], a[156:159], v[148:151], v[60:63]
v_rcp_f32 v97, v97
s_waitcnt vmcnt(23)
v_mfma_f32_16x16x32_bf16 v[16:19], a[160:163], v[152:155], v[16:19]
v_rcp_f32 v98, v98
v_mul_f32 v32, v32, v96
v_rcp_f32 v99, v99
v_mfma_f32_16x16x32_bf16 v[24:27], a[164:167], v[152:155], v[24:27]
v_mul_f32 v33, v33, v97
s_add_u32 s29, s30, 53248
buffer_load_dwordx4 v[240:243], v1, s[4:7], s29 offen offset:0 sc1
v_mfma_f32_16x16x32_bf16 v[48:51], a[168:171], v[152:155], v[48:51]
v_rcp_f32 v100, v100
v_mul_f32 v34, v34, v98
v_mfma_f32_16x16x32_bf16 v[56:59], a[172:175], v[152:155], v[56:59]
v_rcp_f32 v101, v101
v_mul_f32 v35, v35, v99
s_waitcnt vmcnt(23)
v_mfma_f32_16x16x32_bf16 v[20:23], a[160:163], v[156:159], v[20:23]
v_rcp_f32 v102, v102
v_mul_f32 v36, v36, v100
v_mfma_f32_16x16x32_bf16 v[28:31], a[164:167], v[156:159], v[28:31]
v_rcp_f32 v103, v103
v_mul_f32 v37, v37, v101
buffer_load_dwordx4 v[244:247], v1, s[4:7], s29 offen offset:1024 sc1
v_mfma_f32_16x16x32_bf16 v[52:55], a[168:171], v[156:159], v[52:55]
v_mul_f32 v38, v38, v102
v_mul_f32 v39, v39, v103
v_cvt_pk_bf16_f32 v112, v32, v33
v_mfma_f32_16x16x32_bf16 v[60:63], a[172:175], v[156:159], v[60:63]
v_cvt_pk_bf16_f32 v113, v34, v35
v_cvt_pk_bf16_f32 v114, v36, v37
v_cvt_pk_bf16_f32 v115, v38, v39
s_waitcnt vmcnt(23)
v_mfma_f32_16x16x32_bf16 v[16:19], a[176:179], v[160:163], v[16:19]
buffer_store_dwordx4 v[112:115], v119, s[4:7], s26 offen
s_add_u32 s26, s26, 114688
v_mfma_f32_16x16x32_bf16 v[24:27], a[180:183], v[160:163], v[24:27]
v_add_u32 v47, s23, v1
buffer_load_dwordx4 v[248:251], v1, s[4:7], s29 offen offset:2048 sc1
v_mfma_f32_16x16x32_bf16 v[48:51], a[184:187], v[160:163], v[48:51]
v_add_u32 v4, s65, v1
v_xor_b32 v5, 128, v4
s_waitcnt vmcnt(20)
v_mfma_f32_16x16x32_bf16 v[56:59], a[188:191], v[160:163], v[56:59]
ds_read_b128 v[80:83], v47 offset:5120
buffer_load_dwordx4 v[120:123], v1, s[4:7], s20 offen offset:3072 sc1
v_mfma_f32_16x16x32_bf16 v[20:23], a[176:179], v[164:167], v[20:23]
s_waitcnt vmcnt(20)
ds_read_b128 v[84:87], v47 offset:6144
v_mfma_f32_16x16x32_bf16 v[28:31], a[180:183], v[164:167], v[28:31]
buffer_load_dwordx4 v[252:255], v1, s[4:7], s29 offen offset:3072 sc1
v_mfma_f32_16x16x32_bf16 v[52:55], a[184:187], v[164:167], v[52:55]
s_waitcnt vmcnt(20)
ds_read_b128 v[88:91], v47 offset:7168
v_mfma_f32_16x16x32_bf16 v[60:63], a[188:191], v[164:167], v[60:63]
buffer_load_dwordx4 v[124:127], v1, s[4:7], s68 offen offset:3072 sc1
v_mfma_f32_16x16x32_bf16 v[16:19], a[192:195], v[168:171], v[16:19]
s_waitcnt vmcnt(20)
ds_read_b128 v[92:95], v47 offset:8192
v_mfma_f32_16x16x32_bf16 v[24:27], a[196:199], v[168:171], v[24:27]
v_mfma_f32_16x16x32_bf16 v[48:51], a[200:203], v[168:171], v[48:51]
s_waitcnt vmcnt(19)
ds_read_b128 v[96:99], v47 offset:9216
s_add_u32 s20, s20, 4096
v_mfma_f32_16x16x32_bf16 v[56:59], a[204:207], v[168:171], v[56:59]
buffer_load_dwordx4 v[128:131], v1, s[4:7], s20 offen offset:0 sc1
v_mfma_f32_16x16x32_bf16 v[20:23], a[192:195], v[172:175], v[20:23]
s_waitcnt vmcnt(19)
ds_read_b128 v[100:103], v47 offset:10240
v_mfma_f32_16x16x32_bf16 v[28:31], a[196:199], v[172:175], v[28:31]
v_mfma_f32_16x16x32_bf16 v[52:55], a[200:203], v[172:175], v[52:55]
s_waitcnt vmcnt(18)
ds_read_b128 v[104:107], v47 offset:11264
s_add_u32 s68, s68, 4096
v_mfma_f32_16x16x32_bf16 v[60:63], a[204:207], v[172:175], v[60:63]
buffer_load_dwordx4 v[132:135], v1, s[4:7], s68 offen offset:0 sc1
s_waitcnt lgkmcnt(6)
v_mfma_f32_16x16x32_bf16 v[16:19], a[208:211], v[80:83], v[16:19]
s_waitcnt vmcnt(6)
s_barrier
s_add_u32 s3, s32, 5
v_bfrev_b32 v40, 1
v_mov_b32 v41, s3
v_mfma_f32_16x16x32_bf16 v[24:27], a[212:215], v[80:83], v[24:27]
v_writelane_b32 v40, s50, 0
buffer_store_dword v41, v40, s[4:7], s46 offen
ds_read_b128 v[108:111], v47 offset:12288
v_mfma_f32_16x16x32_bf16 v[48:51], a[216:219], v[80:83], v[48:51]
ds_read_b128 v[112:115], v47 offset:13312
v_mfma_f32_16x16x32_bf16 v[56:59], a[220:223], v[80:83], v[56:59]
buffer_load_dwordx4 v[136:139], v1, s[4:7], s20 offen offset:1024 sc1
s_waitcnt lgkmcnt(7)
v_mfma_f32_16x16x32_bf16 v[20:23], a[208:211], v[84:87], v[20:23]
ds_read_b128 v[116:119], v47 offset:14336
v_mfma_f32_16x16x32_bf16 v[28:31], a[212:215], v[84:87], v[28:31]
v_mfma_f32_16x16x32_bf16 v[52:55], a[216:219], v[84:87], v[52:55]
buffer_load_dwordx4 v[140:143], v1, s[4:7], s68 offen offset:1024 sc1
v_mfma_f32_16x16x32_bf16 v[60:63], a[220:223], v[84:87], v[60:63]
s_waitcnt lgkmcnt(7)
v_mfma_f32_16x16x32_bf16 v[16:19], a[224:227], v[88:91], v[16:19]
v_mfma_f32_16x16x32_bf16 v[24:27], a[228:231], v[88:91], v[24:27]
v_mfma_f32_16x16x32_bf16 v[48:51], a[232:235], v[88:91], v[48:51]
v_mfma_f32_16x16x32_bf16 v[56:59], a[236:239], v[88:91], v[56:59]
s_waitcnt lgkmcnt(6)
v_mfma_f32_16x16x32_bf16 v[20:23], a[224:227], v[92:95], v[20:23]
v_mfma_f32_16x16x32_bf16 v[28:31], a[228:231], v[92:95], v[28:31]
v_mfma_f32_16x16x32_bf16 v[52:55], a[232:235], v[92:95], v[52:55]
v_mfma_f32_16x16x32_bf16 v[60:63], a[236:239], v[92:95], v[60:63]
s_waitcnt lgkmcnt(5)
v_mfma_f32_16x16x32_bf16 v[16:19], a[240:243], v[96:99], v[16:19]
v_mfma_f32_16x16x32_bf16 v[24:27], a[244:247], v[96:99], v[24:27]
v_mfma_f32_16x16x32_bf16 v[48:51], a[248:251], v[96:99], v[48:51]
v_mfma_f32_16x16x32_bf16 v[56:59], a[252:255], v[96:99], v[56:59]
s_waitcnt lgkmcnt(4)
v_mfma_f32_16x16x32_bf16 v[20:23], a[240:243], v[100:103], v[20:23]
v_lshlrev_b32 v42, 2, v0
v_mfma_f32_16x16x32_bf16 v[28:31], a[244:247], v[100:103], v[28:31]
buffer_load_dword v44, v42, s[4:7], s43 offen sc1
v_mfma_f32_16x16x32_bf16 v[52:55], a[248:251], v[100:103], v[52:55]
v_mfma_f32_16x16x32_bf16 v[60:63], a[252:255], v[100:103], v[60:63]
s_waitcnt lgkmcnt(3)
v_mfma_f32_16x16x32_bf16 v[16:19], v[176:179], v[104:107], v[16:19]
v_mfma_f32_16x16x32_bf16 v[24:27], v[180:183], v[104:107], v[24:27]
v_mfma_f32_16x16x32_bf16 v[48:51], v[184:187], v[104:107], v[48:51]
v_mfma_f32_16x16x32_bf16 v[56:59], v[188:191], v[104:107], v[56:59]
s_waitcnt lgkmcnt(2)
v_mfma_f32_16x16x32_bf16 v[20:23], v[176:179], v[108:111], v[20:23]
v_mfma_f32_16x16x32_bf16 v[28:31], v[180:183], v[108:111], v[28:31]
v_mfma_f32_16x16x32_bf16 v[52:55], v[184:187], v[108:111], v[52:55]
s_add_u32 s3, s32, 5
s_waitcnt vmcnt(0)
v_subrev_u32 v44, s3, v44
v_cmp_le_u32 vcc, 11, v44
s_nop 0
s_and_b64 vcc, vcc, s[48:49]
v_mfma_f32_16x16x32_bf16 v[60:63], v[188:191], v[108:111], v[60:63]
s_cbranch_scc0 L_chk_10_ok
s_mov_b32 s15, 0
L_chk_10:
buffer_load_dword v44, v42, s[4:7], s43 offen sc1
s_waitcnt vmcnt(0)
s_add_u32 s3, s32, 5
v_subrev_u32 v44, s3, v44
v_cmp_le_u32 vcc, 11, v44
s_nop 0
s_and_b64 vcc, vcc, s[48:49]
s_cbranch_scc0 L_chk_10_ok
s_add_u32 s15, s15, 1
s_cmp_lt_u32 s15, 131072
s_cbranch_scc1 L_chk_10
L_chk_10_ok:
s_waitcnt lgkmcnt(1)
v_mfma_f32_16x16x32_bf16 v[16:19], v[192:195], v[112:115], v[16:19]
buffer_load_dwordx4 v[144:147], v1, s[4:7], s21 offen offset:0 sc1
v_mfma_f32_16x16x32_bf16 v[24:27], v[196:199], v[112:115], v[24:27]
v_mfma_f32_16x16x32_bf16 v[48:51], v[200:203], v[112:115], v[48:51]
buffer_load_dwordx4 v[148:151], v1, s[4:7], s69 offen offset:0 sc1
v_mfma_f32_16x16x32_bf16 v[56:59], v[204:207], v[112:115], v[56:59]
s_waitcnt lgkmcnt(0)
v_mfma_f32_16x16x32_bf16 v[20:23], v[192:195], v[116:119], v[20:23]
buffer_load_dwordx4 v[152:155], v1, s[4:7], s21 offen offset:1024 sc1
v_mfma_f32_16x16x32_bf16 v[28:31], v[196:199], v[116:119], v[28:31]
v_mfma_f32_16x16x32_bf16 v[52:55], v[200:203], v[116:119], v[52:55]
buffer_load_dwordx4 v[156:159], v1, s[4:7], s69 offen offset:1024 sc1
v_mfma_f32_16x16x32_bf16 v[60:63], v[204:207], v[116:119], v[60:63]
v_mfma_f32_16x16x32_bf16 v[16:19], v[208:211], v[120:123], v[16:19]
buffer_load_dwordx4 v[160:163], v1, s[4:7], s21 offen offset:2048 sc1
v_mfma_f32_16x16x32_bf16 v[24:27], v[212:215], v[120:123], v[24:27]
v_mfma_f32_16x16x32_bf16 v[48:51], v[216:219], v[120:123], v[48:51]
buffer_load_dwordx4 v[164:167], v1, s[4:7], s69 offen offset:2048 sc1
v_mfma_f32_16x16x32_bf16 v[56:59], v[220:223], v[120:123], v[56:59]
v_mfma_f32_16x16x32_bf16 v[20:23], v[208:211], v[124:127], v[20:23]
buffer_load_dwordx4 v[168:171], v1, s[4:7], s21 offen offset:3072 sc1
v_mfma_f32_16x16x32_bf16 v[28:31], v[212:215], v[124:127], v[28:31]
v_mfma_f32_16x16x32_bf16 v[52:55], v[216:219], v[124:127], v[52:55]
buffer_load_dwordx4 v[172:175], v1, s[4:7], s69 offen offset:3072 sc1
v_mfma_f32_16x16x32_bf16 v[60:63], v[220:223], v[124:127], v[60:63]
v_mfma_f32_16x16x32_bf16 v[16:19], v[224:227], v[128:131], v[16:19]
s_add_u32 s21, s21, 4096
v_mfma_f32_16x16x32_bf16 v[24:27], v[228:231], v[128:131], v[24:27]
buffer_load_dwordx4 v[80:83], v1, s[4:7], s21 offen offset:0 sc1
v_mfma_f32_16x16x32_bf16 v[48:51], v[232:235], v[128:131], v[48:51]
s_add_u32 s69, s69, 4096
v_mfma_f32_16x16x32_bf16 v[56:59], v[236:239], v[128:131], v[56:59]
buffer_load_dwordx4 v[84:87], v1, s[4:7], s69 offen offset:0 sc1
v_mfma_f32_16x16x32_bf16 v[20:23], v[224:227], v[132:135], v[20:23]
buffer_load_dwordx4 v[88:91], v1, s[4:7], s21 offen offset:1024 sc1
v_mfma_f32_16x16x32_bf16 v[28:31], v[228:231], v[132:135], v[28:31]
v_mfma_f32_16x16x32_bf16 v[52:55], v[232:235], v[132:135], v[52:55]
buffer_load_dwordx4 v[92:95], v1, s[4:7], s69 offen offset:1024 sc1
v_mfma_f32_16x16x32_bf16 v[60:63], v[236:239], v[132:135], v[60:63]
v_mfma_f32_16x16x32_bf16 v[16:19], v[240:243], v[136:139], v[16:19]
buffer_load_dwordx4 v[96:99], v1, s[4:7], s21 offen offset:2048 sc1
v_mfma_f32_16x16x32_bf16 v[24:27], v[244:247], v[136:139], v[24:27]
v_mfma_f32_16x16x32_bf16 v[48:51], v[248:251], v[136:139], v[48:51]
buffer_load_dwordx4 v[100:103], v1, s[4:7], s69 offen offset:2048 sc1
v_mfma_f32_16x16x32_bf16 v[56:59], v[252:255], v[136:139], v[56:59]
v_mfma_f32_16x16x32_bf16 v[20:23], v[240:243], v[140:143], v[20:23]
buffer_load_dwordx4 v[104:107], v1, s[4:7], s21 offen offset:3072 sc1
v_mfma_f32_16x16x32_bf16 v[28:31], v[244:247], v[140:143], v[28:31]
v_mfma_f32_16x16x32_bf16 v[52:55], v[248:251], v[140:143], v[52:55]
buffer_load_dwordx4 v[108:111], v1, s[4:7], s69 offen offset:3072 sc1
v_mfma_f32_16x16x32_bf16 v[60:63], v[252:255], v[140:143], v[60:63]
s_waitcnt vmcnt(15)
v_mfma_f32_16x16x32_bf16 v[32:35], a[112:115], v[144:147], 0
v_mfma_f32_16x16x32_bf16 v[40:43], a[116:119], v[144:147], 0
v_mfma_f32_16x16x32_bf16 v[64:67], a[120:123], v[144:147], 0
s_add_u32 s21, s21, 4096
v_mfma_f32_16x16x32_bf16 v[72:75], a[124:127], v[144:147], 0
buffer_load_dwordx4 v[112:115], v1, s[4:7], s21 offen offset:0 sc1
s_waitcnt vmcnt(15)
v_mfma_f32_16x16x32_bf16 v[36:39], a[112:115], v[148:151], 0
ds_write_b128 v4, v[16:19] offset:0
v_mfma_f32_16x16x32_bf16 v[44:47], a[116:119], v[148:151], 0
v_mfma_f32_16x16x32_bf16 v[68:71], a[120:123], v[148:151], 0
s_add_u32 s69, s69, 4096
v_mfma_f32_16x16x32_bf16 v[76:79], a[124:127], v[148:151], 0
buffer_load_dwordx4 v[116:119], v1, s[4:7], s69 offen offset:0 sc1
s_waitcnt vmcnt(15)
v_mfma_f32_16x16x32_bf16 v[32:35], a[128:131], v[152:155], v[32:35]
ds_write_b128 v4, v[20:23] offset:1024
v_mfma_f32_16x16x32_bf16 v[40:43], a[132:135], v[152:155], v[40:43]
v_mfma_f32_16x16x32_bf16 v[64:67], a[136:139], v[152:155], v[64:67]
buffer_load_dwordx4 v[120:123], v1, s[4:7], s21 offen offset:1024 sc1
v_mfma_f32_16x16x32_bf16 v[72:75], a[140:143], v[152:155], v[72:75]
s_waitcnt vmcnt(15)
v_mfma_f32_16x16x32_bf16 v[36:39], a[128:131], v[156:159], v[36:39]
ds_write_b128 v5, v[24:27] offset:2048
v_mfma_f32_16x16x32_bf16 v[44:47], a[132:135], v[156:159], v[44:47]
v_mfma_f32_16x16x32_bf16 v[68:71], a[136:139], v[156:159], v[68:71]
buffer_load_dwordx4 v[124:127], v1, s[4:7], s69 offen offset:1024 sc1
v_mfma_f32_16x16x32_bf16 v[76:79], a[140:143], v[156:159], v[76:79]
s_waitcnt vmcnt(15)
v_mfma_f32_16x16x32_bf16 v[32:35], a[144:147], v[160:163], v[32:35]
ds_write_b128 v5, v[28:31] offset:3072
v_mfma_f32_16x16x32_bf16 v[40:43], a[148:151], v[160:163], v[40:43]
v_mfma_f32_16x16x32_bf16 v[64:67], a[152:155], v[160:163], v[64:67]
buffer_load_dwordx4 v[128:131], v1, s[4:7], s21 offen offset:2048 sc1
v_mfma_f32_16x16x32_bf16 v[72:75], a[156:159], v[160:163], v[72:75]
s_waitcnt vmcnt(15)
v_mfma_f32_16x16x32_bf16 v[36:39], a[144:147], v[164:167], v[36:39]
ds_write_b128 v4, v[48:51] offset:4096
v_mfma_f32_16x16x32_bf16 v[44:47], a[148:151], v[164:167], v[44:47]
v_mfma_f32_16x16x32_bf16 v[68:71], a[152:155], v[164:167], v[68:71]
buffer_load_dwordx4 v[132:135], v1, s[4:7], s69 offen offset:2048 sc1
v_mfma_f32_16x16x32_bf16 v[76:79], a[156:159], v[164:167], v[76:79]
s_waitcnt vmcnt(15)
v_mfma_f32_16x16x32_bf16 v[32:35], a[160:163], v[168:171], v[32:35]
ds_write_b128 v4, v[52:55] offset:5120
v_mfma_f32_16x16x32_bf16 v[40:43], a[164:167], v[168:171], v[40:43]
v_mfma_f32_16x16x32_bf16 v[64:67], a[168:171], v[168:171], v[64:67]
buffer_load_dwordx4 v[136:139], v1, s[4:7], s21 offen offset:3072 sc1
v_mfma_f32_16x16x32_bf16 v[72:75], a[172:175], v[168:171], v[72:75]
s_waitcnt vmcnt(15)
v_mfma_f32_16x16x32_bf16 v[36:39], a[160:163], v[172:175], v[36:39]
ds_write_b128 v5, v[56:59] offset:6144
v_mfma_f32_16x16x32_bf16 v[44:47], a[164:167], v[172:175], v[44:47]
v_mfma_f32_16x16x32_bf16 v[68:71], a[168:171], v[172:175], v[68:71]
buffer_load_dwordx4 v[140:143], v1, s[4:7], s69 offen offset:3072 sc1
v_mfma_f32_16x16x32_bf16 v[76:79], a[172:175], v[172:175], v[76:79]
s_waitcnt vmcnt(15)
v_mfma_f32_16x16x32_bf16 v[32:35], a[176:179], v[80:83], v[32:35]
ds_write_b128 v5, v[60:63] offset:7168
v_mfma_f32_16x16x32_bf16 v[40:43], a[180:183], v[80:83], v[40:43]
v_mfma_f32_16x16x32_bf16 v[64:67], a[184:187], v[80:83], v[64:67]
s_add_u32 s21, s21, 4096
v_mfma_f32_16x16x32_bf16 v[72:75], a[188:191], v[80:83], v[72:75]
buffer_load_dwordx4 v[144:147], v1, s[4:7], s21 offen offset:0 sc1
s_waitcnt vmcnt(15)
v_mfma_f32_16x16x32_bf16 v[36:39], a[176:179], v[84:87], v[36:39]
v_mfma_f32_16x16x32_bf16 v[44:47], a[180:183], v[84:87], v[44:47]
v_mfma_f32_16x16x32_bf16 v[68:71], a[184:187], v[84:87], v[68:71]
s_add_u32 s69, s69, 4096
v_mfma_f32_16x16x32_bf16 v[76:79], a[188:191], v[84:87], v[76:79]
buffer_load_dwordx4 v[148:151], v1, s[4:7], s69 offen offset:0 sc1
s_waitcnt vmcnt(15)
v_mfma_f32_16x16x32_bf16 v[32:35], a[192:195], v[88:91], v[32:35]
s_waitcnt lgkmcnt(0)
s_barrier
v_mfma_f32_16x16x32_bf16 v[40:43], a[196:199], v[88:91], v[40:43]
ds_read_b128 v[16:19], v2 offset:0
ds_read_b128 v[20:23], v2 offset:512
v_mfma_f32_16x16x32_bf16 v[64:67], a[200:203], v[88:91], v[64:67]
buffer_load_dwordx4 v[152:155], v1, s[4:7], s21 offen offset:1024 sc1
ds_read_b128 v[24:27], v2 offset:8192
v_mfma_f32_16x16x32_bf16 v[72:75], a[204:207], v[88:91], v[72:75]
ds_read_b128 v[28:31], v2 offset:8704
s_waitcnt vmcnt(15)
v_mfma_f32_16x16x32_bf16 v[36:39], a[192:195], v[92:95], v[36:39]
ds_read_b128 v[48:51], v2 offset:16384
v_mfma_f32_16x16x32_bf16 v[44:47], a[196:199], v[92:95], v[44:47]
ds_read_b128 v[52:55], v2 offset:16896
v_mfma_f32_16x16x32_bf16 v[68:71], a[200:203], v[92:95], v[68:71]
buffer_load_dwordx4 v[156:159], v1, s[4:7], s69 offen offset:1024 sc1
ds_read_b128 v[56:59], v2 offset:24576
v_mfma_f32_16x16x32_bf16 v[76:79], a[204:207], v[92:95], v[76:79]
ds_read_b128 v[60:63], v2 offset:25088
s_waitcnt vmcnt(15)
v_mfma_f32_16x16x32_bf16 v[32:35], a[208:211], v[96:99], v[32:35]
v_mfma_f32_16x16x32_bf16 v[40:43], a[212:215], v[96:99], v[40:43]
v_mfma_f32_16x16x32_bf16 v[64:67], a[216:219], v[96:99], v[64:67]
s_waitcnt lgkmcnt(5)
v_add_f32 v24, v24, v16
v_add_f32 v25, v25, v17
v_mfma_f32_16x16x32_bf16 v[72:75], a[220:223], v[96:99], v[72:75]
v_add_f32 v26, v26, v18
v_add_f32 v27, v27, v19
s_waitcnt vmcnt(14)
v_mfma_f32_16x16x32_bf16 v[36:39], a[208:211], v[100:103], v[36:39]
s_waitcnt lgkmcnt(4)
v_add_f32 v28, v28, v20
v_add_f32 v29, v29, v21
v_mfma_f32_16x16x32_bf16 v[44:47], a[212:215], v[100:103], v[44:47]
v_add_f32 v30, v30, v22
v_add_f32 v31, v31, v23
v_mfma_f32_16x16x32_bf16 v[68:71], a[216:219], v[100:103], v[68:71]
v_lshlrev_b32 v16, 16, v8
v_and_b32 v17, 0xffff0000, v8
v_mfma_f32_16x16x32_bf16 v[76:79], a[220:223], v[100:103], v[76:79]
v_lshlrev_b32 v18, 16, v9
v_and_b32 v19, 0xffff0000, v9
s_waitcnt vmcnt(13)
v_mfma_f32_16x16x32_bf16 v[32:35], a[224:227], v[104:107], v[32:35]
v_lshlrev_b32 v20, 16, v10
v_and_b32 v21, 0xffff0000, v10
v_mfma_f32_16x16x32_bf16 v[40:43], a[228:231], v[104:107], v[40:43]
v_lshlrev_b32 v22, 16, v11
v_and_b32 v23, 0xffff0000, v11
v_mfma_f32_16x16x32_bf16 v[64:67], a[232:235], v[104:107], v[64:67]
v_add_f32 v24, v24, v16
v_add_f32 v25, v25, v17
v_mfma_f32_16x16x32_bf16 v[72:75], a[236:239], v[104:107], v[72:75]
v_add_f32 v26, v26, v18
v_add_f32 v27, v27, v19
s_waitcnt vmcnt(12)
v_mfma_f32_16x16x32_bf16 v[36:39], a[224:227], v[108:111], v[36:39]
v_add_f32 v28, v28, v20
v_add_f32 v29, v29, v21
v_mfma_f32_16x16x32_bf16 v[44:47], a[228:231], v[108:111], v[44:47]
v_add_f32 v30, v30, v22
v_add_f32 v31, v31, v23
v_mfma_f32_16x16x32_bf16 v[68:71], a[232:235], v[108:111], v[68:71]
s_waitcnt lgkmcnt(1)
v_add_f32 v48, v48, v56
v_add_f32 v49, v49, v57
v_mfma_f32_16x16x32_bf16 v[76:79], a[236:239], v[108:111], v[76:79]
v_add_f32 v50, v50, v58
v_add_f32 v51, v51, v59
s_waitcnt vmcnt(11)
v_mfma_f32_16x16x32_bf16 v[32:35], a[240:243], v[112:115], v[32:35]
s_waitcnt lgkmcnt(0)
v_add_f32 v52, v52, v60
v_add_f32 v53, v53, v61
v_mfma_f32_16x16x32_bf16 v[40:43], a[244:247], v[112:115], v[40:43]
v_add_f32 v54, v54, v62
v_add_f32 v55, v55, v63
v_mfma_f32_16x16x32_bf16 v[64:67], a[248:251], v[112:115], v[64:67]
v_add_f32 v24, v24, v48
v_add_f32 v25, v25, v49
v_mfma_f32_16x16x32_bf16 v[72:75], a[252:255], v[112:115], v[72:75]
v_add_f32 v26, v26, v50
v_add_f32 v27, v27, v51
s_waitcnt vmcnt(10)
v_mfma_f32_16x16x32_bf16 v[36:39], a[240:243], v[116:119], v[36:39]
v_add_f32 v28, v28, v52
v_add_f32 v29, v29, v53
v_mfma_f32_16x16x32_bf16 v[44:47], a[244:247], v[116:119], v[44:47]
v_add_f32 v30, v30, v54
v_add_f32 v31, v31, v55
v_mfma_f32_16x16x32_bf16 v[68:71], a[248:251], v[116:119], v[68:71]
v_cvt_pk_bf16_f32 v8, v24, v25
v_cvt_pk_bf16_f32 v9, v26, v27
v_mfma_f32_16x16x32_bf16 v[76:79], a[252:255], v[116:119], v[76:79]
PG_A_6:
s_cbranch_execz PG_A_ret
v_cvt_pk_bf16_f32 v10, v28, v29
v_cvt_pk_bf16_f32 v11, v30, v31
s_waitcnt vmcnt(9)
v_mfma_f32_16x16x32_bf16 v[32:35], v[176:179], v[120:123], v[32:35]
s_cmp_eq_u32 s41, 3
s_cselect_b32 s16, 0x40000000, s18
v_mfma_f32_16x16x32_bf16 v[40:43], v[180:183], v[120:123], v[40:43]
s_cselect_b32 s17, s18, 0x40000000
buffer_store_dwordx4 v[8:11], v3, s[4:7], s16 offen
v_mfma_f32_16x16x32_bf16 v[64:67], v[184:187], v[120:123], v[64:67]
buffer_store_dwordx4 v[8:11], v3, s[4:7], s17 offen sc1
v_add_f32 v16, v24, v25
v_mfma_f32_16x16x32_bf16 v[72:75], v[188:191], v[120:123], v[72:75]
v_mul_f32 v17, v24, v24
v_add_f32 v18, v26, v27
s_waitcnt vmcnt(10)
v_mfma_f32_16x16x32_bf16 v[36:39], v[176:179], v[124:127], v[36:39]
v_mul_f32 v19, v25, v25
v_fmac_f32 v17, v26, v26
v_mfma_f32_16x16x32_bf16 v[44:47], v[180:183], v[124:127], v[44:47]
v_fmac_f32 v19, v27, v27
v_add_f32 v16, v16, v28
v_mfma_f32_16x16x32_bf16 v[68:71], v[184:187], v[124:127], v[68:71]
v_fmac_f32 v17, v28, v28
v_add_f32 v18, v18, v29
v_mfma_f32_16x16x32_bf16 v[76:79], v[188:191], v[124:127], v[76:79]
v_fmac_f32 v19, v29, v29
v_add_f32 v16, v16, v30
s_waitcnt vmcnt(9)
v_mfma_f32_16x16x32_bf16 v[32:35], v[192:195], v[128:131], v[32:35]
v_fmac_f32 v17, v30, v30
v_add_f32 v18, v18, v31
v_mfma_f32_16x16x32_bf16 v[40:43], v[196:199], v[128:131], v[40:43]
v_fmac_f32 v19, v31, v31
v_add_f32 v16, v16, v18
v_mfma_f32_16x16x32_bf16 v[64:67], v[200:203], v[128:131], v[64:67]
v_add_f32 v17, v17, v19
s_nop 1
v_permlane32_swap_b32 v16, v17
v_mfma_f32_16x16x32_bf16 v[72:75], v[204:207], v[128:131], v[72:75]
v_add_f32 v16, v16, v17
v_mov_b32 v17, v16
s_waitcnt vmcnt(8)
v_mfma_f32_16x16x32_bf16 v[36:39], v[192:195], v[132:135], v[36:39]
v_permlane16_swap_b32 v16, v17
v_add_f32 v16, v16, v17
v_mfma_f32_16x16x32_bf16 v[44:47], v[196:199], v[132:135], v[44:47]
s_nop 0
v_add_f32_dpp v17, v16, v16 row_ror:8 row_mask:0xf bank_mask:0xf
s_cmp_eq_u32 s41, 3
v_mfma_f32_16x16x32_bf16 v[68:71], v[200:203], v[132:135], v[68:71]
s_cselect_b32 s16, 0x40000000, s19
s_cselect_b32 s17, s19, 0x40000000
v_mfma_f32_16x16x32_bf16 v[76:79], v[204:207], v[132:135], v[76:79]
buffer_store_dword v17, v7, s[4:7], s16 offen
buffer_store_dword v17, v7, s[4:7], s17 offen sc1
s_waitcnt vmcnt(9)
v_mfma_f32_16x16x32_bf16 v[32:35], v[208:211], v[136:139], v[32:35]
v_mfma_f32_16x16x32_bf16 v[40:43], v[212:215], v[136:139], v[40:43]
s_waitcnt vmcnt(8)
v_mfma_f32_16x16x32_bf16 v[36:39], v[208:211], v[140:143], v[36:39]
v_mfma_f32_16x16x32_bf16 v[44:47], v[212:215], v[140:143], v[44:47]
s_waitcnt vmcnt(7)
v_mfma_f32_16x16x32_bf16 v[32:35], v[224:227], v[144:147], v[32:35]
v_mfma_f32_16x16x32_bf16 v[40:43], v[228:231], v[144:147], v[40:43]
s_waitcnt vmcnt(6)
v_mfma_f32_16x16x32_bf16 v[36:39], v[224:227], v[148:151], v[36:39]
v_mfma_f32_16x16x32_bf16 v[44:47], v[228:231], v[148:151], v[44:47]
s_waitcnt vmcnt(5)
v_mfma_f32_16x16x32_bf16 v[32:35], v[240:243], v[152:155], v[32:35]
v_mfma_f32_16x16x32_bf16 v[40:43], v[244:247], v[152:155], v[40:43]
s_waitcnt vmcnt(4)
v_mfma_f32_16x16x32_bf16 v[36:39], v[240:243], v[156:159], v[36:39]
v_mfma_f32_16x16x32_bf16 v[44:47], v[244:247], v[156:159], v[44:47]
v_mfma_f32_16x16x32_bf16 v[64:67], v[216:219], v[136:139], v[64:67]
v_mfma_f32_16x16x32_bf16 v[72:75], v[220:223], v[136:139], v[72:75]
v_mfma_f32_16x16x32_bf16 v[68:71], v[216:219], v[140:143], v[68:71]
v_mfma_f32_16x16x32_bf16 v[76:79], v[220:223], v[140:143], v[76:79]
v_mfma_f32_16x16x32_bf16 v[64:67], v[232:235], v[144:147], v[64:67]
ds_write_b128 v4, v[32:35] offset:32768
v_mfma_f32_16x16x32_bf16 v[72:75], v[236:239], v[144:147], v[72:75]
v_mfma_f32_16x16x32_bf16 v[68:71], v[232:235], v[148:151], v[68:71]
ds_write_b128 v4, v[36:39] offset:33792
v_mfma_f32_16x16x32_bf16 v[76:79], v[236:239], v[148:151], v[76:79]
v_mfma_f32_16x16x32_bf16 v[64:67], v[248:251], v[152:155], v[64:67]
ds_write_b128 v5, v[40:43] offset:34816
v_mfma_f32_16x16x32_bf16 v[72:75], v[252:255], v[152:155], v[72:75]
v_mfma_f32_16x16x32_bf16 v[68:71], v[248:251], v[156:159], v[68:71]
ds_write_b128 v5, v[44:47] offset:35840
v_mfma_f32_16x16x32_bf16 v[76:79], v[252:255], v[156:159], v[76:79]
v_lshlrev_b32 v128, 16, v12
v_and_b32 v129, 0xffff0000, v12
v_lshlrev_b32 v130, 16, v13
v_and_b32 v131, 0xffff0000, v13
v_lshlrev_b32 v132, 16, v14
v_and_b32 v133, 0xffff0000, v14
v_lshlrev_b32 v134, 16, v15
v_and_b32 v135, 0xffff0000, v15
ds_write_b128 v4, v[64:67] offset:36864
ds_write_b128 v4, v[68:71] offset:37888
ds_write_b128 v5, v[72:75] offset:38912
ds_write_b128 v5, v[76:79] offset:39936
s_waitcnt vmcnt(0)
s_waitcnt lgkmcnt(0)
s_barrier
ds_read_b128 v[32:35], v2 offset:32768
ds_read_b128 v[36:39], v2 offset:33280
ds_read_b128 v[40:43], v2 offset:40960
ds_read_b128 v[44:47], v2 offset:41472
ds_read_b128 v[64:67], v2 offset:49152
ds_read_b128 v[68:71], v2 offset:49664
ds_read_b128 v[72:75], v2 offset:57344
ds_read_b128 v[76:79], v2 offset:57856
v_bfrev_b32 v136, 1
v_writelane_b32 v136, s50, 0
v_mov_b32 v137, s33
s_cmp_eq_u32 s41, 3
s_cselect_b32 s16, s51, 0x40000000
buffer_store_dword v137, v136, s[4:7], s16 offen sc1
s_waitcnt lgkmcnt(7)
v_add_f32 v128, v128, v32
v_add_f32 v129, v129, v33
v_add_f32 v130, v130, v34
v_add_f32 v131, v131, v35
s_waitcnt lgkmcnt(6)
v_add_f32 v132, v132, v36
v_add_f32 v133, v133, v37
v_add_f32 v134, v134, v38
v_add_f32 v135, v135, v39
s_waitcnt lgkmcnt(5)
v_add_f32 v128, v128, v40
v_add_f32 v129, v129, v41
v_add_f32 v130, v130, v42
v_add_f32 v131, v131, v43
s_waitcnt lgkmcnt(4)
v_add_f32 v132, v132, v44
v_add_f32 v133, v133, v45
v_add_f32 v134, v134, v46
v_add_f32 v135, v135, v47
s_waitcnt lgkmcnt(1)
v_add_f32 v64, v64, v72
v_add_f32 v65, v65, v73
v_add_f32 v66, v66, v74
v_add_f32 v67, v67, v75
s_waitcnt lgkmcnt(0)
v_add_f32 v68, v68, v76
v_add_f32 v69, v69, v77
v_add_f32 v70, v70, v78
v_add_f32 v71, v71, v79
v_add_f32 v128, v128, v64
v_add_f32 v129, v129, v65
v_add_f32 v130, v130, v66
v_add_f32 v131, v131, v67
v_add_f32 v132, v132, v68
v_add_f32 v133, v133, v69
v_add_f32 v134, v134, v70
v_add_f32 v135, v135, v71
v_cvt_pk_bf16_f32 v12, v128, v129
v_cvt_pk_bf16_f32 v13, v130, v131
v_cvt_pk_bf16_f32 v14, v132, v133
v_cvt_pk_bf16_f32 v15, v134, v135
s_sub_u32 s18, s18, 114688
buffer_store_dwordx4 v[12:15], v3, s[4:7], s18 offen
v_add_f32 v32, v128, v129
v_mul_f32 v33, v128, v128
v_add_f32 v34, v130, v131
v_mul_f32 v35, v129, v129
v_fmac_f32 v33, v130, v130
v_fmac_f32 v35, v131, v131
v_add_f32 v32, v32, v132
v_fmac_f32 v33, v132, v132
v_add_f32 v34, v34, v133
v_fmac_f32 v35, v133, v133
v_add_f32 v32, v32, v134
v_fmac_f32 v33, v134, v134
v_add_f32 v34, v34, v135
v_fmac_f32 v35, v135, v135
v_add_f32 v32, v32, v34
v_add_f32 v33, v33, v35
s_sub_u32 s19, s19, 8192
s_nop 0
v_permlane32_swap_b32 v32, v33
v_add_f32 v32, v32, v33
v_mov_b32 v33, v32
s_nop 1
v_permlane16_swap_b32 v32, v33
v_add_f32 v32, v32, v33
s_nop 1
v_add_f32_dpp v33, v32, v32 row_ror:8 row_mask:0xf bank_mask:0xf
buffer_store_dword v33, v7, s[4:7], s19 offen
s_lshl_b32 s29, s12, 12
s_add_u32 s29, s29, 16878208
v_min_u32 v138, 6, v0
v_lshlrev_b32 v138, 7, v138
buffer_load_dword v140, v138, s[4:7], s29 offen sc1
s_lshl_b32 s20, s12, 4
s_lshr_b32 s16, s13, 4
s_lshl_b32 s16, s16, 3
s_add_u32 s20, s20, s16
s_lshl_b32 s16, s14, 1
s_add_u32 s20, s20, s16
s_and_b32 s16, s20, 63
s_cmp_eq_u32 s16, 0
s_cselect_b32 s21, 0, 1
s_sub_u32 s22, s20, s21
s_sub_u32 s17, s20, s14
s_sub_u32 s17, s17, 1
s_mul_i32 s24, s17, 14336
s_add_u32 s24, s24, 3440640
s_add_u32 s25, s24, 57344
s_mul_i32 s16, s14, 13312
s_sub_u32 s23, s25, s16
s_add_u32 s23, s23, 57344
s_cmp_lt_u32 s14, 2
s_cselect_b32 s23, s23, 0x40000000
s_xor_b32 s16, s21, 1
s_mul_i32 s16, s16, 14336
s_add_u32 s24, s24, s16
s_lshl_b32 s22, s14, 11
s_add_u32 s22, s22, 86016
s_lshl_b32 s19, s14, 10
s_add_u32 s19, s19, 102400
s_lshl_b32 s16, s14, 12
s_add_u32 s16, s16, 86016
v_add_u32 v152, s16, v1
s_lshl_b32 s27, s20, 10
s_add_u32 s27, s27, 16678912
s_lshl_b32 s16, s21, 11
s_sub_u32 s26, s27, s16
v_cmp_gt_u32 vcc, 48, v0
v_bfrev_b32 v207, 1
s_nop 0
v_cndmask_b32 v207, v207, v1, vcc
s_mul_i32 s18, s42, 28
s_lshl_b32 s16, s40, 1
s_add_u32 s18, s18, s16
s_lshr_b32 s16, s14, 1
s_add_u32 s18, s18, s16
s_lshl_b32 s18, s18, 10
s_and_b32 s16, s14, 1
s_lshl_b32 s16, s16, 9
s_add_u32 s18, s18, s16
s_add_u32 s18, s18, 3440640
v_and_b32 v153, 31, v0
v_lshlrev_b32 v153, 4, v153
v_lshrrev_b32 v154, 5, v0
v_lshl_add_u32 v153, v154, 3, v153
s_lshl_b32 s28, s20, 14
s_and_b32 s17, s13, 15
s_lshl_b32 s17, s17, 10
s_add_u32 s28, s28, s17
s_add_u32 s28, s28, 5275648
s_waitcnt vmcnt(1)
s_barrier
s_add_u32 s3, s32, 6
v_bfrev_b32 v76, 1
v_mov_b32 v77, s3
v_writelane_b32 v76, s50, 0
buffer_store_dword v77, v76, s[4:7], s46 offen
s_branch interleave_layers__sliding_local_dilated__glu_gated_swiglu__prompt_kernel_jL
interleave_layers__sliding_local_dilated__glu_gated_swiglu__prompt_kernel_h0L:
s_cmp_lg_u32 s2, 255
s_cbranch_scc1 interleave_layers__sliding_local_dilated__glu_gated_swiglu__prompt_kernel_h1L
s_lshl_b32 s16, s14, 13
s_add_u32 s16, s16, 16846848
v_lshlrev_b32 v16, 7, v0
s_mov_b64 s[18:19], -1
s_mov_b32 s15, 0
L_epL:
buffer_load_dword v18, v16, s[4:7], s16 offen sc1
s_waitcnt vmcnt(0)
s_add_u32 s3, s33, 0
v_subrev_u32 v18, s3, v18
v_cmp_le_u32 vcc, 16, v18
s_nop 0
s_and_b64 vcc, vcc, s[18:19]
s_cbranch_scc0 L_epL_ok
s_add_u32 s15, s15, 1
s_cmp_lt_u32 s15, 131072
s_cbranch_scc1 L_epL
L_epL_ok:
s_barrier
s_mov_b32 s16, 17043456
v_bfrev_b32 v16, 1
v_mov_b32 v17, s33
v_writelane_b32 v16, s50, 0
buffer_store_dword v17, v16, s[4:7], s16 offen sc1
interleave_layers__sliding_local_dilated__glu_gated_swiglu__prompt_kernel_h1L:
s_mul_i32 s17, s12, 917504
s_mul_i32 s16, s45, 57344
s_add_u32 s16, s16, 9207808
s_add_u32 s16, s16, s17
v_lshlrev_b32 v2, 7, v0
buffer_load_dword v16, v2, s[4:7], s16 offen
s_add_u32 s16, s16, 8192
buffer_load_dword v17, v2, s[4:7], s16 offen
s_add_u32 s16, s16, 8192
buffer_load_dword v18, v2, s[4:7], s16 offen
s_add_u32 s16, s16, 8192
buffer_load_dword v19, v2, s[4:7], s16 offen
s_add_u32 s16, s16, 8192
buffer_load_dword v20, v2, s[4:7], s16 offen
s_add_u32 s16, s16, 8192
buffer_load_dword v21, v2, s[4:7], s16 offen
s_add_u32 s16, s16, 8192
buffer_load_dword v22, v2, s[4:7], s16 offen
s_add_u32 s16, s16, 8192
s_waitcnt vmcnt(0)
s_mul_i32 s17, s12, 229376
s_mul_i32 s16, s45, 14336
s_add_u32 s16, s16, 3440640
s_add_u32 s16, s16, s17
v_lshlrev_b32 v2, 7, v0
buffer_load_dword v16, v2, s[4:7], s16 offen
s_add_u32 s16, s16, 8192
buffer_load_dword v17, v2, s[4:7], s16 offen
s_add_u32 s16, s16, 8192
s_waitcnt vmcnt(0)
s_mul_i32 s17, s12, 16384
s_mul_i32 s16, s45, 1024
s_add_u32 s16, s16, 16678912
s_add_u32 s16, s16, s17
v_lshlrev_b32 v2, 7, v0
buffer_load_dword v16, v2, s[4:7], s16 offen
s_add_u32 s16, s16, 8192
s_waitcnt vmcnt(0)
s_lshl_b32 s20, s12, 4
s_lshr_b32 s16, s13, 4
s_lshl_b32 s16, s16, 3
s_add_u32 s20, s20, s16
s_lshl_b32 s16, s14, 1
s_add_u32 s20, s20, s16
s_and_b32 s16, s20, 63
s_cmp_eq_u32 s16, 0
s_cselect_b32 s21, 0, 1
s_sub_u32 s22, s20, s21
s_sub_u32 s17, s20, s14
s_sub_u32 s17, s17, 1
s_mul_i32 s24, s17, 14336
s_add_u32 s24, s24, 3440640
s_add_u32 s25, s24, 57344
s_mul_i32 s16, s14, 13312
s_sub_u32 s23, s25, s16
s_add_u32 s23, s23, 57344
s_cmp_lt_u32 s14, 2
s_cselect_b32 s23, s23, 0x40000000
s_xor_b32 s16, s21, 1
s_mul_i32 s16, s16, 14336
s_add_u32 s24, s24, s16
s_lshl_b32 s22, s14, 11
s_add_u32 s22, s22, 86016
s_lshl_b32 s19, s14, 10
s_add_u32 s19, s19, 102400
s_lshl_b32 s16, s14, 12
s_add_u32 s16, s16, 86016
v_add_u32 v152, s16, v1
s_lshl_b32 s27, s20, 10
s_add_u32 s27, s27, 16678912
s_lshl_b32 s16, s21, 11
s_sub_u32 s26, s27, s16
v_cmp_gt_u32 vcc, 48, v0
v_bfrev_b32 v207, 1
s_nop 0
v_cndmask_b32 v207, v207, v1, vcc
s_mul_i32 s18, s42, 28
s_lshl_b32 s16, s40, 1
s_add_u32 s18, s18, s16
s_lshr_b32 s16, s14, 1
s_add_u32 s18, s18, s16
s_lshl_b32 s18, s18, 10
s_and_b32 s16, s14, 1
s_lshl_b32 s16, s16, 9
s_add_u32 s18, s18, s16
s_add_u32 s18, s18, 3440640
v_and_b32 v153, 31, v0
v_lshlrev_b32 v153, 4, v153
v_lshrrev_b32 v154, 5, v0
v_lshl_add_u32 v153, v154, 3, v153
s_lshl_b32 s28, s20, 14
s_and_b32 s17, s13, 15
s_lshl_b32 s17, s17, 10
s_add_u32 s28, s28, s17
s_add_u32 s28, s28, 5275648
s_cmp_lg_u32 s14, 0
s_cbranch_scc1 L_hs_12_ok
v_lshlrev_b32 v72, 2, v0
s_mov_b32 s15, 0
L_hs_12:
s_sleep 32
buffer_load_dword v74, v72, s[4:7], s43 offen sc1
s_waitcnt vmcnt(0)
s_add_u32 s3, s32, 5
v_subrev_u32 v74, s3, v74
v_cmp_le_u32 vcc, 11, v74
s_nop 0
s_and_b64 vcc, vcc, s[48:49]
s_cbranch_scc0 L_hs_12_ok
s_add_u32 s15, s15, 1
s_cmp_lt_u32 s15, 16384
s_cbranch_scc1 L_hs_12
L_hs_12_ok:
interleave_layers__sliding_local_dilated__glu_gated_swiglu__prompt_kernel_jL:
v_lshrrev_b32 v59, 4, v0
v_and_b32 v61, 15, v0
v_lshlrev_b32 v60, 2, v59
v_sub_u32 v60, v60, v61
v_mov_b32 v62, 0xf149f2ca
v_cmp_le_i32 vcc, 9, v60
s_nop 1
v_cndmask_b32 v216, v62, 0, vcc
v_add_u32 v63, 7, v60
v_cmp_gt_u32 vcc, 8, v63
s_nop 1
v_cndmask_b32 v220, v62, 0, vcc
v_cmp_le_i32 vcc, 8, v60
s_nop 1
v_cndmask_b32 v217, v62, 0, vcc
v_add_u32 v63, 8, v60
v_cmp_gt_u32 vcc, 8, v63
s_nop 1
v_cndmask_b32 v221, v62, 0, vcc
v_cmp_le_i32 vcc, 7, v60
s_nop 1
v_cndmask_b32 v218, v62, 0, vcc
v_add_u32 v63, 9, v60
v_cmp_gt_u32 vcc, 8, v63
s_nop 1
v_cndmask_b32 v222, v62, 0, vcc
v_cmp_le_i32 vcc, 6, v60
s_nop 1
v_cndmask_b32 v219, v62, 0, vcc
v_add_u32 v63, 10, v60
v_cmp_gt_u32 vcc, 8, v63
s_nop 1
v_cndmask_b32 v223, v62, 0, vcc
v_add_u32 v252, 49152, v1
v_lshlrev_b32 v62, 4, v59
v_lshlrev_b32 v63, 2, v61
v_add_u32 v62, 159744, v62
v_add_u32 v63, 159744, v63
ds_read_b128 v[224:227], v62 offset:0
ds_read_b128 v[228:231], v62 offset:64
ds_read_b128 v[232:235], v62 offset:128
ds_read_b128 v[236:239], v62 offset:192
ds_read_b32 v5, v63 offset:256
ds_read_b32 v6, v63 offset:320
s_waitcnt lgkmcnt(0)
s_and_b32 s16, s20, 15
s_cmp_eq_u32 s16, 0
s_cselect_b32 s30, s21, 0
s_mov_b32 s31, 0
s_mul_i32 s30, s30, 0x7f
s_waitcnt vmcnt(1)
s_add_u32 s3, s33, 0
v_subrev_u32 v140, s3, v140
v_cmp_le_u32 vcc, 16, v140
s_nop 0
s_and_b64 vcc, vcc, s[30:31]
s_cbranch_scc0 L_chk_11_ok
s_mov_b32 s15, 0
L_chk_11:
buffer_load_dword v140, v138, s[4:7], s29 offen sc1
s_waitcnt vmcnt(0)
s_add_u32 s3, s33, 0
v_subrev_u32 v140, s3, v140
v_cmp_le_u32 vcc, 16, v140
s_nop 0
s_and_b64 vcc, vcc, s[30:31]
s_cbranch_scc0 L_chk_11_ok
s_add_u32 s15, s15, 1
s_cmp_lt_u32 s15, 131072
s_cbranch_scc1 L_chk_11
L_chk_11_ok:
s_cmp_lg_u32 s14, 0
s_cbranch_scc1 L_wt_13
v_lshlrev_b32 v72, 2, v0
s_add_u32 s3, s32, 6
s_mov_b32 s15, 0
buffer_load_dword v73, v72, s[4:7], s43 offen sc1
s_sleep 1
buffer_load_dword v74, v72, s[4:7], s43 offen sc1
s_sleep 1
L_wt_13_p:
buffer_load_dword v75, v72, s[4:7], s43 offen sc1
s_waitcnt vmcnt(2)
v_subrev_u32 v73, s3, v73
v_cmp_le_u32 vcc, 10, v73
s_nop 0
s_and_b64 vcc, vcc, s[48:49]
s_cbranch_scc0 L_wt_13
buffer_load_dword v73, v72, s[4:7], s43 offen sc1
s_waitcnt vmcnt(2)
v_subrev_u32 v74, s3, v74
v_cmp_le_u32 vcc, 10, v74
s_nop 0
s_and_b64 vcc, vcc, s[48:49]
s_cbranch_scc0 L_wt_13
buffer_load_dword v74, v72, s[4:7], s43 offen sc1
s_waitcnt vmcnt(2)
v_subrev_u32 v75, s3, v75
v_cmp_le_u32 vcc, 10, v75
s_nop 0
s_and_b64 vcc, vcc, s[48:49]
s_cbranch_scc0 L_wt_13
s_add_u32 s15, s15, 1
s_cmp_lt_u32 s15, 131072
s_cbranch_scc1 L_wt_13_p
L_wt_13:
s_barrier
s_add_u32 m0, s22, 0
s_add_u32 s31, s24, 0
buffer_load_dwordx4 v1, s[4:7], s31 offen offset:0 sc1 lds
buffer_load_dwordx4 v1, s[4:7], s31 offen offset:1024 sc1 lds
s_add_u32 m0, s22, 8192
s_add_u32 s31, s25, 0
buffer_load_dwordx4 v1, s[4:7], s31 offen offset:0 sc1 lds
buffer_load_dwordx4 v1, s[4:7], s31 offen offset:1024 sc1 lds
s_add_u32 m0, s19, 0
s_add_u32 s31, s23, 0
buffer_load_dwordx4 v1, s[4:7], s31 offen sc1 lds
s_add_u32 m0, s22, 20480
s_add_u32 s31, s24, 2048
buffer_load_dwordx4 v1, s[4:7], s31 offen offset:0 sc1 lds
buffer_load_dwordx4 v1, s[4:7], s31 offen offset:1024 sc1 lds
s_add_u32 m0, s22, 28672
s_add_u32 s31, s25, 2048
buffer_load_dwordx4 v1, s[4:7], s31 offen offset:0 sc1 lds
buffer_load_dwordx4 v1, s[4:7], s31 offen offset:1024 sc1 lds
s_add_u32 m0, s19, 20480
s_add_u32 s31, s23, 2048
buffer_load_dwordx4 v1, s[4:7], s31 offen sc1 lds
s_waitcnt vmcnt(5)
s_barrier
ds_read_b128 v[136:139], v152 offset:4096
ds_read_b128 v[132:135], v152 offset:2048
ds_read_b128 v[128:131], v152 offset:0
ds_read_b128 v[88:91], v1 offset:2048
ds_read_b128 v[92:95], v1 offset:3072
ds_read_b128 v[80:83], v1 offset:0
ds_read_b128 v[84:87], v1 offset:1024
ds_read_b128 v[96:99], v1 offset:4096
ds_read_b128 v[100:103], v1 offset:5120
s_waitcnt lgkmcnt(0)
v_mfma_f32_16x16x32_bf16 v[48:51], v[88:91], v[136:139], 0
ds_read_b128 v[112:115], v1 offset:8192
buffer_load_dwordx4 v[188:191], v1, s[4:7], s27 offen sc1
v_mfma_f32_16x16x32_bf16 v[40:43], v[88:91], v[132:135], 0
ds_read_b128 v[116:119], v1 offset:9216
buffer_load_dwordx4 v[192:195], v207, s[4:7], s27 offen offset:1024 sc1
v_mfma_f32_16x16x32_bf16 v[32:35], v[88:91], v[128:131], 0
ds_read_b128 v[148:151], v152 offset:5120
buffer_load_dwordx4 v[196:199], v1, s[4:7], s26 offen sc1
v_mfma_f32_16x16x32_bf16 v[52:55], v[92:95], v[136:139], 0
ds_read_b128 v[144:147], v152 offset:3072
buffer_load_dwordx4 v[200:203], v207, s[4:7], s26 offen offset:1024 sc1
v_mfma_f32_16x16x32_bf16 v[44:47], v[92:95], v[132:135], 0
ds_read_b128 v[140:143], v152 offset:1024
s_add_u32 m0, s22, 40960
v_mfma_f32_16x16x32_bf16 v[36:39], v[92:95], v[128:131], 0
ds_read_b128 v[104:107], v1 offset:6144
s_add_u32 s31, s24, 4096
v_mfma_f32_16x16x32_bf16 v[16:19], v[80:83], v[132:135], 0
ds_read_b128 v[108:111], v1 offset:7168
buffer_load_dwordx4 v1, s[4:7], s31 offen offset:0 sc1 lds
v_mfma_f32_16x16x32_bf16 v[24:27], v[80:83], v[136:139], 0
ds_read_b128 v[120:123], v1 offset:10240
buffer_load_dwordx4 v1, s[4:7], s31 offen offset:1024 sc1 lds
v_mfma_f32_16x16x32_bf16 v[20:23], v[84:87], v[132:135], 0
ds_read_b128 v[124:127], v1 offset:11264
s_add_u32 m0, s22, 49152
v_mfma_f32_16x16x32_bf16 v[28:31], v[84:87], v[136:139], 0
s_add_u32 s31, s25, 4096
buffer_load_dwordx4 v1, s[4:7], s31 offen offset:0 sc1 lds
v_mfma_f32_16x16x32_bf16 v[56:59], v[128:131], v[96:99], 0
buffer_load_dwordx4 v1, s[4:7], s31 offen offset:1024 sc1 lds
v_mfma_f32_16x16x32_bf16 v[64:67], v[132:135], v[96:99], 0
s_add_u32 m0, s19, 40960
s_add_u32 s31, s23, 4096
v_mfma_f32_16x16x32_bf16 v[72:75], v[136:139], v[96:99], 0
buffer_load_dwordx4 v1, s[4:7], s31 offen sc1 lds
v_mfma_f32_16x16x32_bf16 v[60:63], v[128:131], v[100:103], 0
v_mfma_f32_16x16x32_bf16 v[68:71], v[132:135], v[100:103], 0
v_mfma_f32_16x16x32_bf16 v[76:79], v[136:139], v[100:103], 0
s_waitcnt lgkmcnt(0)
v_mfma_f32_16x16x32_bf16 v[48:51], v[112:115], v[148:151], v[48:51]
s_waitcnt vmcnt(9)
s_barrier
v_mfma_f32_16x16x32_bf16 v[40:43], v[112:115], v[144:147], v[40:43]
ds_read_b128 v[88:91], v1 offset:14336
s_add_u32 m0, s22, 0
v_mfma_f32_16x16x32_bf16 v[32:35], v[112:115], v[140:143], v[32:35]
ds_read_b128 v[92:95], v1 offset:15360
s_add_u32 s31, s24, 6144
v_mfma_f32_16x16x32_bf16 v[52:55], v[116:119], v[148:151], v[52:55]
ds_read_b128 v[136:139], v152 offset:24576
buffer_load_dwordx4 v1, s[4:7], s31 offen offset:0 sc1 lds
v_mfma_f32_16x16x32_bf16 v[44:47], v[116:119], v[144:147], v[44:47]
ds_read_b128 v[132:135], v152 offset:22528
v_mfma_f32_16x16x32_bf16 v[36:39], v[116:119], v[140:143], v[36:39]
ds_read_b128 v[128:131], v152 offset:20480
v_mfma_f32_16x16x32_bf16 v[16:19], v[104:107], v[144:147], v[16:19]
ds_read_b128 v[80:83], v1 offset:12288
s_lshl_b32 s16, s14, 9
v_mfma_f32_16x16x32_bf16 v[24:27], v[104:107], v[148:151], v[24:27]
ds_read_b128 v[84:87], v1 offset:13312
buffer_load_dwordx4 v1, s[4:7], s31 offen offset:1024 sc1 lds
v_mfma_f32_16x16x32_bf16 v[20:23], v[108:111], v[144:147], v[20:23]
ds_read_b128 v[96:99], v1 offset:16384
s_add_u32 s16, s16, 160768
v_mfma_f32_16x16x32_bf16 v[28:31], v[108:111], v[148:151], v[28:31]
ds_read_b128 v[100:103], v1 offset:17408
v_and_b32 v254, 7, v0
v_mfma_f32_16x16x32_bf16 v[56:59], v[140:143], v[120:123], v[56:59]
v_lshrrev_b32 v255, 4, v0
v_lshl_add_u32 v254, v254, 2, v255
v_mfma_f32_16x16x32_bf16 v[64:67], v[144:147], v[120:123], v[64:67]
s_add_u32 m0, s22, 8192
s_add_u32 s31, s25, 6144
v_mfma_f32_16x16x32_bf16 v[72:75], v[148:151], v[120:123], v[72:75]
buffer_load_dwordx4 v1, s[4:7], s31 offen offset:0 sc1 lds
v_lshl_add_u32 v254, v254, 2, s16
v_mfma_f32_16x16x32_bf16 v[60:63], v[140:143], v[124:127], v[60:63]
s_waitcnt vmcnt(10)
v_add_f32 v188, v188, v192
s_waitcnt vmcnt(8)
v_add_f32 v196, v196, v200
v_mfma_f32_16x16x32_bf16 v[68:71], v[144:147], v[124:127], v[68:71]
v_add_f32 v189, v189, v193
v_add_f32 v197, v197, v201
v_mfma_f32_16x16x32_bf16 v[76:79], v[148:151], v[124:127], v[76:79]
v_add_f32 v190, v190, v194
s_waitcnt lgkmcnt(0)
v_mfma_f32_16x16x32_bf16 v[48:51], v[88:91], v[136:139], v[48:51]
ds_read_b128 v[112:115], v1 offset:20480
buffer_load_dwordx4 v1, s[4:7], s31 offen offset:1024 sc1 lds
v_mfma_f32_16x16x32_bf16 v[40:43], v[88:91], v[132:135], v[40:43]
ds_read_b128 v[116:119], v1 offset:21504
v_add_f32 v198, v198, v202
v_mfma_f32_16x16x32_bf16 v[32:35], v[88:91], v[128:131], v[32:35]
ds_read_b128 v[148:151], v152 offset:25600
v_add_f32 v191, v191, v195
v_mfma_f32_16x16x32_bf16 v[52:55], v[92:95], v[136:139], v[52:55]
ds_read_b128 v[144:147], v152 offset:23552
v_add_f32 v199, v199, v203
v_mfma_f32_16x16x32_bf16 v[44:47], v[92:95], v[132:135], v[44:47]
ds_read_b128 v[140:143], v152 offset:21504
s_add_u32 m0, s19, 0
v_mfma_f32_16x16x32_bf16 v[36:39], v[92:95], v[128:131], v[36:39]
ds_read_b128 v[104:107], v1 offset:18432
s_add_u32 s31, s23, 6144
v_mfma_f32_16x16x32_bf16 v[16:19], v[80:83], v[132:135], v[16:19]
ds_read_b128 v[108:111], v1 offset:19456
buffer_load_dwordx4 v1, s[4:7], s31 offen sc1 lds
v_mfma_f32_16x16x32_bf16 v[24:27], v[80:83], v[136:139], v[24:27]
ds_read_b128 v[120:123], v1 offset:22528
v_permlane32_swap_b32 v188, v190
v_mfma_f32_16x16x32_bf16 v[20:23], v[84:87], v[132:135], v[20:23]
ds_read_b128 v[124:127], v1 offset:23552
v_permlane32_swap_b32 v196, v198
v_mfma_f32_16x16x32_bf16 v[28:31], v[84:87], v[136:139], v[28:31]
v_permlane32_swap_b32 v189, v191
v_permlane32_swap_b32 v197, v199
v_mfma_f32_16x16x32_bf16 v[56:59], v[128:131], v[96:99], v[56:59]
v_add_f32 v188, v188, v190
v_add_f32 v196, v196, v198
v_mfma_f32_16x16x32_bf16 v[64:67], v[132:135], v[96:99], v[64:67]
v_add_f32 v189, v189, v191
v_add_f32 v197, v197, v199
v_mfma_f32_16x16x32_bf16 v[72:75], v[136:139], v[96:99], v[72:75]
v_permlane16_swap_b32 v188, v189
v_permlane16_swap_b32 v196, v197
v_mfma_f32_16x16x32_bf16 v[60:63], v[128:131], v[100:103], v[60:63]
v_add_f32 v188, v188, v189
v_add_f32 v196, v196, v197
v_mfma_f32_16x16x32_bf16 v[68:71], v[132:135], v[100:103], v[68:71]
v_mul_f32 v188, 0x3b124925, v188
v_mul_f32 v196, 0x3b124925, v196
v_mfma_f32_16x16x32_bf16 v[76:79], v[136:139], v[100:103], v[76:79]
v_mov_b32_dpp v189, v188 row_ror:8 row_mask:0xf bank_mask:0xf
s_waitcnt lgkmcnt(0)
v_mfma_f32_16x16x32_bf16 v[48:51], v[112:115], v[148:151], v[48:51]
s_waitcnt vmcnt(5)
s_barrier
v_mfma_f32_16x16x32_bf16 v[40:43], v[112:115], v[144:147], v[40:43]
ds_read_b128 v[88:91], v1 offset:26624
s_add_u32 m0, s22, 20480
v_mfma_f32_16x16x32_bf16 v[32:35], v[112:115], v[140:143], v[32:35]
ds_read_b128 v[92:95], v1 offset:27648
s_add_u32 s31, s24, 8192
v_mfma_f32_16x16x32_bf16 v[52:55], v[116:119], v[148:151], v[52:55]
ds_read_b128 v[136:139], v152 offset:45056
buffer_load_dwordx4 v1, s[4:7], s31 offen offset:0 sc1 lds
v_mfma_f32_16x16x32_bf16 v[44:47], v[116:119], v[144:147], v[44:47]
ds_read_b128 v[132:135], v152 offset:43008
v_mov_b32_dpp v197, v196 row_ror:8 row_mask:0xf bank_mask:0xf
v_mfma_f32_16x16x32_bf16 v[36:39], v[116:119], v[140:143], v[36:39]
ds_read_b128 v[128:131], v152 offset:40960
v_fma_f32 v189, -v188, v188, v189
v_mfma_f32_16x16x32_bf16 v[16:19], v[104:107], v[144:147], v[16:19]
ds_read_b128 v[80:83], v1 offset:24576
v_fma_f32 v197, -v196, v196, v197
v_mfma_f32_16x16x32_bf16 v[24:27], v[104:107], v[148:151], v[24:27]
ds_read_b128 v[84:87], v1 offset:25600
buffer_load_dwordx4 v1, s[4:7], s31 offen offset:1024 sc1 lds
v_mfma_f32_16x16x32_bf16 v[20:23], v[108:111], v[144:147], v[20:23]
ds_read_b128 v[96:99], v1 offset:28672
PG_B_0:
s_cbranch_execz PG_B_4
v_max_f32 v189, 0, v189
v_mfma_f32_16x16x32_bf16 v[28:31], v[108:111], v[148:151], v[28:31]
ds_read_b128 v[100:103], v1 offset:29696
v_max_f32 v197, 0, v197
v_mfma_f32_16x16x32_bf16 v[56:59], v[140:143], v[120:123], v[56:59]
v_add_f32 v189, 0x3727c5ac, v189
v_add_f32 v197, 0x3727c5ac, v197
v_mfma_f32_16x16x32_bf16 v[64:67], v[144:147], v[120:123], v[64:67]
s_add_u32 m0, s22, 28672
s_add_u32 s31, s25, 8192
v_mfma_f32_16x16x32_bf16 v[72:75], v[148:151], v[120:123], v[72:75]
buffer_load_dwordx4 v1, s[4:7], s31 offen offset:0 sc1 lds
v_mfma_f32_16x16x32_bf16 v[60:63], v[140:143], v[124:127], v[60:63]
v_rsq_f32 v189, v189
v_mfma_f32_16x16x32_bf16 v[68:71], v[144:147], v[124:127], v[68:71]
v_rsq_f32 v197, v197
v_mfma_f32_16x16x32_bf16 v[76:79], v[148:151], v[124:127], v[76:79]
s_mov_b32 exec_lo, 0x00ff00ff
s_mov_b32 exec_hi, 0x00ff00ff
ds_write2_b32 v254, v188, v189 offset0:32 offset1:96
ds_write2_b32 v254, v196, v197 offset0:0 offset1:64
s_mov_b64 exec, -1
s_waitcnt lgkmcnt(0)
v_mfma_f32_16x16x32_bf16 v[48:51], v[88:91], v[136:139], v[48:51]
ds_read_b128 v[112:115], v1 offset:32768
buffer_load_dwordx4 v1, s[4:7], s31 offen offset:1024 sc1 lds
v_mfma_f32_16x16x32_bf16 v[40:43], v[88:91], v[132:135], v[40:43]
ds_read_b128 v[116:119], v1 offset:33792
v_and_b32 v254, 15, v0
v_mfma_f32_16x16x32_bf16 v[32:35], v[88:91], v[128:131], v[32:35]
ds_read_b128 v[148:151], v152 offset:46080
v_lshl_add_u32 v254, v254, 2, s16
v_mfma_f32_16x16x32_bf16 v[52:55], v[92:95], v[136:139], v[52:55]
ds_read_b128 v[144:147], v152 offset:44032
v_lshl_add_u32 v255, v255, 4, s16
v_mfma_f32_16x16x32_bf16 v[44:47], v[92:95], v[132:135], v[44:47]
ds_read_b128 v[140:143], v152 offset:41984
s_add_u32 m0, s19, 20480
v_mfma_f32_16x16x32_bf16 v[36:39], v[92:95], v[128:131], v[36:39]
ds_read_b128 v[104:107], v1 offset:30720
s_add_u32 s31, s23, 8192
v_mfma_f32_16x16x32_bf16 v[16:19], v[80:83], v[132:135], v[16:19]
ds_read_b128 v[108:111], v1 offset:31744
buffer_load_dwordx4 v1, s[4:7], s31 offen sc1 lds
v_mfma_f32_16x16x32_bf16 v[24:27], v[80:83], v[136:139], v[24:27]
ds_read_b128 v[120:123], v1 offset:34816
v_mfma_f32_16x16x32_bf16 v[20:23], v[84:87], v[132:135], v[20:23]
ds_read_b128 v[124:127], v1 offset:35840
v_mfma_f32_16x16x32_bf16 v[28:31], v[84:87], v[136:139], v[28:31]
v_mfma_f32_16x16x32_bf16 v[56:59], v[128:131], v[96:99], v[56:59]
v_mfma_f32_16x16x32_bf16 v[64:67], v[132:135], v[96:99], v[64:67]
v_mfma_f32_16x16x32_bf16 v[72:75], v[136:139], v[96:99], v[72:75]
v_mfma_f32_16x16x32_bf16 v[60:63], v[128:131], v[100:103], v[60:63]
v_mfma_f32_16x16x32_bf16 v[68:71], v[132:135], v[100:103], v[68:71]
v_mfma_f32_16x16x32_bf16 v[76:79], v[136:139], v[100:103], v[76:79]
s_waitcnt lgkmcnt(0)
v_mfma_f32_16x16x32_bf16 v[48:51], v[112:115], v[148:151], v[48:51]
s_waitcnt vmcnt(5)
s_barrier
v_mfma_f32_16x16x32_bf16 v[40:43], v[112:115], v[144:147], v[40:43]
ds_read_b128 v[88:91], v1 offset:38912
s_add_u32 m0, s22, 40960
v_mfma_f32_16x16x32_bf16 v[32:35], v[112:115], v[140:143], v[32:35]
ds_read_b128 v[92:95], v1 offset:39936
s_add_u32 s31, s24, 10240
v_mfma_f32_16x16x32_bf16 v[52:55], v[116:119], v[148:151], v[52:55]
ds_read_b128 v[136:139], v152 offset:4096
buffer_load_dwordx4 v1, s[4:7], s31 offen offset:0 sc1 lds
v_mfma_f32_16x16x32_bf16 v[44:47], v[116:119], v[144:147], v[44:47]
ds_read_b128 v[132:135], v152 offset:2048
v_mfma_f32_16x16x32_bf16 v[36:39], v[116:119], v[140:143], v[36:39]
ds_read_b128 v[128:131], v152 offset:0
v_mfma_f32_16x16x32_bf16 v[16:19], v[104:107], v[144:147], v[16:19]
ds_read_b128 v[80:83], v1 offset:36864
v_mfma_f32_16x16x32_bf16 v[24:27], v[104:107], v[148:151], v[24:27]
ds_read_b128 v[84:87], v1 offset:37888
buffer_load_dwordx4 v1, s[4:7], s31 offen offset:1024 sc1 lds
v_mfma_f32_16x16x32_bf16 v[20:23], v[108:111], v[144:147], v[20:23]
ds_read_b128 v[96:99], v1 offset:40960
ds_read_b32 v2, v254 offset:64
v_mfma_f32_16x16x32_bf16 v[28:31], v[108:111], v[148:151], v[28:31]
ds_read_b128 v[100:103], v1 offset:41984
ds_read_b32 v3, v254 offset:128
v_mfma_f32_16x16x32_bf16 v[56:59], v[140:143], v[120:123], v[56:59]
ds_read_b32 v4, v254 offset:192
ds_read_b128 v[240:243], v255 offset:64
v_mfma_f32_16x16x32_bf16 v[64:67], v[144:147], v[120:123], v[64:67]
s_add_u32 m0, s22, 49152
s_add_u32 s31, s25, 10240
v_mfma_f32_16x16x32_bf16 v[72:75], v[148:151], v[120:123], v[72:75]
buffer_load_dwordx4 v1, s[4:7], s31 offen offset:0 sc1 lds
ds_read_b128 v[244:247], v255 offset:128
v_mfma_f32_16x16x32_bf16 v[60:63], v[140:143], v[124:127], v[60:63]
ds_read_b128 v[248:251], v255 offset:192
v_mfma_f32_16x16x32_bf16 v[68:71], v[144:147], v[124:127], v[68:71]
v_mfma_f32_16x16x32_bf16 v[76:79], v[148:151], v[124:127], v[76:79]
s_waitcnt lgkmcnt(0)
v_mfma_f32_16x16x32_bf16 v[48:51], v[88:91], v[136:139], v[48:51]
ds_read_b128 v[112:115], v1 offset:45056
buffer_load_dwordx4 v1, s[4:7], s31 offen offset:1024 sc1 lds
v_mfma_f32_16x16x32_bf16 v[40:43], v[88:91], v[132:135], v[40:43]
ds_read_b128 v[116:119], v1 offset:46080
v_fma_f32 v44, -v3, v236, v44
v_mfma_f32_16x16x32_bf16 v[32:35], v[88:91], v[128:131], v[32:35]
ds_read_b128 v[148:151], v152 offset:5120
v_fma_f32 v36, -v2, v236, v36
v_mfma_f32_16x16x32_bf16 v[52:55], v[92:95], v[136:139], v[52:55]
ds_read_b128 v[144:147], v152 offset:3072
v_fma_f32 v16, -v3, v224, v16
v_mfma_f32_16x16x32_bf16 v[44:47], v[92:95], v[132:135], v[44:47]
ds_read_b128 v[140:143], v152 offset:1024
s_add_u32 m0, s19, 40960
v_mfma_f32_16x16x32_bf16 v[36:39], v[92:95], v[128:131], v[36:39]
ds_read_b128 v[104:107], v1 offset:43008
s_add_u32 s31, s23, 10240
v_mfma_f32_16x16x32_bf16 v[16:19], v[80:83], v[132:135], v[16:19]
ds_read_b128 v[108:111], v1 offset:44032
buffer_load_dwordx4 v1, s[4:7], s31 offen sc1 lds
v_mfma_f32_16x16x32_bf16 v[24:27], v[80:83], v[136:139], v[24:27]
ds_read_b128 v[120:123], v1 offset:47104
v_fma_f32 v48, -v4, v232, v48
v_mfma_f32_16x16x32_bf16 v[20:23], v[84:87], v[132:135], v[20:23]
ds_read_b128 v[124:127], v1 offset:48128
v_fma_f32 v49, -v4, v233, v49
v_mfma_f32_16x16x32_bf16 v[28:31], v[84:87], v[136:139], v[28:31]
v_fma_f32 v50, -v4, v234, v50
v_fma_f32 v51, -v4, v235, v51
v_mfma_f32_16x16x32_bf16 v[56:59], v[128:131], v[96:99], v[56:59]
v_fma_f32 v40, -v3, v232, v40
v_fma_f32 v41, -v3, v233, v41
v_mfma_f32_16x16x32_bf16 v[64:67], v[132:135], v[96:99], v[64:67]
v_fma_f32 v42, -v3, v234, v42
v_fma_f32 v43, -v3, v235, v43
v_mfma_f32_16x16x32_bf16 v[72:75], v[136:139], v[96:99], v[72:75]
v_fma_f32 v32, -v2, v232, v32
v_fma_f32 v33, -v2, v233, v33
v_mfma_f32_16x16x32_bf16 v[60:63], v[128:131], v[100:103], v[60:63]
v_fma_f32 v34, -v2, v234, v34
v_fma_f32 v35, -v2, v235, v35
v_mfma_f32_16x16x32_bf16 v[68:71], v[132:135], v[100:103], v[68:71]
v_fma_f32 v52, -v4, v236, v52
v_fma_f32 v53, -v4, v237, v53
v_mfma_f32_16x16x32_bf16 v[76:79], v[136:139], v[100:103], v[76:79]
v_fma_f32 v54, -v4, v238, v54
s_waitcnt lgkmcnt(0)
v_mfma_f32_16x16x32_bf16 v[48:51], v[112:115], v[148:151], v[48:51]
s_waitcnt vmcnt(5)
s_barrier
v_mfma_f32_16x16x32_bf16 v[40:43], v[112:115], v[144:147], v[40:43]
ds_read_b128 v[88:91], v252 offset:2048
s_add_u32 m0, s22, 0
v_mfma_f32_16x16x32_bf16 v[32:35], v[112:115], v[140:143], v[32:35]
ds_read_b128 v[92:95], v252 offset:3072
s_add_u32 s31, s24, 12288
v_mfma_f32_16x16x32_bf16 v[52:55], v[116:119], v[148:151], v[52:55]
ds_read_b128 v[136:139], v152 offset:24576
buffer_load_dwordx4 v1, s[4:7], s31 offen offset:0 sc1 lds
v_mfma_f32_16x16x32_bf16 v[44:47], v[116:119], v[144:147], v[44:47]
ds_read_b128 v[132:135], v152 offset:22528
v_fma_f32 v24, -v4, v224, v24
v_mfma_f32_16x16x32_bf16 v[36:39], v[116:119], v[140:143], v[36:39]
ds_read_b128 v[128:131], v152 offset:20480
v_fma_f32 v20, -v3, v228, v20
v_mfma_f32_16x16x32_bf16 v[16:19], v[104:107], v[144:147], v[16:19]
ds_read_b128 v[80:83], v252 offset:0
v_fma_f32 v28, -v4, v228, v28
v_mfma_f32_16x16x32_bf16 v[24:27], v[104:107], v[148:151], v[24:27]
ds_read_b128 v[84:87], v252 offset:1024
buffer_load_dwordx4 v1, s[4:7], s31 offen offset:1024 sc1 lds
v_mfma_f32_16x16x32_bf16 v[20:23], v[108:111], v[144:147], v[20:23]
ds_read_b128 v[96:99], v252 offset:4096
v_fma_f32 v64, -v244, v5, v64
v_mfma_f32_16x16x32_bf16 v[28:31], v[108:111], v[148:151], v[28:31]
ds_read_b128 v[100:103], v252 offset:5120
v_fma_f32 v55, -v4, v239, v55
v_mfma_f32_16x16x32_bf16 v[56:59], v[140:143], v[120:123], v[56:59]
v_fma_f32 v45, -v3, v237, v45
v_fma_f32 v46, -v3, v238, v46
v_mfma_f32_16x16x32_bf16 v[64:67], v[144:147], v[120:123], v[64:67]
s_add_u32 m0, s22, 8192
s_add_u32 s31, s25, 12288
v_mfma_f32_16x16x32_bf16 v[72:75], v[148:151], v[120:123], v[72:75]
buffer_load_dwordx4 v1, s[4:7], s31 offen offset:0 sc1 lds
v_fma_f32 v47, -v3, v239, v47
v_mfma_f32_16x16x32_bf16 v[60:63], v[140:143], v[124:127], v[60:63]
v_fma_f32 v37, -v2, v237, v37
v_fma_f32 v38, -v2, v238, v38
v_mfma_f32_16x16x32_bf16 v[68:71], v[144:147], v[124:127], v[68:71]
v_fma_f32 v39, -v2, v239, v39
v_fma_f32 v17, -v3, v225, v17
v_mfma_f32_16x16x32_bf16 v[76:79], v[148:151], v[124:127], v[76:79]
v_fma_f32 v18, -v3, v226, v18
s_waitcnt lgkmcnt(0)
v_mfma_f32_16x16x32_bf16 v[48:51], v[88:91], v[136:139], v[48:51]
ds_read_b128 v[112:115], v252 offset:8192
buffer_load_dwordx4 v1, s[4:7], s31 offen offset:1024 sc1 lds
v_mfma_f32_16x16x32_bf16 v[40:43], v[88:91], v[132:135], v[40:43]
ds_read_b128 v[116:119], v252 offset:9216
v_fma_f32 v19, -v3, v227, v19
v_mfma_f32_16x16x32_bf16 v[32:35], v[88:91], v[128:131], v[32:35]
ds_read_b128 v[148:151], v152 offset:25600
v_fma_f32 v25, -v4, v225, v25
v_mfma_f32_16x16x32_bf16 v[52:55], v[92:95], v[136:139], v[52:55]
ds_read_b128 v[144:147], v152 offset:23552
v_fma_f32 v26, -v4, v226, v26
v_mfma_f32_16x16x32_bf16 v[44:47], v[92:95], v[132:135], v[44:47]
ds_read_b128 v[140:143], v152 offset:21504
s_add_u32 m0, s19, 0
v_mfma_f32_16x16x32_bf16 v[36:39], v[92:95], v[128:131], v[36:39]
ds_read_b128 v[104:107], v252 offset:6144
s_add_u32 s31, s23, 12288
v_mfma_f32_16x16x32_bf16 v[16:19], v[80:83], v[132:135], v[16:19]
ds_read_b128 v[108:111], v252 offset:7168
buffer_load_dwordx4 v1, s[4:7], s31 offen sc1 lds
v_mfma_f32_16x16x32_bf16 v[24:27], v[80:83], v[136:139], v[24:27]
ds_read_b128 v[120:123], v252 offset:10240
v_fma_f32 v56, -v240, v5, v56
v_mfma_f32_16x16x32_bf16 v[20:23], v[84:87], v[132:135], v[20:23]
ds_read_b128 v[124:127], v252 offset:11264
buffer_load_dwordx2 v[8:9], v153, s[4:7], s18 offen sc1
v_mfma_f32_16x16x32_bf16 v[28:31], v[84:87], v[136:139], v[28:31]
v_fma_f32 v72, -v248, v5, v72
v_fma_f32 v73, -v249, v5, v73
v_mfma_f32_16x16x32_bf16 v[56:59], v[128:131], v[96:99], v[56:59]
s_add_u32 s18, s18, 14336
buffer_load_dwordx2 v[10:11], v153, s[4:7], s18 offen sc1
v_mfma_f32_16x16x32_bf16 v[64:67], v[132:135], v[96:99], v[64:67]
v_fma_f32 v68, -v244, v6, v68
v_fma_f32 v69, -v245, v6, v69
v_mfma_f32_16x16x32_bf16 v[72:75], v[136:139], v[96:99], v[72:75]
s_add_u32 s18, s18, 100352
buffer_load_dwordx2 v[12:13], v153, s[4:7], s18 offen sc1
v_mfma_f32_16x16x32_bf16 v[60:63], v[128:131], v[100:103], v[60:63]
v_fma_f32 v27, -v4, v227, v27
v_mfma_f32_16x16x32_bf16 v[68:71], v[132:135], v[100:103], v[68:71]
s_add_u32 s18, s18, 14336
buffer_load_dwordx2 v[14:15], v153, s[4:7], s18 offen sc1
v_mfma_f32_16x16x32_bf16 v[76:79], v[136:139], v[100:103], v[76:79]
v_fma_f32 v21, -v3, v229, v21
s_waitcnt lgkmcnt(0)
v_mfma_f32_16x16x32_bf16 v[48:51], v[112:115], v[148:151], v[48:51]
s_waitcnt vmcnt(9)
s_barrier
v_mfma_f32_16x16x32_bf16 v[40:43], v[112:115], v[144:147], v[40:43]
ds_read_b128 v[88:91], v252 offset:14336
v_fma_f32 v22, -v3, v230, v22
v_mfma_f32_16x16x32_bf16 v[32:35], v[112:115], v[140:143], v[32:35]
ds_read_b128 v[92:95], v252 offset:15360
s_lshl_b32 s30, s40, 16
v_mfma_f32_16x16x32_bf16 v[52:55], v[116:119], v[148:151], v[52:55]
ds_read_b128 v[136:139], v152 offset:45056
s_lshl_b32 s29, s14, 14
v_mfma_f32_16x16x32_bf16 v[44:47], v[116:119], v[144:147], v[44:47]
ds_read_b128 v[132:135], v152 offset:43008
s_add_u32 s30, s30, s29
v_mfma_f32_16x16x32_bf16 v[36:39], v[116:119], v[140:143], v[36:39]
ds_read_b128 v[128:131], v152 offset:40960
s_add_u32 s30, s30, 1605632
v_mfma_f32_16x16x32_bf16 v[16:19], v[104:107], v[144:147], v[16:19]
ds_read_b128 v[80:83], v252 offset:12288
s_add_u32 s29, s30, 0
v_mfma_f32_16x16x32_bf16 v[24:27], v[104:107], v[148:151], v[24:27]
ds_read_b128 v[84:87], v252 offset:13312
buffer_load_dwordx4 v[156:159], v1, s[4:7], s29 offen offset:3072 sc1
v_mfma_f32_16x16x32_bf16 v[20:23], v[108:111], v[144:147], v[20:23]
ds_read_b128 v[96:99], v252 offset:16384
v_fma_f32 v65, -v245, v5, v65
v_mfma_f32_16x16x32_bf16 v[28:31], v[108:111], v[148:151], v[28:31]
ds_read_b128 v[100:103], v252 offset:17408
v_fma_f32 v74, -v250, v5, v74
v_mfma_f32_16x16x32_bf16 v[56:59], v[140:143], v[120:123], v[56:59]
v_fma_f32 v60, -v240, v6, v60
v_fma_f32 v61, -v241, v6, v61
v_mfma_f32_16x16x32_bf16 v[64:67], v[144:147], v[120:123], v[64:67]
v_fma_f32 v70, -v246, v6, v70
v_fma_f32 v71, -v247, v6, v71
v_mfma_f32_16x16x32_bf16 v[72:75], v[148:151], v[120:123], v[72:75]
s_add_u32 s29, s30, 4096
buffer_load_dwordx4 v[160:163], v1, s[4:7], s29 offen offset:0 sc1
v_mfma_f32_16x16x32_bf16 v[60:63], v[140:143], v[124:127], v[60:63]
v_mfma_f32_16x16x32_bf16 v[68:71], v[144:147], v[124:127], v[68:71]
v_fma_f32 v23, -v3, v231, v23
v_mfma_f32_16x16x32_bf16 v[76:79], v[148:151], v[124:127], v[76:79]
v_fma_f32 v29, -v4, v229, v29
s_waitcnt lgkmcnt(0)
v_mfma_f32_16x16x32_bf16 v[48:51], v[88:91], v[136:139], v[48:51]
ds_read_b128 v[112:115], v252 offset:20480
v_fma_f32 v30, -v4, v230, v30
v_mfma_f32_16x16x32_bf16 v[40:43], v[88:91], v[132:135], v[40:43]
ds_read_b128 v[116:119], v252 offset:21504
v_fma_f32 v31, -v4, v231, v31
v_mfma_f32_16x16x32_bf16 v[32:35], v[88:91], v[128:131], v[32:35]
ds_read_b128 v[148:151], v152 offset:46080
buffer_load_dwordx4 v[164:167], v1, s[4:7], s29 offen offset:1024 sc1
v_mfma_f32_16x16x32_bf16 v[52:55], v[92:95], v[136:139], v[52:55]
ds_read_b128 v[144:147], v152 offset:44032
v_fma_f32 v57, -v241, v5, v57
v_mfma_f32_16x16x32_bf16 v[44:47], v[92:95], v[132:135], v[44:47]
ds_read_b128 v[140:143], v152 offset:41984
v_fma_f32 v58, -v242, v5, v58
v_mfma_f32_16x16x32_bf16 v[36:39], v[92:95], v[128:131], v[36:39]
ds_read_b128 v[104:107], v252 offset:18432
buffer_load_dwordx4 v[168:171], v1, s[4:7], s29 offen offset:2048 sc1
v_mfma_f32_16x16x32_bf16 v[16:19], v[80:83], v[132:135], v[16:19]
ds_read_b128 v[108:111], v252 offset:19456
v_fma_f32 v59, -v243, v5, v59
v_mfma_f32_16x16x32_bf16 v[24:27], v[80:83], v[136:139], v[24:27]
ds_read_b128 v[120:123], v252 offset:22528
v_fma_f32 v66, -v246, v5, v66
v_mfma_f32_16x16x32_bf16 v[20:23], v[84:87], v[132:135], v[20:23]
ds_read_b128 v[124:127], v252 offset:23552
buffer_load_dwordx4 v[172:175], v1, s[4:7], s29 offen offset:3072 sc1
v_mfma_f32_16x16x32_bf16 v[28:31], v[84:87], v[136:139], v[28:31]
v_fma_f32 v75, -v251, v5, v75
v_fma_f32 v62, -v242, v6, v62
v_mfma_f32_16x16x32_bf16 v[56:59], v[128:131], v[96:99], v[56:59]
v_fma_f32 v63, -v243, v6, v63
v_fma_f32 v76, -v248, v6, v76
v_mfma_f32_16x16x32_bf16 v[64:67], v[132:135], v[96:99], v[64:67]
v_fma_f32 v77, -v249, v6, v77
v_fma_f32 v78, -v250, v6, v78
v_mfma_f32_16x16x32_bf16 v[72:75], v[136:139], v[96:99], v[72:75]
v_fma_f32 v79, -v251, v6, v79
v_mfma_f32_16x16x32_bf16 v[60:63], v[128:131], v[100:103], v[60:63]
v_mfma_f32_16x16x32_bf16 v[68:71], v[132:135], v[100:103], v[68:71]
v_mfma_f32_16x16x32_bf16 v[76:79], v[136:139], v[100:103], v[76:79]
s_waitcnt lgkmcnt(0)
v_mfma_f32_16x16x32_bf16 v[48:51], v[112:115], v[148:151], v[48:51]
s_waitcnt vmcnt(9)
s_barrier
v_mfma_f32_16x16x32_bf16 v[40:43], v[112:115], v[144:147], v[40:43]
ds_read_b128 v[88:91], v252 offset:26624
v_fma_f32 v67, -v247, v5, v67
v_mfma_f32_16x16x32_bf16 v[32:35], v[112:115], v[140:143], v[32:35]
ds_read_b128 v[92:95], v252 offset:27648
s_add_u32 s29, s30, 8192
v_mfma_f32_16x16x32_bf16 v[52:55], v[116:119], v[148:151], v[52:55]
ds_read_b128 v[136:139], v152 offset:4096
buffer_load_dwordx4 v[176:179], v1, s[4:7], s29 offen offset:0 sc1
v_mfma_f32_16x16x32_bf16 v[44:47], v[116:119], v[144:147], v[44:47]
ds_read_b128 v[132:135], v152 offset:2048
v_mfma_f32_16x16x32_bf16 v[36:39], v[116:119], v[140:143], v[36:39]
ds_read_b128 v[128:131], v152 offset:0
v_mfma_f32_16x16x32_bf16 v[16:19], v[104:107], v[144:147], v[16:19]
ds_read_b128 v[80:83], v252 offset:24576
buffer_load_dwordx4 v[180:183], v1, s[4:7], s29 offen offset:1024 sc1
v_mfma_f32_16x16x32_bf16 v[24:27], v[104:107], v[148:151], v[24:27]
ds_read_b128 v[84:87], v252 offset:25600
v_mfma_f32_16x16x32_bf16 v[20:23], v[108:111], v[144:147], v[20:23]
ds_read_b128 v[96:99], v252 offset:28672
v_mfma_f32_16x16x32_bf16 v[28:31], v[108:111], v[148:151], v[28:31]
ds_read_b128 v[100:103], v252 offset:29696
buffer_load_dwordx4 v[184:187], v1, s[4:7], s29 offen offset:2048 sc1
v_mfma_f32_16x16x32_bf16 v[56:59], v[140:143], v[120:123], v[56:59]
v_mfma_f32_16x16x32_bf16 v[64:67], v[144:147], v[120:123], v[64:67]
v_mfma_f32_16x16x32_bf16 v[72:75], v[148:151], v[120:123], v[72:75]
v_mfma_f32_16x16x32_bf16 v[60:63], v[140:143], v[124:127], v[60:63]
v_mfma_f32_16x16x32_bf16 v[68:71], v[144:147], v[124:127], v[68:71]
v_mfma_f32_16x16x32_bf16 v[76:79], v[148:151], v[124:127], v[76:79]
s_waitcnt lgkmcnt(0)
v_mfma_f32_16x16x32_bf16 v[48:51], v[88:91], v[136:139], v[48:51]
ds_read_b128 v[112:115], v252 offset:32768
v_mfma_f32_16x16x32_bf16 v[40:43], v[88:91], v[132:135], v[40:43]
ds_read_b128 v[116:119], v252 offset:33792
v_mfma_f32_16x16x32_bf16 v[32:35], v[88:91], v[128:131], v[32:35]
ds_read_b128 v[148:151], v152 offset:5120
buffer_load_dwordx4 v[188:191], v1, s[4:7], s29 offen offset:3072 sc1
v_mfma_f32_16x16x32_bf16 v[52:55], v[92:95], v[136:139], v[52:55]
ds_read_b128 v[144:147], v152 offset:3072
v_mfma_f32_16x16x32_bf16 v[44:47], v[92:95], v[132:135], v[44:47]
ds_read_b128 v[140:143], v152 offset:1024
v_mfma_f32_16x16x32_bf16 v[36:39], v[92:95], v[128:131], v[36:39]
ds_read_b128 v[104:107], v252 offset:30720
s_add_u32 s29, s30, 12288
v_mfma_f32_16x16x32_bf16 v[16:19], v[80:83], v[132:135], v[16:19]
ds_read_b128 v[108:111], v252 offset:31744
buffer_load_dwordx4 v[192:195], v1, s[4:7], s29 offen offset:0 sc1
v_mfma_f32_16x16x32_bf16 v[24:27], v[80:83], v[136:139], v[24:27]
ds_read_b128 v[120:123], v252 offset:34816
v_mfma_f32_16x16x32_bf16 v[20:23], v[84:87], v[132:135], v[20:23]
ds_read_b128 v[124:127], v252 offset:35840
v_mfma_f32_16x16x32_bf16 v[28:31], v[84:87], v[136:139], v[28:31]
buffer_load_dwordx4 v[196:199], v1, s[4:7], s29 offen offset:1024 sc1
v_mfma_f32_16x16x32_bf16 v[56:59], v[128:131], v[96:99], v[56:59]
v_mfma_f32_16x16x32_bf16 v[64:67], v[132:135], v[96:99], v[64:67]
v_mfma_f32_16x16x32_bf16 v[72:75], v[136:139], v[96:99], v[72:75]
v_mfma_f32_16x16x32_bf16 v[60:63], v[128:131], v[100:103], v[60:63]
v_mfma_f32_16x16x32_bf16 v[68:71], v[132:135], v[100:103], v[68:71]
v_mfma_f32_16x16x32_bf16 v[76:79], v[136:139], v[100:103], v[76:79]
s_waitcnt lgkmcnt(0)
v_mfma_f32_16x16x32_bf16 v[48:51], v[112:115], v[148:151], v[48:51]
v_mfma_f32_16x16x32_bf16 v[40:43], v[112:115], v[144:147], v[40:43]
v_mfma_f32_16x16x32_bf16 v[32:35], v[112:115], v[140:143], v[32:35]
buffer_load_dwordx4 v[200:203], v1, s[4:7], s29 offen offset:2048 sc1
v_mfma_f32_16x16x32_bf16 v[52:55], v[116:119], v[148:151], v[52:55]
v_mfma_f32_16x16x32_bf16 v[44:47], v[116:119], v[144:147], v[44:47]
v_mfma_f32_16x16x32_bf16 v[36:39], v[116:119], v[140:143], v[36:39]
v_mfma_f32_16x16x32_bf16 v[16:19], v[104:107], v[144:147], v[16:19]
v_mfma_f32_16x16x32_bf16 v[24:27], v[104:107], v[148:151], v[24:27]
buffer_load_dwordx4 v[204:207], v1, s[4:7], s29 offen offset:3072 sc1
v_mfma_f32_16x16x32_bf16 v[20:23], v[108:111], v[144:147], v[20:23]
v_mfma_f32_16x16x32_bf16 v[28:31], v[108:111], v[148:151], v[28:31]
v_mfma_f32_16x16x32_bf16 v[56:59], v[140:143], v[120:123], v[56:59]
v_mfma_f32_16x16x32_bf16 v[64:67], v[144:147], v[120:123], v[64:67]
v_mfma_f32_16x16x32_bf16 v[72:75], v[148:151], v[120:123], v[72:75]
v_mfma_f32_16x16x32_bf16 v[60:63], v[140:143], v[124:127], v[60:63]
v_mfma_f32_16x16x32_bf16 v[68:71], v[144:147], v[124:127], v[68:71]
v_mfma_f32_16x16x32_bf16 v[76:79], v[148:151], v[124:127], v[76:79]
s_lshl_b32 s30, s40, 16
s_lshl_b32 s29, s14, 14
s_add_u32 s30, s30, s29
s_add_u32 s30, s30, 1605632
s_add_u32 s29, s30, 0
buffer_load_dwordx4 v[144:147], v1, s[4:7], s29 offen offset:0 sc1
buffer_load_dwordx4 v[148:151], v1, s[4:7], s29 offen offset:1024 sc1
buffer_load_dwordx4 v[152:155], v1, s[4:7], s29 offen offset:2048 sc1
s_lshl_b32 s16, s14, 9
s_add_u32 s16, s16, 160768
v_and_b32 v130, 15, v0
v_lshrrev_b32 v131, 4, v0
v_lshl_add_u32 v132, v130, 2, s16
v_lshl_add_u32 v133, v131, 4, s16
ds_read_b32 v112, v132 offset:320
ds_read_b32 v113, v132 offset:384
ds_read_b32 v114, v132 offset:448
ds_read_b128 v[116:119], v133 offset:320
ds_read_b128 v[120:123], v133 offset:384
ds_read_b128 v[124:127], v133 offset:448
v_cvt_pk_bf16_f32 v92, v16, v17
v_cvt_pk_bf16_f32 v93, v18, v19
v_cvt_pk_bf16_f32 v94, v20, v21
v_cvt_pk_bf16_f32 v95, v22, v23
v_cvt_pk_bf16_f32 v96, v24, v25
v_cvt_pk_bf16_f32 v97, v26, v27
v_cvt_pk_bf16_f32 v98, v28, v29
v_cvt_pk_bf16_f32 v99, v30, v31
s_cmp_eq_u32 s21, 1
s_cselect_b64 vcc, -1, 0
v_mov_b32 v140, 0xf149f2ca
s_waitcnt lgkmcnt(5)
v_mul_f32 v32, v32, v112
v_mul_f32 v33, v33, v112
v_mul_f32 v34, v34, v112
v_mul_f32 v35, v35, v112
v_cvt_pk_bf16_f32 v80, v32, v33
v_cvt_pk_bf16_f32 v81, v34, v35
v_mul_f32 v36, v36, v112
v_mul_f32 v37, v37, v112
v_mul_f32 v38, v38, v112
v_mul_f32 v39, v39, v112
v_cvt_pk_bf16_f32 v82, v36, v37
v_cvt_pk_bf16_f32 v83, v38, v39
s_waitcnt lgkmcnt(4)
v_mul_f32 v40, v40, v113
v_mul_f32 v41, v41, v113
v_mul_f32 v42, v42, v113
v_mul_f32 v43, v43, v113
v_cvt_pk_bf16_f32 v84, v40, v41
v_cvt_pk_bf16_f32 v85, v42, v43
v_mul_f32 v44, v44, v113
v_mul_f32 v45, v45, v113
v_mul_f32 v46, v46, v113
v_mul_f32 v47, v47, v113
v_cvt_pk_bf16_f32 v86, v44, v45
v_cvt_pk_bf16_f32 v87, v46, v47
s_waitcnt lgkmcnt(3)
v_mul_f32 v48, v48, v114
v_mul_f32 v49, v49, v114
v_mul_f32 v50, v50, v114
v_mul_f32 v51, v51, v114
v_cvt_pk_bf16_f32 v88, v48, v49
v_cvt_pk_bf16_f32 v89, v50, v51
v_mul_f32 v52, v52, v114
v_mul_f32 v53, v53, v114
v_mul_f32 v54, v54, v114
v_mul_f32 v55, v55, v114
v_cvt_pk_bf16_f32 v90, v52, v53
v_cvt_pk_bf16_f32 v91, v54, v55
v_cndmask_b32 v136, v140, v216, vcc
v_cndmask_b32 v137, v140, v217, vcc
v_cndmask_b32 v138, v140, v218, vcc
v_cndmask_b32 v139, v140, v219, vcc
v_mul_f32 v141, 0x3e8b97f6, v113
v_mul_f32 v142, 0x3e8b97f6, v114
v_mfma_f32_16x16x32_bf16 v[16:19], v[80:83], v[92:95], v[136:139]
v_mfma_f32_16x16x32_bf16 v[20:23], v[84:87], v[92:95], v[220:223]
v_mfma_f32_16x16x32_bf16 v[24:27], v[84:87], v[96:99], v[216:219]
v_mfma_f32_16x16x32_bf16 v[28:31], v[88:91], v[96:99], v[220:223]
s_waitcnt lgkmcnt(2)
v_mul_f32 v56, v56, v116
v_mul_f32 v57, v57, v117
v_mul_f32 v58, v58, v118
v_mul_f32 v59, v59, v119
v_cvt_pk_bf16_f32 v100, v56, v57
v_cvt_pk_bf16_f32 v101, v58, v59
v_mul_f32 v60, v60, v116
v_mul_f32 v61, v61, v117
v_max3_f32 v40, v16, v17, v18
v_max3_f32 v41, v19, v20, v21
v_max3_f32 v40, v40, v22, v23
v_max_f32 v40, v40, v41
v_max3_f32 v44, v24, v25, v26
v_max3_f32 v45, v27, v28, v29
v_max3_f32 v44, v44, v30, v31
v_max_f32 v44, v44, v45
v_mov_b32 v41, v40
v_mov_b32 v45, v44
v_mul_f32 v62, v62, v118
v_mul_f32 v63, v63, v119
v_permlane16_swap_b32 v40, v41
v_permlane16_swap_b32 v44, v45
v_max_f32 v40, v40, v41
v_max_f32 v44, v44, v45
v_mov_b32 v41, v40
v_mov_b32 v45, v44
v_cvt_pk_bf16_f32 v106, v60, v61
v_cvt_pk_bf16_f32 v107, v62, v63
v_permlane32_swap_b32 v40, v41
v_permlane32_swap_b32 v44, v45
v_max_f32 v40, v40, v41
v_max_f32 v44, v44, v45
v_mul_f32 v40, v40, v141
v_mul_f32 v44, v44, v142
v_fma_f32 v16, v16, v141, -v40
v_fma_f32 v17, v17, v141, -v40
v_fma_f32 v18, v18, v141, -v40
v_fma_f32 v19, v19, v141, -v40
v_fma_f32 v20, v20, v141, -v40
v_fma_f32 v21, v21, v141, -v40
v_fma_f32 v22, v22, v141, -v40
v_fma_f32 v23, v23, v141, -v40
v_fma_f32 v24, v24, v142, -v44
v_fma_f32 v25, v25, v142, -v44
v_fma_f32 v26, v26, v142, -v44
v_fma_f32 v27, v27, v142, -v44
v_fma_f32 v28, v28, v142, -v44
v_fma_f32 v29, v29, v142, -v44
v_fma_f32 v30, v30, v142, -v44
v_fma_f32 v31, v31, v142, -v44
v_exp_f32 v16, v16
v_exp_f32 v17, v17
v_exp_f32 v18, v18
v_exp_f32 v19, v19
v_exp_f32 v20, v20
v_exp_f32 v21, v21
v_exp_f32 v22, v22
v_exp_f32 v23, v23
v_exp_f32 v24, v24
v_exp_f32 v25, v25
v_exp_f32 v26, v26
v_exp_f32 v27, v27
v_exp_f32 v28, v28
v_exp_f32 v29, v29
v_exp_f32 v30, v30
v_exp_f32 v31, v31
s_waitcnt lgkmcnt(1)
v_mul_f32 v64, v64, v120
v_add_f32 v40, v16, v17
v_add_f32 v41, v18, v19
v_add_f32 v42, v20, v21
v_add_f32 v43, v22, v23
v_add_f32 v40, v40, v41
v_add_f32 v42, v42, v43
v_add_f32 v40, v40, v42
v_add_f32 v44, v24, v25
v_add_f32 v45, v26, v27
v_add_f32 v46, v28, v29
v_add_f32 v47, v30, v31
v_add_f32 v44, v44, v45
v_add_f32 v46, v46, v47
v_add_f32 v44, v44, v46
v_mov_b32 v41, v40
v_mov_b32 v45, v44
v_mul_f32 v65, v65, v121
v_mul_f32 v66, v66, v122
v_permlane16_swap_b32 v40, v41
v_permlane16_swap_b32 v44, v45
v_add_f32 v40, v40, v41
PG_B_1:
s_cbranch_execz PG_B_ret
v_add_f32 v44, v44, v45
v_mov_b32 v41, v40
v_mov_b32 v45, v44
v_mul_f32 v67, v67, v123
v_cvt_pk_bf16_f32 v102, v64, v65
v_permlane32_swap_b32 v40, v41
v_permlane32_swap_b32 v44, v45
v_add_f32 v40, v40, v41
v_add_f32 v44, v44, v45
v_rcp_f32 v40, v40
v_rcp_f32 v44, v44
v_cvt_pk_bf16_f32 v103, v66, v67
v_mul_f32 v68, v68, v120
v_mul_f32 v69, v69, v121
v_mul_f32 v70, v70, v122
v_mul_f32 v71, v71, v123
v_cvt_pk_bf16_f32 v108, v68, v69
v_cvt_pk_bf16_f32 v109, v70, v71
s_waitcnt lgkmcnt(0)
v_mul_f32 v72, v72, v124
v_mul_f32 v73, v73, v125
v_mul_f32 v74, v74, v126
v_mul_f32 v75, v75, v127
v_cvt_pk_bf16_f32 v104, v72, v73
v_cvt_pk_bf16_f32 v105, v74, v75
v_mul_f32 v76, v76, v124
v_mul_f32 v77, v77, v125
v_mul_f32 v78, v78, v126
v_mul_f32 v79, v79, v127
v_cvt_pk_bf16_f32 v110, v76, v77
v_cvt_pk_bf16_f32 v111, v78, v79
v_mul_f32 v16, v16, v40
v_mul_f32 v17, v17, v40
v_mul_f32 v18, v18, v40
v_mul_f32 v19, v19, v40
v_mul_f32 v20, v20, v40
v_mul_f32 v21, v21, v40
v_mul_f32 v22, v22, v40
v_mul_f32 v23, v23, v40
v_cvt_pk_bf16_f32 v32, v16, v17
v_cvt_pk_bf16_f32 v33, v18, v19
v_cvt_pk_bf16_f32 v34, v20, v21
v_cvt_pk_bf16_f32 v35, v22, v23
s_nop 1
v_mfma_f32_16x16x32_bf16 v[48:51], v[100:103], v[32:35], 0
v_mfma_f32_16x16x32_bf16 v[52:55], v[106:109], v[32:35], 0
v_mul_f32 v24, v24, v44
v_mul_f32 v25, v25, v44
v_mul_f32 v26, v26, v44
v_mul_f32 v27, v27, v44
v_mul_f32 v28, v28, v44
v_mul_f32 v29, v29, v44
v_mul_f32 v30, v30, v44
v_mul_f32 v31, v31, v44
v_cvt_pk_bf16_f32 v36, v24, v25
v_cvt_pk_bf16_f32 v37, v26, v27
v_cvt_pk_bf16_f32 v38, v28, v29
v_cvt_pk_bf16_f32 v39, v30, v31
s_nop 1
v_mfma_f32_16x16x32_bf16 v[56:59], v[102:105], v[36:39], 0
v_mfma_f32_16x16x32_bf16 v[60:63], v[108:111], v[36:39], 0
v_cvt_pk_bf16_f32 v64, v48, v49
v_cvt_pk_bf16_f32 v65, v50, v51
v_cvt_pk_bf16_f32 v66, v52, v53
v_cvt_pk_bf16_f32 v67, v54, v55
buffer_store_dwordx4 v[64:67], v1, s[4:7], s28 offen
s_nop 1
v_cvt_pk_bf16_f32 v68, v56, v57
v_cvt_pk_bf16_f32 v69, v58, v59
v_cvt_pk_bf16_f32 v70, v60, v61
v_cvt_pk_bf16_f32 v71, v62, v63
s_add_u32 s28, s28, 16384
buffer_store_dwordx4 v[68:71], v1, s[4:7], s28 offen
s_add_u32 s16, s42, 4
s_lshl_b32 s19, s16, 11
s_mul_i32 s18, s16, 28
s_lshl_b32 s16, s16, 1
s_lshr_b32 s17, s14, 1
s_add_u32 s16, s16, s17
s_lshl_b32 s20, s16, 14
s_and_b32 s17, s14, 1
s_lshl_b32 s17, s17, 12
s_add_u32 s20, s20, s17
s_add_u32 s20, s20, 5275648
s_lshl_b32 s17, s40, 8
s_add_u32 s19, s19, s17
s_add_u32 s19, s19, 16547840
s_lshr_b32 s17, s50, 1
s_add_u32 s19, s19, s17
s_lshl_b32 s21, s14, 12
s_add_u32 s21, s21, 86016
s_lshl_b32 s16, s40, 2
s_add_u32 s18, s18, s16
s_add_u32 s18, s18, s14
s_lshl_b32 s18, s18, 10
s_add_u32 s18, s18, 7372800
v_add_u32 v2, 86016, v1
v_and_b32 v3, 15, v0
v_lshrrev_b32 v4, 5, v0
v_lshl_add_u32 v3, v4, 4, v3
v_lshlrev_b32 v3, 4, v3
v_bfe_u32 v4, v0, 4, 1
v_lshl_add_u32 v3, v4, 9, v3
v_lshlrev_b32 v6, 2, v0
v_add_u32 v5, 160768, v6
s_lshl_b32 s16, s14, 8
v_add_u32 v4, s16, v5
s_waitcnt vmcnt(0)
s_barrier
s_add_u32 s3, s32, 7
v_bfrev_b32 v76, 1
v_mov_b32 v77, s3
v_writelane_b32 v76, s50, 0
buffer_store_dword v77, v76, s[4:7], s46 offen
s_cmp_ge_u32 s13, 28
s_cbranch_scc1 interleave_layers__sliding_local_dilated__glu_gated_swiglu__prompt_kernel_h2L
s_cmp_lg_u32 s14, 0
s_cbranch_scc1 L_wt_14
v_lshlrev_b32 v72, 2, v0
s_add_u32 s3, s32, 7
s_mov_b32 s15, 0
buffer_load_dword v73, v72, s[4:7], s43 offen sc1
s_sleep 1
buffer_load_dword v74, v72, s[4:7], s43 offen sc1
s_sleep 1
L_wt_14_p:
buffer_load_dword v75, v72, s[4:7], s43 offen sc1
s_waitcnt vmcnt(2)
v_subrev_u32 v73, s3, v73
v_cmp_le_u32 vcc, 9, v73
s_nop 0
s_and_b64 vcc, vcc, s[38:39]
s_cbranch_scc0 L_wt_14
buffer_load_dword v73, v72, s[4:7], s43 offen sc1
s_waitcnt vmcnt(2)
v_subrev_u32 v74, s3, v74
v_cmp_le_u32 vcc, 9, v74
s_nop 0
s_and_b64 vcc, vcc, s[38:39]
s_cbranch_scc0 L_wt_14
buffer_load_dword v74, v72, s[4:7], s43 offen sc1
s_waitcnt vmcnt(2)
v_subrev_u32 v75, s3, v75
v_cmp_le_u32 vcc, 9, v75
s_nop 0
s_and_b64 vcc, vcc, s[38:39]
s_cbranch_scc0 L_wt_14
s_add_u32 s15, s15, 1
s_cmp_lt_u32 s15, 131072
s_cbranch_scc1 L_wt_14_p
L_wt_14:
s_barrier
s_add_u32 m0, s21, 0
s_add_u32 s31, s20, 0x0
buffer_load_dwordx4 v1, s[4:7], s31 offen offset:0 sc1 lds
buffer_load_dwordx4 v1, s[4:7], s31 offen offset:1024 sc1 lds
buffer_load_dwordx4 v1, s[4:7], s31 offen offset:2048 sc1 lds
buffer_load_dwordx4 v1, s[4:7], s31 offen offset:3072 sc1 lds
s_add_u32 m0, s21, 16384
s_add_u32 s31, s20, 0x2000
buffer_load_dwordx4 v1, s[4:7], s31 offen offset:0 sc1 lds
buffer_load_dwordx4 v1, s[4:7], s31 offen offset:1024 sc1 lds
buffer_load_dwordx4 v1, s[4:7], s31 offen offset:2048 sc1 lds
buffer_load_dwordx4 v1, s[4:7], s31 offen offset:3072 sc1 lds
v_lshlrev_b32 v32, 16, v8
v_and_b32 v33, 0xffff0000, v8
v_lshlrev_b32 v34, 16, v9
v_and_b32 v35, 0xffff0000, v9
v_lshlrev_b32 v36, 16, v10
v_and_b32 v37, 0xffff0000, v10
v_lshlrev_b32 v38, 16, v11
v_and_b32 v39, 0xffff0000, v11
v_lshlrev_b32 v40, 16, v12
v_and_b32 v41, 0xffff0000, v12
v_lshlrev_b32 v42, 16, v13
v_and_b32 v43, 0xffff0000, v13
v_lshlrev_b32 v44, 16, v14
v_and_b32 v45, 0xffff0000, v14
v_lshlrev_b32 v46, 16, v15
v_and_b32 v47, 0xffff0000, v15
s_waitcnt vmcnt(4)
s_barrier
ds_read_b128 v[48:51], v2 offset:0
s_add_u32 m0, s21, 32768
ds_read_b128 v[52:55], v2 offset:8192
s_add_u32 s31, s20, 0xfffe0000
ds_read_b128 v[56:59], v2 offset:1024
buffer_load_dwordx4 v1, s[4:7], s31 offen offset:0 sc1 lds
ds_read_b128 v[60:63], v2 offset:9216
buffer_load_dwordx4 v1, s[4:7], s31 offen offset:1024 sc1 lds
ds_read_b128 v[64:67], v2 offset:2048
buffer_load_dwordx4 v1, s[4:7], s31 offen offset:2048 sc1 lds
ds_read_b128 v[68:71], v2 offset:10240
buffer_load_dwordx4 v1, s[4:7], s31 offen offset:3072 sc1 lds
ds_read_b128 v[72:75], v2 offset:3072
s_add_u32 m0, s21, 49152
ds_read_b128 v[76:79], v2 offset:11264
s_add_u32 s31, s20, 0xfffe2000
s_waitcnt lgkmcnt(7)
v_mfma_f32_16x16x32_bf16 v[24:27], v[144:147], v[48:51], v[40:43]
ds_read_b128 v[80:83], v2 offset:4096
buffer_load_dwordx4 v1, s[4:7], s31 offen offset:0 sc1 lds
s_waitcnt lgkmcnt(7)
v_mfma_f32_16x16x32_bf16 v[28:31], v[144:147], v[52:55], v[44:47]
ds_read_b128 v[84:87], v2 offset:12288
buffer_load_dwordx4 v1, s[4:7], s31 offen offset:1024 sc1 lds
s_waitcnt lgkmcnt(7)
v_mfma_f32_16x16x32_bf16 v[24:27], v[148:151], v[56:59], v[24:27]
ds_read_b128 v[88:91], v2 offset:5120
buffer_load_dwordx4 v1, s[4:7], s31 offen offset:2048 sc1 lds
s_waitcnt lgkmcnt(7)
v_mfma_f32_16x16x32_bf16 v[28:31], v[148:151], v[60:63], v[28:31]
ds_read_b128 v[92:95], v2 offset:13312
buffer_load_dwordx4 v1, s[4:7], s31 offen offset:3072 sc1 lds
s_waitcnt lgkmcnt(7)
v_mfma_f32_16x16x32_bf16 v[24:27], v[152:155], v[64:67], v[24:27]
ds_read_b128 v[96:99], v2 offset:6144
s_waitcnt lgkmcnt(7)
v_mfma_f32_16x16x32_bf16 v[28:31], v[152:155], v[68:71], v[28:31]
ds_read_b128 v[100:103], v2 offset:14336
s_waitcnt lgkmcnt(7)
v_mfma_f32_16x16x32_bf16 v[24:27], v[156:159], v[72:75], v[24:27]
ds_read_b128 v[104:107], v2 offset:7168
s_waitcnt lgkmcnt(7)
v_mfma_f32_16x16x32_bf16 v[28:31], v[156:159], v[76:79], v[28:31]
ds_read_b128 v[108:111], v2 offset:15360
s_waitcnt vmcnt(8)
s_barrier
s_waitcnt lgkmcnt(7)
v_mfma_f32_16x16x32_bf16 v[24:27], v[160:163], v[80:83], v[24:27]
ds_read_b128 v[48:51], v2 offset:16384
s_mul_i32 s30, s40, 229376
s_waitcnt lgkmcnt(7)
v_mfma_f32_16x16x32_bf16 v[28:31], v[160:163], v[84:87], v[28:31]
ds_read_b128 v[52:55], v2 offset:24576
s_mul_i32 s29, s14, 57344
s_waitcnt lgkmcnt(7)
v_mfma_f32_16x16x32_bf16 v[24:27], v[164:167], v[88:91], v[24:27]
ds_read_b128 v[56:59], v2 offset:17408
s_add_u32 s30, s30, s29
s_waitcnt lgkmcnt(7)
v_mfma_f32_16x16x32_bf16 v[28:31], v[164:167], v[92:95], v[28:31]
ds_read_b128 v[60:63], v2 offset:25600
s_add_u32 s30, s30, 0
s_waitcnt lgkmcnt(7)
v_mfma_f32_16x16x32_bf16 v[24:27], v[168:171], v[96:99], v[24:27]
ds_read_b128 v[64:67], v2 offset:18432
s_add_u32 s29, s30, 49152
s_waitcnt lgkmcnt(7)
v_mfma_f32_16x16x32_bf16 v[28:31], v[168:171], v[100:103], v[28:31]
ds_read_b128 v[68:71], v2 offset:26624
buffer_load_dwordx4 v[232:235], v1, s[4:7], s29 offen offset:2048 sc1
s_waitcnt lgkmcnt(7)
v_mfma_f32_16x16x32_bf16 v[24:27], v[172:175], v[104:107], v[24:27]
ds_read_b128 v[72:75], v2 offset:19456
buffer_load_dwordx4 v[236:239], v1, s[4:7], s29 offen offset:3072 sc1
s_waitcnt lgkmcnt(7)
v_mfma_f32_16x16x32_bf16 v[28:31], v[172:175], v[108:111], v[28:31]
ds_read_b128 v[76:79], v2 offset:27648
s_add_u32 s29, s30, 53248
s_waitcnt lgkmcnt(7)
v_mfma_f32_16x16x32_bf16 v[24:27], v[176:179], v[48:51], v[24:27]
ds_read_b128 v[80:83], v2 offset:20480
buffer_load_dwordx4 v[240:243], v1, s[4:7], s29 offen offset:0 sc1
s_waitcnt lgkmcnt(7)
v_mfma_f32_16x16x32_bf16 v[28:31], v[176:179], v[52:55], v[28:31]
ds_read_b128 v[84:87], v2 offset:28672
buffer_load_dwordx4 v[244:247], v1, s[4:7], s29 offen offset:1024 sc1
s_waitcnt lgkmcnt(7)
v_mfma_f32_16x16x32_bf16 v[24:27], v[180:183], v[56:59], v[24:27]
ds_read_b128 v[88:91], v2 offset:21504
buffer_load_dwordx4 v[248:251], v1, s[4:7], s29 offen offset:2048 sc1
s_waitcnt lgkmcnt(7)
v_mfma_f32_16x16x32_bf16 v[28:31], v[180:183], v[60:63], v[28:31]
ds_read_b128 v[92:95], v2 offset:29696
buffer_load_dwordx4 v[252:255], v1, s[4:7], s29 offen offset:3072 sc1
s_waitcnt lgkmcnt(7)
v_mfma_f32_16x16x32_bf16 v[24:27], v[184:187], v[64:67], v[24:27]
ds_read_b128 v[96:99], v2 offset:22528
s_waitcnt lgkmcnt(7)
v_mfma_f32_16x16x32_bf16 v[28:31], v[184:187], v[68:71], v[28:31]
ds_read_b128 v[100:103], v2 offset:30720
s_waitcnt lgkmcnt(7)
v_mfma_f32_16x16x32_bf16 v[24:27], v[188:191], v[72:75], v[24:27]
ds_read_b128 v[104:107], v2 offset:23552
s_waitcnt lgkmcnt(7)
v_mfma_f32_16x16x32_bf16 v[28:31], v[188:191], v[76:79], v[28:31]
ds_read_b128 v[108:111], v2 offset:31744
s_waitcnt vmcnt(10)
s_barrier
s_waitcnt lgkmcnt(7)
v_mfma_f32_16x16x32_bf16 v[24:27], v[192:195], v[80:83], v[24:27]
ds_read_b128 v[48:51], v2 offset:32768
s_waitcnt lgkmcnt(7)
v_mfma_f32_16x16x32_bf16 v[28:31], v[192:195], v[84:87], v[28:31]
ds_read_b128 v[52:55], v2 offset:40960
s_waitcnt lgkmcnt(7)
v_mfma_f32_16x16x32_bf16 v[24:27], v[196:199], v[88:91], v[24:27]
ds_read_b128 v[56:59], v2 offset:33792
s_waitcnt lgkmcnt(7)
v_mfma_f32_16x16x32_bf16 v[28:31], v[196:199], v[92:95], v[28:31]
ds_read_b128 v[60:63], v2 offset:41984
s_waitcnt lgkmcnt(7)
v_mfma_f32_16x16x32_bf16 v[24:27], v[200:203], v[96:99], v[24:27]
ds_read_b128 v[64:67], v2 offset:34816
s_waitcnt lgkmcnt(7)
v_mfma_f32_16x16x32_bf16 v[28:31], v[200:203], v[100:103], v[28:31]
ds_read_b128 v[68:71], v2 offset:43008
s_waitcnt lgkmcnt(7)
v_mfma_f32_16x16x32_bf16 v[24:27], v[204:207], v[104:107], v[24:27]
ds_read_b128 v[72:75], v2 offset:35840
s_waitcnt lgkmcnt(7)
v_mfma_f32_16x16x32_bf16 v[28:31], v[204:207], v[108:111], v[28:31]
ds_read_b128 v[76:79], v2 offset:44032
s_waitcnt lgkmcnt(7)
v_mfma_f32_16x16x32_bf16 v[16:19], v[144:147], v[48:51], v[32:35]
ds_read_b128 v[80:83], v2 offset:36864
s_waitcnt lgkmcnt(7)
v_mfma_f32_16x16x32_bf16 v[20:23], v[144:147], v[52:55], v[36:39]
ds_read_b128 v[84:87], v2 offset:45056
s_waitcnt lgkmcnt(7)
v_mfma_f32_16x16x32_bf16 v[16:19], v[148:151], v[56:59], v[16:19]
ds_read_b128 v[88:91], v2 offset:37888
v_cvt_pk_bf16_f32 v112, v24, v25
s_waitcnt lgkmcnt(7)
v_mfma_f32_16x16x32_bf16 v[20:23], v[148:151], v[60:63], v[20:23]
ds_read_b128 v[92:95], v2 offset:46080
v_cvt_pk_bf16_f32 v113, v26, v27
v_cvt_pk_bf16_f32 v114, v28, v29
s_waitcnt lgkmcnt(7)
v_mfma_f32_16x16x32_bf16 v[16:19], v[152:155], v[64:67], v[16:19]
ds_read_b128 v[96:99], v2 offset:38912
v_cvt_pk_bf16_f32 v115, v30, v31
s_waitcnt lgkmcnt(7)
v_mfma_f32_16x16x32_bf16 v[20:23], v[152:155], v[68:71], v[20:23]
ds_read_b128 v[100:103], v2 offset:47104
v_add_f32 v116, v24, v25
v_mul_f32 v117, v24, v24
s_waitcnt lgkmcnt(7)
v_mfma_f32_16x16x32_bf16 v[16:19], v[156:159], v[72:75], v[16:19]
ds_read_b128 v[104:107], v2 offset:39936
v_add_f32 v118, v28, v29
s_waitcnt lgkmcnt(7)
v_mfma_f32_16x16x32_bf16 v[20:23], v[156:159], v[76:79], v[20:23]
ds_read_b128 v[108:111], v2 offset:48128
v_mul_f32 v119, v28, v28
v_permlane32_swap_b32 v112, v114
s_waitcnt vmcnt(6)
s_barrier
s_waitcnt lgkmcnt(7)
v_mfma_f32_16x16x32_bf16 v[16:19], v[160:163], v[80:83], v[16:19]
ds_read_b128 v[48:51], v2 offset:49152
v_permlane32_swap_b32 v113, v115
s_waitcnt lgkmcnt(7)
v_mfma_f32_16x16x32_bf16 v[20:23], v[160:163], v[84:87], v[20:23]
ds_read_b128 v[52:55], v2 offset:57344
buffer_store_dwordx4 v[112:115], v3, s[4:7], s18 offen
v_fmac_f32 v117, v25, v25
s_waitcnt lgkmcnt(7)
v_mfma_f32_16x16x32_bf16 v[16:19], v[164:167], v[88:91], v[16:19]
ds_read_b128 v[56:59], v2 offset:50176
v_fmac_f32 v119, v29, v29
s_waitcnt lgkmcnt(7)
v_mfma_f32_16x16x32_bf16 v[20:23], v[164:167], v[92:95], v[20:23]
ds_read_b128 v[60:63], v2 offset:58368
v_add_f32 v116, v116, v26
v_fmac_f32 v117, v26, v26
s_waitcnt lgkmcnt(7)
v_mfma_f32_16x16x32_bf16 v[16:19], v[168:171], v[96:99], v[16:19]
ds_read_b128 v[64:67], v2 offset:51200
v_add_f32 v118, v118, v30
s_waitcnt lgkmcnt(7)
v_mfma_f32_16x16x32_bf16 v[20:23], v[168:171], v[100:103], v[20:23]
ds_read_b128 v[68:71], v2 offset:59392
v_fmac_f32 v119, v30, v30
v_add_f32 v116, v116, v27
s_waitcnt lgkmcnt(7)
v_mfma_f32_16x16x32_bf16 v[16:19], v[172:175], v[104:107], v[16:19]
ds_read_b128 v[72:75], v2 offset:52224
v_fmac_f32 v117, v27, v27
s_waitcnt lgkmcnt(7)
v_mfma_f32_16x16x32_bf16 v[20:23], v[172:175], v[108:111], v[20:23]
ds_read_b128 v[76:79], v2 offset:60416
v_add_f32 v118, v118, v31
v_fmac_f32 v119, v31, v31
s_waitcnt lgkmcnt(7)
v_mfma_f32_16x16x32_bf16 v[16:19], v[176:179], v[48:51], v[16:19]
ds_read_b128 v[80:83], v2 offset:53248
v_permlane32_swap_b32 v116, v117
s_waitcnt lgkmcnt(7)
v_mfma_f32_16x16x32_bf16 v[20:23], v[176:179], v[52:55], v[20:23]
ds_read_b128 v[84:87], v2 offset:61440
v_permlane32_swap_b32 v118, v119
v_add_f32 v116, v116, v117
s_waitcnt lgkmcnt(7)
v_mfma_f32_16x16x32_bf16 v[16:19], v[180:183], v[56:59], v[16:19]
ds_read_b128 v[88:91], v2 offset:54272
v_add_f32 v118, v118, v119
s_waitcnt lgkmcnt(7)
v_mfma_f32_16x16x32_bf16 v[20:23], v[180:183], v[60:63], v[20:23]
ds_read_b128 v[92:95], v2 offset:62464
v_permlane16_swap_b32 v116, v118
v_add_f32 v116, v116, v118
s_waitcnt lgkmcnt(7)
v_mfma_f32_16x16x32_bf16 v[16:19], v[184:187], v[64:67], v[16:19]
ds_read_b128 v[96:99], v2 offset:55296
ds_write_b32 v4, v116 offset:1024
s_waitcnt lgkmcnt(8)
v_mfma_f32_16x16x32_bf16 v[20:23], v[184:187], v[68:71], v[20:23]
ds_read_b128 v[100:103], v2 offset:63488
s_waitcnt lgkmcnt(8)
v_mfma_f32_16x16x32_bf16 v[16:19], v[188:191], v[72:75], v[16:19]
ds_read_b128 v[104:107], v2 offset:56320
s_waitcnt lgkmcnt(8)
v_mfma_f32_16x16x32_bf16 v[20:23], v[188:191], v[76:79], v[20:23]
ds_read_b128 v[108:111], v2 offset:64512
s_waitcnt lgkmcnt(3)
s_barrier
v_mfma_f32_16x16x32_bf16 v[16:19], v[192:195], v[80:83], v[16:19]
ds_read2st64_b32 v[120:121], v5 offset0:4 offset1:5
ds_read2st64_b32 v[122:123], v5 offset0:6 offset1:7
v_mfma_f32_16x16x32_bf16 v[20:23], v[192:195], v[84:87], v[20:23]
s_waitcnt lgkmcnt(1)
v_add_f32 v120, v120, v121
s_waitcnt lgkmcnt(0)
v_add_f32 v122, v122, v123
v_mfma_f32_16x16x32_bf16 v[16:19], v[196:199], v[88:91], v[16:19]
v_add_f32 v120, v120, v122
buffer_store_dword v120, v6, s[4:7], s19 offen
v_mfma_f32_16x16x32_bf16 v[20:23], v[196:199], v[92:95], v[20:23]
v_mfma_f32_16x16x32_bf16 v[16:19], v[200:203], v[96:99], v[16:19]
v_mfma_f32_16x16x32_bf16 v[20:23], v[200:203], v[100:103], v[20:23]
v_mfma_f32_16x16x32_bf16 v[16:19], v[204:207], v[104:107], v[16:19]
v_mfma_f32_16x16x32_bf16 v[20:23], v[204:207], v[108:111], v[20:23]
s_nop 6
v_cvt_pk_bf16_f32 v124, v16, v17
v_cvt_pk_bf16_f32 v125, v18, v19
v_cvt_pk_bf16_f32 v126, v20, v21
v_cvt_pk_bf16_f32 v127, v22, v23
v_add_f32 v48, v16, v17
v_mul_f32 v49, v16, v16
v_add_f32 v50, v20, v21
v_mul_f32 v51, v20, v20
v_permlane32_swap_b32 v124, v126
v_permlane32_swap_b32 v125, v127
s_sub_u32 s18, s18, 114688
buffer_store_dwordx4 v[124:127], v3, s[4:7], s18 offen
v_fmac_f32 v49, v17, v17
v_fmac_f32 v51, v21, v21
v_add_f32 v48, v48, v18
v_fmac_f32 v49, v18, v18
v_add_f32 v50, v50, v22
v_fmac_f32 v51, v22, v22
v_add_f32 v48, v48, v19
v_fmac_f32 v49, v19, v19
v_add_f32 v50, v50, v23
v_fmac_f32 v51, v23, v23
v_permlane32_swap_b32 v48, v49
s_nop 0
v_permlane32_swap_b32 v50, v51
v_add_f32 v48, v48, v49
v_add_f32 v50, v50, v51
s_nop 1
v_permlane16_swap_b32 v48, v50
v_add_f32 v48, v48, v50
ds_write_b32 v4, v48 offset:0
s_waitcnt vmcnt(1)
s_waitcnt lgkmcnt(0)
s_barrier
ds_read2st64_b32 v[60:61], v5 offset0:0 offset1:1
ds_read2st64_b32 v[62:63], v5 offset0:2 offset1:3
s_add_u32 s3, s32, 8
v_bfrev_b32 v128, 1
v_mov_b32 v129, s3
v_writelane_b32 v128, s50, 0
buffer_store_dword v129, v128, s[4:7], s46 offen
s_waitcnt lgkmcnt(1)
v_add_f32 v60, v60, v61
s_waitcnt lgkmcnt(0)
v_add_f32 v62, v62, v63
v_add_f32 v60, v60, v62
s_sub_u32 s19, s19, 8192
buffer_store_dword v60, v6, s[4:7], s19 offen
v_lshlrev_b32 v130, 2, v0
buffer_load_dword v132, v130, s[4:7], s43 offen sc1
s_load_dwordx2 s[8:9], s[0:1], 56
s_mov_b32 s10, 1835008
s_mov_b32 s11, 0x20000
s_waitcnt lgkmcnt(0)
s_and_b32 s9, s9, 0xffff
s_lshl_b32 s16, s14, 7
s_add_u32 s16, s16, 160256
v_lshrrev_b32 v148, 5, v0
v_lshl_add_u32 v148, v148, 6, s16
ds_read_b128 v[80:83], v148 offset:0
ds_read_b128 v[84:87], v148 offset:16
ds_read_b128 v[88:91], v148 offset:32
ds_read_b128 v[92:95], v148 offset:48
s_lshl_b32 s16, s13, 2
s_add_u32 s16, s16, s14
s_lshl_b32 s20, s12, 3
s_mul_i32 s26, s20, 224
s_add_u32 s26, s26, s16
s_lshl_b32 s26, s26, 9
s_add_u32 s26, s26, 9666560
v_bfe_u32 v119, v0, 4, 1
v_mul_u32_u24 v119, 57344, v119
v_lshrrev_b32 v6, 5, v0
v_lshl_add_u32 v119, v6, 8, v119
v_and_b32 v6, 15, v0
v_lshl_add_u32 v119, v6, 4, v119
s_add_u32 s16, s14, s20
s_lshl_b32 s25, s16, 11
s_add_u32 s25, s25, 16547840
s_add_u32 s24, s25, 8192
s_mul_i32 s22, s20, 28672
s_mul_i32 s16, s14, 7168
s_add_u32 s22, s22, s16
s_add_u32 s22, s22, 7372800
s_mul_i32 s23, s14, 17408
s_add_u32 s23, s23, 86016
v_add_u32 v4, 86016, v1
v_add_u32 v5, 151552, v1
v_and_b32 v6, 31, v0
v_lshlrev_b32 v6, 4, v6
v_add_u32 v6, 155648, v6
v_and_b32 v145, 7, v0
v_lshrrev_b32 v144, 4, v0
v_lshl_add_u32 v145, v145, 2, v144
s_lshl_b32 s16, s14, 9
s_add_u32 s16, s16, 155648
v_lshl_add_u32 v145, v145, 4, s16
v_cmp_gt_u32 vcc, 48, v0
v_bfrev_b32 v144, 1
s_nop 0
v_cndmask_b32 v144, v144, v1, vcc
s_waitcnt lgkmcnt(0)
s_add_u32 s3, s32, 8
s_waitcnt vmcnt(0)
v_subrev_u32 v132, s3, v132
v_cmp_le_u32 vcc, 8, v132
s_nop 0
s_and_b64 vcc, vcc, s[48:49]
s_cbranch_scc0 L_chk_15_ok
s_mov_b32 s15, 0
L_chk_15:
buffer_load_dword v132, v130, s[4:7], s43 offen sc1
s_waitcnt vmcnt(0)
s_add_u32 s3, s32, 8
v_subrev_u32 v132, s3, v132
v_cmp_le_u32 vcc, 8, v132
s_nop 0
s_and_b64 vcc, vcc, s[48:49]
s_cbranch_scc0 L_chk_15_ok
s_add_u32 s15, s15, 1
s_cmp_lt_u32 s15, 131072
s_cbranch_scc1 L_chk_15
L_chk_15_ok:
s_add_u32 m0, s23, 0
s_add_u32 s31, s22, 114688
buffer_load_dwordx4 v1, s[4:7], s31 offen offset:0 sc1 lds
buffer_load_dwordx4 v1, s[4:7], s31 offen offset:1024 sc1 lds
buffer_load_dwordx4 v1, s[4:7], s31 offen offset:2048 sc1 lds
buffer_load_dwordx4 v1, s[4:7], s31 offen offset:3072 sc1 lds
s_add_u32 m0, s23, 4096
s_add_u32 s31, s22, 118784
buffer_load_dwordx4 v1, s[4:7], s31 offen offset:0 sc1 lds
buffer_load_dwordx4 v1, s[4:7], s31 offen offset:1024 sc1 lds
buffer_load_dwordx4 v1, s[4:7], s31 offen offset:2048 sc1 lds
s_barrier
s_add_u32 s3, s32, 9
v_bfrev_b32 v76, 1
v_mov_b32 v77, s3
v_writelane_b32 v76, s50, 0
buffer_store_dword v77, v76, s[4:7], s46 offen
s_add_u32 s44, s42, 4
s_mul_i32 s16, s14, 14
s_mul_i32 s20, s44, 112
s_add_u32 s20, s20, s16
s_lshl_b32 s20, s20, 10
s_add_u32 s20, s20, 9207808
s_sub_u32 s21, s20, 458752
s_add_u32 s68, s20, 57344
s_add_u32 s69, s21, 57344
s_lshl_b32 s65, s14, 13
s_add_u32 s65, s65, 86016
v_and_b32 v3, 7, v0
v_lshlrev_b32 v3, 4, v3
s_and_b32 s16, s14, 1
s_lshl_b32 s16, s16, 7
s_lshr_b32 s17, s14, 1
s_lshl_b32 s17, s17, 10
s_add_u32 s16, s16, s17
v_add_u32 v2, s16, v3
v_bfe_u32 v146, v0, 3, 1
v_lshl_add_u32 v2, v146, 8, v2
v_bfe_u32 v7, v0, 4, 1
v_lshlrev_b32 v7, 7, v7
v_xor_b32 v2, v2, v7
v_lshrrev_b32 v7, 4, v0
v_lshl_add_u32 v2, v7, 11, v2
v_add_u32 v2, 86016, v2
s_and_b32 s16, s44, 31
s_lshl_b32 s16, s16, 6
s_lshr_b32 s17, s44, 5
s_add_u32 s16, s16, s17
s_lshl_b32 s17, s14, 4
s_add_u32 s16, s16, s17
s_mul_i32 s18, s16, 896
s_lshl_b32 s16, s40, 7
s_add_u32 s18, s18, s16
v_mul_u32_u24 v3, 112, v3
v_lshl_add_u32 v3, v7, 5, v3
v_lshl_add_u32 v3, v146, 3, v3
s_mul_i32 s64, s44, 28
s_lshl_b32 s16, s40, 2
s_add_u32 s64, s64, s16
s_lshl_b32 s64, s64, 10
s_lshl_b32 s16, s14, 7
s_add_u32 s64, s64, s16
s_add_u32 s64, s64, 7372800
v_and_b32 v147, 7, v0
v_lshrrev_b32 v146, 3, v0
v_lshlrev_b32 v147, 4, v147
v_lshl_add_u32 v147, v146, 9, v147
s_sub_u32 s27, s23, 4096
s_sub_u32 s66, s64, 114688
s_waitcnt vmcnt(4)
s_barrier
ds_read_b128 v[48:51], v4 offset:0
ds_read_b128 v[52:55], v4 offset:17408
ds_read_b128 v[56:59], v4 offset:34816
ds_read_b128 v[60:63], v4 offset:52224
s_waitcnt lgkmcnt(2)
v_mfma_f32_32x32x16_bf16 v[16:31], a[0:3], v[48:51], 0
ds_read_b128 v[64:67], v4 offset:1024
buffer_load_dwordx4 v[128:131], v1, s[4:7], s24 offen sc1
v_mfma_f32_32x32x16_bf16 v[16:31], a[28:31], v[52:55], v[16:31]
ds_read_b128 v[68:71], v4 offset:18432
s_waitcnt lgkmcnt(2)
v_mfma_f32_32x32x16_bf16 v[16:31], a[56:59], v[56:59], v[16:31]
ds_read_b128 v[72:75], v4 offset:35840
buffer_load_dwordx4 v[132:135], v144, s[4:7], s24 offen offset:1024 sc1
v_mfma_f32_32x32x16_bf16 v[16:31], a[84:87], v[60:63], v[16:31]
ds_read_b128 v[76:79], v4 offset:53248
s_waitcnt lgkmcnt(2)
v_mfma_f32_32x32x16_bf16 v[16:31], a[4:7], v[64:67], v[16:31]
ds_read_b128 v[48:51], v4 offset:2048
s_add_u32 m0, s23, 7168
s_add_u32 s31, s22, 143360
buffer_load_dwordx4 v1, s[4:7], s31 offen offset:0 sc1 lds
v_mfma_f32_32x32x16_bf16 v[16:31], a[32:35], v[68:71], v[16:31]
ds_read_b128 v[52:55], v4 offset:19456
s_waitcnt lgkmcnt(2)
v_mfma_f32_32x32x16_bf16 v[16:31], a[60:63], v[72:75], v[16:31]
ds_read_b128 v[56:59], v4 offset:36864
buffer_load_dwordx4 v1, s[4:7], s31 offen offset:1024 sc1 lds
v_mfma_f32_32x32x16_bf16 v[16:31], a[88:91], v[76:79], v[16:31]
ds_read_b128 v[60:63], v4 offset:54272
s_waitcnt lgkmcnt(2)
v_mfma_f32_32x32x16_bf16 v[16:31], a[8:11], v[48:51], v[16:31]
ds_read_b128 v[64:67], v4 offset:3072
buffer_load_dwordx4 v1, s[4:7], s31 offen offset:2048 sc1 lds
v_mfma_f32_32x32x16_bf16 v[16:31], a[36:39], v[52:55], v[16:31]
s_waitcnt vmcnt(6)
s_barrier
ds_read_b128 v[68:71], v4 offset:20480
s_waitcnt lgkmcnt(2)
v_mfma_f32_32x32x16_bf16 v[16:31], a[64:67], v[56:59], v[16:31]
ds_read_b128 v[72:75], v4 offset:37888
buffer_load_dwordx4 v1, s[4:7], s31 offen offset:3072 sc1 lds
v_mfma_f32_32x32x16_bf16 v[16:31], a[92:95], v[60:63], v[16:31]
ds_read_b128 v[76:79], v4 offset:55296
s_waitcnt lgkmcnt(2)
v_mfma_f32_32x32x16_bf16 v[16:31], a[12:15], v[64:67], v[16:31]
ds_read_b128 v[48:51], v4 offset:4096
s_add_u32 m0, s23, 11264
s_add_u32 s31, s22, 147456
buffer_load_dwordx4 v1, s[4:7], s31 offen offset:0 sc1 lds
s_waitcnt vmcnt(5)
v_add_f32 v128, v128, v132
v_add_f32 v129, v129, v133
v_mfma_f32_32x32x16_bf16 v[16:31], a[40:43], v[68:71], v[16:31]
ds_read_b128 v[52:55], v4 offset:21504
PG_B_2:
s_cbranch_execz PG_B_ret
v_add_f32 v130, v130, v134
v_add_f32 v131, v131, v135
s_nop 0
v_permlane32_swap_b32 v128, v130
v_permlane32_swap_b32 v129, v131
s_waitcnt lgkmcnt(2)
v_mfma_f32_32x32x16_bf16 v[16:31], a[68:71], v[72:75], v[16:31]
ds_read_b128 v[56:59], v4 offset:38912
buffer_load_dwordx4 v1, s[4:7], s31 offen offset:1024 sc1 lds
v_add_f32 v128, v128, v130
v_add_f32 v129, v129, v131
s_nop 1
v_permlane16_swap_b32 v128, v129
v_add_f32 v128, v128, v129
s_mul_i32 s30, s40, 229376
s_mul_i32 s29, s14, 57344
s_add_u32 s30, s30, s29
s_add_u32 s30, s30, 0
s_add_u32 s29, s30, 36864
buffer_load_dwordx4 v[176:179], v1, s[4:7], s29 offen offset:0 sc1
v_mfma_f32_32x32x16_bf16 v[16:31], a[96:99], v[76:79], v[16:31]
ds_read_b128 v[60:63], v4 offset:56320
v_mul_f32 v128, 0x3b124925, v128
s_nop 1
v_mov_b32_dpp v129, v128 row_ror:8 row_mask:0xf bank_mask:0xf
v_fma_f32 v129, -v128, v128, v129
v_max_f32 v129, 0, v129
s_waitcnt lgkmcnt(2)
v_mfma_f32_32x32x16_bf16 v[16:31], a[16:19], v[48:51], v[16:31]
ds_read_b128 v[64:67], v4 offset:5120
buffer_load_dwordx4 v1, s[4:7], s31 offen offset:2048 sc1 lds
v_add_f32 v129, 0x3727c5ac, v129
v_rsq_f32 v131, v129
v_mov_b32 v130, v129
v_mfma_f32_32x32x16_bf16 v[16:31], a[44:47], v[52:55], v[16:31]
ds_read_b128 v[68:71], v4 offset:22528
v_mul_f32 v129, 0xbfb8aa3b, v131
s_waitcnt lgkmcnt(2)
v_mfma_f32_32x32x16_bf16 v[16:31], a[72:75], v[56:59], v[16:31]
ds_read_b128 v[72:75], v4 offset:39936
s_add_u32 m0, s23, 14336
s_add_u32 s31, s22, 172032
buffer_load_dwordx4 v1, s[4:7], s31 offen offset:0 sc1 lds
s_mov_b32 exec_lo, 0x00ff00ff
s_mov_b32 exec_hi, 0x00ff00ff
ds_write_b96 v145, v[128:130] offset:0
s_mov_b64 exec, -1
v_mfma_f32_32x32x16_bf16 v[16:31], a[100:103], v[60:63], v[16:31]
ds_read_b128 v[76:79], v4 offset:57344
s_waitcnt lgkmcnt(3)
v_mfma_f32_32x32x16_bf16 v[16:31], a[20:23], v[64:67], v[16:31]
ds_read_b128 v[48:51], v4 offset:6144
buffer_load_dwordx4 v1, s[4:7], s31 offen offset:1024 sc1 lds
v_lshlrev_b32 v168, 2, v0
buffer_load_dword v170, v168, s[4:7], s43 offen sc1
v_mfma_f32_32x32x16_bf16 v[16:31], a[48:51], v[68:71], v[16:31]
ds_read_b128 v[52:55], v4 offset:23552
s_waitcnt lgkmcnt(2)
v_mfma_f32_32x32x16_bf16 v[16:31], a[76:79], v[72:75], v[16:31]
ds_read_b128 v[56:59], v4 offset:40960
buffer_load_dwordx4 v1, s[4:7], s31 offen offset:2048 sc1 lds
v_mfma_f32_32x32x16_bf16 v[16:31], a[104:107], v[76:79], v[16:31]
s_waitcnt vmcnt(4)
s_barrier
ds_read_b128 v[60:63], v4 offset:58368
s_waitcnt lgkmcnt(2)
v_mfma_f32_32x32x16_bf16 v[16:31], a[24:27], v[48:51], v[16:31]
ds_read_b128 v[64:67], v4 offset:7168
s_add_u32 m0, s23, 0
s_add_u32 s31, s22, 175104
buffer_load_dwordx4 v1, s[4:7], s31 offen offset:0 sc1 lds
v_mfma_f32_32x32x16_bf16 v[16:31], a[52:55], v[52:55], v[16:31]
ds_read_b128 v[68:71], v4 offset:24576
ds_read_b96 v[120:122], v6 offset:0
s_waitcnt lgkmcnt(3)
v_mfma_f32_32x32x16_bf16 v[16:31], a[80:83], v[56:59], v[16:31]
ds_read_b128 v[72:75], v4 offset:41984
s_add_u32 m0, s23, 1024
s_add_u32 s31, s22, 176128
buffer_load_dwordx4 v1, s[4:7], s31 offen offset:0 sc1 lds
v_mfma_f32_32x32x16_bf16 v[16:31], a[108:111], v[60:63], v[16:31]
ds_read_b128 v[76:79], v4 offset:59392
s_add_u32 s3, s32, 9
s_waitcnt vmcnt(3)
v_subrev_u32 v170, s3, v170
v_cmp_le_u32 vcc, 7, v170
s_nop 0
s_and_b64 vcc, vcc, s[48:49]
s_cbranch_scc0 L_chk_16_ok
s_mov_b32 s15, 0
L_chk_16:
buffer_load_dword v170, v168, s[4:7], s43 offen sc1
s_waitcnt vmcnt(0)
s_add_u32 s3, s32, 9
v_subrev_u32 v170, s3, v170
v_cmp_le_u32 vcc, 7, v170
s_nop 0
s_and_b64 vcc, vcc, s[48:49]
s_cbranch_scc0 L_chk_16_ok
s_add_u32 s15, s15, 1
s_cmp_lt_u32 s15, 131072
s_cbranch_scc1 L_chk_16
L_chk_16_ok:
s_waitcnt lgkmcnt(3)
v_mfma_f32_32x32x16_bf16 v[32:47], a[0:3], v[64:67], 0
ds_read_b128 v[48:51], v4 offset:8192
buffer_load_dwordx4 v[136:139], v1, s[4:7], s25 offen sc1
v_mfma_f32_32x32x16_bf16 v[32:47], a[28:31], v[68:71], v[32:47]
ds_read_b128 v[52:55], v4 offset:25600
buffer_load_dwordx4 v1, s[4:7], s31 offen offset:1024 sc1 lds
s_waitcnt lgkmcnt(2)
v_mfma_f32_32x32x16_bf16 v[32:47], a[56:59], v[72:75], v[32:47]
ds_read_b128 v[56:59], v4 offset:43008
buffer_load_dwordx4 v[140:143], v144, s[4:7], s25 offen offset:1024 sc1
v_fma_f32 v16, -v120, v80, v16
v_fma_f32 v17, -v120, v81, v17
v_fma_f32 v18, -v120, v82, v18
v_fma_f32 v19, -v120, v83, v19
v_mfma_f32_32x32x16_bf16 v[32:47], a[84:87], v[76:79], v[32:47]
ds_read_b128 v[60:63], v4 offset:60416
v_fma_f32 v20, -v120, v84, v20
v_fma_f32 v21, -v120, v85, v21
v_fma_f32 v22, -v120, v86, v22
v_fma_f32 v23, -v120, v87, v23
s_waitcnt lgkmcnt(2)
v_mfma_f32_32x32x16_bf16 v[32:47], a[4:7], v[48:51], v[32:47]
ds_read_b128 v[64:67], v4 offset:9216
buffer_load_dwordx4 v1, s[4:7], s31 offen offset:2048 sc1 lds
v_fma_f32 v24, -v120, v88, v24
v_fma_f32 v25, -v120, v89, v25
v_fma_f32 v26, -v120, v90, v26
v_fma_f32 v27, -v120, v91, v27
v_mfma_f32_32x32x16_bf16 v[32:47], a[32:35], v[52:55], v[32:47]
ds_read_b128 v[68:71], v4 offset:26624
v_fma_f32 v28, -v120, v92, v28
v_fma_f32 v29, -v120, v93, v29
v_fma_f32 v30, -v120, v94, v30
v_fma_f32 v31, -v120, v95, v31
s_waitcnt lgkmcnt(2)
v_mfma_f32_32x32x16_bf16 v[32:47], a[60:63], v[56:59], v[32:47]
ds_read_b128 v[72:75], v4 offset:44032
v_mul_f32 v96, v16, v121
v_mul_f32 v97, v17, v121
v_mul_f32 v98, v18, v121
v_mul_f32 v99, v19, v121
v_mul_f32 v100, v20, v121
v_mfma_f32_32x32x16_bf16 v[32:47], a[88:91], v[60:63], v[32:47]
ds_read_b128 v[76:79], v4 offset:61440
v_mul_f32 v101, v21, v121
v_mul_f32 v102, v22, v121
v_mul_f32 v103, v23, v121
s_waitcnt lgkmcnt(2)
v_mfma_f32_32x32x16_bf16 v[32:47], a[8:11], v[64:67], v[32:47]
ds_read_b128 v[48:51], v4 offset:10240
v_exp_f32 v96, v96
v_mul_f32 v16, v16, v24
v_exp_f32 v97, v97
v_mfma_f32_32x32x16_bf16 v[32:47], a[36:39], v[68:71], v[32:47]
ds_read_b128 v[52:55], v4 offset:27648
v_mul_f32 v17, v17, v25
v_exp_f32 v98, v98
v_mul_f32 v18, v18, v26
s_waitcnt lgkmcnt(2)
v_mfma_f32_32x32x16_bf16 v[32:47], a[64:67], v[72:75], v[32:47]
ds_read_b128 v[56:59], v4 offset:45056
v_exp_f32 v99, v99
v_mul_f32 v19, v19, v27
v_exp_f32 v100, v100
v_mfma_f32_32x32x16_bf16 v[32:47], a[92:95], v[76:79], v[32:47]
ds_read_b128 v[60:63], v4 offset:62464
v_mul_f32 v20, v20, v28
v_exp_f32 v101, v101
v_mul_f32 v21, v21, v29
s_waitcnt lgkmcnt(2)
v_mfma_f32_32x32x16_bf16 v[32:47], a[12:15], v[48:51], v[32:47]
ds_read_b128 v[64:67], v4 offset:11264
v_exp_f32 v102, v102
v_mul_f32 v22, v22, v30
v_exp_f32 v103, v103
v_mfma_f32_32x32x16_bf16 v[32:47], a[40:43], v[52:55], v[32:47]
ds_read_b128 v[68:71], v4 offset:28672
v_mul_f32 v23, v23, v31
v_fma_f32 v96, v96, v122, v122
v_fma_f32 v97, v97, v122, v122
v_fma_f32 v98, v98, v122, v122
s_waitcnt lgkmcnt(2)
v_mfma_f32_32x32x16_bf16 v[32:47], a[68:71], v[56:59], v[32:47]
ds_read_b128 v[72:75], v4 offset:46080
v_fma_f32 v99, v99, v122, v122
v_fma_f32 v100, v100, v122, v122
v_fma_f32 v101, v101, v122, v122
v_fma_f32 v102, v102, v122, v122
v_fma_f32 v103, v103, v122, v122
v_mfma_f32_32x32x16_bf16 v[32:47], a[96:99], v[60:63], v[32:47]
ds_read_b128 v[76:79], v4 offset:63488
v_rcp_f32 v96, v96
v_rcp_f32 v97, v97
s_waitcnt lgkmcnt(2)
v_mfma_f32_32x32x16_bf16 v[32:47], a[16:19], v[64:67], v[32:47]
ds_read_b128 v[48:51], v4 offset:12288
v_rcp_f32 v98, v98
v_mul_f32 v16, v16, v96
v_rcp_f32 v99, v99
v_mfma_f32_32x32x16_bf16 v[32:47], a[44:47], v[68:71], v[32:47]
ds_read_b128 v[52:55], v4 offset:29696
v_mul_f32 v17, v17, v97
v_rcp_f32 v100, v100
v_mul_f32 v18, v18, v98
s_waitcnt lgkmcnt(2)
v_mfma_f32_32x32x16_bf16 v[32:47], a[72:75], v[72:75], v[32:47]
ds_read_b128 v[56:59], v4 offset:47104
v_rcp_f32 v101, v101
v_mul_f32 v19, v19, v99
v_rcp_f32 v102, v102
v_mfma_f32_32x32x16_bf16 v[32:47], a[100:103], v[76:79], v[32:47]
ds_read_b128 v[60:63], v4 offset:64512
v_mul_f32 v20, v20, v100
v_rcp_f32 v103, v103
v_mul_f32 v21, v21, v101
s_waitcnt lgkmcnt(2)
v_mfma_f32_32x32x16_bf16 v[32:47], a[20:23], v[48:51], v[32:47]
ds_read_b128 v[64:67], v4 offset:13312
buffer_load_dwordx4 v[180:183], v1, s[4:7], s29 offen offset:1024 sc1
v_mul_f32 v22, v22, v102
v_mul_f32 v23, v23, v103
v_cvt_pk_bf16_f32 v112, v16, v17
v_cvt_pk_bf16_f32 v113, v18, v19
v_mfma_f32_32x32x16_bf16 v[32:47], a[48:51], v[52:55], v[32:47]
ds_read_b128 v[68:71], v4 offset:30720
v_cvt_pk_bf16_f32 v114, v20, v21
v_cvt_pk_bf16_f32 v115, v22, v23
buffer_store_dwordx4 v[112:115], v119, s[4:7], s26 offen nt
s_add_u32 s26, s26, 114688
s_waitcnt lgkmcnt(2)
v_mfma_f32_32x32x16_bf16 v[32:47], a[76:79], v[56:59], v[32:47]
ds_read_b128 v[72:75], v4 offset:48128
v_mfma_f32_32x32x16_bf16 v[32:47], a[104:107], v[60:63], v[32:47]
s_waitcnt vmcnt(2)
s_barrier
ds_read_b128 v[76:79], v5 offset:0
s_waitcnt lgkmcnt(2)
v_mfma_f32_32x32x16_bf16 v[32:47], a[24:27], v[64:67], v[32:47]
ds_read_b128 v[48:51], v4 offset:14336
s_add_u32 m0, s23, 4096
s_add_u32 s31, s22, 200704
buffer_load_dwordx4 v1, s[4:7], s31 offen offset:0 sc1 lds
v_mfma_f32_32x32x16_bf16 v[32:47], a[52:55], v[68:71], v[32:47]
ds_read_b128 v[52:55], v4 offset:31744
ds_read_b96 v[124:126], v6 offset:512
s_waitcnt lgkmcnt(3)
v_mfma_f32_32x32x16_bf16 v[32:47], a[80:83], v[72:75], v[32:47]
ds_read_b128 v[56:59], v4 offset:49152
buffer_load_dwordx4 v1, s[4:7], s31 offen offset:1024 sc1 lds
v_mfma_f32_32x32x16_bf16 v[32:47], a[108:111], v[76:79], v[32:47]
ds_read_b128 v[60:63], v5 offset:1024
s_waitcnt lgkmcnt(3)
v_mfma_f32_32x32x16_bf16 v[16:31], a[0:3], v[48:51], 0
ds_read_b128 v[64:67], v4 offset:15360
buffer_load_dwordx4 v1, s[4:7], s31 offen offset:2048 sc1 lds
v_mfma_f32_32x32x16_bf16 v[16:31], a[28:31], v[52:55], v[16:31]
ds_read_b128 v[68:71], v4 offset:32768
s_waitcnt lgkmcnt(2)
v_mfma_f32_32x32x16_bf16 v[16:31], a[56:59], v[56:59], v[16:31]
ds_read_b128 v[72:75], v4 offset:50176
buffer_load_dwordx4 v1, s[4:7], s31 offen offset:3072 sc1 lds
s_nop 0
v_fma_f32 v32, -v124, v80, v32
v_fma_f32 v33, -v124, v81, v33
v_fma_f32 v34, -v124, v82, v34
v_fma_f32 v35, -v124, v83, v35
v_mfma_f32_32x32x16_bf16 v[16:31], a[84:87], v[60:63], v[16:31]
ds_read_b128 v[76:79], v5 offset:2048
v_fma_f32 v36, -v124, v84, v36
v_fma_f32 v37, -v124, v85, v37
v_fma_f32 v38, -v124, v86, v38
v_fma_f32 v39, -v124, v87, v39
s_waitcnt lgkmcnt(2)
v_mfma_f32_32x32x16_bf16 v[16:31], a[4:7], v[64:67], v[16:31]
ds_read_b128 v[48:51], v4 offset:16384
s_add_u32 m0, s23, 8192
s_add_u32 s31, s22, 204800
buffer_load_dwordx4 v1, s[4:7], s31 offen offset:0 sc1 lds
v_fma_f32 v40, -v124, v88, v40
v_fma_f32 v41, -v124, v89, v41
v_mfma_f32_32x32x16_bf16 v[16:31], a[32:35], v[68:71], v[16:31]
ds_read_b128 v[52:55], v4 offset:33792
v_fma_f32 v42, -v124, v90, v42
v_fma_f32 v43, -v124, v91, v43
v_fma_f32 v44, -v124, v92, v44
v_fma_f32 v45, -v124, v93, v45
s_waitcnt lgkmcnt(2)
v_mfma_f32_32x32x16_bf16 v[16:31], a[60:63], v[72:75], v[16:31]
ds_read_b128 v[56:59], v4 offset:51200
buffer_load_dwordx4 v1, s[4:7], s31 offen offset:1024 sc1 lds
v_fma_f32 v46, -v124, v94, v46
v_fma_f32 v47, -v124, v95, v47
v_mul_f32 v96, v32, v125
v_mul_f32 v97, v33, v125
v_mfma_f32_32x32x16_bf16 v[16:31], a[88:91], v[76:79], v[16:31]
ds_read_b128 v[60:63], v5 offset:3072
v_mul_f32 v98, v34, v125
v_mul_f32 v99, v35, v125
v_mul_f32 v100, v36, v125
v_mul_f32 v101, v37, v125
s_waitcnt lgkmcnt(2)
v_mfma_f32_32x32x16_bf16 v[16:31], a[8:11], v[48:51], v[16:31]
ds_read_b128 v[64:67], v4 offset:0
buffer_load_dwordx4 v1, s[4:7], s31 offen offset:2048 sc1 lds
v_mul_f32 v102, v38, v125
v_mul_f32 v103, v39, v125
v_exp_f32 v96, v96
v_mfma_f32_32x32x16_bf16 v[16:31], a[36:39], v[52:55], v[16:31]
ds_read_b128 v[68:71], v4 offset:17408
v_mul_f32 v32, v32, v40
v_exp_f32 v97, v97
v_mul_f32 v33, v33, v41
s_waitcnt lgkmcnt(2)
v_mfma_f32_32x32x16_bf16 v[16:31], a[64:67], v[56:59], v[16:31]
ds_read_b128 v[72:75], v4 offset:34816
v_exp_f32 v98, v98
v_mul_f32 v34, v34, v42
v_exp_f32 v99, v99
v_mfma_f32_32x32x16_bf16 v[16:31], a[92:95], v[60:63], v[16:31]
ds_read_b128 v[76:79], v4 offset:52224
v_mul_f32 v35, v35, v43
v_exp_f32 v100, v100
v_mul_f32 v36, v36, v44
s_waitcnt lgkmcnt(2)
v_mfma_f32_32x32x16_bf16 v[16:31], a[12:15], v[64:67], v[16:31]
ds_read_b128 v[48:51], v4 offset:1024
v_exp_f32 v101, v101
v_mul_f32 v37, v37, v45
v_exp_f32 v102, v102
v_mfma_f32_32x32x16_bf16 v[16:31], a[40:43], v[68:71], v[16:31]
ds_read_b128 v[52:55], v4 offset:18432
v_mul_f32 v38, v38, v46
v_exp_f32 v103, v103
v_mul_f32 v39, v39, v47
s_waitcnt lgkmcnt(2)
v_mfma_f32_32x32x16_bf16 v[16:31], a[68:71], v[72:75], v[16:31]
ds_read_b128 v[56:59], v4 offset:35840
v_fma_f32 v96, v96, v126, v126
v_fma_f32 v97, v97, v126, v126
v_fma_f32 v98, v98, v126, v126
v_fma_f32 v99, v99, v126, v126
v_fma_f32 v100, v100, v126, v126
v_mfma_f32_32x32x16_bf16 v[16:31], a[96:99], v[76:79], v[16:31]
ds_read_b128 v[60:63], v4 offset:53248
v_fma_f32 v101, v101, v126, v126
v_fma_f32 v102, v102, v126, v126
v_fma_f32 v103, v103, v126, v126
s_waitcnt lgkmcnt(2)
v_mfma_f32_32x32x16_bf16 v[16:31], a[16:19], v[48:51], v[16:31]
ds_read_b128 v[64:67], v4 offset:2048
v_rcp_f32 v96, v96
v_rcp_f32 v97, v97
v_mfma_f32_32x32x16_bf16 v[16:31], a[44:47], v[52:55], v[16:31]
ds_read_b128 v[68:71], v4 offset:19456
v_rcp_f32 v98, v98
v_mul_f32 v32, v32, v96
s_waitcnt lgkmcnt(2)
v_mfma_f32_32x32x16_bf16 v[16:31], a[72:75], v[56:59], v[16:31]
ds_read_b128 v[72:75], v4 offset:36864
v_rcp_f32 v99, v99
v_mul_f32 v33, v33, v97
v_rcp_f32 v100, v100
v_mfma_f32_32x32x16_bf16 v[16:31], a[100:103], v[60:63], v[16:31]
ds_read_b128 v[76:79], v4 offset:54272
v_mul_f32 v34, v34, v98
v_rcp_f32 v101, v101
v_mul_f32 v35, v35, v99
s_waitcnt lgkmcnt(2)
v_mfma_f32_32x32x16_bf16 v[16:31], a[20:23], v[64:67], v[16:31]
ds_read_b128 v[48:51], v4 offset:3072
v_rcp_f32 v102, v102
v_mul_f32 v36, v36, v100
v_rcp_f32 v103, v103
v_mfma_f32_32x32x16_bf16 v[16:31], a[48:51], v[68:71], v[16:31]
ds_read_b128 v[52:55], v4 offset:20480
v_mul_f32 v37, v37, v101
v_mul_f32 v38, v38, v102
v_mul_f32 v39, v39, v103
v_cvt_pk_bf16_f32 v112, v32, v33
s_waitcnt lgkmcnt(2)
v_mfma_f32_32x32x16_bf16 v[16:31], a[76:79], v[72:75], v[16:31]
ds_read_b128 v[56:59], v4 offset:37888
v_cvt_pk_bf16_f32 v113, v34, v35
v_cvt_pk_bf16_f32 v114, v36, v37
v_cvt_pk_bf16_f32 v115, v38, v39
buffer_store_dwordx4 v[112:115], v119, s[4:7], s26 offen nt
s_add_u32 s26, s26, 114688
v_mfma_f32_32x32x16_bf16 v[16:31], a[104:107], v[76:79], v[16:31]
s_waitcnt vmcnt(1)
s_barrier
ds_read_b128 v[60:63], v4 offset:55296
v_add_f32 v136, v136, v140
v_add_f32 v137, v137, v141
v_add_f32 v138, v138, v142
s_waitcnt lgkmcnt(2)
v_mfma_f32_32x32x16_bf16 v[16:31], a[24:27], v[48:51], v[16:31]
ds_read_b128 v[64:67], v4 offset:4096
s_add_u32 m0, s23, 11264
s_add_u32 s31, s22, 0
buffer_load_dwordx4 v1, s[4:7], s31 offen offset:0 sc1 lds
v_add_f32 v139, v139, v143
v_permlane32_swap_b32 v136, v138
v_mfma_f32_32x32x16_bf16 v[16:31], a[52:55], v[52:55], v[16:31]
ds_read_b128 v[68:71], v4 offset:21504
v_permlane32_swap_b32 v137, v139
v_add_f32 v136, v136, v138
v_add_f32 v137, v137, v139
s_nop 1
v_permlane16_swap_b32 v136, v137
ds_read_b96 v[120:122], v6 offset:1024
s_waitcnt lgkmcnt(3)
v_mfma_f32_32x32x16_bf16 v[16:31], a[80:83], v[56:59], v[16:31]
ds_read_b128 v[72:75], v4 offset:38912
buffer_load_dwordx4 v1, s[4:7], s31 offen offset:1024 sc1 lds
buffer_load_dwordx4 v[184:187], v1, s[4:7], s29 offen offset:2048 sc1
v_mfma_f32_32x32x16_bf16 v[16:31], a[108:111], v[60:63], v[16:31]
ds_read_b128 v[76:79], v4 offset:56320
s_waitcnt lgkmcnt(3)
v_mfma_f32_32x32x16_bf16 v[32:47], a[0:3], v[64:67], 0
ds_read_b128 v[48:51], v4 offset:5120
buffer_load_dwordx4 v1, s[4:7], s31 offen offset:2048 sc1 lds
v_mfma_f32_32x32x16_bf16 v[32:47], a[28:31], v[68:71], v[32:47]
ds_read_b128 v[52:55], v4 offset:22528
s_waitcnt lgkmcnt(2)
v_mfma_f32_32x32x16_bf16 v[32:47], a[56:59], v[72:75], v[32:47]
ds_read_b128 v[56:59], v4 offset:39936
buffer_load_dwordx4 v1, s[4:7], s31 offen offset:3072 sc1 lds
s_nop 0
v_fma_f32 v16, -v120, v80, v16
v_fma_f32 v17, -v120, v81, v17
v_fma_f32 v18, -v120, v82, v18
v_fma_f32 v19, -v120, v83, v19
v_mfma_f32_32x32x16_bf16 v[32:47], a[84:87], v[76:79], v[32:47]
ds_read_b128 v[60:63], v4 offset:57344
v_fma_f32 v20, -v120, v84, v20
v_fma_f32 v21, -v120, v85, v21
v_fma_f32 v22, -v120, v86, v22
v_fma_f32 v23, -v120, v87, v23
s_waitcnt lgkmcnt(2)
v_mfma_f32_32x32x16_bf16 v[32:47], a[4:7], v[48:51], v[32:47]
ds_read_b128 v[64:67], v4 offset:6144
s_add_u32 m0, s23, 15360
s_add_u32 s31, s22, 4096
buffer_load_dwordx4 v1, s[4:7], s31 offen offset:0 sc1 lds
v_fma_f32 v24, -v120, v88, v24
v_fma_f32 v25, -v120, v89, v25
v_mfma_f32_32x32x16_bf16 v[32:47], a[32:35], v[52:55], v[32:47]
ds_read_b128 v[68:71], v4 offset:23552
v_fma_f32 v26, -v120, v90, v26
v_fma_f32 v27, -v120, v91, v27
v_fma_f32 v28, -v120, v92, v28
v_fma_f32 v29, -v120, v93, v29
s_waitcnt lgkmcnt(2)
v_mfma_f32_32x32x16_bf16 v[32:47], a[60:63], v[56:59], v[32:47]
ds_read_b128 v[72:75], v4 offset:40960
buffer_load_dwordx4 v1, s[4:7], s31 offen offset:1024 sc1 lds
v_fma_f32 v30, -v120, v94, v30
v_fma_f32 v31, -v120, v95, v31
v_mul_f32 v96, v16, v121
v_mul_f32 v97, v17, v121
v_mfma_f32_32x32x16_bf16 v[32:47], a[88:91], v[60:63], v[32:47]
ds_read_b128 v[76:79], v4 offset:58368
v_mul_f32 v98, v18, v121
v_mul_f32 v99, v19, v121
v_mul_f32 v100, v20, v121
v_mul_f32 v101, v21, v121
s_waitcnt lgkmcnt(2)
v_mfma_f32_32x32x16_bf16 v[32:47], a[8:11], v[64:67], v[32:47]
ds_read_b128 v[48:51], v4 offset:7168
s_add_u32 m0, s23, 0
s_add_u32 s31, s22, 6144
buffer_load_dwordx4 v1, s[4:7], s31 offen offset:0 sc1 lds
v_mul_f32 v102, v22, v121
v_mul_f32 v103, v23, v121
v_mfma_f32_32x32x16_bf16 v[32:47], a[36:39], v[68:71], v[32:47]
ds_read_b128 v[52:55], v4 offset:24576
v_exp_f32 v96, v96
v_mul_f32 v16, v16, v24
s_waitcnt lgkmcnt(2)
v_mfma_f32_32x32x16_bf16 v[32:47], a[64:67], v[72:75], v[32:47]
ds_read_b128 v[56:59], v4 offset:41984
v_exp_f32 v97, v97
v_mul_f32 v17, v17, v25
v_exp_f32 v98, v98
v_mfma_f32_32x32x16_bf16 v[32:47], a[92:95], v[76:79], v[32:47]
ds_read_b128 v[60:63], v4 offset:59392
v_mul_f32 v18, v18, v26
v_exp_f32 v99, v99
v_mul_f32 v19, v19, v27
s_waitcnt lgkmcnt(2)
v_mfma_f32_32x32x16_bf16 v[32:47], a[12:15], v[48:51], v[32:47]
ds_read_b128 v[64:67], v4 offset:8192
v_exp_f32 v100, v100
v_mul_f32 v20, v20, v28
v_exp_f32 v101, v101
v_mfma_f32_32x32x16_bf16 v[32:47], a[40:43], v[52:55], v[32:47]
ds_read_b128 v[68:71], v4 offset:25600
v_mul_f32 v21, v21, v29
v_exp_f32 v102, v102
v_mul_f32 v22, v22, v30
s_waitcnt lgkmcnt(2)
v_mfma_f32_32x32x16_bf16 v[32:47], a[68:71], v[56:59], v[32:47]
ds_read_b128 v[72:75], v4 offset:43008
v_exp_f32 v103, v103
v_mul_f32 v23, v23, v31
v_fma_f32 v96, v96, v122, v122
v_fma_f32 v97, v97, v122, v122
v_mfma_f32_32x32x16_bf16 v[32:47], a[96:99], v[60:63], v[32:47]
ds_read_b128 v[76:79], v4 offset:60416
v_fma_f32 v98, v98, v122, v122
v_fma_f32 v99, v99, v122, v122
v_fma_f32 v100, v100, v122, v122
v_fma_f32 v101, v101, v122, v122
s_waitcnt lgkmcnt(2)
v_mfma_f32_32x32x16_bf16 v[32:47], a[16:19], v[64:67], v[32:47]
ds_read_b128 v[48:51], v4 offset:9216
v_fma_f32 v102, v102, v122, v122
v_fma_f32 v103, v103, v122, v122
v_rcp_f32 v96, v96
v_mfma_f32_32x32x16_bf16 v[32:47], a[44:47], v[68:71], v[32:47]
ds_read_b128 v[52:55], v4 offset:26624
v_rcp_f32 v97, v97
v_rcp_f32 v98, v98
s_waitcnt lgkmcnt(2)
v_mfma_f32_32x32x16_bf16 v[32:47], a[72:75], v[72:75], v[32:47]
ds_read_b128 v[56:59], v4 offset:44032
v_mul_f32 v16, v16, v96
v_rcp_f32 v99, v99
v_mul_f32 v17, v17, v97
v_mfma_f32_32x32x16_bf16 v[32:47], a[100:103], v[76:79], v[32:47]
ds_read_b128 v[60:63], v4 offset:61440
v_rcp_f32 v100, v100
v_mul_f32 v18, v18, v98
s_waitcnt lgkmcnt(2)
v_mfma_f32_32x32x16_bf16 v[32:47], a[20:23], v[48:51], v[32:47]
ds_read_b128 v[64:67], v4 offset:10240
v_rcp_f32 v101, v101
v_mul_f32 v19, v19, v99
v_rcp_f32 v102, v102
v_mfma_f32_32x32x16_bf16 v[32:47], a[48:51], v[52:55], v[32:47]
ds_read_b128 v[68:71], v4 offset:27648
v_mul_f32 v20, v20, v100
v_rcp_f32 v103, v103
v_mul_f32 v21, v21, v101
s_waitcnt lgkmcnt(2)
v_mfma_f32_32x32x16_bf16 v[32:47], a[76:79], v[56:59], v[32:47]
ds_read_b128 v[72:75], v4 offset:45056
v_mul_f32 v22, v22, v102
v_mul_f32 v23, v23, v103
v_cvt_pk_bf16_f32 v112, v16, v17
v_cvt_pk_bf16_f32 v113, v18, v19
v_cvt_pk_bf16_f32 v114, v20, v21
v_mfma_f32_32x32x16_bf16 v[32:47], a[104:107], v[60:63], v[32:47]
s_waitcnt vmcnt(0)
s_barrier
ds_read_b128 v[76:79], v4 offset:62464
v_cvt_pk_bf16_f32 v115, v22, v23
buffer_store_dwordx4 v[112:115], v119, s[4:7], s26 offen nt
s_add_u32 s26, s26, 114688
s_waitcnt lgkmcnt(2)
v_mfma_f32_32x32x16_bf16 v[32:47], a[24:27], v[64:67], v[32:47]
ds_read_b128 v[48:51], v4 offset:11264
s_add_u32 m0, s23, 1024
s_add_u32 s31, s22, 28672
buffer_load_dwordx4 v1, s[4:7], s31 offen offset:0 sc1 lds
v_add_f32 v136, v136, v137
v_mul_f32 v136, 0x3b124925, v136
v_mfma_f32_32x32x16_bf16 v[32:47], a[52:55], v[68:71], v[32:47]
ds_read_b128 v[52:55], v4 offset:28672
v_mov_b32_dpp v137, v136 row_ror:8 row_mask:0xf bank_mask:0xf
v_fma_f32 v137, -v136, v136, v137
v_max_f32 v137, 0, v137
v_add_f32 v137, 0x3727c5ac, v137
ds_read_b96 v[124:126], v6 offset:1536
s_waitcnt lgkmcnt(3)
v_mfma_f32_32x32x16_bf16 v[32:47], a[80:83], v[72:75], v[32:47]
ds_read_b128 v[56:59], v4 offset:46080
buffer_load_dwordx4 v1, s[4:7], s31 offen offset:1024 sc1 lds
v_rsq_f32 v139, v137
v_mov_b32 v138, v137
v_mul_f32 v137, 0xbfb8aa3b, v139
v_mfma_f32_32x32x16_bf16 v[32:47], a[108:111], v[76:79], v[32:47]
ds_read_b128 v[60:63], v4 offset:63488
s_mov_b32 exec_lo, 0x00ff00ff
s_mov_b32 exec_hi, 0x00ff00ff
ds_write_b96 v145, v[136:138] offset:2048
s_mov_b64 exec, -1
s_waitcnt lgkmcnt(4)
v_mfma_f32_32x32x16_bf16 v[16:31], a[0:3], v[48:51], 0
ds_read_b128 v[64:67], v4 offset:12288
buffer_load_dwordx4 v1, s[4:7], s31 offen offset:2048 sc1 lds
v_mfma_f32_32x32x16_bf16 v[16:31], a[28:31], v[52:55], v[16:31]
ds_read_b128 v[68:71], v4 offset:29696
s_waitcnt lgkmcnt(3)
v_mfma_f32_32x32x16_bf16 v[16:31], a[56:59], v[56:59], v[16:31]
ds_read_b128 v[72:75], v4 offset:47104
buffer_load_dwordx4 v1, s[4:7], s31 offen offset:3072 sc1 lds
v_fma_f32 v32, -v124, v80, v32
v_fma_f32 v33, -v124, v81, v33
v_fma_f32 v34, -v124, v82, v34
v_fma_f32 v35, -v124, v83, v35
v_mfma_f32_32x32x16_bf16 v[16:31], a[84:87], v[60:63], v[16:31]
ds_read_b128 v[76:79], v4 offset:64512
v_fma_f32 v36, -v124, v84, v36
v_fma_f32 v37, -v124, v85, v37
v_fma_f32 v38, -v124, v86, v38
v_fma_f32 v39, -v124, v87, v39
s_waitcnt lgkmcnt(2)
v_mfma_f32_32x32x16_bf16 v[16:31], a[4:7], v[64:67], v[16:31]
ds_read_b128 v[48:51], v4 offset:13312
s_add_u32 m0, s23, 5120
s_add_u32 s31, s22, 32768
buffer_load_dwordx4 v1, s[4:7], s31 offen offset:0 sc1 lds
v_fma_f32 v40, -v124, v88, v40
v_fma_f32 v41, -v124, v89, v41
v_mfma_f32_32x32x16_bf16 v[16:31], a[32:35], v[68:71], v[16:31]
ds_read_b128 v[52:55], v4 offset:30720
buffer_load_dwordx4 v[188:191], v1, s[4:7], s29 offen offset:3072 sc1
v_fma_f32 v42, -v124, v90, v42
v_fma_f32 v43, -v124, v91, v43
v_fma_f32 v44, -v124, v92, v44
s_waitcnt lgkmcnt(2)
v_mfma_f32_32x32x16_bf16 v[16:31], a[60:63], v[72:75], v[16:31]
ds_read_b128 v[56:59], v4 offset:48128
buffer_load_dwordx4 v1, s[4:7], s31 offen offset:1024 sc1 lds
v_fma_f32 v45, -v124, v93, v45
v_fma_f32 v46, -v124, v94, v46
PG_B_3:
s_cbranch_execz PG_B_ret
v_fma_f32 v47, -v124, v95, v47
v_mul_f32 v96, v32, v125
v_mfma_f32_32x32x16_bf16 v[16:31], a[88:91], v[76:79], v[16:31]
ds_read_b128 v[60:63], v5 offset:0
v_mul_f32 v97, v33, v125
v_mul_f32 v98, v34, v125
v_mul_f32 v99, v35, v125
v_mul_f32 v100, v36, v125
s_waitcnt lgkmcnt(2)
v_mfma_f32_32x32x16_bf16 v[16:31], a[8:11], v[48:51], v[16:31]
ds_read_b128 v[64:67], v4 offset:14336
buffer_load_dwordx4 v1, s[4:7], s31 offen offset:2048 sc1 lds
v_mul_f32 v101, v37, v125
v_mul_f32 v102, v38, v125
v_mul_f32 v103, v39, v125
v_mfma_f32_32x32x16_bf16 v[16:31], a[36:39], v[52:55], v[16:31]
ds_read_b128 v[68:71], v4 offset:31744
v_exp_f32 v96, v96
v_mul_f32 v32, v32, v40
s_waitcnt lgkmcnt(2)
v_mfma_f32_32x32x16_bf16 v[16:31], a[64:67], v[56:59], v[16:31]
ds_read_b128 v[72:75], v4 offset:49152
v_exp_f32 v97, v97
v_mul_f32 v33, v33, v41
v_exp_f32 v98, v98
v_mfma_f32_32x32x16_bf16 v[16:31], a[92:95], v[60:63], v[16:31]
ds_read_b128 v[76:79], v5 offset:1024
v_mul_f32 v34, v34, v42
v_exp_f32 v99, v99
v_mul_f32 v35, v35, v43
s_waitcnt lgkmcnt(2)
v_mfma_f32_32x32x16_bf16 v[16:31], a[12:15], v[64:67], v[16:31]
ds_read_b128 v[48:51], v4 offset:15360
v_exp_f32 v100, v100
v_mul_f32 v36, v36, v44
v_exp_f32 v101, v101
v_mfma_f32_32x32x16_bf16 v[16:31], a[40:43], v[68:71], v[16:31]
ds_read_b128 v[52:55], v4 offset:32768
v_mul_f32 v37, v37, v45
v_exp_f32 v102, v102
v_mul_f32 v38, v38, v46
s_waitcnt lgkmcnt(2)
v_mfma_f32_32x32x16_bf16 v[16:31], a[68:71], v[72:75], v[16:31]
ds_read_b128 v[56:59], v4 offset:50176
buffer_load_dwordx4 v[8:11], v147, s[4:7], s64 offen sc1
v_exp_f32 v103, v103
v_mul_f32 v39, v39, v47
v_fma_f32 v96, v96, v126, v126
v_mfma_f32_32x32x16_bf16 v[16:31], a[96:99], v[76:79], v[16:31]
ds_read_b128 v[60:63], v5 offset:2048
v_fma_f32 v97, v97, v126, v126
v_fma_f32 v98, v98, v126, v126
v_fma_f32 v99, v99, v126, v126
v_fma_f32 v100, v100, v126, v126
s_waitcnt lgkmcnt(2)
v_mfma_f32_32x32x16_bf16 v[16:31], a[16:19], v[48:51], v[16:31]
ds_read_b128 v[64:67], v4 offset:16384
v_fma_f32 v101, v101, v126, v126
v_fma_f32 v102, v102, v126, v126
v_fma_f32 v103, v103, v126, v126
v_rcp_f32 v96, v96
v_mfma_f32_32x32x16_bf16 v[16:31], a[44:47], v[52:55], v[16:31]
ds_read_b128 v[68:71], v4 offset:33792
v_rcp_f32 v97, v97
v_rcp_f32 v98, v98
s_waitcnt lgkmcnt(2)
v_mfma_f32_32x32x16_bf16 v[16:31], a[72:75], v[56:59], v[16:31]
ds_read_b128 v[72:75], v4 offset:51200
buffer_load_dwordx4 v[12:15], v147, s[4:7], s66 offen sc1
v_mul_f32 v32, v32, v96
v_rcp_f32 v99, v99
v_mul_f32 v33, v33, v97
v_mfma_f32_32x32x16_bf16 v[16:31], a[100:103], v[60:63], v[16:31]
ds_read_b128 v[76:79], v5 offset:3072
v_rcp_f32 v100, v100
v_mul_f32 v34, v34, v98
s_waitcnt lgkmcnt(2)
v_mfma_f32_32x32x16_bf16 v[16:31], a[20:23], v[64:67], v[16:31]
ds_read_b128 v[48:51], v4 offset:0
v_rcp_f32 v101, v101
v_mul_f32 v35, v35, v99
v_rcp_f32 v102, v102
v_mfma_f32_32x32x16_bf16 v[16:31], a[48:51], v[68:71], v[16:31]
ds_read_b128 v[52:55], v4 offset:17408
v_mul_f32 v36, v36, v100
v_rcp_f32 v103, v103
v_mul_f32 v37, v37, v101
s_waitcnt lgkmcnt(2)
v_mfma_f32_32x32x16_bf16 v[16:31], a[76:79], v[72:75], v[16:31]
ds_read_b128 v[56:59], v4 offset:34816
v_mul_f32 v38, v38, v102
v_mul_f32 v39, v39, v103
v_cvt_pk_bf16_f32 v112, v32, v33
v_cvt_pk_bf16_f32 v113, v34, v35
v_cvt_pk_bf16_f32 v114, v36, v37
v_mfma_f32_32x32x16_bf16 v[16:31], a[104:107], v[76:79], v[16:31]
s_waitcnt vmcnt(6)
s_barrier
ds_read_b128 v[60:63], v4 offset:52224
v_cvt_pk_bf16_f32 v115, v38, v39
buffer_store_dwordx4 v[112:115], v119, s[4:7], s26 offen nt
s_sub_u32 s26, s26, 802816
s_waitcnt lgkmcnt(2)
v_mfma_f32_32x32x16_bf16 v[16:31], a[24:27], v[48:51], v[16:31]
ds_read_b128 v[64:67], v4 offset:1024
s_add_u32 m0, s23, 8192
s_add_u32 s31, s22, 57344
buffer_load_dwordx4 v1, s[4:7], s31 offen offset:0 sc1 lds
v_mfma_f32_32x32x16_bf16 v[16:31], a[52:55], v[52:55], v[16:31]
ds_read_b128 v[68:71], v4 offset:18432
ds_read_b96 v[120:122], v6 offset:2048
s_waitcnt lgkmcnt(3)
v_mfma_f32_32x32x16_bf16 v[16:31], a[80:83], v[56:59], v[16:31]
ds_read_b128 v[72:75], v4 offset:35840
buffer_load_dwordx4 v1, s[4:7], s31 offen offset:1024 sc1 lds
v_mfma_f32_32x32x16_bf16 v[16:31], a[108:111], v[60:63], v[16:31]
ds_read_b128 v[76:79], v4 offset:53248
s_waitcnt lgkmcnt(3)
v_mfma_f32_32x32x16_bf16 v[32:47], a[0:3], v[64:67], 0
ds_read_b128 v[48:51], v4 offset:2048
buffer_load_dwordx4 v1, s[4:7], s31 offen offset:2048 sc1 lds
v_mfma_f32_32x32x16_bf16 v[32:47], a[28:31], v[68:71], v[32:47]
ds_read_b128 v[52:55], v4 offset:19456
s_waitcnt lgkmcnt(2)
v_mfma_f32_32x32x16_bf16 v[32:47], a[56:59], v[72:75], v[32:47]
ds_read_b128 v[56:59], v4 offset:36864
buffer_load_dwordx4 v1, s[4:7], s31 offen offset:3072 sc1 lds
s_nop 0
v_fma_f32 v16, -v120, v80, v16
v_fma_f32 v17, -v120, v81, v17
v_fma_f32 v18, -v120, v82, v18
v_fma_f32 v19, -v120, v83, v19
v_mfma_f32_32x32x16_bf16 v[32:47], a[84:87], v[76:79], v[32:47]
ds_read_b128 v[60:63], v4 offset:54272
v_fma_f32 v20, -v120, v84, v20
v_fma_f32 v21, -v120, v85, v21
v_fma_f32 v22, -v120, v86, v22
v_fma_f32 v23, -v120, v87, v23
s_waitcnt lgkmcnt(2)
v_mfma_f32_32x32x16_bf16 v[32:47], a[4:7], v[48:51], v[32:47]
ds_read_b128 v[64:67], v4 offset:3072
s_add_u32 m0, s23, 12288
s_add_u32 s31, s22, 61440
buffer_load_dwordx4 v1, s[4:7], s31 offen offset:0 sc1 lds
v_fma_f32 v24, -v120, v88, v24
v_fma_f32 v25, -v120, v89, v25
v_mfma_f32_32x32x16_bf16 v[32:47], a[32:35], v[52:55], v[32:47]
ds_read_b128 v[68:71], v4 offset:20480
v_fma_f32 v26, -v120, v90, v26
v_fma_f32 v27, -v120, v91, v27
v_fma_f32 v28, -v120, v92, v28
v_fma_f32 v29, -v120, v93, v29
s_waitcnt lgkmcnt(2)
v_mfma_f32_32x32x16_bf16 v[32:47], a[60:63], v[56:59], v[32:47]
ds_read_b128 v[72:75], v4 offset:37888
buffer_load_dwordx4 v1, s[4:7], s31 offen offset:1024 sc1 lds
v_fma_f32 v30, -v120, v94, v30
v_fma_f32 v31, -v120, v95, v31
v_mul_f32 v96, v16, v121
v_mul_f32 v97, v17, v121
v_mfma_f32_32x32x16_bf16 v[32:47], a[88:91], v[60:63], v[32:47]
ds_read_b128 v[76:79], v4 offset:55296
v_mul_f32 v98, v18, v121
v_mul_f32 v99, v19, v121
v_mul_f32 v100, v20, v121
v_mul_f32 v101, v21, v121
s_waitcnt lgkmcnt(2)
v_mfma_f32_32x32x16_bf16 v[32:47], a[8:11], v[64:67], v[32:47]
ds_read_b128 v[48:51], v4 offset:4096
buffer_load_dwordx4 v1, s[4:7], s31 offen offset:2048 sc1 lds
v_mul_f32 v102, v22, v121
v_mul_f32 v103, v23, v121
v_exp_f32 v96, v96
v_mfma_f32_32x32x16_bf16 v[32:47], a[36:39], v[68:71], v[32:47]
s_waitcnt vmcnt(7)
s_barrier
ds_read_b128 v[52:55], v4 offset:21504
v_mul_f32 v16, v16, v24
v_exp_f32 v97, v97
s_waitcnt lgkmcnt(2)
v_mfma_f32_32x32x16_bf16 v[32:47], a[64:67], v[72:75], v[32:47]
ds_read_b128 v[56:59], v4 offset:38912
s_add_u32 m0, s23, 15360
s_add_u32 s31, s22, 86016
buffer_load_dwordx4 v1, s[4:7], s31 offen offset:0 sc1 lds
v_mul_f32 v17, v17, v25
v_mfma_f32_32x32x16_bf16 v[32:47], a[92:95], v[76:79], v[32:47]
ds_read_b128 v[60:63], v4 offset:56320
s_add_u32 s3, s32, 10
v_bfrev_b32 v116, 1
v_mov_b32 v117, s3
v_writelane_b32 v116, s50, 0
buffer_store_dword v117, v116, s[4:7], s46 offen
s_waitcnt lgkmcnt(2)
v_mfma_f32_32x32x16_bf16 v[32:47], a[12:15], v[48:51], v[32:47]
ds_read_b128 v[64:67], v4 offset:5120
v_exp_f32 v98, v98
v_mul_f32 v18, v18, v26
v_exp_f32 v99, v99
v_mfma_f32_32x32x16_bf16 v[32:47], a[40:43], v[52:55], v[32:47]
ds_read_b128 v[68:71], v4 offset:22528
buffer_load_dwordx4 v1, s[4:7], s31 offen offset:1024 sc1 lds
v_mul_f32 v19, v19, v27
v_exp_f32 v100, v100
s_waitcnt lgkmcnt(2)
v_mfma_f32_32x32x16_bf16 v[32:47], a[68:71], v[56:59], v[32:47]
ds_read_b128 v[72:75], v4 offset:39936
v_mul_f32 v20, v20, v28
v_exp_f32 v101, v101
v_mul_f32 v21, v21, v29
v_mfma_f32_32x32x16_bf16 v[32:47], a[96:99], v[60:63], v[32:47]
ds_read_b128 v[76:79], v4 offset:57344
v_exp_f32 v102, v102
v_mul_f32 v22, v22, v30
s_waitcnt lgkmcnt(2)
v_mfma_f32_32x32x16_bf16 v[32:47], a[16:19], v[64:67], v[32:47]
ds_read_b128 v[48:51], v4 offset:6144
s_add_u32 m0, s23, 0
s_add_u32 s31, s22, 88064
buffer_load_dwordx4 v1, s[4:7], s31 offen offset:0 sc1 lds
v_exp_f32 v103, v103
v_mfma_f32_32x32x16_bf16 v[32:47], a[44:47], v[68:71], v[32:47]
ds_read_b128 v[52:55], v4 offset:23552
v_mul_f32 v23, v23, v31
v_fma_f32 v96, v96, v122, v122
v_fma_f32 v97, v97, v122, v122
v_fma_f32 v98, v98, v122, v122
s_waitcnt lgkmcnt(2)
v_mfma_f32_32x32x16_bf16 v[32:47], a[72:75], v[72:75], v[32:47]
ds_read_b128 v[56:59], v4 offset:40960
v_fma_f32 v99, v99, v122, v122
v_fma_f32 v100, v100, v122, v122
v_fma_f32 v101, v101, v122, v122
v_fma_f32 v102, v102, v122, v122
v_fma_f32 v103, v103, v122, v122
v_mfma_f32_32x32x16_bf16 v[32:47], a[100:103], v[76:79], v[32:47]
ds_read_b128 v[60:63], v4 offset:58368
buffer_load_dwordx4 v1, s[4:7], s31 offen offset:1024 sc1 lds
v_rcp_f32 v96, v96
s_waitcnt lgkmcnt(2)
v_mfma_f32_32x32x16_bf16 v[32:47], a[20:23], v[48:51], v[32:47]
ds_read_b128 v[64:67], v4 offset:7168
v_rcp_f32 v97, v97
v_rcp_f32 v98, v98
v_mul_f32 v16, v16, v96
v_mfma_f32_32x32x16_bf16 v[32:47], a[48:51], v[52:55], v[32:47]
ds_read_b128 v[68:71], v4 offset:24576
v_rcp_f32 v99, v99
v_mul_f32 v17, v17, v97
s_waitcnt lgkmcnt(2)
v_mfma_f32_32x32x16_bf16 v[32:47], a[76:79], v[56:59], v[32:47]
ds_read_b128 v[72:75], v4 offset:41984
v_rcp_f32 v100, v100
v_mul_f32 v18, v18, v98
v_rcp_f32 v101, v101
v_mfma_f32_32x32x16_bf16 v[32:47], a[104:107], v[60:63], v[32:47]
s_waitcnt vmcnt(8)
s_barrier
ds_read_b128 v[76:79], v4 offset:59392
v_mul_f32 v19, v19, v99
v_rcp_f32 v102, v102
s_waitcnt lgkmcnt(2)
v_mfma_f32_32x32x16_bf16 v[32:47], a[24:27], v[64:67], v[32:47]
ds_read_b128 v[48:51], v4 offset:8192
s_add_u32 m0, s23, 2048
s_add_u32 s31, s22, 90112
buffer_load_dwordx4 v1, s[4:7], s31 offen offset:0 sc1 lds
v_lshlrev_b32 v172, 2, v0
buffer_load_dword v174, v172, s[4:7], s43 offen sc1
v_mfma_f32_32x32x16_bf16 v[32:47], a[52:55], v[68:71], v[32:47]
ds_read_b128 v[52:55], v4 offset:25600
v_mul_f32 v20, v20, v100
v_rcp_f32 v103, v103
v_mul_f32 v21, v21, v101
ds_read_b96 v[124:126], v6 offset:2560
s_waitcnt lgkmcnt(3)
v_mfma_f32_32x32x16_bf16 v[32:47], a[80:83], v[72:75], v[32:47]
ds_read_b128 v[56:59], v4 offset:43008
v_mul_f32 v22, v22, v102
v_mul_f32 v23, v23, v103
v_cvt_pk_bf16_f32 v112, v16, v17
v_cvt_pk_bf16_f32 v113, v18, v19
v_cvt_pk_bf16_f32 v114, v20, v21
v_mfma_f32_32x32x16_bf16 v[32:47], a[108:111], v[76:79], v[32:47]
ds_read_b128 v[60:63], v4 offset:60416
buffer_load_dwordx4 v1, s[4:7], s31 offen offset:1024 sc1 lds
v_cvt_pk_bf16_f32 v115, v22, v23
buffer_store_dwordx4 v[112:115], v119, s[4:7], s26 offen nt
s_add_u32 s26, s26, 114688
s_waitcnt lgkmcnt(3)
v_mfma_f32_32x32x16_bf16 v[16:31], a[0:3], v[48:51], 0
ds_read_b128 v[64:67], v4 offset:9216
v_mfma_f32_32x32x16_bf16 v[16:31], a[28:31], v[52:55], v[16:31]
ds_read_b128 v[68:71], v4 offset:26624
s_waitcnt lgkmcnt(2)
v_mfma_f32_32x32x16_bf16 v[16:31], a[56:59], v[56:59], v[16:31]
ds_read_b128 v[72:75], v4 offset:44032
buffer_load_dwordx4 v1, s[4:7], s31 offen offset:2048 sc1 lds
v_fma_f32 v32, -v124, v80, v32
v_fma_f32 v33, -v124, v81, v33
v_fma_f32 v34, -v124, v82, v34
v_fma_f32 v35, -v124, v83, v35
v_mfma_f32_32x32x16_bf16 v[16:31], a[84:87], v[60:63], v[16:31]
ds_read_b128 v[76:79], v4 offset:61440
s_add_u32 s3, s32, 10
s_waitcnt vmcnt(3)
v_subrev_u32 v174, s3, v174
v_cmp_le_u32 vcc, 6, v174
s_nop 0
s_and_b64 vcc, vcc, s[48:49]
s_cbranch_scc0 L_chk_17_ok
s_mov_b32 s15, 0
L_chk_17:
buffer_load_dword v174, v172, s[4:7], s43 offen sc1
s_waitcnt vmcnt(0)
s_add_u32 s3, s32, 10
v_subrev_u32 v174, s3, v174
v_cmp_le_u32 vcc, 6, v174
s_nop 0
s_and_b64 vcc, vcc, s[48:49]
s_cbranch_scc0 L_chk_17_ok
s_add_u32 s15, s15, 1
s_cmp_lt_u32 s15, 131072
s_cbranch_scc1 L_chk_17
L_chk_17_ok:
s_waitcnt lgkmcnt(2)
v_mfma_f32_32x32x16_bf16 v[16:31], a[4:7], v[64:67], v[16:31]
ds_read_b128 v[48:51], v4 offset:10240
buffer_load_dwordx4 v[128:131], v1, s[4:7], s20 offen offset:0 sc1
v_fma_f32 v36, -v124, v84, v36
v_fma_f32 v37, -v124, v85, v37
v_fma_f32 v38, -v124, v86, v38
v_fma_f32 v39, -v124, v87, v39
v_mfma_f32_32x32x16_bf16 v[16:31], a[32:35], v[68:71], v[16:31]
ds_read_b128 v[52:55], v4 offset:27648
v_fma_f32 v40, -v124, v88, v40
v_fma_f32 v41, -v124, v89, v41
v_fma_f32 v42, -v124, v90, v42
v_fma_f32 v43, -v124, v91, v43
s_waitcnt lgkmcnt(2)
v_mfma_f32_32x32x16_bf16 v[16:31], a[60:63], v[72:75], v[16:31]
ds_read_b128 v[56:59], v4 offset:45056
buffer_load_dwordx4 v[132:135], v1, s[4:7], s68 offen offset:0 sc1
v_fma_f32 v44, -v124, v92, v44
v_fma_f32 v45, -v124, v93, v45
v_fma_f32 v46, -v124, v94, v46
v_fma_f32 v47, -v124, v95, v47
v_mfma_f32_32x32x16_bf16 v[16:31], a[88:91], v[76:79], v[16:31]
ds_read_b128 v[60:63], v4 offset:62464
v_mul_f32 v96, v32, v125
v_mul_f32 v97, v33, v125
v_mul_f32 v98, v34, v125
v_mul_f32 v99, v35, v125
s_waitcnt lgkmcnt(2)
v_mfma_f32_32x32x16_bf16 v[16:31], a[8:11], v[48:51], v[16:31]
ds_read_b128 v[64:67], v4 offset:11264
buffer_load_dwordx4 v[136:139], v1, s[4:7], s20 offen offset:1024 sc1
v_mul_f32 v100, v36, v125
v_mul_f32 v101, v37, v125
v_mul_f32 v102, v38, v125
v_mul_f32 v103, v39, v125
v_mfma_f32_32x32x16_bf16 v[16:31], a[36:39], v[52:55], v[16:31]
s_barrier
ds_read_b128 v[68:71], v4 offset:28672
v_exp_f32 v96, v96
v_mul_f32 v32, v32, v40
s_waitcnt lgkmcnt(2)
v_mfma_f32_32x32x16_bf16 v[16:31], a[64:67], v[56:59], v[16:31]
ds_read_b128 v[72:75], v4 offset:46080
buffer_load_dwordx4 v[140:143], v1, s[4:7], s68 offen offset:1024 sc1
v_exp_f32 v97, v97
v_mul_f32 v33, v33, v41
v_mfma_f32_32x32x16_bf16 v[16:31], a[92:95], v[60:63], v[16:31]
ds_read_b128 v[76:79], v4 offset:63488
v_exp_f32 v98, v98
v_mul_f32 v34, v34, v42
s_waitcnt lgkmcnt(2)
v_mfma_f32_32x32x16_bf16 v[16:31], a[12:15], v[64:67], v[16:31]
ds_read_b128 v[48:51], v4 offset:12288
buffer_load_dwordx4 v[144:147], v1, s[4:7], s20 offen offset:2048 sc1
v_exp_f32 v99, v99
v_mul_f32 v35, v35, v43
v_mfma_f32_32x32x16_bf16 v[16:31], a[40:43], v[68:71], v[16:31]
ds_read_b128 v[52:55], v4 offset:29696
v_exp_f32 v100, v100
v_mul_f32 v36, v36, v44
s_waitcnt lgkmcnt(2)
v_mfma_f32_32x32x16_bf16 v[16:31], a[68:71], v[72:75], v[16:31]
ds_read_b128 v[56:59], v4 offset:47104
buffer_load_dwordx4 v[148:151], v1, s[4:7], s68 offen offset:2048 sc1
v_exp_f32 v101, v101
v_mul_f32 v37, v37, v45
v_mfma_f32_32x32x16_bf16 v[16:31], a[96:99], v[76:79], v[16:31]
ds_read_b128 v[60:63], v4 offset:64512
v_exp_f32 v102, v102
v_mul_f32 v38, v38, v46
s_waitcnt lgkmcnt(2)
v_mfma_f32_32x32x16_bf16 v[16:31], a[16:19], v[48:51], v[16:31]
ds_read_b128 v[64:67], v4 offset:13312
buffer_load_dwordx4 v[152:155], v1, s[4:7], s20 offen offset:3072 sc1
v_exp_f32 v103, v103
v_mul_f32 v39, v39, v47
v_fma_f32 v96, v96, v126, v126
v_mfma_f32_32x32x16_bf16 v[16:31], a[44:47], v[52:55], v[16:31]
ds_read_b128 v[68:71], v4 offset:30720
v_fma_f32 v97, v97, v126, v126
v_fma_f32 v98, v98, v126, v126
v_fma_f32 v99, v99, v126, v126
v_fma_f32 v100, v100, v126, v126
s_waitcnt lgkmcnt(2)
v_mfma_f32_32x32x16_bf16 v[16:31], a[72:75], v[56:59], v[16:31]
ds_read_b128 v[72:75], v4 offset:48128
buffer_load_dwordx4 v[156:159], v1, s[4:7], s68 offen offset:3072 sc1
v_fma_f32 v101, v101, v126, v126
v_fma_f32 v102, v102, v126, v126
v_fma_f32 v103, v103, v126, v126
v_mfma_f32_32x32x16_bf16 v[16:31], a[100:103], v[60:63], v[16:31]
ds_read_b128 v[76:79], v5 offset:0
v_rcp_f32 v96, v96
v_rcp_f32 v97, v97
s_waitcnt lgkmcnt(2)
v_mfma_f32_32x32x16_bf16 v[16:31], a[20:23], v[64:67], v[16:31]
ds_read_b128 v[48:51], v4 offset:14336
s_add_u32 s20, s20, 4096
buffer_load_dwordx4 v[160:163], v1, s[4:7], s20 offen offset:0 sc1
v_rcp_f32 v98, v98
v_mul_f32 v32, v32, v96
v_mfma_f32_32x32x16_bf16 v[16:31], a[48:51], v[68:71], v[16:31]
ds_read_b128 v[52:55], v4 offset:31744
v_rcp_f32 v99, v99
v_mul_f32 v33, v33, v97
s_waitcnt lgkmcnt(2)
v_mfma_f32_32x32x16_bf16 v[16:31], a[76:79], v[72:75], v[16:31]
ds_read_b128 v[56:59], v4 offset:49152
s_add_u32 s68, s68, 4096
buffer_load_dwordx4 v[164:167], v1, s[4:7], s68 offen offset:0 sc1
v_rcp_f32 v100, v100
v_mul_f32 v34, v34, v98
v_mfma_f32_32x32x16_bf16 v[16:31], a[104:107], v[76:79], v[16:31]
s_barrier
ds_read_b128 v[60:63], v5 offset:1024
v_rcp_f32 v101, v101
v_mul_f32 v35, v35, v99
s_waitcnt lgkmcnt(2)
v_mfma_f32_32x32x16_bf16 v[16:31], a[24:27], v[48:51], v[16:31]
ds_read_b128 v[64:67], v4 offset:15360
buffer_load_dwordx4 v[168:171], v1, s[4:7], s20 offen offset:1024 sc1
v_rcp_f32 v102, v102
v_mul_f32 v36, v36, v100
v_mfma_f32_32x32x16_bf16 v[16:31], a[52:55], v[52:55], v[16:31]
ds_read_b128 v[68:71], v4 offset:32768
v_rcp_f32 v103, v103
v_mul_f32 v37, v37, v101
v_mul_f32 v38, v38, v102
ds_read_b96 v[120:122], v6 offset:3072
s_waitcnt lgkmcnt(3)
v_mfma_f32_32x32x16_bf16 v[16:31], a[80:83], v[56:59], v[16:31]
ds_read_b128 v[72:75], v4 offset:50176
buffer_load_dwordx4 v[172:175], v1, s[4:7], s68 offen offset:1024 sc1
v_mul_f32 v39, v39, v103
v_cvt_pk_bf16_f32 v112, v32, v33
v_cvt_pk_bf16_f32 v113, v34, v35
v_cvt_pk_bf16_f32 v114, v36, v37
v_mfma_f32_32x32x16_bf16 v[16:31], a[108:111], v[60:63], v[16:31]
ds_read_b128 v[76:79], v5 offset:2048
v_cvt_pk_bf16_f32 v115, v38, v39
buffer_store_dwordx4 v[112:115], v119, s[4:7], s26 offen nt
s_add_u32 s26, s26, 114688
s_waitcnt lgkmcnt(3)
v_mfma_f32_32x32x16_bf16 v[32:47], a[0:3], v[64:67], 0
ds_read_b128 v[48:51], v4 offset:16384
s_add_u32 m0, s27, 7168
s_nop 0
buffer_load_dwordx4 v1, s[4:7], s20 offen offset:2048 sc1 lds
v_mfma_f32_32x32x16_bf16 v[32:47], a[28:31], v[68:71], v[32:47]
ds_read_b128 v[52:55], v4 offset:33792
s_waitcnt lgkmcnt(2)
v_mfma_f32_32x32x16_bf16 v[32:47], a[56:59], v[72:75], v[32:47]
ds_read_b128 v[56:59], v4 offset:51200
s_add_u32 m0, s27, 8192
s_nop 0
buffer_load_dwordx4 v1, s[4:7], s68 offen offset:2048 sc1 lds
v_fma_f32 v16, -v120, v80, v16
v_fma_f32 v17, -v120, v81, v17
v_fma_f32 v18, -v120, v82, v18
v_mfma_f32_32x32x16_bf16 v[32:47], a[84:87], v[76:79], v[32:47]
ds_read_b128 v[60:63], v5 offset:3072
v_fma_f32 v19, -v120, v83, v19
v_fma_f32 v20, -v120, v84, v20
v_fma_f32 v21, -v120, v85, v21
v_fma_f32 v22, -v120, v86, v22
s_waitcnt lgkmcnt(2)
v_mfma_f32_32x32x16_bf16 v[32:47], a[4:7], v[48:51], v[32:47]
ds_read_b128 v[64:67], v4 offset:0
s_add_u32 m0, s27, 8192
s_nop 0
buffer_load_dwordx4 v1, s[4:7], s20 offen offset:3072 sc1 lds
v_fma_f32 v23, -v120, v87, v23
v_fma_f32 v24, -v120, v88, v24
v_fma_f32 v25, -v120, v89, v25
v_mfma_f32_32x32x16_bf16 v[32:47], a[32:35], v[52:55], v[32:47]
ds_read_b128 v[68:71], v4 offset:17408
v_fma_f32 v26, -v120, v90, v26
v_fma_f32 v27, -v120, v91, v27
v_fma_f32 v28, -v120, v92, v28
v_fma_f32 v29, -v120, v93, v29
s_waitcnt lgkmcnt(2)
v_mfma_f32_32x32x16_bf16 v[32:47], a[60:63], v[56:59], v[32:47]
ds_read_b128 v[72:75], v4 offset:34816
s_add_u32 m0, s27, 9216
s_nop 0
buffer_load_dwordx4 v1, s[4:7], s68 offen offset:3072 sc1 lds
v_fma_f32 v30, -v120, v94, v30
v_fma_f32 v31, -v120, v95, v31
v_mul_f32 v96, v16, v121
v_mfma_f32_32x32x16_bf16 v[32:47], a[88:91], v[60:63], v[32:47]
ds_read_b128 v[76:79], v4 offset:52224
v_mul_f32 v97, v17, v121
v_mul_f32 v98, v18, v121
v_mul_f32 v99, v19, v121
v_mul_f32 v100, v20, v121
s_waitcnt lgkmcnt(2)
v_mfma_f32_32x32x16_bf16 v[32:47], a[8:11], v[64:67], v[32:47]
ds_read_b128 v[48:51], v4 offset:1024
s_add_u32 s20, s20, 4096
s_add_u32 m0, s27, 13312
s_nop 0
buffer_load_dwordx4 v1, s[4:7], s20 offen offset:0 sc1 lds
v_mul_f32 v101, v21, v121
v_mul_f32 v102, v22, v121
v_mfma_f32_32x32x16_bf16 v[32:47], a[36:39], v[68:71], v[32:47]
s_waitcnt vmcnt(18)
s_barrier
ds_read_b128 v[52:55], v4 offset:18432
v_mul_f32 v103, v23, v121
v_exp_f32 v96, v96
s_waitcnt lgkmcnt(2)
v_mfma_f32_32x32x16_bf16 v[32:47], a[64:67], v[72:75], v[32:47]
ds_read_b128 v[56:59], v4 offset:35840
s_add_u32 s68, s68, 4096
s_add_u32 m0, s27, 14336
s_nop 0
buffer_load_dwordx4 v1, s[4:7], s68 offen offset:0 sc1 lds
v_mul_f32 v16, v16, v24
v_mfma_f32_32x32x16_bf16 v[32:47], a[92:95], v[76:79], v[32:47]
ds_read_b128 v[60:63], v4 offset:53248
v_exp_f32 v97, v97
v_mul_f32 v17, v17, v25
s_waitcnt lgkmcnt(2)
v_mfma_f32_32x32x16_bf16 v[32:47], a[12:15], v[48:51], v[32:47]
ds_read_b128 v[64:67], v4 offset:2048
s_add_u32 m0, s27, 14336
s_nop 0
buffer_load_dwordx4 v1, s[4:7], s20 offen offset:1024 sc1 lds
v_exp_f32 v98, v98
v_mul_f32 v18, v18, v26
v_mfma_f32_32x32x16_bf16 v[32:47], a[40:43], v[52:55], v[32:47]
ds_read_b128 v[68:71], v4 offset:19456
v_exp_f32 v99, v99
v_mul_f32 v19, v19, v27
s_waitcnt lgkmcnt(2)
v_mfma_f32_32x32x16_bf16 v[32:47], a[68:71], v[56:59], v[32:47]
ds_read_b128 v[72:75], v4 offset:36864
s_add_u32 m0, s27, 15360
s_nop 0
buffer_load_dwordx4 v1, s[4:7], s68 offen offset:1024 sc1 lds
v_exp_f32 v100, v100
v_mul_f32 v20, v20, v28
v_mfma_f32_32x32x16_bf16 v[32:47], a[96:99], v[60:63], v[32:47]
ds_read_b128 v[76:79], v4 offset:54272
v_exp_f32 v101, v101
v_mul_f32 v21, v21, v29
s_waitcnt lgkmcnt(2)
v_mfma_f32_32x32x16_bf16 v[32:47], a[16:19], v[64:67], v[32:47]
ds_read_b128 v[48:51], v4 offset:3072
s_add_u32 m0, s27, 15360
s_nop 0
buffer_load_dwordx4 v1, s[4:7], s20 offen offset:2048 sc1 lds
v_exp_f32 v102, v102
v_mul_f32 v22, v22, v30
v_mfma_f32_32x32x16_bf16 v[32:47], a[44:47], v[68:71], v[32:47]
ds_read_b128 v[52:55], v4 offset:20480
v_exp_f32 v103, v103
v_mul_f32 v23, v23, v31
v_fma_f32 v96, v96, v122, v122
s_waitcnt lgkmcnt(2)
v_mfma_f32_32x32x16_bf16 v[32:47], a[72:75], v[72:75], v[32:47]
ds_read_b128 v[56:59], v4 offset:37888
s_add_u32 m0, s27, 16384
s_nop 0
buffer_load_dwordx4 v1, s[4:7], s68 offen offset:2048 sc1 lds
v_fma_f32 v97, v97, v122, v122
v_fma_f32 v98, v98, v122, v122
v_fma_f32 v99, v99, v122, v122
v_mfma_f32_32x32x16_bf16 v[32:47], a[100:103], v[76:79], v[32:47]
ds_read_b128 v[60:63], v4 offset:55296
v_fma_f32 v100, v100, v122, v122
v_fma_f32 v101, v101, v122, v122
v_fma_f32 v102, v102, v122, v122
v_fma_f32 v103, v103, v122, v122
s_waitcnt lgkmcnt(2)
v_mfma_f32_32x32x16_bf16 v[32:47], a[20:23], v[48:51], v[32:47]
ds_read_b128 v[64:67], v4 offset:4096
v_rcp_f32 v96, v96
v_rcp_f32 v97, v97
v_mfma_f32_32x32x16_bf16 v[32:47], a[48:51], v[52:55], v[32:47]
ds_read_b128 v[68:71], v4 offset:21504
v_rcp_f32 v98, v98
v_mul_f32 v16, v16, v96
s_waitcnt lgkmcnt(2)
v_mfma_f32_32x32x16_bf16 v[32:47], a[76:79], v[56:59], v[32:47]
ds_read_b128 v[72:75], v4 offset:38912
v_rcp_f32 v99, v99
v_mul_f32 v17, v17, v97
v_rcp_f32 v100, v100
v_mfma_f32_32x32x16_bf16 v[32:47], a[104:107], v[60:63], v[32:47]
ds_read_b128 v[76:79], v4 offset:56320
v_mul_f32 v18, v18, v98
v_rcp_f32 v101, v101
v_mul_f32 v19, v19, v99
s_waitcnt lgkmcnt(2)
v_mfma_f32_32x32x16_bf16 v[32:47], a[24:27], v[64:67], v[32:47]
v_rcp_f32 v102, v102
v_mul_f32 v20, v20, v100
v_rcp_f32 v103, v103
v_mul_f32 v21, v21, v101
v_mfma_f32_32x32x16_bf16 v[32:47], a[52:55], v[68:71], v[32:47]
v_mul_f32 v22, v22, v102
v_mul_f32 v23, v23, v103
v_cvt_pk_bf16_f32 v112, v16, v17
v_cvt_pk_bf16_f32 v113, v18, v19
v_cvt_pk_bf16_f32 v114, v20, v21
ds_read_b96 v[124:126], v6 offset:3584
s_waitcnt lgkmcnt(1)
v_mfma_f32_32x32x16_bf16 v[32:47], a[80:83], v[72:75], v[32:47]
v_cvt_pk_bf16_f32 v115, v22, v23
buffer_store_dwordx4 v[112:115], v119, s[4:7], s26 offen nt
s_add_u32 s26, s26, 114688
v_mfma_f32_32x32x16_bf16 v[32:47], a[108:111], v[76:79], v[32:47]
s_waitcnt vmcnt(23)
v_mfma_f32_16x16x32_bf16 v[16:19], a[112:115], v[128:131], 0
s_add_u32 s29, s30, 40960
PG_B_4:
s_cbranch_execz PG_B_ret
v_mfma_f32_16x16x32_bf16 v[24:27], a[116:119], v[128:131], 0
buffer_load_dwordx4 v[192:195], v1, s[4:7], s29 offen offset:0 sc1
v_mfma_f32_16x16x32_bf16 v[48:51], a[120:123], v[128:131], 0
v_mfma_f32_16x16x32_bf16 v[56:59], a[124:127], v[128:131], 0
s_waitcnt vmcnt(23)
v_mfma_f32_16x16x32_bf16 v[20:23], a[112:115], v[132:135], 0
s_waitcnt lgkmcnt(0)
s_nop 1
v_fma_f32 v32, -v124, v80, v32
v_fma_f32 v33, -v124, v81, v33
v_fma_f32 v34, -v124, v82, v34
v_fma_f32 v35, -v124, v83, v35
v_mfma_f32_16x16x32_bf16 v[28:31], a[116:119], v[132:135], 0
v_fma_f32 v36, -v124, v84, v36
v_fma_f32 v37, -v124, v85, v37
buffer_load_dwordx4 v[196:199], v1, s[4:7], s29 offen offset:1024 sc1
v_mfma_f32_16x16x32_bf16 v[52:55], a[120:123], v[132:135], 0
v_fma_f32 v38, -v124, v86, v38
v_fma_f32 v39, -v124, v87, v39
v_fma_f32 v40, -v124, v88, v40
v_mfma_f32_16x16x32_bf16 v[60:63], a[124:127], v[132:135], 0
v_fma_f32 v41, -v124, v89, v41
v_fma_f32 v42, -v124, v90, v42
v_fma_f32 v43, -v124, v91, v43
s_waitcnt vmcnt(23)
v_mfma_f32_16x16x32_bf16 v[16:19], a[128:131], v[136:139], v[16:19]
v_fma_f32 v44, -v124, v92, v44
v_fma_f32 v45, -v124, v93, v45
v_fma_f32 v46, -v124, v94, v46
v_fma_f32 v47, -v124, v95, v47
v_mfma_f32_16x16x32_bf16 v[24:27], a[132:135], v[136:139], v[24:27]
v_mul_f32 v96, v32, v125
v_mul_f32 v97, v33, v125
buffer_load_dwordx4 v[200:203], v1, s[4:7], s29 offen offset:2048 sc1
v_mfma_f32_16x16x32_bf16 v[48:51], a[136:139], v[136:139], v[48:51]
v_mul_f32 v98, v34, v125
v_mul_f32 v99, v35, v125
v_mul_f32 v100, v36, v125
v_mfma_f32_16x16x32_bf16 v[56:59], a[140:143], v[136:139], v[56:59]
v_mul_f32 v101, v37, v125
v_mul_f32 v102, v38, v125
v_mul_f32 v103, v39, v125
s_waitcnt vmcnt(23)
v_mfma_f32_16x16x32_bf16 v[20:23], a[128:131], v[140:143], v[20:23]
v_exp_f32 v96, v96
v_mul_f32 v32, v32, v40
v_mfma_f32_16x16x32_bf16 v[28:31], a[132:135], v[140:143], v[28:31]
v_exp_f32 v97, v97
v_mul_f32 v33, v33, v41
buffer_load_dwordx4 v[204:207], v1, s[4:7], s29 offen offset:3072 sc1
v_mfma_f32_16x16x32_bf16 v[52:55], a[136:139], v[140:143], v[52:55]
v_exp_f32 v98, v98
v_mul_f32 v34, v34, v42
v_mfma_f32_16x16x32_bf16 v[60:63], a[140:143], v[140:143], v[60:63]
v_exp_f32 v99, v99
v_mul_f32 v35, v35, v43
s_waitcnt vmcnt(23)
v_mfma_f32_16x16x32_bf16 v[16:19], a[144:147], v[144:147], v[16:19]
v_exp_f32 v100, v100
v_mul_f32 v36, v36, v44
v_exp_f32 v101, v101
v_mfma_f32_16x16x32_bf16 v[24:27], a[148:151], v[144:147], v[24:27]
v_mul_f32 v37, v37, v45
s_add_u32 s29, s30, 45056
buffer_load_dwordx4 v[208:211], v1, s[4:7], s29 offen offset:0 sc1
v_mfma_f32_16x16x32_bf16 v[48:51], a[152:155], v[144:147], v[48:51]
v_exp_f32 v102, v102
v_mul_f32 v38, v38, v46
v_mfma_f32_16x16x32_bf16 v[56:59], a[156:159], v[144:147], v[56:59]
v_exp_f32 v103, v103
v_mul_f32 v39, v39, v47
s_waitcnt vmcnt(23)
v_mfma_f32_16x16x32_bf16 v[20:23], a[144:147], v[148:151], v[20:23]
v_fma_f32 v96, v96, v126, v126
v_fma_f32 v97, v97, v126, v126
v_fma_f32 v98, v98, v126, v126
v_fma_f32 v99, v99, v126, v126
v_mfma_f32_16x16x32_bf16 v[28:31], a[148:151], v[148:151], v[28:31]
v_fma_f32 v100, v100, v126, v126
v_fma_f32 v101, v101, v126, v126
buffer_load_dwordx4 v[212:215], v1, s[4:7], s29 offen offset:1024 sc1
v_mfma_f32_16x16x32_bf16 v[52:55], a[152:155], v[148:151], v[52:55]
v_fma_f32 v102, v102, v126, v126
v_fma_f32 v103, v103, v126, v126
v_rcp_f32 v96, v96
v_mfma_f32_16x16x32_bf16 v[60:63], a[156:159], v[148:151], v[60:63]
v_rcp_f32 v97, v97
s_waitcnt vmcnt(23)
v_mfma_f32_16x16x32_bf16 v[16:19], a[160:163], v[152:155], v[16:19]
v_rcp_f32 v98, v98
v_mul_f32 v32, v32, v96
v_mfma_f32_16x16x32_bf16 v[24:27], a[164:167], v[152:155], v[24:27]
v_rcp_f32 v99, v99
v_mul_f32 v33, v33, v97
buffer_load_dwordx4 v[216:219], v1, s[4:7], s29 offen offset:2048 sc1
v_mfma_f32_16x16x32_bf16 v[48:51], a[168:171], v[152:155], v[48:51]
v_rcp_f32 v100, v100
v_mul_f32 v34, v34, v98
v_mfma_f32_16x16x32_bf16 v[56:59], a[172:175], v[152:155], v[56:59]
v_rcp_f32 v101, v101
v_mul_f32 v35, v35, v99
s_waitcnt vmcnt(23)
v_mfma_f32_16x16x32_bf16 v[20:23], a[160:163], v[156:159], v[20:23]
v_rcp_f32 v102, v102
v_mul_f32 v36, v36, v100
v_mfma_f32_16x16x32_bf16 v[28:31], a[164:167], v[156:159], v[28:31]
v_rcp_f32 v103, v103
v_mul_f32 v37, v37, v101
buffer_load_dwordx4 v[220:223], v1, s[4:7], s29 offen offset:3072 sc1
v_mfma_f32_16x16x32_bf16 v[52:55], a[168:171], v[156:159], v[52:55]
v_mul_f32 v38, v38, v102
v_mul_f32 v39, v39, v103
v_cvt_pk_bf16_f32 v112, v32, v33
v_mfma_f32_16x16x32_bf16 v[60:63], a[172:175], v[156:159], v[60:63]
v_cvt_pk_bf16_f32 v113, v34, v35
v_cvt_pk_bf16_f32 v114, v36, v37
v_cvt_pk_bf16_f32 v115, v38, v39
s_waitcnt vmcnt(23)
v_mfma_f32_16x16x32_bf16 v[16:19], a[176:179], v[160:163], v[16:19]
buffer_store_dwordx4 v[112:115], v119, s[4:7], s26 offen nt
s_add_u32 s26, s26, 114688
v_add_u32 v47, s23, v1
v_mfma_f32_16x16x32_bf16 v[24:27], a[180:183], v[160:163], v[24:27]
s_add_u32 s29, s30, 49152
buffer_load_dwordx4 v[224:227], v1, s[4:7], s29 offen offset:0 sc1
v_mfma_f32_16x16x32_bf16 v[48:51], a[184:187], v[160:163], v[48:51]
v_add_u32 v4, s65, v1
v_xor_b32 v5, 128, v4
s_waitcnt vmcnt(20)
v_mfma_f32_16x16x32_bf16 v[56:59], a[188:191], v[160:163], v[56:59]
ds_read_b128 v[80:83], v47 offset:5120
buffer_load_dwordx4 v[120:123], v1, s[4:7], s20 offen offset:3072 sc1
v_mfma_f32_16x16x32_bf16 v[20:23], a[176:179], v[164:167], v[20:23]
s_waitcnt vmcnt(20)
ds_read_b128 v[84:87], v47 offset:6144
v_mfma_f32_16x16x32_bf16 v[28:31], a[180:183], v[164:167], v[28:31]
buffer_load_dwordx4 v[228:231], v1, s[4:7], s29 offen offset:1024 sc1
v_mfma_f32_16x16x32_bf16 v[52:55], a[184:187], v[164:167], v[52:55]
s_waitcnt vmcnt(20)
ds_read_b128 v[88:91], v47 offset:7168
v_mfma_f32_16x16x32_bf16 v[60:63], a[188:191], v[164:167], v[60:63]
buffer_load_dwordx4 v[124:127], v1, s[4:7], s68 offen offset:3072 sc1
v_mfma_f32_16x16x32_bf16 v[16:19], a[192:195], v[168:171], v[16:19]
s_waitcnt vmcnt(20)
ds_read_b128 v[92:95], v47 offset:8192
v_mfma_f32_16x16x32_bf16 v[24:27], a[196:199], v[168:171], v[24:27]
v_mfma_f32_16x16x32_bf16 v[48:51], a[200:203], v[168:171], v[48:51]
s_waitcnt vmcnt(19)
ds_read_b128 v[96:99], v47 offset:9216
s_add_u32 s20, s20, 4096
v_mfma_f32_16x16x32_bf16 v[56:59], a[204:207], v[168:171], v[56:59]
buffer_load_dwordx4 v[128:131], v1, s[4:7], s20 offen offset:0 sc1
v_mfma_f32_16x16x32_bf16 v[20:23], a[192:195], v[172:175], v[20:23]
s_waitcnt vmcnt(19)
ds_read_b128 v[100:103], v47 offset:10240
v_mfma_f32_16x16x32_bf16 v[28:31], a[196:199], v[172:175], v[28:31]
v_mfma_f32_16x16x32_bf16 v[52:55], a[200:203], v[172:175], v[52:55]
s_waitcnt vmcnt(18)
ds_read_b128 v[104:107], v47 offset:11264
s_add_u32 s68, s68, 4096
v_mfma_f32_16x16x32_bf16 v[60:63], a[204:207], v[172:175], v[60:63]
buffer_load_dwordx4 v[132:135], v1, s[4:7], s68 offen offset:0 sc1
s_waitcnt lgkmcnt(6)
v_mfma_f32_16x16x32_bf16 v[16:19], a[208:211], v[80:83], v[16:19]
s_waitcnt vmcnt(6)
s_barrier
s_add_u32 s3, s32, 11
v_bfrev_b32 v40, 1
v_mov_b32 v41, s3
v_mfma_f32_16x16x32_bf16 v[24:27], a[212:215], v[80:83], v[24:27]
v_writelane_b32 v40, s50, 0
buffer_store_dword v41, v40, s[4:7], s46 offen
ds_read_b128 v[108:111], v47 offset:12288
v_mfma_f32_16x16x32_bf16 v[48:51], a[216:219], v[80:83], v[48:51]
ds_read_b128 v[112:115], v47 offset:13312
v_mfma_f32_16x16x32_bf16 v[56:59], a[220:223], v[80:83], v[56:59]
buffer_load_dwordx4 v[136:139], v1, s[4:7], s20 offen offset:1024 sc1
s_waitcnt lgkmcnt(7)
v_mfma_f32_16x16x32_bf16 v[20:23], a[208:211], v[84:87], v[20:23]
ds_read_b128 v[116:119], v47 offset:14336
v_mfma_f32_16x16x32_bf16 v[28:31], a[212:215], v[84:87], v[28:31]
v_mfma_f32_16x16x32_bf16 v[52:55], a[216:219], v[84:87], v[52:55]
buffer_load_dwordx4 v[140:143], v1, s[4:7], s68 offen offset:1024 sc1
v_mfma_f32_16x16x32_bf16 v[60:63], a[220:223], v[84:87], v[60:63]
s_waitcnt lgkmcnt(7)
v_mfma_f32_16x16x32_bf16 v[16:19], a[224:227], v[88:91], v[16:19]
v_mfma_f32_16x16x32_bf16 v[24:27], a[228:231], v[88:91], v[24:27]
v_mfma_f32_16x16x32_bf16 v[48:51], a[232:235], v[88:91], v[48:51]
v_mfma_f32_16x16x32_bf16 v[56:59], a[236:239], v[88:91], v[56:59]
s_waitcnt lgkmcnt(6)
v_mfma_f32_16x16x32_bf16 v[20:23], a[224:227], v[92:95], v[20:23]
v_mfma_f32_16x16x32_bf16 v[28:31], a[228:231], v[92:95], v[28:31]
v_mfma_f32_16x16x32_bf16 v[52:55], a[232:235], v[92:95], v[52:55]
v_mfma_f32_16x16x32_bf16 v[60:63], a[236:239], v[92:95], v[60:63]
s_waitcnt lgkmcnt(5)
v_mfma_f32_16x16x32_bf16 v[16:19], a[240:243], v[96:99], v[16:19]
v_mfma_f32_16x16x32_bf16 v[24:27], a[244:247], v[96:99], v[24:27]
v_mfma_f32_16x16x32_bf16 v[48:51], a[248:251], v[96:99], v[48:51]
v_mfma_f32_16x16x32_bf16 v[56:59], a[252:255], v[96:99], v[56:59]
s_waitcnt lgkmcnt(4)
v_mfma_f32_16x16x32_bf16 v[20:23], a[240:243], v[100:103], v[20:23]
v_lshlrev_b32 v42, 2, v0
v_mfma_f32_16x16x32_bf16 v[28:31], a[244:247], v[100:103], v[28:31]
buffer_load_dword v44, v42, s[4:7], s43 offen sc1
v_mfma_f32_16x16x32_bf16 v[52:55], a[248:251], v[100:103], v[52:55]
v_mfma_f32_16x16x32_bf16 v[60:63], a[252:255], v[100:103], v[60:63]
s_waitcnt lgkmcnt(3)
v_mfma_f32_16x16x32_bf16 v[16:19], v[176:179], v[104:107], v[16:19]
v_mfma_f32_16x16x32_bf16 v[24:27], v[180:183], v[104:107], v[24:27]
v_mfma_f32_16x16x32_bf16 v[48:51], v[184:187], v[104:107], v[48:51]
v_mfma_f32_16x16x32_bf16 v[56:59], v[188:191], v[104:107], v[56:59]
s_waitcnt lgkmcnt(2)
v_mfma_f32_16x16x32_bf16 v[20:23], v[176:179], v[108:111], v[20:23]
v_mfma_f32_16x16x32_bf16 v[28:31], v[180:183], v[108:111], v[28:31]
v_mfma_f32_16x16x32_bf16 v[52:55], v[184:187], v[108:111], v[52:55]
s_add_u32 s3, s32, 11
s_waitcnt vmcnt(0)
v_subrev_u32 v44, s3, v44
v_cmp_le_u32 vcc, 5, v44
s_nop 0
s_and_b64 vcc, vcc, s[48:49]
v_mfma_f32_16x16x32_bf16 v[60:63], v[188:191], v[108:111], v[60:63]
s_cbranch_scc0 L_chk_18_ok
s_mov_b32 s15, 0
L_chk_18:
buffer_load_dword v44, v42, s[4:7], s43 offen sc1
s_waitcnt vmcnt(0)
s_add_u32 s3, s32, 11
v_subrev_u32 v44, s3, v44
v_cmp_le_u32 vcc, 5, v44
s_nop 0
s_and_b64 vcc, vcc, s[48:49]
s_cbranch_scc0 L_chk_18_ok
s_add_u32 s15, s15, 1
s_cmp_lt_u32 s15, 131072
s_cbranch_scc1 L_chk_18
L_chk_18_ok:
s_waitcnt lgkmcnt(1)
v_mfma_f32_16x16x32_bf16 v[16:19], v[192:195], v[112:115], v[16:19]
buffer_load_dwordx4 v[144:147], v1, s[4:7], s21 offen offset:0 sc1
v_mfma_f32_16x16x32_bf16 v[24:27], v[196:199], v[112:115], v[24:27]
v_mfma_f32_16x16x32_bf16 v[48:51], v[200:203], v[112:115], v[48:51]
buffer_load_dwordx4 v[148:151], v1, s[4:7], s69 offen offset:0 sc1
v_mfma_f32_16x16x32_bf16 v[56:59], v[204:207], v[112:115], v[56:59]
s_waitcnt lgkmcnt(0)
v_mfma_f32_16x16x32_bf16 v[20:23], v[192:195], v[116:119], v[20:23]
buffer_load_dwordx4 v[152:155], v1, s[4:7], s21 offen offset:1024 sc1
v_mfma_f32_16x16x32_bf16 v[28:31], v[196:199], v[116:119], v[28:31]
v_mfma_f32_16x16x32_bf16 v[52:55], v[200:203], v[116:119], v[52:55]
buffer_load_dwordx4 v[156:159], v1, s[4:7], s69 offen offset:1024 sc1
v_mfma_f32_16x16x32_bf16 v[60:63], v[204:207], v[116:119], v[60:63]
v_mfma_f32_16x16x32_bf16 v[16:19], v[208:211], v[120:123], v[16:19]
buffer_load_dwordx4 v[160:163], v1, s[4:7], s21 offen offset:2048 sc1
v_mfma_f32_16x16x32_bf16 v[24:27], v[212:215], v[120:123], v[24:27]
v_mfma_f32_16x16x32_bf16 v[48:51], v[216:219], v[120:123], v[48:51]
buffer_load_dwordx4 v[164:167], v1, s[4:7], s69 offen offset:2048 sc1
v_mfma_f32_16x16x32_bf16 v[56:59], v[220:223], v[120:123], v[56:59]
v_mfma_f32_16x16x32_bf16 v[20:23], v[208:211], v[124:127], v[20:23]
buffer_load_dwordx4 v[168:171], v1, s[4:7], s21 offen offset:3072 sc1
v_mfma_f32_16x16x32_bf16 v[28:31], v[212:215], v[124:127], v[28:31]
v_mfma_f32_16x16x32_bf16 v[52:55], v[216:219], v[124:127], v[52:55]
buffer_load_dwordx4 v[172:175], v1, s[4:7], s69 offen offset:3072 sc1
v_mfma_f32_16x16x32_bf16 v[60:63], v[220:223], v[124:127], v[60:63]
v_mfma_f32_16x16x32_bf16 v[16:19], v[224:227], v[128:131], v[16:19]
s_add_u32 s21, s21, 4096
v_mfma_f32_16x16x32_bf16 v[24:27], v[228:231], v[128:131], v[24:27]
buffer_load_dwordx4 v[80:83], v1, s[4:7], s21 offen offset:0 sc1
v_mfma_f32_16x16x32_bf16 v[48:51], v[232:235], v[128:131], v[48:51]
s_add_u32 s69, s69, 4096
v_mfma_f32_16x16x32_bf16 v[56:59], v[236:239], v[128:131], v[56:59]
buffer_load_dwordx4 v[84:87], v1, s[4:7], s69 offen offset:0 sc1
v_mfma_f32_16x16x32_bf16 v[20:23], v[224:227], v[132:135], v[20:23]
buffer_load_dwordx4 v[88:91], v1, s[4:7], s21 offen offset:1024 sc1
v_mfma_f32_16x16x32_bf16 v[28:31], v[228:231], v[132:135], v[28:31]
v_mfma_f32_16x16x32_bf16 v[52:55], v[232:235], v[132:135], v[52:55]
buffer_load_dwordx4 v[92:95], v1, s[4:7], s69 offen offset:1024 sc1
v_mfma_f32_16x16x32_bf16 v[60:63], v[236:239], v[132:135], v[60:63]
v_mfma_f32_16x16x32_bf16 v[16:19], v[240:243], v[136:139], v[16:19]
buffer_load_dwordx4 v[96:99], v1, s[4:7], s21 offen offset:2048 sc1
v_mfma_f32_16x16x32_bf16 v[24:27], v[244:247], v[136:139], v[24:27]
v_mfma_f32_16x16x32_bf16 v[48:51], v[248:251], v[136:139], v[48:51]
buffer_load_dwordx4 v[100:103], v1, s[4:7], s69 offen offset:2048 sc1
v_mfma_f32_16x16x32_bf16 v[56:59], v[252:255], v[136:139], v[56:59]
v_mfma_f32_16x16x32_bf16 v[20:23], v[240:243], v[140:143], v[20:23]
buffer_load_dwordx4 v[104:107], v1, s[4:7], s21 offen offset:3072 sc1
v_mfma_f32_16x16x32_bf16 v[28:31], v[244:247], v[140:143], v[28:31]
v_mfma_f32_16x16x32_bf16 v[52:55], v[248:251], v[140:143], v[52:55]
buffer_load_dwordx4 v[108:111], v1, s[4:7], s69 offen offset:3072 sc1
v_mfma_f32_16x16x32_bf16 v[60:63], v[252:255], v[140:143], v[60:63]
s_waitcnt vmcnt(15)
v_mfma_f32_16x16x32_bf16 v[32:35], a[112:115], v[144:147], 0
v_mfma_f32_16x16x32_bf16 v[40:43], a[116:119], v[144:147], 0
v_mfma_f32_16x16x32_bf16 v[64:67], a[120:123], v[144:147], 0
s_add_u32 s21, s21, 4096
v_mfma_f32_16x16x32_bf16 v[72:75], a[124:127], v[144:147], 0
buffer_load_dwordx4 v[112:115], v1, s[4:7], s21 offen offset:0 sc1
s_waitcnt vmcnt(15)
v_mfma_f32_16x16x32_bf16 v[36:39], a[112:115], v[148:151], 0
ds_write_b128 v4, v[16:19] offset:0
v_mfma_f32_16x16x32_bf16 v[44:47], a[116:119], v[148:151], 0
v_mfma_f32_16x16x32_bf16 v[68:71], a[120:123], v[148:151], 0
s_add_u32 s69, s69, 4096
v_mfma_f32_16x16x32_bf16 v[76:79], a[124:127], v[148:151], 0
buffer_load_dwordx4 v[116:119], v1, s[4:7], s69 offen offset:0 sc1
s_waitcnt vmcnt(15)
v_mfma_f32_16x16x32_bf16 v[32:35], a[128:131], v[152:155], v[32:35]
ds_write_b128 v4, v[20:23] offset:1024
v_mfma_f32_16x16x32_bf16 v[40:43], a[132:135], v[152:155], v[40:43]
v_mfma_f32_16x16x32_bf16 v[64:67], a[136:139], v[152:155], v[64:67]
buffer_load_dwordx4 v[120:123], v1, s[4:7], s21 offen offset:1024 sc1
v_mfma_f32_16x16x32_bf16 v[72:75], a[140:143], v[152:155], v[72:75]
s_waitcnt vmcnt(15)
v_mfma_f32_16x16x32_bf16 v[36:39], a[128:131], v[156:159], v[36:39]
ds_write_b128 v5, v[24:27] offset:2048
v_mfma_f32_16x16x32_bf16 v[44:47], a[132:135], v[156:159], v[44:47]
v_mfma_f32_16x16x32_bf16 v[68:71], a[136:139], v[156:159], v[68:71]
buffer_load_dwordx4 v[124:127], v1, s[4:7], s69 offen offset:1024 sc1
v_mfma_f32_16x16x32_bf16 v[76:79], a[140:143], v[156:159], v[76:79]
s_waitcnt vmcnt(15)
v_mfma_f32_16x16x32_bf16 v[32:35], a[144:147], v[160:163], v[32:35]
ds_write_b128 v5, v[28:31] offset:3072
v_mfma_f32_16x16x32_bf16 v[40:43], a[148:151], v[160:163], v[40:43]
v_mfma_f32_16x16x32_bf16 v[64:67], a[152:155], v[160:163], v[64:67]
buffer_load_dwordx4 v[128:131], v1, s[4:7], s21 offen offset:2048 sc1
v_mfma_f32_16x16x32_bf16 v[72:75], a[156:159], v[160:163], v[72:75]
s_waitcnt vmcnt(15)
v_mfma_f32_16x16x32_bf16 v[36:39], a[144:147], v[164:167], v[36:39]
ds_write_b128 v4, v[48:51] offset:4096
v_mfma_f32_16x16x32_bf16 v[44:47], a[148:151], v[164:167], v[44:47]
v_mfma_f32_16x16x32_bf16 v[68:71], a[152:155], v[164:167], v[68:71]
buffer_load_dwordx4 v[132:135], v1, s[4:7], s69 offen offset:2048 sc1
v_mfma_f32_16x16x32_bf16 v[76:79], a[156:159], v[164:167], v[76:79]
s_waitcnt vmcnt(15)
v_mfma_f32_16x16x32_bf16 v[32:35], a[160:163], v[168:171], v[32:35]
ds_write_b128 v4, v[52:55] offset:5120
v_mfma_f32_16x16x32_bf16 v[40:43], a[164:167], v[168:171], v[40:43]
v_mfma_f32_16x16x32_bf16 v[64:67], a[168:171], v[168:171], v[64:67]
buffer_load_dwordx4 v[136:139], v1, s[4:7], s21 offen offset:3072 sc1
v_mfma_f32_16x16x32_bf16 v[72:75], a[172:175], v[168:171], v[72:75]
s_waitcnt vmcnt(15)
v_mfma_f32_16x16x32_bf16 v[36:39], a[160:163], v[172:175], v[36:39]
ds_write_b128 v5, v[56:59] offset:6144
v_mfma_f32_16x16x32_bf16 v[44:47], a[164:167], v[172:175], v[44:47]
v_mfma_f32_16x16x32_bf16 v[68:71], a[168:171], v[172:175], v[68:71]
buffer_load_dwordx4 v[140:143], v1, s[4:7], s69 offen offset:3072 sc1
v_mfma_f32_16x16x32_bf16 v[76:79], a[172:175], v[172:175], v[76:79]
s_waitcnt vmcnt(15)
v_mfma_f32_16x16x32_bf16 v[32:35], a[176:179], v[80:83], v[32:35]
ds_write_b128 v5, v[60:63] offset:7168
v_mfma_f32_16x16x32_bf16 v[40:43], a[180:183], v[80:83], v[40:43]
v_mfma_f32_16x16x32_bf16 v[64:67], a[184:187], v[80:83], v[64:67]
s_add_u32 s21, s21, 4096
v_mfma_f32_16x16x32_bf16 v[72:75], a[188:191], v[80:83], v[72:75]
buffer_load_dwordx4 v[144:147], v1, s[4:7], s21 offen offset:0 sc1
s_waitcnt vmcnt(15)
v_mfma_f32_16x16x32_bf16 v[36:39], a[176:179], v[84:87], v[36:39]
v_mfma_f32_16x16x32_bf16 v[44:47], a[180:183], v[84:87], v[44:47]
v_mfma_f32_16x16x32_bf16 v[68:71], a[184:187], v[84:87], v[68:71]
s_add_u32 s69, s69, 4096
v_mfma_f32_16x16x32_bf16 v[76:79], a[188:191], v[84:87], v[76:79]
buffer_load_dwordx4 v[148:151], v1, s[4:7], s69 offen offset:0 sc1
s_waitcnt vmcnt(15)
v_mfma_f32_16x16x32_bf16 v[32:35], a[192:195], v[88:91], v[32:35]
s_waitcnt lgkmcnt(0)
s_barrier
v_mfma_f32_16x16x32_bf16 v[40:43], a[196:199], v[88:91], v[40:43]
ds_read_b128 v[16:19], v2 offset:0
ds_read_b128 v[20:23], v2 offset:512
v_mfma_f32_16x16x32_bf16 v[64:67], a[200:203], v[88:91], v[64:67]
buffer_load_dwordx4 v[152:155], v1, s[4:7], s21 offen offset:1024 sc1
ds_read_b128 v[24:27], v2 offset:8192
v_mfma_f32_16x16x32_bf16 v[72:75], a[204:207], v[88:91], v[72:75]
ds_read_b128 v[28:31], v2 offset:8704
s_waitcnt vmcnt(15)
v_mfma_f32_16x16x32_bf16 v[36:39], a[192:195], v[92:95], v[36:39]
ds_read_b128 v[48:51], v2 offset:16384
v_mfma_f32_16x16x32_bf16 v[44:47], a[196:199], v[92:95], v[44:47]
ds_read_b128 v[52:55], v2 offset:16896
v_mfma_f32_16x16x32_bf16 v[68:71], a[200:203], v[92:95], v[68:71]
buffer_load_dwordx4 v[156:159], v1, s[4:7], s69 offen offset:1024 sc1
ds_read_b128 v[56:59], v2 offset:24576
v_mfma_f32_16x16x32_bf16 v[76:79], a[204:207], v[92:95], v[76:79]
ds_read_b128 v[60:63], v2 offset:25088
s_waitcnt vmcnt(15)
v_mfma_f32_16x16x32_bf16 v[32:35], a[208:211], v[96:99], v[32:35]
v_mfma_f32_16x16x32_bf16 v[40:43], a[212:215], v[96:99], v[40:43]
v_mfma_f32_16x16x32_bf16 v[64:67], a[216:219], v[96:99], v[64:67]
s_waitcnt lgkmcnt(5)
v_add_f32 v24, v24, v16
v_add_f32 v25, v25, v17
v_mfma_f32_16x16x32_bf16 v[72:75], a[220:223], v[96:99], v[72:75]
v_add_f32 v26, v26, v18
v_add_f32 v27, v27, v19
s_waitcnt vmcnt(14)
v_mfma_f32_16x16x32_bf16 v[36:39], a[208:211], v[100:103], v[36:39]
s_waitcnt lgkmcnt(4)
v_add_f32 v28, v28, v20
v_add_f32 v29, v29, v21
v_mfma_f32_16x16x32_bf16 v[44:47], a[212:215], v[100:103], v[44:47]
v_add_f32 v30, v30, v22
v_add_f32 v31, v31, v23
v_mfma_f32_16x16x32_bf16 v[68:71], a[216:219], v[100:103], v[68:71]
v_lshlrev_b32 v16, 16, v8
v_and_b32 v17, 0xffff0000, v8
v_mfma_f32_16x16x32_bf16 v[76:79], a[220:223], v[100:103], v[76:79]
v_lshlrev_b32 v18, 16, v9
v_and_b32 v19, 0xffff0000, v9
s_waitcnt vmcnt(13)
v_mfma_f32_16x16x32_bf16 v[32:35], a[224:227], v[104:107], v[32:35]
v_lshlrev_b32 v20, 16, v10
v_and_b32 v21, 0xffff0000, v10
v_mfma_f32_16x16x32_bf16 v[40:43], a[228:231], v[104:107], v[40:43]
v_lshlrev_b32 v22, 16, v11
v_and_b32 v23, 0xffff0000, v11
v_mfma_f32_16x16x32_bf16 v[64:67], a[232:235], v[104:107], v[64:67]
v_add_f32 v24, v24, v16
v_add_f32 v25, v25, v17
v_mfma_f32_16x16x32_bf16 v[72:75], a[236:239], v[104:107], v[72:75]
v_add_f32 v26, v26, v18
v_add_f32 v27, v27, v19
s_waitcnt vmcnt(12)
v_mfma_f32_16x16x32_bf16 v[36:39], a[224:227], v[108:111], v[36:39]
v_add_f32 v28, v28, v20
v_add_f32 v29, v29, v21
v_mfma_f32_16x16x32_bf16 v[44:47], a[228:231], v[108:111], v[44:47]
v_add_f32 v30, v30, v22
v_add_f32 v31, v31, v23
v_mfma_f32_16x16x32_bf16 v[68:71], a[232:235], v[108:111], v[68:71]
s_waitcnt lgkmcnt(1)
v_add_f32 v48, v48, v56
v_add_f32 v49, v49, v57
v_mfma_f32_16x16x32_bf16 v[76:79], a[236:239], v[108:111], v[76:79]
v_add_f32 v50, v50, v58
v_add_f32 v51, v51, v59
s_waitcnt vmcnt(11)
v_mfma_f32_16x16x32_bf16 v[32:35], a[240:243], v[112:115], v[32:35]
s_waitcnt lgkmcnt(0)
v_add_f32 v52, v52, v60
v_add_f32 v53, v53, v61
v_mfma_f32_16x16x32_bf16 v[40:43], a[244:247], v[112:115], v[40:43]
v_add_f32 v54, v54, v62
v_add_f32 v55, v55, v63
v_mfma_f32_16x16x32_bf16 v[64:67], a[248:251], v[112:115], v[64:67]
v_add_f32 v24, v24, v48
v_add_f32 v25, v25, v49
v_mfma_f32_16x16x32_bf16 v[72:75], a[252:255], v[112:115], v[72:75]
v_add_f32 v26, v26, v50
v_add_f32 v27, v27, v51
s_waitcnt vmcnt(10)
v_mfma_f32_16x16x32_bf16 v[36:39], a[240:243], v[116:119], v[36:39]
v_add_f32 v28, v28, v52
v_add_f32 v29, v29, v53
v_mfma_f32_16x16x32_bf16 v[44:47], a[244:247], v[116:119], v[44:47]
v_add_f32 v30, v30, v54
v_add_f32 v31, v31, v55
v_mfma_f32_16x16x32_bf16 v[68:71], a[248:251], v[116:119], v[68:71]
v_cvt_pk_bf16_f32 v8, v24, v25
v_cvt_pk_bf16_f32 v9, v26, v27
v_mfma_f32_16x16x32_bf16 v[76:79], a[252:255], v[116:119], v[76:79]
v_cvt_pk_bf16_f32 v10, v28, v29
v_cvt_pk_bf16_f32 v11, v30, v31
s_waitcnt vmcnt(9)
v_mfma_f32_16x16x32_bf16 v[32:35], v[176:179], v[120:123], v[32:35]
buffer_store_dwordx2 v[8:9], v3, s[8:11], s18 offen offset:0 nt
v_mfma_f32_16x16x32_bf16 v[40:43], v[180:183], v[120:123], v[40:43]
buffer_store_dwordx2 v[10:11], v3, s[8:11], s18 offen offset:16 nt
v_mfma_f32_16x16x32_bf16 v[64:67], v[184:187], v[120:123], v[64:67]
v_mfma_f32_16x16x32_bf16 v[72:75], v[188:191], v[120:123], v[72:75]
s_waitcnt vmcnt(10)
v_mfma_f32_16x16x32_bf16 v[36:39], v[176:179], v[124:127], v[36:39]
v_mfma_f32_16x16x32_bf16 v[44:47], v[180:183], v[124:127], v[44:47]
v_mfma_f32_16x16x32_bf16 v[68:71], v[184:187], v[124:127], v[68:71]
v_mfma_f32_16x16x32_bf16 v[76:79], v[188:191], v[124:127], v[76:79]
s_waitcnt vmcnt(9)
v_mfma_f32_16x16x32_bf16 v[32:35], v[192:195], v[128:131], v[32:35]
v_mfma_f32_16x16x32_bf16 v[40:43], v[196:199], v[128:131], v[40:43]
v_mfma_f32_16x16x32_bf16 v[64:67], v[200:203], v[128:131], v[64:67]
v_mfma_f32_16x16x32_bf16 v[72:75], v[204:207], v[128:131], v[72:75]
s_waitcnt vmcnt(8)
v_mfma_f32_16x16x32_bf16 v[36:39], v[192:195], v[132:135], v[36:39]
v_mfma_f32_16x16x32_bf16 v[44:47], v[196:199], v[132:135], v[44:47]
v_mfma_f32_16x16x32_bf16 v[68:71], v[200:203], v[132:135], v[68:71]
v_mfma_f32_16x16x32_bf16 v[76:79], v[204:207], v[132:135], v[76:79]
s_waitcnt vmcnt(7)
v_mfma_f32_16x16x32_bf16 v[32:35], v[208:211], v[136:139], v[32:35]
v_mfma_f32_16x16x32_bf16 v[40:43], v[212:215], v[136:139], v[40:43]
s_waitcnt vmcnt(6)
v_mfma_f32_16x16x32_bf16 v[36:39], v[208:211], v[140:143], v[36:39]
v_mfma_f32_16x16x32_bf16 v[44:47], v[212:215], v[140:143], v[44:47]
s_waitcnt vmcnt(5)
v_mfma_f32_16x16x32_bf16 v[32:35], v[224:227], v[144:147], v[32:35]
v_mfma_f32_16x16x32_bf16 v[40:43], v[228:231], v[144:147], v[40:43]
s_waitcnt vmcnt(4)
v_mfma_f32_16x16x32_bf16 v[36:39], v[224:227], v[148:151], v[36:39]
v_mfma_f32_16x16x32_bf16 v[44:47], v[228:231], v[148:151], v[44:47]
s_waitcnt vmcnt(3)
v_mfma_f32_16x16x32_bf16 v[32:35], v[240:243], v[152:155], v[32:35]
v_mfma_f32_16x16x32_bf16 v[40:43], v[244:247], v[152:155], v[40:43]
s_waitcnt vmcnt(2)
v_mfma_f32_16x16x32_bf16 v[36:39], v[240:243], v[156:159], v[36:39]
v_mfma_f32_16x16x32_bf16 v[44:47], v[244:247], v[156:159], v[44:47]
v_mfma_f32_16x16x32_bf16 v[64:67], v[216:219], v[136:139], v[64:67]
v_mfma_f32_16x16x32_bf16 v[72:75], v[220:223], v[136:139], v[72:75]
v_mfma_f32_16x16x32_bf16 v[68:71], v[216:219], v[140:143], v[68:71]
v_mfma_f32_16x16x32_bf16 v[76:79], v[220:223], v[140:143], v[76:79]
v_mfma_f32_16x16x32_bf16 v[64:67], v[232:235], v[144:147], v[64:67]
ds_write_b128 v4, v[32:35] offset:32768
v_mfma_f32_16x16x32_bf16 v[72:75], v[236:239], v[144:147], v[72:75]
v_mfma_f32_16x16x32_bf16 v[68:71], v[232:235], v[148:151], v[68:71]
ds_write_b128 v4, v[36:39] offset:33792
v_mfma_f32_16x16x32_bf16 v[76:79], v[236:239], v[148:151], v[76:79]
v_mfma_f32_16x16x32_bf16 v[64:67], v[248:251], v[152:155], v[64:67]
ds_write_b128 v5, v[40:43] offset:34816
v_mfma_f32_16x16x32_bf16 v[72:75], v[252:255], v[152:155], v[72:75]
v_mfma_f32_16x16x32_bf16 v[68:71], v[248:251], v[156:159], v[68:71]
ds_write_b128 v5, v[44:47] offset:35840
v_mfma_f32_16x16x32_bf16 v[76:79], v[252:255], v[156:159], v[76:79]
v_lshlrev_b32 v128, 16, v12
v_and_b32 v129, 0xffff0000, v12
v_lshlrev_b32 v130, 16, v13
v_and_b32 v131, 0xffff0000, v13
v_lshlrev_b32 v132, 16, v14
v_and_b32 v133, 0xffff0000, v14
v_lshlrev_b32 v134, 16, v15
v_and_b32 v135, 0xffff0000, v15
ds_write_b128 v4, v[64:67] offset:36864
ds_write_b128 v4, v[68:71] offset:37888
ds_write_b128 v5, v[72:75] offset:38912
ds_write_b128 v5, v[76:79] offset:39936
s_waitcnt lgkmcnt(0)
s_barrier
ds_read_b128 v[32:35], v2 offset:32768
ds_read_b128 v[36:39], v2 offset:33280
ds_read_b128 v[40:43], v2 offset:40960
ds_read_b128 v[44:47], v2 offset:41472
ds_read_b128 v[64:67], v2 offset:49152
ds_read_b128 v[68:71], v2 offset:49664
ds_read_b128 v[72:75], v2 offset:57344
ds_read_b128 v[76:79], v2 offset:57856
s_waitcnt lgkmcnt(7)
v_add_f32 v128, v128, v32
v_add_f32 v129, v129, v33
v_add_f32 v130, v130, v34
v_add_f32 v131, v131, v35
s_waitcnt lgkmcnt(6)
v_add_f32 v132, v132, v36
v_add_f32 v133, v133, v37
v_add_f32 v134, v134, v38
v_add_f32 v135, v135, v39
s_waitcnt lgkmcnt(5)
v_add_f32 v128, v128, v40
v_add_f32 v129, v129, v41
v_add_f32 v130, v130, v42
v_add_f32 v131, v131, v43
s_waitcnt lgkmcnt(4)
v_add_f32 v132, v132, v44
v_add_f32 v133, v133, v45
v_add_f32 v134, v134, v46
v_add_f32 v135, v135, v47
s_waitcnt lgkmcnt(1)
v_add_f32 v64, v64, v72
v_add_f32 v65, v65, v73
v_add_f32 v66, v66, v74
v_add_f32 v67, v67, v75
s_waitcnt lgkmcnt(0)
v_add_f32 v68, v68, v76
v_add_f32 v69, v69, v77
v_add_f32 v70, v70, v78
v_add_f32 v71, v71, v79
v_add_f32 v128, v128, v64
v_add_f32 v129, v129, v65
v_add_f32 v130, v130, v66
v_add_f32 v131, v131, v67
v_add_f32 v132, v132, v68
v_add_f32 v133, v133, v69
v_add_f32 v134, v134, v70
v_add_f32 v135, v135, v71
v_cvt_pk_bf16_f32 v12, v128, v129
v_cvt_pk_bf16_f32 v13, v130, v131
v_cvt_pk_bf16_f32 v14, v132, v133
v_cvt_pk_bf16_f32 v15, v134, v135
s_sub_u32 s18, s18, 229376
buffer_store_dwordx2 v[12:13], v3, s[8:11], s18 offen offset:0 nt
buffer_store_dwordx2 v[14:15], v3, s[8:11], s18 offen offset:16 nt
s_endpgm
interleave_layers__sliding_local_dilated__glu_gated_swiglu__prompt_kernel_h2L:
s_endpgm
interleave_layers__sliding_local_dilated__glu_gated_swiglu__prompt_kernel_gl:
s_waitcnt vmcnt(0)
s_mov_b32 s32, s33
s_lshl_b32 s43, s12, 12
s_add_u32 s43, s43, 16814080
s_sub_u32 s46, s51, 65536
s_lshl_b32 s16, s14, 9
s_add_u32 s16, s16, 160768
v_and_b32 v130, 15, v0
v_lshrrev_b32 v131, 4, v0
v_lshl_add_u32 v132, v130, 2, s16
v_lshl_add_u32 v133, v131, 4, s16
ds_read_b32 v112, v132 offset:320
ds_read_b32 v113, v132 offset:384
ds_read_b32 v114, v132 offset:448
ds_read_b128 v[116:119], v133 offset:320
ds_read_b128 v[120:123], v133 offset:384
ds_read_b128 v[124:127], v133 offset:448
v_lshlrev_b32 v134, 4, v131
v_lshlrev_b32 v135, 2, v130
v_add_u32 v134, 159744, v134
v_add_u32 v135, 159744, v135
v_accvgpr_read_b32 v224, a88
v_accvgpr_read_b32 v225, a89
v_accvgpr_read_b32 v226, a90
v_accvgpr_read_b32 v227, a91
v_accvgpr_read_b32 v228, a92
v_accvgpr_read_b32 v229, a93
v_accvgpr_read_b32 v230, a94
v_accvgpr_read_b32 v231, a95
v_accvgpr_read_b32 v232, a96
v_accvgpr_read_b32 v233, a97
v_accvgpr_read_b32 v234, a98
v_accvgpr_read_b32 v235, a99
v_accvgpr_read_b32 v236, a100
v_accvgpr_read_b32 v237, a101
v_accvgpr_read_b32 v238, a102
v_accvgpr_read_b32 v239, a103
v_accvgpr_read_b32 v5, a104
v_accvgpr_read_b32 v6, a108
v_fma_f32 v16, -v3, v224, v16
v_fma_f32 v17, -v3, v225, v17
v_fma_f32 v18, -v3, v226, v18
v_fma_f32 v19, -v3, v227, v19
v_fma_f32 v20, -v3, v228, v20
v_fma_f32 v21, -v3, v229, v21
v_fma_f32 v22, -v3, v230, v22
v_fma_f32 v23, -v3, v231, v23
v_fma_f32 v24, -v4, v224, v24
v_fma_f32 v25, -v4, v225, v25
v_fma_f32 v26, -v4, v226, v26
v_fma_f32 v27, -v4, v227, v27
v_fma_f32 v28, -v4, v228, v28
v_fma_f32 v29, -v4, v229, v29
v_fma_f32 v30, -v4, v230, v30
v_fma_f32 v31, -v4, v231, v31
v_fma_f32 v32, -v2, v232, v32
v_fma_f32 v33, -v2, v233, v33
v_fma_f32 v34, -v2, v234, v34
v_fma_f32 v35, -v2, v235, v35
v_fma_f32 v36, -v2, v236, v36
v_fma_f32 v37, -v2, v237, v37
v_fma_f32 v38, -v2, v238, v38
v_fma_f32 v39, -v2, v239, v39
v_fma_f32 v40, -v3, v232, v40
v_fma_f32 v41, -v3, v233, v41
v_fma_f32 v42, -v3, v234, v42
v_fma_f32 v43, -v3, v235, v43
v_fma_f32 v44, -v3, v236, v44
v_fma_f32 v45, -v3, v237, v45
v_fma_f32 v46, -v3, v238, v46
v_fma_f32 v47, -v3, v239, v47
v_fma_f32 v48, -v4, v232, v48
v_fma_f32 v49, -v4, v233, v49
v_fma_f32 v50, -v4, v234, v50
v_fma_f32 v51, -v4, v235, v51
v_fma_f32 v52, -v4, v236, v52
v_fma_f32 v53, -v4, v237, v53
v_fma_f32 v54, -v4, v238, v54
v_fma_f32 v55, -v4, v239, v55
ds_write_b128 v134, v[224:227] offset:0
ds_write_b128 v134, v[228:231] offset:64
ds_write_b128 v134, v[232:235] offset:128
ds_write_b128 v134, v[236:239] offset:192
ds_write_b32 v135, v5 offset:256
ds_write_b32 v135, v6 offset:320
v_fma_f32 v56, -v240, v5, v56
v_fma_f32 v57, -v241, v5, v57
v_fma_f32 v58, -v242, v5, v58
v_fma_f32 v59, -v243, v5, v59
v_fma_f32 v60, -v240, v6, v60
v_fma_f32 v61, -v241, v6, v61
v_fma_f32 v62, -v242, v6, v62
v_fma_f32 v63, -v243, v6, v63
v_fma_f32 v64, -v244, v5, v64
v_fma_f32 v65, -v245, v5, v65
v_fma_f32 v66, -v246, v5, v66
v_fma_f32 v67, -v247, v5, v67
v_fma_f32 v68, -v244, v6, v68
v_fma_f32 v69, -v245, v6, v69
v_fma_f32 v70, -v246, v6, v70
v_fma_f32 v71, -v247, v6, v71
v_fma_f32 v72, -v248, v5, v72
v_fma_f32 v73, -v249, v5, v73
v_fma_f32 v74, -v250, v5, v74
v_fma_f32 v75, -v251, v5, v75
v_fma_f32 v76, -v248, v6, v76
v_fma_f32 v77, -v249, v6, v77
v_fma_f32 v78, -v250, v6, v78
v_fma_f32 v79, -v251, v6, v79
v_cvt_pk_bf16_f32 v92, v16, v17
v_cvt_pk_bf16_f32 v93, v18, v19
v_cvt_pk_bf16_f32 v94, v20, v21
v_cvt_pk_bf16_f32 v95, v22, v23
v_cvt_pk_bf16_f32 v96, v24, v25
v_cvt_pk_bf16_f32 v97, v26, v27
v_cvt_pk_bf16_f32 v98, v28, v29
v_cvt_pk_bf16_f32 v99, v30, v31
s_cmp_eq_u32 s21, 1
s_cselect_b64 vcc, -1, 0
v_mov_b32 v140, 0xf149f2ca
s_waitcnt lgkmcnt(11)
v_mul_f32 v32, v32, v112
v_mul_f32 v33, v33, v112
v_mul_f32 v34, v34, v112
v_mul_f32 v35, v35, v112
v_cvt_pk_bf16_f32 v80, v32, v33
v_cvt_pk_bf16_f32 v81, v34, v35
v_mul_f32 v36, v36, v112
v_mul_f32 v37, v37, v112
v_mul_f32 v38, v38, v112
v_mul_f32 v39, v39, v112
v_cvt_pk_bf16_f32 v82, v36, v37
v_cvt_pk_bf16_f32 v83, v38, v39
s_waitcnt lgkmcnt(10)
v_mul_f32 v40, v40, v113
v_mul_f32 v41, v41, v113
v_mul_f32 v42, v42, v113
v_mul_f32 v43, v43, v113
v_cvt_pk_bf16_f32 v84, v40, v41
v_cvt_pk_bf16_f32 v85, v42, v43
v_mul_f32 v44, v44, v113
v_mul_f32 v45, v45, v113
v_mul_f32 v46, v46, v113
v_mul_f32 v47, v47, v113
v_cvt_pk_bf16_f32 v86, v44, v45
v_cvt_pk_bf16_f32 v87, v46, v47
s_waitcnt lgkmcnt(9)
v_mul_f32 v48, v48, v114
v_mul_f32 v49, v49, v114
v_mul_f32 v50, v50, v114
v_mul_f32 v51, v51, v114
v_cvt_pk_bf16_f32 v88, v48, v49
v_cvt_pk_bf16_f32 v89, v50, v51
v_mul_f32 v52, v52, v114
v_mul_f32 v53, v53, v114
v_mul_f32 v54, v54, v114
v_mul_f32 v55, v55, v114
v_cvt_pk_bf16_f32 v90, v52, v53
v_cvt_pk_bf16_f32 v91, v54, v55
v_cndmask_b32 v136, v140, v216, vcc
v_cndmask_b32 v137, v140, v217, vcc
v_cndmask_b32 v138, v140, v218, vcc
v_cndmask_b32 v139, v140, v219, vcc
v_mul_f32 v141, 0x3e8b97f6, v113
v_mul_f32 v142, 0x3e8b97f6, v114
v_mfma_f32_16x16x32_bf16 v[16:19], v[80:83], v[92:95], v[136:139]
v_mfma_f32_16x16x32_bf16 v[20:23], v[84:87], v[92:95], v[220:223]
v_mfma_f32_16x16x32_bf16 v[24:27], v[84:87], v[96:99], v[216:219]
v_mfma_f32_16x16x32_bf16 v[28:31], v[88:91], v[96:99], v[220:223]
s_waitcnt lgkmcnt(8)
v_mul_f32 v56, v56, v116
v_mul_f32 v57, v57, v117
v_mul_f32 v58, v58, v118
v_mul_f32 v59, v59, v119
v_cvt_pk_bf16_f32 v100, v56, v57
v_cvt_pk_bf16_f32 v101, v58, v59
v_mul_f32 v60, v60, v116
v_mul_f32 v61, v61, v117
v_max3_f32 v40, v16, v17, v18
v_max3_f32 v41, v19, v20, v21
v_max3_f32 v40, v40, v22, v23
v_max_f32 v40, v40, v41
v_max3_f32 v44, v24, v25, v26
v_max3_f32 v45, v27, v28, v29
v_max3_f32 v44, v44, v30, v31
v_max_f32 v44, v44, v45
v_mov_b32 v41, v40
v_mov_b32 v45, v44
v_mul_f32 v62, v62, v118
v_mul_f32 v63, v63, v119
v_permlane16_swap_b32 v40, v41
v_permlane16_swap_b32 v44, v45
v_max_f32 v40, v40, v41
v_max_f32 v44, v44, v45
v_mov_b32 v41, v40
v_mov_b32 v45, v44
v_cvt_pk_bf16_f32 v106, v60, v61
v_cvt_pk_bf16_f32 v107, v62, v63
v_permlane32_swap_b32 v40, v41
v_permlane32_swap_b32 v44, v45
v_max_f32 v40, v40, v41
v_max_f32 v44, v44, v45
v_mul_f32 v40, v40, v141
v_mul_f32 v44, v44, v142
v_fma_f32 v16, v16, v141, -v40
v_fma_f32 v17, v17, v141, -v40
v_fma_f32 v18, v18, v141, -v40
v_fma_f32 v19, v19, v141, -v40
v_fma_f32 v20, v20, v141, -v40
v_fma_f32 v21, v21, v141, -v40
v_fma_f32 v22, v22, v141, -v40
v_fma_f32 v23, v23, v141, -v40
v_fma_f32 v24, v24, v142, -v44
v_fma_f32 v25, v25, v142, -v44
v_fma_f32 v26, v26, v142, -v44
v_fma_f32 v27, v27, v142, -v44
v_fma_f32 v28, v28, v142, -v44
v_fma_f32 v29, v29, v142, -v44
v_fma_f32 v30, v30, v142, -v44
v_fma_f32 v31, v31, v142, -v44
v_exp_f32 v16, v16
v_exp_f32 v17, v17
v_exp_f32 v18, v18
v_exp_f32 v19, v19
v_exp_f32 v20, v20
v_exp_f32 v21, v21
v_exp_f32 v22, v22
v_exp_f32 v23, v23
v_exp_f32 v24, v24
v_exp_f32 v25, v25
v_exp_f32 v26, v26
v_exp_f32 v27, v27
v_exp_f32 v28, v28
v_exp_f32 v29, v29
v_exp_f32 v30, v30
v_exp_f32 v31, v31
s_waitcnt lgkmcnt(7)
v_mul_f32 v64, v64, v120
v_add_f32 v40, v16, v17
v_add_f32 v41, v18, v19
v_add_f32 v42, v20, v21
v_add_f32 v43, v22, v23
v_add_f32 v40, v40, v41
v_add_f32 v42, v42, v43
v_add_f32 v40, v40, v42
v_add_f32 v44, v24, v25
v_add_f32 v45, v26, v27
v_add_f32 v46, v28, v29
v_add_f32 v47, v30, v31
v_add_f32 v44, v44, v45
v_add_f32 v46, v46, v47
v_add_f32 v44, v44, v46
v_mov_b32 v41, v40
v_mov_b32 v45, v44
v_mul_f32 v65, v65, v121
v_mul_f32 v66, v66, v122
v_permlane16_swap_b32 v40, v41
v_permlane16_swap_b32 v44, v45
v_add_f32 v40, v40, v41
v_add_f32 v44, v44, v45
v_mov_b32 v41, v40
v_mov_b32 v45, v44
v_mul_f32 v67, v67, v123
v_cvt_pk_bf16_f32 v102, v64, v65
v_permlane32_swap_b32 v40, v41
v_permlane32_swap_b32 v44, v45
v_add_f32 v40, v40, v41
v_add_f32 v44, v44, v45
v_rcp_f32 v40, v40
v_rcp_f32 v44, v44
v_cvt_pk_bf16_f32 v103, v66, v67
v_mul_f32 v68, v68, v120
v_mul_f32 v69, v69, v121
v_mul_f32 v70, v70, v122
v_mul_f32 v71, v71, v123
v_cvt_pk_bf16_f32 v108, v68, v69
v_cvt_pk_bf16_f32 v109, v70, v71
s_waitcnt lgkmcnt(6)
v_mul_f32 v72, v72, v124
v_mul_f32 v73, v73, v125
v_mul_f32 v74, v74, v126
v_mul_f32 v75, v75, v127
v_cvt_pk_bf16_f32 v104, v72, v73
v_cvt_pk_bf16_f32 v105, v74, v75
v_mul_f32 v76, v76, v124
v_mul_f32 v77, v77, v125
v_mul_f32 v78, v78, v126
v_mul_f32 v79, v79, v127
v_cvt_pk_bf16_f32 v110, v76, v77
v_cvt_pk_bf16_f32 v111, v78, v79
v_mul_f32 v16, v16, v40
v_mul_f32 v17, v17, v40
v_mul_f32 v18, v18, v40
v_mul_f32 v19, v19, v40
v_mul_f32 v20, v20, v40
v_mul_f32 v21, v21, v40
v_mul_f32 v22, v22, v40
v_mul_f32 v23, v23, v40
v_cvt_pk_bf16_f32 v32, v16, v17
v_cvt_pk_bf16_f32 v33, v18, v19
v_cvt_pk_bf16_f32 v34, v20, v21
v_cvt_pk_bf16_f32 v35, v22, v23
s_nop 1
v_mfma_f32_16x16x32_bf16 v[48:51], v[100:103], v[32:35], 0
v_mfma_f32_16x16x32_bf16 v[52:55], v[106:109], v[32:35], 0
v_mul_f32 v24, v24, v44
v_mul_f32 v25, v25, v44
v_mul_f32 v26, v26, v44
v_mul_f32 v27, v27, v44
v_mul_f32 v28, v28, v44
v_mul_f32 v29, v29, v44
v_mul_f32 v30, v30, v44
v_mul_f32 v31, v31, v44
v_cvt_pk_bf16_f32 v36, v24, v25
v_cvt_pk_bf16_f32 v37, v26, v27
v_cvt_pk_bf16_f32 v38, v28, v29
v_cvt_pk_bf16_f32 v39, v30, v31
s_nop 1
v_mfma_f32_16x16x32_bf16 v[56:59], v[102:105], v[36:39], 0
v_mfma_f32_16x16x32_bf16 v[60:63], v[108:111], v[36:39], 0
v_cvt_pk_bf16_f32 v64, v48, v49
v_cvt_pk_bf16_f32 v65, v50, v51
v_cvt_pk_bf16_f32 v66, v52, v53
v_cvt_pk_bf16_f32 v67, v54, v55
buffer_store_dwordx4 v[64:67], v1, s[4:7], s28 offen sc1
s_nop 1
v_cvt_pk_bf16_f32 v68, v56, v57
v_cvt_pk_bf16_f32 v69, v58, v59
v_cvt_pk_bf16_f32 v70, v60, v61
v_cvt_pk_bf16_f32 v71, v62, v63
s_add_u32 s28, s28, 16384
buffer_store_dwordx4 v[68:71], v1, s[4:7], s28 offen sc1
s_add_u32 s16, s42, 4
s_lshl_b32 s19, s16, 11
s_mul_i32 s18, s16, 28
s_lshl_b32 s16, s16, 1
s_lshr_b32 s17, s14, 1
s_add_u32 s16, s16, s17
s_lshl_b32 s20, s16, 14
s_and_b32 s17, s14, 1
s_lshl_b32 s17, s17, 12
s_add_u32 s20, s20, s17
s_add_u32 s20, s20, 5275648
s_lshl_b32 s17, s40, 8
s_add_u32 s19, s19, s17
s_add_u32 s19, s19, 16547840
s_lshr_b32 s17, s50, 1
s_add_u32 s19, s19, s17
s_lshl_b32 s21, s14, 12
s_add_u32 s21, s21, 86016
s_lshl_b32 s16, s40, 2
s_add_u32 s18, s18, s16
s_add_u32 s18, s18, s14
s_lshl_b32 s18, s18, 10
s_add_u32 s18, s18, 7372800
v_add_u32 v2, 86016, v1
v_and_b32 v3, 15, v0
v_lshrrev_b32 v4, 5, v0
v_lshl_add_u32 v3, v4, 4, v3
v_lshlrev_b32 v3, 4, v3
v_bfe_u32 v4, v0, 4, 1
v_lshl_add_u32 v3, v4, 9, v3
v_lshlrev_b32 v6, 2, v0
v_add_u32 v5, 160768, v6
s_lshl_b32 s16, s14, 8
v_add_u32 v4, s16, v5
s_waitcnt vmcnt(0)
s_barrier
s_add_u32 s3, s32, 1
v_bfrev_b32 v76, 1
v_mov_b32 v77, s3
v_writelane_b32 v76, s50, 0
buffer_store_dword v77, v76, s[4:7], s46 offen sc1
s_cmp_ge_u32 s13, 28
s_cbranch_scc1 interleave_layers__sliding_local_dilated__glu_gated_swiglu__prompt_kernel_h0G
s_mov_b64 s[16:17], -1
s_add_u32 s3, s33, 0
v_subrev_u32 v254, s3, v254
v_cmp_le_u32 vcc, 16, v254
s_nop 0
s_and_b64 vcc, vcc, s[16:17]
s_cbranch_scc0 L_pk_19_ok
s_mov_b32 s15, 0
L_pk_19:
buffer_load_dword v254, v252, s[4:7], s67 offen sc1
s_waitcnt vmcnt(0)
s_add_u32 s3, s33, 0
v_subrev_u32 v254, s3, v254
v_cmp_le_u32 vcc, 16, v254
s_nop 0
s_and_b64 vcc, vcc, s[16:17]
s_cbranch_scc0 L_pk_19_ok
s_add_u32 s15, s15, 1
s_cmp_lt_u32 s15, 131072
s_cbranch_scc1 L_pk_19
L_pk_19_ok:
s_mul_i32 s30, s40, 229376
s_mul_i32 s29, s14, 57344
s_add_u32 s30, s30, s29
s_add_u32 s30, s30, 0
s_add_u32 s29, s30, 0
buffer_load_dwordx4 a[112:115], v1, s[4:7], s29 offen offset:0 sc1
buffer_load_dwordx4 a[116:119], v1, s[4:7], s29 offen offset:1024 sc1
buffer_load_dwordx4 a[120:123], v1, s[4:7], s29 offen offset:2048 sc1
buffer_load_dwordx4 a[124:127], v1, s[4:7], s29 offen offset:3072 sc1
s_add_u32 s29, s30, 4096
buffer_load_dwordx4 a[128:131], v1, s[4:7], s29 offen offset:0 sc1
buffer_load_dwordx4 a[132:135], v1, s[4:7], s29 offen offset:1024 sc1
buffer_load_dwordx4 a[136:139], v1, s[4:7], s29 offen offset:2048 sc1
buffer_load_dwordx4 a[140:143], v1, s[4:7], s29 offen offset:3072 sc1
s_add_u32 s29, s30, 8192
buffer_load_dwordx4 a[144:147], v1, s[4:7], s29 offen offset:0 sc1
buffer_load_dwordx4 a[148:151], v1, s[4:7], s29 offen offset:1024 sc1
buffer_load_dwordx4 a[152:155], v1, s[4:7], s29 offen offset:2048 sc1
buffer_load_dwordx4 a[156:159], v1, s[4:7], s29 offen offset:3072 sc1
s_add_u32 s29, s30, 12288
buffer_load_dwordx4 a[160:163], v1, s[4:7], s29 offen offset:0 sc1
buffer_load_dwordx4 a[164:167], v1, s[4:7], s29 offen offset:1024 sc1
L_xb_20:
v_bfe_u32 v80, v0, 4, 1
v_bfe_u32 v81, v0, 2, 2
v_lshrrev_b32 v82, 5, v0
v_lshl_add_u32 v82, v82, 2, v81
v_lshlrev_b32 v82, 7, v82
v_lshl_add_u32 v82, v80, 11, v82
v_lshrrev_b32 v81, 1, v81
v_lshl_add_u32 v80, v80, 1, v81
v_add_u32 v80, s14, v80
v_and_b32 v80, 3, v80
v_lshl_add_u32 v82, v80, 5, v82
v_and_b32 v80, 3, v0
v_lshl_add_u32 v82, v80, 3, v82
v_add_u32 v82, 86016, v82
v_add_u32 v81, 32768, v82
ds_read_b64_tr_b16 a[28:29], v82 offset:0
ds_read_b64_tr_b16 a[30:31], v82 offset:1024
ds_read_b64_tr_b16 a[32:33], v82 offset:4096
ds_read_b64_tr_b16 a[34:35], v82 offset:5120
ds_read_b64_tr_b16 a[36:37], v82 offset:8192
ds_read_b64_tr_b16 a[38:39], v82 offset:9216
ds_read_b64_tr_b16 a[40:41], v82 offset:12288
ds_read_b64_tr_b16 a[42:43], v82 offset:13312
ds_read_b64_tr_b16 a[44:45], v82 offset:16384
ds_read_b64_tr_b16 a[46:47], v82 offset:17408
ds_read_b64_tr_b16 a[48:49], v82 offset:20480
ds_read_b64_tr_b16 a[50:51], v82 offset:21504
ds_read_b64_tr_b16 a[52:53], v82 offset:24576
ds_read_b64_tr_b16 a[54:55], v82 offset:25600
ds_read_b64_tr_b16 a[56:57], v82 offset:28672
ds_read_b64_tr_b16 a[58:59], v82 offset:29696
ds_read_b64_tr_b16 a[0:1], v81 offset:0
ds_read_b64_tr_b16 a[2:3], v81 offset:1024
ds_read_b64_tr_b16 a[4:5], v81 offset:4096
ds_read_b64_tr_b16 a[6:7], v81 offset:5120
ds_read_b64_tr_b16 a[8:9], v81 offset:8192
ds_read_b64_tr_b16 a[10:11], v81 offset:9216
ds_read_b64_tr_b16 a[12:13], v81 offset:12288
ds_read_b64_tr_b16 a[14:15], v81 offset:13312
ds_read_b64_tr_b16 a[16:17], v81 offset:16384
ds_read_b64_tr_b16 a[18:19], v81 offset:17408
ds_read_b64_tr_b16 a[20:21], v81 offset:20480
ds_read_b64_tr_b16 a[22:23], v81 offset:21504
ds_read_b64_tr_b16 a[24:25], v81 offset:24576
ds_read_b64_tr_b16 a[26:27], v81 offset:25600
ds_read_b64_tr_b16 a[60:61], v81 offset:36864
ds_read_b64_tr_b16 a[62:63], v81 offset:37888
ds_read_b64_tr_b16 a[64:65], v81 offset:28672
ds_read_b64_tr_b16 a[66:67], v81 offset:29696
ds_read_b64_tr_b16 a[68:69], v81 offset:32768
ds_read_b64_tr_b16 a[70:71], v81 offset:33792
s_waitcnt lgkmcnt(0)
v_mov_b32 v120, 0x3f803f80
v_mov_b32 v121, 0x3f803f80
v_mov_b32 v122, 0x3f803f80
v_mov_b32 v123, 0x3f803f80
s_nop 1
v_mfma_f32_32x32x16_bf16 a[240:255], a[0:3], v[120:123], 0
v_mfma_f32_32x32x16_bf16 a[240:255], a[4:7], v[120:123], a[240:255]
v_mfma_f32_32x32x16_bf16 a[240:255], a[8:11], v[120:123], a[240:255]
v_mfma_f32_32x32x16_bf16 a[240:255], a[12:15], v[120:123], a[240:255]
v_mfma_f32_32x32x16_bf16 a[240:255], a[16:19], v[120:123], a[240:255]
v_mfma_f32_32x32x16_bf16 a[240:255], a[20:23], v[120:123], a[240:255]
v_mfma_f32_32x32x16_bf16 a[240:255], a[24:27], v[120:123], a[240:255]
v_mfma_f32_32x32x16_bf16 a[240:255], a[28:31], v[120:123], a[240:255]
v_mfma_f32_32x32x16_bf16 a[240:255], a[32:35], v[120:123], a[240:255]
v_mfma_f32_32x32x16_bf16 a[240:255], a[36:39], v[120:123], a[240:255]
v_mfma_f32_32x32x16_bf16 a[240:255], a[40:43], v[120:123], a[240:255]
v_mfma_f32_32x32x16_bf16 a[240:255], a[44:47], v[120:123], a[240:255]
s_cmp_lg_u32 s14, 0
s_cbranch_scc1 L_wt_21
v_lshlrev_b32 v72, 7, v0
s_add_u32 s3, s32, 1
s_mov_b32 s15, 0
buffer_load_dword v73, v72, s[4:7], s43 offen sc1
s_sleep 1
buffer_load_dword v74, v72, s[4:7], s43 offen sc1
s_sleep 1
L_wt_21_p:
buffer_load_dword v75, v72, s[4:7], s43 offen sc1
s_waitcnt vmcnt(2)
v_subrev_u32 v73, s3, v73
v_cmp_le_u32 vcc, 15, v73
s_nop 0
s_and_b64 vcc, vcc, s[38:39]
s_cbranch_scc0 L_wt_21
buffer_load_dword v73, v72, s[4:7], s43 offen sc1
s_waitcnt vmcnt(2)
v_subrev_u32 v74, s3, v74
v_cmp_le_u32 vcc, 15, v74
s_nop 0
s_and_b64 vcc, vcc, s[38:39]
s_cbranch_scc0 L_wt_21
buffer_load_dword v74, v72, s[4:7], s43 offen sc1
s_waitcnt vmcnt(2)
v_subrev_u32 v75, s3, v75
v_cmp_le_u32 vcc, 15, v75
s_nop 0
s_and_b64 vcc, vcc, s[38:39]
s_cbranch_scc0 L_wt_21
s_add_u32 s15, s15, 1
s_cmp_lt_u32 s15, 131072
s_cbranch_scc1 L_wt_21_p
L_wt_21:
s_barrier
s_add_u32 m0, s21, 0
s_add_u32 s31, s20, 0x0
buffer_load_dwordx4 v1, s[4:7], s31 offen offset:0 sc1 lds
buffer_load_dwordx4 v1, s[4:7], s31 offen offset:1024 sc1 lds
buffer_load_dwordx4 v1, s[4:7], s31 offen offset:2048 sc1 lds
buffer_load_dwordx4 v1, s[4:7], s31 offen offset:3072 sc1 lds
s_add_u32 m0, s21, 16384
s_add_u32 s31, s20, 0x2000
buffer_load_dwordx4 v1, s[4:7], s31 offen offset:0 sc1 lds
buffer_load_dwordx4 v1, s[4:7], s31 offen offset:1024 sc1 lds
buffer_load_dwordx4 v1, s[4:7], s31 offen offset:2048 sc1 lds
buffer_load_dwordx4 v1, s[4:7], s31 offen offset:3072 sc1 lds
v_lshlrev_b32 v32, 16, v8
v_and_b32 v33, 0xffff0000, v8
v_lshlrev_b32 v34, 16, v9
v_and_b32 v35, 0xffff0000, v9
v_lshlrev_b32 v36, 16, v10
v_and_b32 v37, 0xffff0000, v10
v_lshlrev_b32 v38, 16, v11
v_and_b32 v39, 0xffff0000, v11
v_lshlrev_b32 v40, 16, v12
v_and_b32 v41, 0xffff0000, v12
v_lshlrev_b32 v42, 16, v13
v_and_b32 v43, 0xffff0000, v13
v_lshlrev_b32 v44, 16, v14
v_and_b32 v45, 0xffff0000, v14
v_lshlrev_b32 v46, 16, v15
v_and_b32 v47, 0xffff0000, v15
v_mov_b32 v120, 0x3f803f80
v_mov_b32 v121, 0x3f803f80
v_mov_b32 v122, 0x3f803f80
v_mov_b32 v123, 0x3f803f80
s_nop 1
v_mfma_f32_32x32x16_bf16 a[240:255], a[48:51], v[120:123], a[240:255]
v_mfma_f32_32x32x16_bf16 a[240:255], a[52:55], v[120:123], a[240:255]
v_mfma_f32_32x32x16_bf16 a[240:255], a[56:59], v[120:123], a[240:255]
v_mfma_f32_32x32x16_bf16 a[240:255], a[60:63], v[120:123], a[240:255]
v_mfma_f32_32x32x16_bf16 a[240:255], a[64:67], v[120:123], a[240:255]
v_mfma_f32_32x32x16_bf16 a[240:255], a[68:71], v[120:123], a[240:255]
s_waitcnt vmcnt(4)
s_barrier
ds_read_b128 v[48:51], v2 offset:0
ds_read_b128 v[52:55], v2 offset:8192
ds_read_b128 v[56:59], v2 offset:1024
ds_read_b128 v[60:63], v2 offset:9216
ds_read_b128 v[64:67], v2 offset:2048
ds_read_b128 v[68:71], v2 offset:10240
ds_read_b128 v[72:75], v2 offset:3072
ds_read_b128 v[76:79], v2 offset:11264
s_waitcnt lgkmcnt(7)
v_mfma_f32_16x16x32_bf16 v[24:27], v[144:147], v[48:51], v[40:43]
ds_read_b128 v[80:83], v2 offset:4096
s_waitcnt lgkmcnt(7)
v_mfma_f32_16x16x32_bf16 v[28:31], v[144:147], v[52:55], v[44:47]
ds_read_b128 v[84:87], v2 offset:12288
s_waitcnt lgkmcnt(7)
v_mfma_f32_16x16x32_bf16 v[24:27], v[148:151], v[56:59], v[24:27]
ds_read_b128 v[88:91], v2 offset:5120
s_waitcnt lgkmcnt(7)
v_mfma_f32_16x16x32_bf16 v[28:31], v[148:151], v[60:63], v[28:31]
ds_read_b128 v[92:95], v2 offset:13312
s_waitcnt lgkmcnt(7)
v_mfma_f32_16x16x32_bf16 v[24:27], v[152:155], v[64:67], v[24:27]
ds_read_b128 v[96:99], v2 offset:6144
s_waitcnt lgkmcnt(7)
v_mfma_f32_16x16x32_bf16 v[28:31], v[152:155], v[68:71], v[28:31]
ds_read_b128 v[100:103], v2 offset:14336
s_waitcnt lgkmcnt(7)
v_mfma_f32_16x16x32_bf16 v[24:27], v[156:159], v[72:75], v[24:27]
ds_read_b128 v[104:107], v2 offset:7168
s_waitcnt lgkmcnt(7)
v_mfma_f32_16x16x32_bf16 v[28:31], v[156:159], v[76:79], v[28:31]
ds_read_b128 v[108:111], v2 offset:15360
s_waitcnt vmcnt(0)
s_waitcnt lgkmcnt(0)
s_barrier
v_mfma_f32_16x16x32_bf16 v[24:27], v[160:163], v[80:83], v[24:27]
ds_read_b128 v[48:51], v2 offset:16384
s_add_u32 m0, s21, 0
v_mfma_f32_16x16x32_bf16 v[28:31], v[160:163], v[84:87], v[28:31]
ds_read_b128 v[52:55], v2 offset:24576
s_add_u32 s31, s20, 0xfffe0000
v_mfma_f32_16x16x32_bf16 v[24:27], v[164:167], v[88:91], v[24:27]
ds_read_b128 v[56:59], v2 offset:17408
buffer_load_dwordx4 v1, s[4:7], s31 offen offset:0 sc1 lds
v_mfma_f32_16x16x32_bf16 v[28:31], v[164:167], v[92:95], v[28:31]
ds_read_b128 v[60:63], v2 offset:25600
buffer_load_dwordx4 v1, s[4:7], s31 offen offset:1024 sc1 lds
v_mfma_f32_16x16x32_bf16 v[24:27], v[168:171], v[96:99], v[24:27]
ds_read_b128 v[64:67], v2 offset:18432
buffer_load_dwordx4 v1, s[4:7], s31 offen offset:2048 sc1 lds
v_mfma_f32_16x16x32_bf16 v[28:31], v[168:171], v[100:103], v[28:31]
ds_read_b128 v[68:71], v2 offset:26624
buffer_load_dwordx4 v1, s[4:7], s31 offen offset:3072 sc1 lds
v_mfma_f32_16x16x32_bf16 v[24:27], v[172:175], v[104:107], v[24:27]
ds_read_b128 v[72:75], v2 offset:19456
v_mfma_f32_16x16x32_bf16 v[28:31], v[172:175], v[108:111], v[28:31]
ds_read_b128 v[76:79], v2 offset:27648
s_waitcnt lgkmcnt(7)
v_mfma_f32_16x16x32_bf16 v[24:27], v[176:179], v[48:51], v[24:27]
ds_read_b128 v[80:83], v2 offset:20480
s_waitcnt lgkmcnt(7)
v_mfma_f32_16x16x32_bf16 v[28:31], v[176:179], v[52:55], v[28:31]
ds_read_b128 v[84:87], v2 offset:28672
s_waitcnt lgkmcnt(7)
v_mfma_f32_16x16x32_bf16 v[24:27], v[180:183], v[56:59], v[24:27]
ds_read_b128 v[88:91], v2 offset:21504
s_waitcnt lgkmcnt(7)
v_mfma_f32_16x16x32_bf16 v[28:31], v[180:183], v[60:63], v[28:31]
ds_read_b128 v[92:95], v2 offset:29696
s_waitcnt lgkmcnt(7)
v_mfma_f32_16x16x32_bf16 v[24:27], v[184:187], v[64:67], v[24:27]
ds_read_b128 v[96:99], v2 offset:22528
s_waitcnt lgkmcnt(7)
v_mfma_f32_16x16x32_bf16 v[28:31], v[184:187], v[68:71], v[28:31]
ds_read_b128 v[100:103], v2 offset:30720
s_waitcnt lgkmcnt(7)
v_mfma_f32_16x16x32_bf16 v[24:27], v[188:191], v[72:75], v[24:27]
ds_read_b128 v[104:107], v2 offset:23552
s_waitcnt lgkmcnt(7)
v_mfma_f32_16x16x32_bf16 v[28:31], v[188:191], v[76:79], v[28:31]
ds_read_b128 v[108:111], v2 offset:31744
s_waitcnt vmcnt(0)
s_waitcnt lgkmcnt(0)
s_barrier
v_mfma_f32_16x16x32_bf16 v[24:27], v[192:195], v[80:83], v[24:27]
ds_read_b128 v[48:51], v2 offset:0
s_add_u32 m0, s21, 16384
v_mfma_f32_16x16x32_bf16 v[28:31], v[192:195], v[84:87], v[28:31]
ds_read_b128 v[52:55], v2 offset:8192
s_add_u32 s31, s20, 0xfffe2000
v_mfma_f32_16x16x32_bf16 v[24:27], v[196:199], v[88:91], v[24:27]
ds_read_b128 v[56:59], v2 offset:1024
buffer_load_dwordx4 v1, s[4:7], s31 offen offset:0 sc1 lds
v_mfma_f32_16x16x32_bf16 v[28:31], v[196:199], v[92:95], v[28:31]
ds_read_b128 v[60:63], v2 offset:9216
buffer_load_dwordx4 v1, s[4:7], s31 offen offset:1024 sc1 lds
v_mfma_f32_16x16x32_bf16 v[24:27], v[200:203], v[96:99], v[24:27]
ds_read_b128 v[64:67], v2 offset:2048
buffer_load_dwordx4 v1, s[4:7], s31 offen offset:2048 sc1 lds
v_mfma_f32_16x16x32_bf16 v[28:31], v[200:203], v[100:103], v[28:31]
ds_read_b128 v[68:71], v2 offset:10240
buffer_load_dwordx4 v1, s[4:7], s31 offen offset:3072 sc1 lds
v_mfma_f32_16x16x32_bf16 v[24:27], v[204:207], v[104:107], v[24:27]
ds_read_b128 v[72:75], v2 offset:3072
s_add_u32 m0, s22, 0x8000
v_mfma_f32_16x16x32_bf16 v[28:31], v[204:207], v[108:111], v[28:31]
ds_read_b128 v[76:79], v2 offset:11264
s_add_u32 s29, s47, 1032192
s_waitcnt lgkmcnt(7)
v_mfma_f32_16x16x32_bf16 v[16:19], v[144:147], v[48:51], v[32:35]
ds_read_b128 v[80:83], v2 offset:4096
buffer_load_dwordx4 v255, s[52:55], s29 offen lds
s_waitcnt lgkmcnt(7)
v_mfma_f32_16x16x32_bf16 v[20:23], v[144:147], v[52:55], v[36:39]
ds_read_b128 v[84:87], v2 offset:12288
s_add_u32 m0, s22, 0x9000
s_waitcnt lgkmcnt(7)
v_mfma_f32_16x16x32_bf16 v[16:19], v[148:151], v[56:59], v[16:19]
ds_read_b128 v[88:91], v2 offset:5120
v_cvt_pk_bf16_f32 v112, v24, v25
s_add_u32 s29, s47, 1089536
s_waitcnt lgkmcnt(7)
v_mfma_f32_16x16x32_bf16 v[20:23], v[148:151], v[60:63], v[20:23]
ds_read_b128 v[92:95], v2 offset:13312
v_cvt_pk_bf16_f32 v113, v26, v27
v_cvt_pk_bf16_f32 v114, v28, v29
s_waitcnt lgkmcnt(7)
v_mfma_f32_16x16x32_bf16 v[16:19], v[152:155], v[64:67], v[16:19]
ds_read_b128 v[96:99], v2 offset:6144
v_cvt_pk_bf16_f32 v115, v30, v31
buffer_load_dwordx4 v255, s[52:55], s29 offen lds
s_waitcnt lgkmcnt(7)
v_mfma_f32_16x16x32_bf16 v[20:23], v[152:155], v[68:71], v[20:23]
ds_read_b128 v[100:103], v2 offset:14336
v_add_f32 v116, v24, v25
v_mul_f32 v117, v24, v24
s_waitcnt lgkmcnt(7)
v_mfma_f32_16x16x32_bf16 v[16:19], v[156:159], v[72:75], v[16:19]
ds_read_b128 v[104:107], v2 offset:7168
v_add_f32 v118, v28, v29
s_add_u32 m0, s22, 0xa000
s_waitcnt lgkmcnt(7)
v_mfma_f32_16x16x32_bf16 v[20:23], v[156:159], v[76:79], v[20:23]
ds_read_b128 v[108:111], v2 offset:15360
v_mul_f32 v119, v28, v28
v_permlane32_swap_b32 v112, v114
s_waitcnt vmcnt(2)
s_waitcnt lgkmcnt(0)
s_barrier
v_mfma_f32_16x16x32_bf16 v[16:19], v[160:163], v[80:83], v[16:19]
ds_read_b128 v[48:51], v2 offset:16384
v_permlane32_swap_b32 v113, v115
s_add_u32 s29, s47, 1146880
v_mfma_f32_16x16x32_bf16 v[20:23], v[160:163], v[84:87], v[20:23]
ds_read_b128 v[52:55], v2 offset:24576
buffer_store_dwordx4 v[112:115], v3, s[4:7], s18 offen sc1
v_fmac_f32 v117, v25, v25
v_mfma_f32_16x16x32_bf16 v[16:19], v[164:167], v[88:91], v[16:19]
ds_read_b128 v[56:59], v2 offset:17408
v_fmac_f32 v119, v29, v29
buffer_load_dwordx4 v255, s[52:55], s29 offen lds
v_mfma_f32_16x16x32_bf16 v[20:23], v[164:167], v[92:95], v[20:23]
ds_read_b128 v[60:63], v2 offset:25600
v_add_f32 v116, v116, v26
v_fmac_f32 v117, v26, v26
v_mfma_f32_16x16x32_bf16 v[16:19], v[168:171], v[96:99], v[16:19]
ds_read_b128 v[64:67], v2 offset:18432
v_add_f32 v118, v118, v30
s_add_u32 m0, s22, 0xb000
v_mfma_f32_16x16x32_bf16 v[20:23], v[168:171], v[100:103], v[20:23]
ds_read_b128 v[68:71], v2 offset:26624
v_fmac_f32 v119, v30, v30
v_add_f32 v116, v116, v27
v_mfma_f32_16x16x32_bf16 v[16:19], v[172:175], v[104:107], v[16:19]
ds_read_b128 v[72:75], v2 offset:19456
v_fmac_f32 v117, v27, v27
s_add_u32 s29, s47, 1204224
v_mfma_f32_16x16x32_bf16 v[20:23], v[172:175], v[108:111], v[20:23]
ds_read_b128 v[76:79], v2 offset:27648
v_add_f32 v118, v118, v31
v_fmac_f32 v119, v31, v31
s_waitcnt lgkmcnt(7)
v_mfma_f32_16x16x32_bf16 v[16:19], v[176:179], v[48:51], v[16:19]
ds_read_b128 v[80:83], v2 offset:20480
v_permlane32_swap_b32 v116, v117
buffer_load_dwordx4 v255, s[52:55], s29 offen lds
s_waitcnt lgkmcnt(7)
v_mfma_f32_16x16x32_bf16 v[20:23], v[176:179], v[52:55], v[20:23]
ds_read_b128 v[84:87], v2 offset:28672
v_permlane32_swap_b32 v118, v119
v_add_f32 v116, v116, v117
s_waitcnt lgkmcnt(7)
v_mfma_f32_16x16x32_bf16 v[16:19], v[180:183], v[56:59], v[16:19]
ds_read_b128 v[88:91], v2 offset:21504
v_add_f32 v118, v118, v119
s_add_u32 m0, s22, 0xc000
s_waitcnt lgkmcnt(7)
v_mfma_f32_16x16x32_bf16 v[20:23], v[180:183], v[60:63], v[20:23]
ds_read_b128 v[92:95], v2 offset:29696
v_permlane16_swap_b32 v116, v118
v_add_f32 v116, v116, v118
s_waitcnt lgkmcnt(7)
v_mfma_f32_16x16x32_bf16 v[16:19], v[184:187], v[64:67], v[16:19]
ds_read_b128 v[96:99], v2 offset:22528
ds_write_b32 v4, v116 offset:1024
s_add_u32 s29, s47, 1261568
s_waitcnt lgkmcnt(8)
v_mfma_f32_16x16x32_bf16 v[20:23], v[184:187], v[68:71], v[20:23]
ds_read_b128 v[100:103], v2 offset:30720
buffer_load_dwordx4 v255, s[52:55], s29 offen lds
s_waitcnt lgkmcnt(8)
v_mfma_f32_16x16x32_bf16 v[16:19], v[188:191], v[72:75], v[16:19]
ds_read_b128 v[104:107], v2 offset:23552
s_add_u32 m0, s22, 0xd000
s_waitcnt lgkmcnt(8)
v_mfma_f32_16x16x32_bf16 v[20:23], v[188:191], v[76:79], v[20:23]
ds_read_b128 v[108:111], v2 offset:31744
s_add_u32 s29, s47, 1318912
s_waitcnt lgkmcnt(3)
s_barrier
v_mfma_f32_16x16x32_bf16 v[16:19], v[192:195], v[80:83], v[16:19]
ds_read2st64_b32 v[120:121], v5 offset0:4 offset1:5
ds_read2st64_b32 v[122:123], v5 offset0:6 offset1:7
buffer_load_dwordx4 v255, s[52:55], s29 offen lds
v_mfma_f32_16x16x32_bf16 v[20:23], v[192:195], v[84:87], v[20:23]
s_waitcnt lgkmcnt(1)
v_add_f32 v120, v120, v121
s_waitcnt lgkmcnt(0)
v_add_f32 v122, v122, v123
v_mfma_f32_16x16x32_bf16 v[16:19], v[196:199], v[88:91], v[16:19]
v_add_f32 v120, v120, v122
buffer_store_dword v120, v6, s[4:7], s19 offen sc1
s_add_u32 m0, s22, 0xe000
v_mfma_f32_16x16x32_bf16 v[20:23], v[196:199], v[92:95], v[20:23]
s_add_u32 s29, s47, 1376256
v_mfma_f32_16x16x32_bf16 v[16:19], v[200:203], v[96:99], v[16:19]
buffer_load_dwordx4 v255, s[52:55], s29 offen lds
v_mfma_f32_16x16x32_bf16 v[20:23], v[200:203], v[100:103], v[20:23]
s_add_u32 m0, s22, 0xf000
v_mfma_f32_16x16x32_bf16 v[16:19], v[204:207], v[104:107], v[16:19]
s_add_u32 s29, s47, 1433600
v_mfma_f32_16x16x32_bf16 v[20:23], v[204:207], v[108:111], v[20:23]
buffer_load_dwordx4 v255, s[52:55], s29 offen lds
s_add_u32 m0, s22, 0x10000
s_add_u32 s29, s47, 1490944
buffer_load_dwordx4 v255, s[52:55], s29 offen lds
s_add_u32 m0, s22, 0x11000
s_add_u32 s29, s47, 1548288
buffer_load_dwordx4 v255, s[52:55], s29 offen lds
v_cvt_pk_bf16_f32 v124, v16, v17
v_cvt_pk_bf16_f32 v125, v18, v19
v_cvt_pk_bf16_f32 v126, v20, v21
v_cvt_pk_bf16_f32 v127, v22, v23
v_add_f32 v48, v16, v17
v_mul_f32 v49, v16, v16
v_add_f32 v50, v20, v21
v_mul_f32 v51, v20, v20
v_permlane32_swap_b32 v124, v126
v_permlane32_swap_b32 v125, v127
s_sub_u32 s18, s18, 114688
buffer_store_dwordx4 v[124:127], v3, s[4:7], s18 offen sc1
v_fmac_f32 v49, v17, v17
v_fmac_f32 v51, v21, v21
v_add_f32 v48, v48, v18
v_fmac_f32 v49, v18, v18
v_add_f32 v50, v50, v22
v_fmac_f32 v51, v22, v22
v_add_f32 v48, v48, v19
v_fmac_f32 v49, v19, v19
v_add_f32 v50, v50, v23
v_fmac_f32 v51, v23, v23
v_permlane32_swap_b32 v48, v49
s_nop 0
v_permlane32_swap_b32 v50, v51
v_add_f32 v48, v48, v49
v_add_f32 v50, v50, v51
s_nop 1
v_permlane16_swap_b32 v48, v50
v_add_f32 v48, v48, v50
ds_write_b32 v4, v48 offset:0
s_waitcnt vmcnt(5)
s_waitcnt lgkmcnt(0)
s_barrier
ds_read2st64_b32 v[60:61], v5 offset0:0 offset1:1
ds_read2st64_b32 v[62:63], v5 offset0:2 offset1:3
s_add_u32 s3, s32, 2
v_bfrev_b32 v128, 1
v_mov_b32 v129, s3
v_writelane_b32 v128, s50, 0
buffer_store_dword v129, v128, s[4:7], s46 offen sc1
s_waitcnt lgkmcnt(1)
v_add_f32 v60, v60, v61
s_waitcnt lgkmcnt(0)
v_add_f32 v62, v62, v63
v_add_f32 v60, v60, v62
s_sub_u32 s19, s19, 8192
buffer_store_dword v60, v6, s[4:7], s19 offen sc1
s_lshl_b32 s16, s14, 7
s_add_u32 s16, s16, 160256
v_lshrrev_b32 v148, 5, v0
v_lshl_add_u32 v148, v148, 6, s16
s_lshl_b32 s16, s13, 2
s_add_u32 s16, s16, s14
s_lshl_b32 s20, s12, 3
s_mul_i32 s26, s20, 224
s_add_u32 s26, s26, s16
s_lshl_b32 s26, s26, 9
s_add_u32 s26, s26, 9666560
v_bfe_u32 v119, v0, 4, 1
v_mul_u32_u24 v119, 57344, v119
v_lshrrev_b32 v6, 5, v0
v_lshl_add_u32 v119, v6, 8, v119
v_and_b32 v6, 15, v0
v_lshl_add_u32 v119, v6, 4, v119
s_add_u32 s16, s14, s20
s_lshl_b32 s25, s16, 11
s_add_u32 s25, s25, 16547840
s_add_u32 s24, s25, 8192
s_mul_i32 s22, s20, 28672
s_mul_i32 s16, s14, 7168
s_add_u32 s22, s22, s16
s_add_u32 s22, s22, 7372800
s_mul_i32 s23, s14, 17408
s_add_u32 s23, s23, 86016
v_add_u32 v4, 86016, v1
v_add_u32 v5, 151552, v1
v_and_b32 v6, 31, v0
v_lshlrev_b32 v6, 4, v6
v_add_u32 v6, 155648, v6
v_and_b32 v145, 7, v0
v_lshrrev_b32 v144, 4, v0
v_lshl_add_u32 v145, v145, 2, v144
s_lshl_b32 s16, s14, 9
s_add_u32 s16, s16, 155648
v_lshl_add_u32 v145, v145, 4, s16
v_cmp_gt_u32 vcc, 48, v0
v_bfrev_b32 v144, 1
s_nop 0
v_cndmask_b32 v144, v144, v1, vcc
s_waitcnt lgkmcnt(0)
s_add_u32 s44, s42, 4
s_mul_i32 s16, s14, 14
s_mul_i32 s20, s44, 112
s_add_u32 s20, s20, s16
s_lshl_b32 s20, s20, 10
s_add_u32 s20, s20, 9207808
s_sub_u32 s21, s20, 458752
s_add_u32 s68, s20, 57344
s_add_u32 s69, s21, 57344
s_lshl_b32 s65, s14, 13
s_add_u32 s65, s65, 86016
v_and_b32 v3, 7, v0
v_lshlrev_b32 v3, 4, v3
s_and_b32 s16, s14, 1
s_lshl_b32 s16, s16, 7
s_lshr_b32 s17, s14, 1
s_lshl_b32 s17, s17, 10
s_add_u32 s16, s16, s17
v_add_u32 v2, s16, v3
v_bfe_u32 v146, v0, 3, 1
v_lshl_add_u32 v2, v146, 8, v2
v_bfe_u32 v7, v0, 4, 1
v_lshlrev_b32 v7, 7, v7
v_xor_b32 v2, v2, v7
v_lshrrev_b32 v7, 4, v0
v_lshl_add_u32 v2, v7, 11, v2
v_add_u32 v2, 86016, v2
s_mul_i32 s18, s44, 28
s_lshr_b32 s16, s14, 1
s_mul_i32 s16, s16, 14
s_add_u32 s18, s18, s16
s_lshl_b32 s16, s40, 1
s_add_u32 s18, s18, s16
s_lshl_b32 s18, s18, 10
s_and_b32 s16, s14, 1
s_lshl_b32 s16, s16, 7
s_add_u32 s18, s18, s16
s_add_u32 s18, s18, 3440640
v_lshl_add_u32 v3, v7, 9, v3
v_lshl_add_u32 v3, v146, 8, v3
s_lshl_b32 s19, s44, 11
s_lshl_b32 s16, s40, 8
s_add_u32 s19, s19, s16
s_lshl_b32 s16, s14, 5
s_add_u32 s19, s19, s16
s_add_u32 s19, s19, 16678912
v_and_b32 v7, 7, v0
v_lshrrev_b32 v146, 5, v0
v_lshlrev_b32 v7, 2, v7
v_lshl_add_u32 v7, v146, 7, v7
s_mov_b32 vcc_lo, 0xff
s_mov_b32 vcc_hi, 0xff
v_bfrev_b32 v146, 1
v_cndmask_b32 v7, v146, v7, vcc
s_mul_i32 s64, s44, 28
s_lshl_b32 s16, s40, 2
s_add_u32 s64, s64, s16
s_lshl_b32 s64, s64, 10
s_lshl_b32 s16, s14, 7
s_add_u32 s64, s64, s16
s_add_u32 s64, s64, 7372800
v_and_b32 v147, 7, v0
v_lshrrev_b32 v146, 3, v0
v_lshlrev_b32 v147, 4, v147
v_lshl_add_u32 v147, v146, 9, v147
s_sub_u32 s27, s23, 4096
s_sub_u32 s66, s64, 114688
s_waitcnt vmcnt(0)
s_barrier
s_add_u32 s3, s32, 3
v_bfrev_b32 v76, 1
v_mov_b32 v77, s3
v_writelane_b32 v76, s50, 0
buffer_store_dword v77, v76, s[4:7], s46 offen sc1
v_bfe_u32 v100, v0, 4, 1
v_bfe_u32 v101, v0, 2, 2
v_lshrrev_b32 v102, 5, v0
v_lshl_add_u32 v102, v102, 2, v101
v_lshlrev_b32 v102, 7, v102
v_lshl_add_u32 v102, v100, 11, v102
v_lshrrev_b32 v101, 1, v101
v_lshl_add_u32 v100, v100, 1, v101
v_add_u32 v100, s14, v100
v_and_b32 v100, 3, v100
v_lshl_add_u32 v102, v100, 5, v102
v_and_b32 v100, 3, v0
v_lshl_add_u32 v102, v100, 3, v102
v_add_u32 v102, 86016, v102
v_add_u32 v101, 32768, v102
ds_read_b64_tr_b16 a[72:73], v101 offset:0
ds_read_b64_tr_b16 a[74:75], v101 offset:1024
ds_read_b64_tr_b16 a[76:77], v101 offset:4096
ds_read_b64_tr_b16 a[78:79], v101 offset:5120
ds_read_b64_tr_b16 a[80:81], v101 offset:8192
ds_read_b64_tr_b16 a[82:83], v101 offset:9216
ds_read_b64_tr_b16 a[84:85], v101 offset:12288
ds_read_b64_tr_b16 a[86:87], v101 offset:13312
ds_read_b64_tr_b16 a[88:89], v101 offset:16384
ds_read_b64_tr_b16 a[90:91], v101 offset:17408
ds_read_b64_tr_b16 a[92:93], v101 offset:20480
ds_read_b64_tr_b16 a[94:95], v101 offset:21504
ds_read_b64_tr_b16 a[96:97], v101 offset:24576
ds_read_b64_tr_b16 a[98:99], v101 offset:25600
ds_read_b64_tr_b16 a[100:101], v101 offset:28672
ds_read_b64_tr_b16 a[102:103], v101 offset:29696
ds_read_b64_tr_b16 a[104:105], v101 offset:32768
ds_read_b64_tr_b16 a[106:107], v101 offset:33792
ds_read_b64_tr_b16 a[108:109], v101 offset:36864
ds_read_b64_tr_b16 a[110:111], v101 offset:37888
s_waitcnt lgkmcnt(0)
s_cmp_lg_u32 s14, 0
s_cbranch_scc1 L_wt_22
v_lshlrev_b32 v72, 7, v0
s_add_u32 s3, s32, 2
s_mov_b32 s15, 0
buffer_load_dword v73, v72, s[4:7], s43 offen sc1
s_sleep 1
buffer_load_dword v74, v72, s[4:7], s43 offen sc1
s_sleep 1
L_wt_22_p:
buffer_load_dword v75, v72, s[4:7], s43 offen sc1
s_waitcnt vmcnt(2)
v_subrev_u32 v73, s3, v73
v_cmp_le_u32 vcc, 14, v73
s_nop 0
s_and_b64 vcc, vcc, s[48:49]
s_cbranch_scc0 L_wt_22
buffer_load_dword v73, v72, s[4:7], s43 offen sc1
s_waitcnt vmcnt(2)
v_subrev_u32 v74, s3, v74
v_cmp_le_u32 vcc, 14, v74
s_nop 0
s_and_b64 vcc, vcc, s[48:49]
s_cbranch_scc0 L_wt_22
buffer_load_dword v74, v72, s[4:7], s43 offen sc1
s_waitcnt vmcnt(2)
v_subrev_u32 v75, s3, v75
v_cmp_le_u32 vcc, 14, v75
s_nop 0
s_and_b64 vcc, vcc, s[48:49]
s_cbranch_scc0 L_wt_22
s_add_u32 s15, s15, 1
s_cmp_lt_u32 s15, 131072
s_cbranch_scc1 L_wt_22_p
L_wt_22:
s_barrier
s_add_u32 m0, s23, 0
s_add_u32 s31, s22, 114688
buffer_load_dwordx4 v1, s[4:7], s31 offen offset:0 sc1 lds
buffer_load_dwordx4 v1, s[4:7], s31 offen offset:1024 sc1 lds
buffer_load_dwordx4 v1, s[4:7], s31 offen offset:2048 sc1 lds
buffer_load_dwordx4 v1, s[4:7], s31 offen offset:3072 sc1 lds
s_add_u32 m0, s23, 4096
s_add_u32 s31, s22, 118784
buffer_load_dwordx4 v1, s[4:7], s31 offen offset:0 sc1 lds
buffer_load_dwordx4 v1, s[4:7], s31 offen offset:1024 sc1 lds
buffer_load_dwordx4 v1, s[4:7], s31 offen offset:2048 sc1 lds
v_mov_b32 v96, 0x3f803f80
v_mov_b32 v97, 0x3f803f80
v_mov_b32 v98, 0x3f803f80
v_mov_b32 v99, 0x3f803f80
s_nop 1
v_mfma_f32_32x32x16_bf16 a[240:255], a[72:75], v[96:99], a[240:255]
v_mfma_f32_32x32x16_bf16 a[240:255], a[76:79], v[96:99], a[240:255]
v_mfma_f32_32x32x16_bf16 a[240:255], a[80:83], v[96:99], a[240:255]
v_mfma_f32_32x32x16_bf16 a[240:255], a[84:87], v[96:99], a[240:255]
v_mfma_f32_32x32x16_bf16 a[240:255], a[88:91], v[96:99], a[240:255]
v_mfma_f32_32x32x16_bf16 a[240:255], a[92:95], v[96:99], a[240:255]
s_waitcnt vmcnt(3)
s_barrier
ds_read_b128 v[48:51], v4 offset:0
ds_read_b128 v[52:55], v4 offset:17408
ds_read_b128 v[56:59], v4 offset:34816
ds_read_b128 v[60:63], v4 offset:52224
s_waitcnt lgkmcnt(2)
v_mfma_f32_32x32x16_bf16 v[16:31], a[0:3], v[48:51], 0
ds_read_b128 v[64:67], v4 offset:1024
buffer_load_dwordx4 v[128:131], v1, s[4:7], s24 offen sc1
v_mfma_f32_32x32x16_bf16 v[16:31], a[28:31], v[52:55], v[16:31]
ds_read_b128 v[68:71], v4 offset:18432
s_waitcnt lgkmcnt(2)
v_mfma_f32_32x32x16_bf16 v[16:31], a[56:59], v[56:59], v[16:31]
ds_read_b128 v[72:75], v4 offset:35840
buffer_load_dwordx4 v[132:135], v144, s[4:7], s24 offen offset:1024 sc1
v_mfma_f32_32x32x16_bf16 v[16:31], a[84:87], v[60:63], v[16:31]
ds_read_b128 v[76:79], v4 offset:53248
s_waitcnt lgkmcnt(2)
v_mfma_f32_32x32x16_bf16 v[16:31], a[4:7], v[64:67], v[16:31]
ds_read_b128 v[48:51], v4 offset:2048
s_add_u32 m0, s23, 7168
s_add_u32 s31, s22, 143360
buffer_load_dwordx4 v1, s[4:7], s31 offen offset:0 sc1 lds
v_mfma_f32_32x32x16_bf16 v[16:31], a[32:35], v[68:71], v[16:31]
ds_read_b128 v[52:55], v4 offset:19456
s_waitcnt lgkmcnt(2)
v_mfma_f32_32x32x16_bf16 v[16:31], a[60:63], v[72:75], v[16:31]
ds_read_b128 v[56:59], v4 offset:36864
buffer_load_dwordx4 v1, s[4:7], s31 offen offset:1024 sc1 lds
v_mfma_f32_32x32x16_bf16 v[16:31], a[88:91], v[76:79], v[16:31]
ds_read_b128 v[60:63], v4 offset:54272
s_waitcnt lgkmcnt(2)
v_mfma_f32_32x32x16_bf16 v[16:31], a[8:11], v[48:51], v[16:31]
ds_read_b128 v[64:67], v4 offset:3072
buffer_load_dwordx4 v1, s[4:7], s31 offen offset:2048 sc1 lds
v_mfma_f32_32x32x16_bf16 v[16:31], a[36:39], v[52:55], v[16:31]
s_waitcnt vmcnt(5)
s_barrier
ds_read_b128 v[68:71], v4 offset:20480
s_waitcnt lgkmcnt(2)
v_mfma_f32_32x32x16_bf16 v[16:31], a[64:67], v[56:59], v[16:31]
ds_read_b128 v[72:75], v4 offset:37888
buffer_load_dwordx4 v1, s[4:7], s31 offen offset:3072 sc1 lds
v_mfma_f32_32x32x16_bf16 v[16:31], a[92:95], v[60:63], v[16:31]
ds_read_b128 v[76:79], v4 offset:55296
s_waitcnt lgkmcnt(2)
v_mfma_f32_32x32x16_bf16 v[16:31], a[12:15], v[64:67], v[16:31]
ds_read_b128 v[48:51], v4 offset:4096
v_mfma_f32_32x32x16_bf16 a[240:255], a[96:99], v[96:99], a[240:255]
s_add_u32 m0, s23, 11264
s_add_u32 s31, s22, 147456
buffer_load_dwordx4 v1, s[4:7], s31 offen offset:0 sc1 lds
s_waitcnt vmcnt(5)
v_add_f32 v128, v128, v132
v_mfma_f32_32x32x16_bf16 v[16:31], a[40:43], v[68:71], v[16:31]
ds_read_b128 v[52:55], v4 offset:21504
v_add_f32 v129, v129, v133
v_add_f32 v130, v130, v134
v_add_f32 v131, v131, v135
s_nop 0
v_permlane32_swap_b32 v128, v130
s_waitcnt lgkmcnt(2)
v_mfma_f32_32x32x16_bf16 v[16:31], a[68:71], v[72:75], v[16:31]
ds_read_b128 v[56:59], v4 offset:38912
v_mfma_f32_32x32x16_bf16 a[240:255], a[100:103], v[96:99], a[240:255]
buffer_load_dwordx4 v1, s[4:7], s31 offen offset:1024 sc1 lds
v_permlane32_swap_b32 v129, v131
v_add_f32 v128, v128, v130
v_add_f32 v129, v129, v131
s_mul_i32 s30, s40, 229376
s_mul_i32 s29, s14, 57344
s_add_u32 s30, s30, s29
s_add_u32 s30, s30, 0
s_add_u32 s29, s30, 12288
buffer_load_dwordx4 a[168:171], v1, s[4:7], s29 offen offset:2048 sc1
v_mfma_f32_32x32x16_bf16 v[16:31], a[96:99], v[76:79], v[16:31]
ds_read_b128 v[60:63], v4 offset:56320
v_permlane16_swap_b32 v128, v129
v_add_f32 v128, v128, v129
v_mul_f32 v128, 0x3b124925, v128
s_nop 1
v_mov_b32_dpp v129, v128 row_ror:8 row_mask:0xf bank_mask:0xf
buffer_load_dwordx4 a[172:175], v1, s[4:7], s29 offen offset:3072 sc1
s_waitcnt lgkmcnt(2)
v_mfma_f32_32x32x16_bf16 v[16:31], a[16:19], v[48:51], v[16:31]
ds_read_b128 v[64:67], v4 offset:5120
v_mfma_f32_32x32x16_bf16 a[240:255], a[104:107], v[96:99], a[240:255]
buffer_load_dwordx4 v1, s[4:7], s31 offen offset:2048 sc1 lds
v_fma_f32 v129, -v128, v128, v129
v_max_f32 v129, 0, v129
v_add_f32 v129, 0x3727c5ac, v129
v_mfma_f32_32x32x16_bf16 v[16:31], a[44:47], v[52:55], v[16:31]
ds_read_b128 v[68:71], v4 offset:22528
v_rsq_f32 v131, v129
v_mov_b32 v130, v129
v_mul_f32 v129, 0xbfb8aa3b, v131
s_waitcnt lgkmcnt(2)
v_mfma_f32_32x32x16_bf16 v[16:31], a[72:75], v[56:59], v[16:31]
ds_read_b128 v[72:75], v4 offset:39936
s_add_u32 m0, s23, 14336
s_add_u32 s31, s22, 172032
buffer_load_dwordx4 v1, s[4:7], s31 offen offset:0 sc1 lds
v_mfma_f32_32x32x16_bf16 a[240:255], a[108:111], v[96:99], a[240:255]
s_mov_b32 exec_lo, 0x00ff00ff
s_mov_b32 exec_hi, 0x00ff00ff
ds_write_b96 v145, v[128:130] offset:0
s_mov_b64 exec, -1
v_mfma_f32_32x32x16_bf16 v[16:31], a[100:103], v[60:63], v[16:31]
ds_read_b128 v[76:79], v4 offset:57344
s_waitcnt lgkmcnt(3)
v_mfma_f32_32x32x16_bf16 v[16:31], a[20:23], v[64:67], v[16:31]
ds_read_b128 v[48:51], v4 offset:6144
buffer_load_dwordx4 v1, s[4:7], s31 offen offset:1024 sc1 lds
v_lshlrev_b32 v168, 7, v0
buffer_load_dword v170, v168, s[4:7], s43 offen sc1
s_add_u32 s29, s30, 16384
buffer_load_dwordx4 a[176:179], v1, s[4:7], s29 offen offset:0 sc1
v_mfma_f32_32x32x16_bf16 v[16:31], a[48:51], v[68:71], v[16:31]
ds_read_b128 v[52:55], v4 offset:23552
s_waitcnt lgkmcnt(2)
v_mfma_f32_32x32x16_bf16 v[16:31], a[76:79], v[72:75], v[16:31]
ds_read_b128 v[56:59], v4 offset:40960
buffer_load_dwordx4 v1, s[4:7], s31 offen offset:2048 sc1 lds
v_mfma_f32_32x32x16_bf16 v[16:31], a[104:107], v[76:79], v[16:31]
s_waitcnt vmcnt(10)
s_barrier
ds_read_b128 v[60:63], v4 offset:58368
s_waitcnt lgkmcnt(2)
v_mfma_f32_32x32x16_bf16 v[16:31], a[24:27], v[48:51], v[16:31]
ds_read_b128 v[64:67], v4 offset:7168
s_add_u32 m0, s23, 0
s_add_u32 s31, s22, 175104
buffer_load_dwordx4 v1, s[4:7], s31 offen offset:0 sc1 lds
v_accvgpr_read_b32 v80, a240
v_accvgpr_read_b32 v81, a241
v_mfma_f32_32x32x16_bf16 v[16:31], a[52:55], v[52:55], v[16:31]
ds_read_b128 v[68:71], v4 offset:24576
v_accvgpr_read_b32 v82, a242
v_accvgpr_read_b32 v83, a243
v_accvgpr_read_b32 v84, a244
v_accvgpr_read_b32 v85, a245
ds_read_b96 v[120:122], v6 offset:0
s_waitcnt lgkmcnt(3)
v_mfma_f32_32x32x16_bf16 v[16:31], a[80:83], v[56:59], v[16:31]
ds_read_b128 v[72:75], v4 offset:41984
s_add_u32 m0, s23, 1024
s_add_u32 s31, s22, 176128
buffer_load_dwordx4 v1, s[4:7], s31 offen offset:0 sc1 lds
v_accvgpr_read_b32 v86, a246
v_accvgpr_read_b32 v87, a247
buffer_load_dwordx4 a[180:183], v1, s[4:7], s29 offen offset:1024 sc1
v_mfma_f32_32x32x16_bf16 v[16:31], a[108:111], v[60:63], v[16:31]
ds_read_b128 v[76:79], v4 offset:59392
v_accvgpr_read_b32 v88, a248
v_accvgpr_read_b32 v89, a249
v_accvgpr_read_b32 v90, a250
v_accvgpr_read_b32 v91, a251
s_add_u32 s3, s32, 3
s_waitcnt vmcnt(5)
v_subrev_u32 v170, s3, v170
v_cmp_le_u32 vcc, 13, v170
s_nop 0
s_and_b64 vcc, vcc, s[48:49]
s_cbranch_scc0 L_chk_23_ok
s_mov_b32 s15, 0
L_chk_23:
buffer_load_dword v170, v168, s[4:7], s43 offen sc1
s_waitcnt vmcnt(0)
s_add_u32 s3, s32, 3
v_subrev_u32 v170, s3, v170
v_cmp_le_u32 vcc, 13, v170
s_nop 0
s_and_b64 vcc, vcc, s[48:49]
s_cbranch_scc0 L_chk_23_ok
s_add_u32 s15, s15, 1
s_cmp_lt_u32 s15, 131072
s_cbranch_scc1 L_chk_23
L_chk_23_ok:
s_waitcnt lgkmcnt(3)
v_mfma_f32_32x32x16_bf16 v[32:47], a[0:3], v[64:67], 0
ds_read_b128 v[48:51], v4 offset:8192
v_accvgpr_read_b32 v92, a252
v_accvgpr_read_b32 v93, a253
v_accvgpr_read_b32 v94, a254
v_accvgpr_read_b32 v95, a255
buffer_load_dwordx4 v[136:139], v1, s[4:7], s25 offen sc1
buffer_load_dwordx4 a[184:187], v1, s[4:7], s29 offen offset:2048 sc1
v_mfma_f32_32x32x16_bf16 v[32:47], a[28:31], v[68:71], v[32:47]
ds_read_b128 v[52:55], v4 offset:25600
buffer_load_dwordx4 v1, s[4:7], s31 offen offset:1024 sc1 lds
s_waitcnt lgkmcnt(2)
v_mfma_f32_32x32x16_bf16 v[32:47], a[56:59], v[72:75], v[32:47]
ds_read_b128 v[56:59], v4 offset:43008
buffer_load_dwordx4 v[140:143], v144, s[4:7], s25 offen offset:1024 sc1
v_fma_f32 v16, -v120, v80, v16
v_fma_f32 v17, -v120, v81, v17
v_fma_f32 v18, -v120, v82, v18
v_fma_f32 v19, -v120, v83, v19
v_mfma_f32_32x32x16_bf16 v[32:47], a[84:87], v[76:79], v[32:47]
ds_read_b128 v[60:63], v4 offset:60416
v_fma_f32 v20, -v120, v84, v20
v_fma_f32 v21, -v120, v85, v21
v_fma_f32 v22, -v120, v86, v22
v_fma_f32 v23, -v120, v87, v23
s_waitcnt lgkmcnt(2)
v_mfma_f32_32x32x16_bf16 v[32:47], a[4:7], v[48:51], v[32:47]
ds_read_b128 v[64:67], v4 offset:9216
buffer_load_dwordx4 v1, s[4:7], s31 offen offset:2048 sc1 lds
v_fma_f32 v24, -v120, v88, v24
v_fma_f32 v25, -v120, v89, v25
v_fma_f32 v26, -v120, v90, v26
v_fma_f32 v27, -v120, v91, v27
v_mfma_f32_32x32x16_bf16 v[32:47], a[32:35], v[52:55], v[32:47]
ds_read_b128 v[68:71], v4 offset:26624
buffer_load_dwordx4 a[188:191], v1, s[4:7], s29 offen offset:3072 sc1
v_fma_f32 v28, -v120, v92, v28
v_fma_f32 v29, -v120, v93, v29
v_fma_f32 v30, -v120, v94, v30
s_waitcnt lgkmcnt(2)
v_mfma_f32_32x32x16_bf16 v[32:47], a[60:63], v[56:59], v[32:47]
ds_read_b128 v[72:75], v4 offset:44032
v_fma_f32 v31, -v120, v95, v31
v_mul_f32 v96, v16, v121
v_mul_f32 v97, v17, v121
v_mul_f32 v98, v18, v121
v_mul_f32 v99, v19, v121
v_mfma_f32_32x32x16_bf16 v[32:47], a[88:91], v[60:63], v[32:47]
ds_read_b128 v[76:79], v4 offset:61440
v_mul_f32 v100, v20, v121
v_mul_f32 v101, v21, v121
v_mul_f32 v102, v22, v121
v_mul_f32 v103, v23, v121
s_waitcnt lgkmcnt(2)
v_mfma_f32_32x32x16_bf16 v[32:47], a[8:11], v[64:67], v[32:47]
ds_read_b128 v[48:51], v4 offset:10240
v_exp_f32 v96, v96
v_mul_f32 v16, v16, v24
v_exp_f32 v97, v97
v_mfma_f32_32x32x16_bf16 v[32:47], a[36:39], v[68:71], v[32:47]
s_barrier
ds_read_b128 v[52:55], v4 offset:27648
v_mul_f32 v17, v17, v25
v_exp_f32 v98, v98
s_waitcnt lgkmcnt(2)
v_mfma_f32_32x32x16_bf16 v[32:47], a[64:67], v[72:75], v[32:47]
ds_read_b128 v[56:59], v4 offset:45056
s_add_u32 m0, s23, 4096
s_add_u32 s31, s22, 200704
buffer_load_dwordx4 v1, s[4:7], s31 offen offset:0 sc1 lds
v_mul_f32 v18, v18, v26
v_mfma_f32_32x32x16_bf16 v[32:47], a[92:95], v[76:79], v[32:47]
ds_read_b128 v[60:63], v4 offset:62464
s_add_u32 s29, s30, 20480
buffer_load_dwordx4 a[192:195], v1, s[4:7], s29 offen offset:0 sc1
v_exp_f32 v99, v99
s_waitcnt lgkmcnt(2)
v_mfma_f32_32x32x16_bf16 v[32:47], a[12:15], v[48:51], v[32:47]
ds_read_b128 v[64:67], v4 offset:11264
ds_write_b128 v148, v[80:83] offset:0
v_mul_f32 v19, v19, v27
v_exp_f32 v100, v100
v_mul_f32 v20, v20, v28
v_mfma_f32_32x32x16_bf16 v[32:47], a[40:43], v[52:55], v[32:47]
ds_read_b128 v[68:71], v4 offset:28672
buffer_load_dwordx4 v1, s[4:7], s31 offen offset:1024 sc1 lds
v_exp_f32 v101, v101
v_mul_f32 v21, v21, v29
s_waitcnt lgkmcnt(3)
v_mfma_f32_32x32x16_bf16 v[32:47], a[68:71], v[56:59], v[32:47]
ds_read_b128 v[72:75], v4 offset:46080
ds_write_b128 v148, v[84:87] offset:16
buffer_load_dwordx4 a[196:199], v1, s[4:7], s29 offen offset:1024 sc1
v_exp_f32 v102, v102
v_mul_f32 v22, v22, v30
v_mfma_f32_32x32x16_bf16 v[32:47], a[96:99], v[60:63], v[32:47]
ds_read_b128 v[76:79], v4 offset:63488
v_exp_f32 v103, v103
v_mul_f32 v23, v23, v31
v_fma_f32 v96, v96, v122, v122
s_waitcnt lgkmcnt(3)
v_mfma_f32_32x32x16_bf16 v[32:47], a[16:19], v[64:67], v[32:47]
ds_read_b128 v[48:51], v4 offset:12288
buffer_load_dwordx4 v1, s[4:7], s31 offen offset:2048 sc1 lds
ds_write_b128 v148, v[88:91] offset:32
v_fma_f32 v97, v97, v122, v122
v_fma_f32 v98, v98, v122, v122
v_fma_f32 v99, v99, v122, v122
v_mfma_f32_32x32x16_bf16 v[32:47], a[44:47], v[68:71], v[32:47]
ds_read_b128 v[52:55], v4 offset:29696
buffer_load_dwordx4 a[200:203], v1, s[4:7], s29 offen offset:2048 sc1
v_fma_f32 v100, v100, v122, v122
v_fma_f32 v101, v101, v122, v122
v_fma_f32 v102, v102, v122, v122
s_waitcnt lgkmcnt(3)
v_mfma_f32_32x32x16_bf16 v[32:47], a[72:75], v[72:75], v[32:47]
ds_read_b128 v[56:59], v4 offset:47104
ds_write_b128 v148, v[92:95] offset:48
v_fma_f32 v103, v103, v122, v122
v_rcp_f32 v96, v96
v_mfma_f32_32x32x16_bf16 v[32:47], a[100:103], v[76:79], v[32:47]
ds_read_b128 v[60:63], v4 offset:64512
buffer_load_dwordx4 v1, s[4:7], s31 offen offset:3072 sc1 lds
v_rcp_f32 v97, v97
s_waitcnt lgkmcnt(3)
v_mfma_f32_32x32x16_bf16 v[32:47], a[20:23], v[48:51], v[32:47]
ds_read_b128 v[64:67], v4 offset:13312
v_rcp_f32 v98, v98
v_mul_f32 v16, v16, v96
v_rcp_f32 v99, v99
v_mfma_f32_32x32x16_bf16 v[32:47], a[48:51], v[52:55], v[32:47]
ds_read_b128 v[68:71], v4 offset:30720
buffer_load_dwordx4 a[204:207], v1, s[4:7], s29 offen offset:3072 sc1
v_mul_f32 v17, v17, v97
v_rcp_f32 v100, v100
s_waitcnt lgkmcnt(2)
v_mfma_f32_32x32x16_bf16 v[32:47], a[76:79], v[56:59], v[32:47]
ds_read_b128 v[72:75], v4 offset:48128
v_mul_f32 v18, v18, v98
v_rcp_f32 v101, v101
v_mul_f32 v19, v19, v99
v_mfma_f32_32x32x16_bf16 v[32:47], a[104:107], v[60:63], v[32:47]
s_waitcnt vmcnt(16)
s_barrier
ds_read_b128 v[76:79], v5 offset:0
v_rcp_f32 v102, v102
v_mul_f32 v20, v20, v100
s_waitcnt lgkmcnt(2)
v_mfma_f32_32x32x16_bf16 v[32:47], a[24:27], v[64:67], v[32:47]
ds_read_b128 v[48:51], v4 offset:14336
s_add_u32 m0, s23, 8192
s_add_u32 s31, s22, 204800
buffer_load_dwordx4 v1, s[4:7], s31 offen offset:0 sc1 lds
v_rcp_f32 v103, v103
v_mfma_f32_32x32x16_bf16 v[32:47], a[52:55], v[68:71], v[32:47]
ds_read_b128 v[52:55], v4 offset:31744
v_mul_f32 v21, v21, v101
v_mul_f32 v22, v22, v102
v_mul_f32 v23, v23, v103
v_cvt_pk_bf16_f32 v112, v16, v17
ds_read_b96 v[124:126], v6 offset:512
s_waitcnt lgkmcnt(3)
v_mfma_f32_32x32x16_bf16 v[32:47], a[80:83], v[72:75], v[32:47]
ds_read_b128 v[56:59], v4 offset:49152
s_add_u32 s29, s30, 24576
buffer_load_dwordx4 a[208:211], v1, s[4:7], s29 offen offset:0 sc1
v_cvt_pk_bf16_f32 v113, v18, v19
v_cvt_pk_bf16_f32 v114, v20, v21
v_cvt_pk_bf16_f32 v115, v22, v23
v_mfma_f32_32x32x16_bf16 v[32:47], a[108:111], v[76:79], v[32:47]
ds_read_b128 v[60:63], v5 offset:1024
buffer_load_dwordx4 v1, s[4:7], s31 offen offset:1024 sc1 lds
buffer_store_dwordx4 v[112:115], v119, s[4:7], s26 offen sc1
s_add_u32 s26, s26, 114688
s_waitcnt lgkmcnt(3)
v_mfma_f32_32x32x16_bf16 v[16:31], a[0:3], v[48:51], 0
ds_read_b128 v[64:67], v4 offset:15360
v_mfma_f32_32x32x16_bf16 v[16:31], a[28:31], v[52:55], v[16:31]
ds_read_b128 v[68:71], v4 offset:32768
s_waitcnt lgkmcnt(2)
v_mfma_f32_32x32x16_bf16 v[16:31], a[56:59], v[56:59], v[16:31]
ds_read_b128 v[72:75], v4 offset:50176
buffer_load_dwordx4 v1, s[4:7], s31 offen offset:2048 sc1 lds
buffer_load_dwordx4 a[212:215], v1, s[4:7], s29 offen offset:1024 sc1
v_fma_f32 v32, -v124, v80, v32
v_fma_f32 v33, -v124, v81, v33
v_fma_f32 v34, -v124, v82, v34
v_fma_f32 v35, -v124, v83, v35
v_mfma_f32_32x32x16_bf16 v[16:31], a[84:87], v[60:63], v[16:31]
ds_read_b128 v[76:79], v5 offset:2048
v_fma_f32 v36, -v124, v84, v36
v_fma_f32 v37, -v124, v85, v37
v_fma_f32 v38, -v124, v86, v38
v_fma_f32 v39, -v124, v87, v39
v_fma_f32 v40, -v124, v88, v40
s_waitcnt lgkmcnt(2)
v_mfma_f32_32x32x16_bf16 v[16:31], a[4:7], v[64:67], v[16:31]
ds_read_b128 v[48:51], v4 offset:16384
v_fma_f32 v41, -v124, v89, v41
v_fma_f32 v42, -v124, v90, v42
v_fma_f32 v43, -v124, v91, v43
v_fma_f32 v44, -v124, v92, v44
v_fma_f32 v45, -v124, v93, v45
v_fma_f32 v46, -v124, v94, v46
v_mfma_f32_32x32x16_bf16 v[16:31], a[32:35], v[68:71], v[16:31]
ds_read_b128 v[52:55], v4 offset:33792
v_fma_f32 v47, -v124, v95, v47
v_mul_f32 v96, v32, v125
v_mul_f32 v97, v33, v125
v_mul_f32 v98, v34, v125
v_mul_f32 v99, v35, v125
s_waitcnt lgkmcnt(2)
v_mfma_f32_32x32x16_bf16 v[16:31], a[60:63], v[72:75], v[16:31]
ds_read_b128 v[56:59], v4 offset:51200
v_mul_f32 v100, v36, v125
v_mul_f32 v101, v37, v125
v_mul_f32 v102, v38, v125
v_mul_f32 v103, v39, v125
v_exp_f32 v96, v96
v_mfma_f32_32x32x16_bf16 v[16:31], a[88:91], v[76:79], v[16:31]
ds_read_b128 v[60:63], v5 offset:3072
v_mul_f32 v32, v32, v40
v_exp_f32 v97, v97
v_mul_f32 v33, v33, v41
s_waitcnt lgkmcnt(2)
v_mfma_f32_32x32x16_bf16 v[16:31], a[8:11], v[48:51], v[16:31]
ds_read_b128 v[64:67], v4 offset:0
buffer_load_dwordx4 a[216:219], v1, s[4:7], s29 offen offset:2048 sc1
v_exp_f32 v98, v98
v_mul_f32 v34, v34, v42
v_exp_f32 v99, v99
v_mfma_f32_32x32x16_bf16 v[16:31], a[36:39], v[52:55], v[16:31]
s_waitcnt vmcnt(16)
s_barrier
ds_read_b128 v[68:71], v4 offset:17408
v_mul_f32 v35, v35, v43
v_exp_f32 v100, v100
v_mul_f32 v36, v36, v44
s_waitcnt lgkmcnt(2)
v_mfma_f32_32x32x16_bf16 v[16:31], a[64:67], v[56:59], v[16:31]
ds_read_b128 v[72:75], v4 offset:34816
s_add_u32 m0, s23, 11264
s_add_u32 s31, s22, 0
buffer_load_dwordx4 v1, s[4:7], s31 offen offset:0 sc1 lds
v_exp_f32 v101, v101
v_mul_f32 v37, v37, v45
v_mfma_f32_32x32x16_bf16 v[16:31], a[92:95], v[60:63], v[16:31]
ds_read_b128 v[76:79], v4 offset:52224
buffer_load_dwordx4 a[220:223], v1, s[4:7], s29 offen offset:3072 sc1
v_exp_f32 v102, v102
v_mul_f32 v38, v38, v46
s_waitcnt lgkmcnt(2)
v_mfma_f32_32x32x16_bf16 v[16:31], a[12:15], v[64:67], v[16:31]
ds_read_b128 v[48:51], v4 offset:1024
v_exp_f32 v103, v103
v_mul_f32 v39, v39, v47
v_fma_f32 v96, v96, v126, v126
v_fma_f32 v97, v97, v126, v126
v_fma_f32 v98, v98, v126, v126
v_mfma_f32_32x32x16_bf16 v[16:31], a[40:43], v[68:71], v[16:31]
ds_read_b128 v[52:55], v4 offset:18432
buffer_load_dwordx4 v1, s[4:7], s31 offen offset:1024 sc1 lds
v_fma_f32 v99, v99, v126, v126
v_fma_f32 v100, v100, v126, v126
v_fma_f32 v101, v101, v126, v126
v_fma_f32 v102, v102, v126, v126
s_waitcnt lgkmcnt(2)
v_mfma_f32_32x32x16_bf16 v[16:31], a[68:71], v[72:75], v[16:31]
ds_read_b128 v[56:59], v4 offset:35840
v_fma_f32 v103, v103, v126, v126
v_rcp_f32 v96, v96
v_rcp_f32 v97, v97
v_mfma_f32_32x32x16_bf16 v[16:31], a[96:99], v[76:79], v[16:31]
ds_read_b128 v[60:63], v4 offset:53248
s_add_u32 s29, s30, 28672
buffer_load_dwordx4 a[224:227], v1, s[4:7], s29 offen offset:0 sc1
v_rcp_f32 v98, v98
v_mul_f32 v32, v32, v96
s_waitcnt lgkmcnt(2)
v_mfma_f32_32x32x16_bf16 v[16:31], a[16:19], v[48:51], v[16:31]
ds_read_b128 v[64:67], v4 offset:2048
buffer_load_dwordx4 v1, s[4:7], s31 offen offset:2048 sc1 lds
v_rcp_f32 v99, v99
v_mul_f32 v33, v33, v97
v_rcp_f32 v100, v100
v_mfma_f32_32x32x16_bf16 v[16:31], a[44:47], v[52:55], v[16:31]
ds_read_b128 v[68:71], v4 offset:19456
v_mul_f32 v34, v34, v98
v_rcp_f32 v101, v101
v_mul_f32 v35, v35, v99
s_waitcnt lgkmcnt(2)
v_mfma_f32_32x32x16_bf16 v[16:31], a[72:75], v[56:59], v[16:31]
ds_read_b128 v[72:75], v4 offset:36864
v_rcp_f32 v102, v102
v_mul_f32 v36, v36, v100
v_rcp_f32 v103, v103
v_mul_f32 v37, v37, v101
v_mfma_f32_32x32x16_bf16 v[16:31], a[100:103], v[60:63], v[16:31]
ds_read_b128 v[76:79], v4 offset:54272
buffer_load_dwordx4 v1, s[4:7], s31 offen offset:3072 sc1 lds
v_mul_f32 v38, v38, v102
v_mul_f32 v39, v39, v103
v_cvt_pk_bf16_f32 v112, v32, v33
v_cvt_pk_bf16_f32 v113, v34, v35
s_waitcnt lgkmcnt(2)
v_mfma_f32_32x32x16_bf16 v[16:31], a[20:23], v[64:67], v[16:31]
ds_read_b128 v[48:51], v4 offset:3072
buffer_load_dwordx4 a[228:231], v1, s[4:7], s29 offen offset:1024 sc1
v_cvt_pk_bf16_f32 v114, v36, v37
v_cvt_pk_bf16_f32 v115, v38, v39
buffer_store_dwordx4 v[112:115], v119, s[4:7], s26 offen sc1
s_add_u32 s26, s26, 114688
v_add_f32 v136, v136, v140
v_mfma_f32_32x32x16_bf16 v[16:31], a[48:51], v[68:71], v[16:31]
ds_read_b128 v[52:55], v4 offset:20480
v_add_f32 v137, v137, v141
v_add_f32 v138, v138, v142
v_add_f32 v139, v139, v143
s_nop 0
v_permlane32_swap_b32 v136, v138
v_permlane32_swap_b32 v137, v139
s_waitcnt lgkmcnt(2)
v_mfma_f32_32x32x16_bf16 v[16:31], a[76:79], v[72:75], v[16:31]
ds_read_b128 v[56:59], v4 offset:37888
v_add_f32 v136, v136, v138
v_add_f32 v137, v137, v139
s_nop 1
v_permlane16_swap_b32 v136, v137
v_mfma_f32_32x32x16_bf16 v[16:31], a[104:107], v[76:79], v[16:31]
s_waitcnt vmcnt(16)
s_barrier
ds_read_b128 v[60:63], v4 offset:55296
s_waitcnt lgkmcnt(2)
v_mfma_f32_32x32x16_bf16 v[16:31], a[24:27], v[48:51], v[16:31]
ds_read_b128 v[64:67], v4 offset:4096
s_add_u32 m0, s23, 15360
s_add_u32 s31, s22, 4096
buffer_load_dwordx4 v1, s[4:7], s31 offen offset:0 sc1 lds
v_mfma_f32_32x32x16_bf16 v[16:31], a[52:55], v[52:55], v[16:31]
ds_read_b128 v[68:71], v4 offset:21504
ds_read_b96 v[120:122], v6 offset:1024
s_waitcnt lgkmcnt(3)
v_mfma_f32_32x32x16_bf16 v[16:31], a[80:83], v[56:59], v[16:31]
ds_read_b128 v[72:75], v4 offset:38912
buffer_load_dwordx4 a[232:235], v1, s[4:7], s29 offen offset:2048 sc1
v_mfma_f32_32x32x16_bf16 v[16:31], a[108:111], v[60:63], v[16:31]
ds_read_b128 v[76:79], v4 offset:56320
buffer_load_dwordx4 v1, s[4:7], s31 offen offset:1024 sc1 lds
s_waitcnt lgkmcnt(3)
v_mfma_f32_32x32x16_bf16 v[32:47], a[0:3], v[64:67], 0
ds_read_b128 v[48:51], v4 offset:5120
buffer_load_dwordx4 a[236:239], v1, s[4:7], s29 offen offset:3072 sc1
v_mfma_f32_32x32x16_bf16 v[32:47], a[28:31], v[68:71], v[32:47]
ds_read_b128 v[52:55], v4 offset:22528
s_waitcnt lgkmcnt(2)
v_mfma_f32_32x32x16_bf16 v[32:47], a[56:59], v[72:75], v[32:47]
ds_read_b128 v[56:59], v4 offset:39936
s_add_u32 m0, s23, 0
s_add_u32 s31, s22, 6144
buffer_load_dwordx4 v1, s[4:7], s31 offen offset:0 sc1 lds
v_fma_f32 v16, -v120, v80, v16
v_fma_f32 v17, -v120, v81, v17
v_fma_f32 v18, -v120, v82, v18
v_mfma_f32_32x32x16_bf16 v[32:47], a[84:87], v[76:79], v[32:47]
ds_read_b128 v[60:63], v4 offset:57344
v_fma_f32 v19, -v120, v83, v19
v_fma_f32 v20, -v120, v84, v20
v_fma_f32 v21, -v120, v85, v21
v_fma_f32 v22, -v120, v86, v22
v_fma_f32 v23, -v120, v87, v23
s_waitcnt lgkmcnt(2)
v_mfma_f32_32x32x16_bf16 v[32:47], a[4:7], v[48:51], v[32:47]
ds_read_b128 v[64:67], v4 offset:6144
v_fma_f32 v24, -v120, v88, v24
v_fma_f32 v25, -v120, v89, v25
v_fma_f32 v26, -v120, v90, v26
v_fma_f32 v27, -v120, v91, v27
v_fma_f32 v28, -v120, v92, v28
v_fma_f32 v29, -v120, v93, v29
v_mfma_f32_32x32x16_bf16 v[32:47], a[32:35], v[52:55], v[32:47]
ds_read_b128 v[68:71], v4 offset:23552
s_add_u32 s29, s30, 32768
buffer_load_dwordx4 a[240:243], v1, s[4:7], s29 offen offset:0 sc1
v_fma_f32 v30, -v120, v94, v30
v_fma_f32 v31, -v120, v95, v31
v_mul_f32 v96, v16, v121
s_waitcnt lgkmcnt(2)
v_mfma_f32_32x32x16_bf16 v[32:47], a[60:63], v[56:59], v[32:47]
ds_read_b128 v[72:75], v4 offset:40960
v_mul_f32 v97, v17, v121
v_mul_f32 v98, v18, v121
v_mul_f32 v99, v19, v121
v_mul_f32 v100, v20, v121
v_mul_f32 v101, v21, v121
v_mul_f32 v102, v22, v121
v_mfma_f32_32x32x16_bf16 v[32:47], a[88:91], v[60:63], v[32:47]
ds_read_b128 v[76:79], v4 offset:58368
v_mul_f32 v103, v23, v121
v_exp_f32 v96, v96
v_mul_f32 v16, v16, v24
s_waitcnt lgkmcnt(2)
v_mfma_f32_32x32x16_bf16 v[32:47], a[8:11], v[64:67], v[32:47]
ds_read_b128 v[48:51], v4 offset:7168
v_exp_f32 v97, v97
v_mul_f32 v17, v17, v25
v_exp_f32 v98, v98
v_mul_f32 v18, v18, v26
v_mfma_f32_32x32x16_bf16 v[32:47], a[36:39], v[68:71], v[32:47]
s_waitcnt vmcnt(16)
s_barrier
ds_read_b128 v[52:55], v4 offset:24576
v_exp_f32 v99, v99
v_mul_f32 v19, v19, v27
s_waitcnt lgkmcnt(2)
v_mfma_f32_32x32x16_bf16 v[32:47], a[64:67], v[72:75], v[32:47]
ds_read_b128 v[56:59], v4 offset:41984
s_add_u32 m0, s23, 1024
s_add_u32 s31, s22, 28672
buffer_load_dwordx4 v1, s[4:7], s31 offen offset:0 sc1 lds
v_exp_f32 v100, v100
v_mul_f32 v20, v20, v28
v_mfma_f32_32x32x16_bf16 v[32:47], a[92:95], v[76:79], v[32:47]
ds_read_b128 v[60:63], v4 offset:59392
buffer_load_dwordx4 a[244:247], v1, s[4:7], s29 offen offset:1024 sc1
v_exp_f32 v101, v101
v_mul_f32 v21, v21, v29
s_waitcnt lgkmcnt(2)
v_mfma_f32_32x32x16_bf16 v[32:47], a[12:15], v[48:51], v[32:47]
ds_read_b128 v[64:67], v4 offset:8192
v_exp_f32 v102, v102
v_mul_f32 v22, v22, v30
v_exp_f32 v103, v103
v_mul_f32 v23, v23, v31
v_mfma_f32_32x32x16_bf16 v[32:47], a[40:43], v[52:55], v[32:47]
ds_read_b128 v[68:71], v4 offset:25600
buffer_load_dwordx4 v1, s[4:7], s31 offen offset:1024 sc1 lds
v_fma_f32 v96, v96, v122, v122
v_fma_f32 v97, v97, v122, v122
v_fma_f32 v98, v98, v122, v122
v_fma_f32 v99, v99, v122, v122
s_waitcnt lgkmcnt(2)
v_mfma_f32_32x32x16_bf16 v[32:47], a[68:71], v[56:59], v[32:47]
ds_read_b128 v[72:75], v4 offset:43008
buffer_load_dwordx4 a[248:251], v1, s[4:7], s29 offen offset:2048 sc1
v_fma_f32 v100, v100, v122, v122
v_fma_f32 v101, v101, v122, v122
v_fma_f32 v102, v102, v122, v122
v_fma_f32 v103, v103, v122, v122
v_mfma_f32_32x32x16_bf16 v[32:47], a[96:99], v[60:63], v[32:47]
ds_read_b128 v[76:79], v4 offset:60416
v_rcp_f32 v96, v96
v_rcp_f32 v97, v97
s_waitcnt lgkmcnt(2)
v_mfma_f32_32x32x16_bf16 v[32:47], a[16:19], v[64:67], v[32:47]
ds_read_b128 v[48:51], v4 offset:9216
buffer_load_dwordx4 v1, s[4:7], s31 offen offset:2048 sc1 lds
v_rcp_f32 v98, v98
v_mul_f32 v16, v16, v96
v_rcp_f32 v99, v99
v_mfma_f32_32x32x16_bf16 v[32:47], a[44:47], v[68:71], v[32:47]
ds_read_b128 v[52:55], v4 offset:26624
buffer_load_dwordx4 a[252:255], v1, s[4:7], s29 offen offset:3072 sc1
v_mul_f32 v17, v17, v97
v_rcp_f32 v100, v100
v_mul_f32 v18, v18, v98
s_waitcnt lgkmcnt(2)
v_mfma_f32_32x32x16_bf16 v[32:47], a[72:75], v[72:75], v[32:47]
ds_read_b128 v[56:59], v4 offset:44032
v_rcp_f32 v101, v101
v_mul_f32 v19, v19, v99
v_rcp_f32 v102, v102
v_mul_f32 v20, v20, v100
v_mfma_f32_32x32x16_bf16 v[32:47], a[100:103], v[76:79], v[32:47]
ds_read_b128 v[60:63], v4 offset:61440
buffer_load_dwordx4 v1, s[4:7], s31 offen offset:3072 sc1 lds
v_rcp_f32 v103, v103
v_mul_f32 v21, v21, v101
v_mul_f32 v22, v22, v102
s_waitcnt lgkmcnt(2)
v_mfma_f32_32x32x16_bf16 v[32:47], a[20:23], v[48:51], v[32:47]
ds_read_b128 v[64:67], v4 offset:10240
v_mul_f32 v23, v23, v103
v_cvt_pk_bf16_f32 v112, v16, v17
v_cvt_pk_bf16_f32 v113, v18, v19
v_cvt_pk_bf16_f32 v114, v20, v21
v_cvt_pk_bf16_f32 v115, v22, v23
buffer_store_dwordx4 v[112:115], v119, s[4:7], s26 offen sc1
v_mfma_f32_32x32x16_bf16 v[32:47], a[48:51], v[52:55], v[32:47]
ds_read_b128 v[68:71], v4 offset:27648
s_add_u32 s29, s30, 36864
buffer_load_dwordx4 v[176:179], v1, s[4:7], s29 offen offset:0 sc1
s_add_u32 s26, s26, 114688
v_add_f32 v136, v136, v137
v_mul_f32 v136, 0x3b124925, v136
s_waitcnt lgkmcnt(2)
v_mfma_f32_32x32x16_bf16 v[32:47], a[76:79], v[56:59], v[32:47]
ds_read_b128 v[72:75], v4 offset:45056
v_mov_b32_dpp v137, v136 row_ror:8 row_mask:0xf bank_mask:0xf
v_fma_f32 v137, -v136, v136, v137
v_max_f32 v137, 0, v137
v_add_f32 v137, 0x3727c5ac, v137
v_rsq_f32 v139, v137
v_mfma_f32_32x32x16_bf16 v[32:47], a[104:107], v[60:63], v[32:47]
s_waitcnt vmcnt(17)
s_barrier
ds_read_b128 v[76:79], v4 offset:62464
v_mov_b32 v138, v137
v_mul_f32 v137, 0xbfb8aa3b, v139
s_waitcnt lgkmcnt(2)
v_mfma_f32_32x32x16_bf16 v[32:47], a[24:27], v[64:67], v[32:47]
ds_read_b128 v[48:51], v4 offset:11264
s_add_u32 m0, s23, 5120
s_add_u32 s31, s22, 32768
buffer_load_dwordx4 v1, s[4:7], s31 offen offset:0 sc1 lds
s_mov_b32 exec_lo, 0x00ff00ff
s_mov_b32 exec_hi, 0x00ff00ff
ds_write_b96 v145, v[136:138] offset:2048
s_mov_b64 exec, -1
v_mfma_f32_32x32x16_bf16 v[32:47], a[52:55], v[68:71], v[32:47]
ds_read_b128 v[52:55], v4 offset:28672
ds_read_b96 v[124:126], v6 offset:1536
s_waitcnt lgkmcnt(4)
v_mfma_f32_32x32x16_bf16 v[32:47], a[80:83], v[72:75], v[32:47]
ds_read_b128 v[56:59], v4 offset:46080
buffer_load_dwordx4 v[180:183], v1, s[4:7], s29 offen offset:1024 sc1
v_mfma_f32_32x32x16_bf16 v[32:47], a[108:111], v[76:79], v[32:47]
ds_read_b128 v[60:63], v4 offset:63488
buffer_load_dwordx4 v1, s[4:7], s31 offen offset:1024 sc1 lds
s_waitcnt lgkmcnt(3)
v_mfma_f32_32x32x16_bf16 v[16:31], a[0:3], v[48:51], 0
ds_read_b128 v[64:67], v4 offset:12288
v_mfma_f32_32x32x16_bf16 v[16:31], a[28:31], v[52:55], v[16:31]
ds_read_b128 v[68:71], v4 offset:29696
s_waitcnt lgkmcnt(2)
v_mfma_f32_32x32x16_bf16 v[16:31], a[56:59], v[56:59], v[16:31]
ds_read_b128 v[72:75], v4 offset:47104
buffer_load_dwordx4 v1, s[4:7], s31 offen offset:2048 sc1 lds
buffer_load_dwordx4 v[184:187], v1, s[4:7], s29 offen offset:2048 sc1
v_fma_f32 v32, -v124, v80, v32
v_fma_f32 v33, -v124, v81, v33
v_fma_f32 v34, -v124, v82, v34
v_mfma_f32_32x32x16_bf16 v[16:31], a[84:87], v[60:63], v[16:31]
ds_read_b128 v[76:79], v4 offset:64512
v_fma_f32 v35, -v124, v83, v35
v_fma_f32 v36, -v124, v84, v36
v_fma_f32 v37, -v124, v85, v37
v_fma_f32 v38, -v124, v86, v38
s_waitcnt lgkmcnt(2)
v_mfma_f32_32x32x16_bf16 v[16:31], a[4:7], v[64:67], v[16:31]
ds_read_b128 v[48:51], v4 offset:13312
v_fma_f32 v39, -v124, v87, v39
v_fma_f32 v40, -v124, v88, v40
v_fma_f32 v41, -v124, v89, v41
v_fma_f32 v42, -v124, v90, v42
v_fma_f32 v43, -v124, v91, v43
v_mfma_f32_32x32x16_bf16 v[16:31], a[32:35], v[68:71], v[16:31]
ds_read_b128 v[52:55], v4 offset:30720
v_fma_f32 v44, -v124, v92, v44
v_fma_f32 v45, -v124, v93, v45
v_fma_f32 v46, -v124, v94, v46
v_fma_f32 v47, -v124, v95, v47
s_waitcnt lgkmcnt(2)
v_mfma_f32_32x32x16_bf16 v[16:31], a[60:63], v[72:75], v[16:31]
ds_read_b128 v[56:59], v4 offset:48128
v_mul_f32 v96, v32, v125
v_mul_f32 v97, v33, v125
v_mul_f32 v98, v34, v125
v_mul_f32 v99, v35, v125
v_mul_f32 v100, v36, v125
v_mfma_f32_32x32x16_bf16 v[16:31], a[88:91], v[76:79], v[16:31]
ds_read_b128 v[60:63], v5 offset:0
v_mul_f32 v101, v37, v125
v_mul_f32 v102, v38, v125
v_mul_f32 v103, v39, v125
s_waitcnt lgkmcnt(2)
v_mfma_f32_32x32x16_bf16 v[16:31], a[8:11], v[48:51], v[16:31]
ds_read_b128 v[64:67], v4 offset:14336
buffer_load_dwordx4 v[188:191], v1, s[4:7], s29 offen offset:3072 sc1
v_exp_f32 v96, v96
v_mul_f32 v32, v32, v40
v_mfma_f32_32x32x16_bf16 v[16:31], a[36:39], v[52:55], v[16:31]
s_waitcnt vmcnt(16)
s_barrier
ds_read_b128 v[68:71], v4 offset:31744
v_exp_f32 v97, v97
v_mul_f32 v33, v33, v41
s_waitcnt lgkmcnt(2)
v_mfma_f32_32x32x16_bf16 v[16:31], a[64:67], v[56:59], v[16:31]
ds_read_b128 v[72:75], v4 offset:49152
s_add_u32 m0, s23, 8192
s_add_u32 s31, s22, 57344
buffer_load_dwordx4 v1, s[4:7], s31 offen offset:0 sc1 lds
v_exp_f32 v98, v98
v_mfma_f32_32x32x16_bf16 v[16:31], a[92:95], v[60:63], v[16:31]
ds_read_b128 v[76:79], v5 offset:1024
s_add_u32 s29, s30, 40960
buffer_load_dwordx4 v[192:195], v1, s[4:7], s29 offen offset:0 sc1
v_mul_f32 v34, v34, v42
s_waitcnt lgkmcnt(2)
v_mfma_f32_32x32x16_bf16 v[16:31], a[12:15], v[64:67], v[16:31]
ds_read_b128 v[48:51], v4 offset:15360
v_exp_f32 v99, v99
v_mul_f32 v35, v35, v43
v_exp_f32 v100, v100
v_mfma_f32_32x32x16_bf16 v[16:31], a[40:43], v[68:71], v[16:31]
ds_read_b128 v[52:55], v4 offset:32768
buffer_load_dwordx4 v1, s[4:7], s31 offen offset:1024 sc1 lds
v_mul_f32 v36, v36, v44
v_exp_f32 v101, v101
s_waitcnt lgkmcnt(2)
v_mfma_f32_32x32x16_bf16 v[16:31], a[68:71], v[72:75], v[16:31]
ds_read_b128 v[56:59], v4 offset:50176
buffer_load_dwordx4 v[8:11], v147, s[4:7], s64 offen sc1
v_mul_f32 v37, v37, v45
v_exp_f32 v102, v102
v_mul_f32 v38, v38, v46
v_mfma_f32_32x32x16_bf16 v[16:31], a[96:99], v[76:79], v[16:31]
ds_read_b128 v[60:63], v5 offset:2048
buffer_load_dwordx4 v[196:199], v1, s[4:7], s29 offen offset:1024 sc1
v_exp_f32 v103, v103
v_mul_f32 v39, v39, v47
s_waitcnt lgkmcnt(2)
v_mfma_f32_32x32x16_bf16 v[16:31], a[16:19], v[48:51], v[16:31]
ds_read_b128 v[64:67], v4 offset:16384
buffer_load_dwordx4 v1, s[4:7], s31 offen offset:2048 sc1 lds
v_fma_f32 v96, v96, v126, v126
v_fma_f32 v97, v97, v126, v126
v_fma_f32 v98, v98, v126, v126
v_fma_f32 v99, v99, v126, v126
v_mfma_f32_32x32x16_bf16 v[16:31], a[44:47], v[52:55], v[16:31]
ds_read_b128 v[68:71], v4 offset:33792
v_fma_f32 v100, v100, v126, v126
v_fma_f32 v101, v101, v126, v126
v_fma_f32 v102, v102, v126, v126
v_fma_f32 v103, v103, v126, v126
s_waitcnt lgkmcnt(2)
v_mfma_f32_32x32x16_bf16 v[16:31], a[72:75], v[56:59], v[16:31]
ds_read_b128 v[72:75], v4 offset:51200
buffer_load_dwordx4 v[12:15], v147, s[4:7], s66 offen sc1
v_rcp_f32 v96, v96
v_rcp_f32 v97, v97
v_mfma_f32_32x32x16_bf16 v[16:31], a[100:103], v[60:63], v[16:31]
ds_read_b128 v[76:79], v5 offset:3072
buffer_load_dwordx4 v1, s[4:7], s31 offen offset:3072 sc1 lds
v_rcp_f32 v98, v98
v_mul_f32 v32, v32, v96
s_waitcnt lgkmcnt(2)
v_mfma_f32_32x32x16_bf16 v[16:31], a[20:23], v[64:67], v[16:31]
ds_read_b128 v[48:51], v4 offset:0
buffer_load_dwordx4 v[200:203], v1, s[4:7], s29 offen offset:2048 sc1
v_rcp_f32 v99, v99
v_mul_f32 v33, v33, v97
v_mfma_f32_32x32x16_bf16 v[16:31], a[48:51], v[68:71], v[16:31]
ds_read_b128 v[52:55], v4 offset:17408
buffer_load_dwordx4 v[204:207], v1, s[4:7], s29 offen offset:3072 sc1
v_rcp_f32 v100, v100
v_mul_f32 v34, v34, v98
s_waitcnt lgkmcnt(2)
v_mfma_f32_32x32x16_bf16 v[16:31], a[76:79], v[72:75], v[16:31]
ds_read_b128 v[56:59], v4 offset:34816
v_rcp_f32 v101, v101
v_mul_f32 v35, v35, v99
v_rcp_f32 v102, v102
v_mfma_f32_32x32x16_bf16 v[16:31], a[104:107], v[76:79], v[16:31]
s_waitcnt vmcnt(18)
s_barrier
ds_read_b128 v[60:63], v4 offset:52224
v_mul_f32 v36, v36, v100
v_rcp_f32 v103, v103
s_waitcnt lgkmcnt(2)
v_mfma_f32_32x32x16_bf16 v[16:31], a[24:27], v[48:51], v[16:31]
ds_read_b128 v[64:67], v4 offset:1024
s_add_u32 m0, s23, 12288
s_add_u32 s31, s22, 61440
buffer_load_dwordx4 v1, s[4:7], s31 offen offset:0 sc1 lds
v_mul_f32 v37, v37, v101
v_mul_f32 v38, v38, v102
v_mfma_f32_32x32x16_bf16 v[16:31], a[52:55], v[52:55], v[16:31]
ds_read_b128 v[68:71], v4 offset:18432
v_mul_f32 v39, v39, v103
v_cvt_pk_bf16_f32 v112, v32, v33
v_cvt_pk_bf16_f32 v113, v34, v35
v_cvt_pk_bf16_f32 v114, v36, v37
ds_read_b96 v[120:122], v6 offset:2048
s_waitcnt lgkmcnt(3)
v_mfma_f32_32x32x16_bf16 v[16:31], a[80:83], v[56:59], v[16:31]
ds_read_b128 v[72:75], v4 offset:35840
v_cvt_pk_bf16_f32 v115, v38, v39
buffer_store_dwordx4 v[112:115], v119, s[4:7], s26 offen sc1
s_sub_u32 s26, s26, 802816
v_mfma_f32_32x32x16_bf16 v[16:31], a[108:111], v[60:63], v[16:31]
ds_read_b128 v[76:79], v4 offset:53248
buffer_load_dwordx4 v1, s[4:7], s31 offen offset:1024 sc1 lds
s_waitcnt lgkmcnt(3)
v_mfma_f32_32x32x16_bf16 v[32:47], a[0:3], v[64:67], 0
ds_read_b128 v[48:51], v4 offset:2048
s_add_u32 s29, s30, 45056
buffer_load_dwordx4 v[208:211], v1, s[4:7], s29 offen offset:0 sc1
v_mfma_f32_32x32x16_bf16 v[32:47], a[28:31], v[68:71], v[32:47]
ds_read_b128 v[52:55], v4 offset:19456
s_waitcnt lgkmcnt(2)
v_mfma_f32_32x32x16_bf16 v[32:47], a[56:59], v[72:75], v[32:47]
ds_read_b128 v[56:59], v4 offset:36864
buffer_load_dwordx4 v1, s[4:7], s31 offen offset:2048 sc1 lds
v_fma_f32 v16, -v120, v80, v16
v_fma_f32 v17, -v120, v81, v17
v_fma_f32 v18, -v120, v82, v18
v_fma_f32 v19, -v120, v83, v19
v_mfma_f32_32x32x16_bf16 v[32:47], a[84:87], v[76:79], v[32:47]
ds_read_b128 v[60:63], v4 offset:54272
v_fma_f32 v20, -v120, v84, v20
v_fma_f32 v21, -v120, v85, v21
v_fma_f32 v22, -v120, v86, v22
v_fma_f32 v23, -v120, v87, v23
s_waitcnt lgkmcnt(2)
v_mfma_f32_32x32x16_bf16 v[32:47], a[4:7], v[48:51], v[32:47]
ds_read_b128 v[64:67], v4 offset:3072
v_fma_f32 v24, -v120, v88, v24
v_fma_f32 v25, -v120, v89, v25
v_fma_f32 v26, -v120, v90, v26
v_fma_f32 v27, -v120, v91, v27
v_fma_f32 v28, -v120, v92, v28
v_mfma_f32_32x32x16_bf16 v[32:47], a[32:35], v[52:55], v[32:47]
ds_read_b128 v[68:71], v4 offset:20480
buffer_load_dwordx4 v[212:215], v1, s[4:7], s29 offen offset:1024 sc1
v_fma_f32 v29, -v120, v93, v29
v_fma_f32 v30, -v120, v94, v30
v_fma_f32 v31, -v120, v95, v31
s_waitcnt lgkmcnt(2)
v_mfma_f32_32x32x16_bf16 v[32:47], a[60:63], v[56:59], v[32:47]
ds_read_b128 v[72:75], v4 offset:37888
v_mul_f32 v96, v16, v121
v_mul_f32 v97, v17, v121
v_mul_f32 v98, v18, v121
v_mul_f32 v99, v19, v121
v_mul_f32 v100, v20, v121
v_mfma_f32_32x32x16_bf16 v[32:47], a[88:91], v[60:63], v[32:47]
ds_read_b128 v[76:79], v4 offset:55296
v_mul_f32 v101, v21, v121
v_mul_f32 v102, v22, v121
v_mul_f32 v103, v23, v121
s_waitcnt lgkmcnt(2)
v_mfma_f32_32x32x16_bf16 v[32:47], a[8:11], v[64:67], v[32:47]
ds_read_b128 v[48:51], v4 offset:4096
v_exp_f32 v96, v96
v_mul_f32 v16, v16, v24
v_exp_f32 v97, v97
v_mfma_f32_32x32x16_bf16 v[32:47], a[36:39], v[68:71], v[32:47]
s_waitcnt vmcnt(4)
s_barrier
ds_read_b128 v[52:55], v4 offset:21504
v_mul_f32 v17, v17, v25
v_exp_f32 v98, v98
s_waitcnt lgkmcnt(2)
v_mfma_f32_32x32x16_bf16 v[32:47], a[64:67], v[72:75], v[32:47]
ds_read_b128 v[56:59], v4 offset:38912
s_add_u32 m0, s23, 15360
s_add_u32 s31, s22, 86016
buffer_load_dwordx4 v1, s[4:7], s31 offen offset:0 sc1 lds
v_mul_f32 v18, v18, v26
v_mfma_f32_32x32x16_bf16 v[32:47], a[92:95], v[76:79], v[32:47]
ds_read_b128 v[60:63], v4 offset:56320
s_add_u32 s3, s32, 4
v_bfrev_b32 v116, 1
v_mov_b32 v117, s3
v_writelane_b32 v116, s50, 0
buffer_store_dword v117, v116, s[4:7], s46 offen sc1
s_waitcnt lgkmcnt(2)
v_mfma_f32_32x32x16_bf16 v[32:47], a[12:15], v[48:51], v[32:47]
ds_read_b128 v[64:67], v4 offset:5120
v_exp_f32 v99, v99
v_mul_f32 v19, v19, v27
v_exp_f32 v100, v100
v_mfma_f32_32x32x16_bf16 v[32:47], a[40:43], v[52:55], v[32:47]
ds_read_b128 v[68:71], v4 offset:22528
buffer_load_dwordx4 v1, s[4:7], s31 offen offset:1024 sc1 lds
v_mul_f32 v20, v20, v28
v_exp_f32 v101, v101
s_waitcnt lgkmcnt(2)
v_mfma_f32_32x32x16_bf16 v[32:47], a[68:71], v[56:59], v[32:47]
ds_read_b128 v[72:75], v4 offset:39936
v_mul_f32 v21, v21, v29
v_exp_f32 v102, v102
v_mul_f32 v22, v22, v30
v_mfma_f32_32x32x16_bf16 v[32:47], a[96:99], v[60:63], v[32:47]
ds_read_b128 v[76:79], v4 offset:57344
v_exp_f32 v103, v103
v_mul_f32 v23, v23, v31
v_fma_f32 v96, v96, v122, v122
s_waitcnt lgkmcnt(2)
v_mfma_f32_32x32x16_bf16 v[32:47], a[16:19], v[64:67], v[32:47]
ds_read_b128 v[48:51], v4 offset:6144
s_add_u32 m0, s23, 0
s_add_u32 s31, s22, 88064
buffer_load_dwordx4 v1, s[4:7], s31 offen offset:0 sc1 lds
v_fma_f32 v97, v97, v122, v122
v_fma_f32 v98, v98, v122, v122
v_mfma_f32_32x32x16_bf16 v[32:47], a[44:47], v[68:71], v[32:47]
ds_read_b128 v[52:55], v4 offset:23552
v_fma_f32 v99, v99, v122, v122
v_fma_f32 v100, v100, v122, v122
v_fma_f32 v101, v101, v122, v122
v_fma_f32 v102, v102, v122, v122
s_waitcnt lgkmcnt(2)
v_mfma_f32_32x32x16_bf16 v[32:47], a[72:75], v[72:75], v[32:47]
ds_read_b128 v[56:59], v4 offset:40960
v_fma_f32 v103, v103, v122, v122
v_rcp_f32 v96, v96
v_rcp_f32 v97, v97
v_mfma_f32_32x32x16_bf16 v[32:47], a[100:103], v[76:79], v[32:47]
ds_read_b128 v[60:63], v4 offset:58368
buffer_load_dwordx4 v1, s[4:7], s31 offen offset:1024 sc1 lds
v_rcp_f32 v98, v98
v_mul_f32 v16, v16, v96
s_waitcnt lgkmcnt(2)
v_mfma_f32_32x32x16_bf16 v[32:47], a[20:23], v[48:51], v[32:47]
ds_read_b128 v[64:67], v4 offset:7168
v_rcp_f32 v99, v99
v_mul_f32 v17, v17, v97
v_rcp_f32 v100, v100
v_mfma_f32_32x32x16_bf16 v[32:47], a[48:51], v[52:55], v[32:47]
ds_read_b128 v[68:71], v4 offset:24576
v_mul_f32 v18, v18, v98
v_rcp_f32 v101, v101
v_mul_f32 v19, v19, v99
s_waitcnt lgkmcnt(2)
v_mfma_f32_32x32x16_bf16 v[32:47], a[76:79], v[56:59], v[32:47]
ds_read_b128 v[72:75], v4 offset:41984
v_rcp_f32 v102, v102
v_mul_f32 v20, v20, v100
v_rcp_f32 v103, v103
v_mfma_f32_32x32x16_bf16 v[32:47], a[104:107], v[60:63], v[32:47]
s_barrier
ds_read_b128 v[76:79], v4 offset:59392
v_mul_f32 v21, v21, v101
v_mul_f32 v22, v22, v102
v_mul_f32 v23, v23, v103
s_waitcnt lgkmcnt(2)
v_mfma_f32_32x32x16_bf16 v[32:47], a[24:27], v[64:67], v[32:47]
ds_read_b128 v[48:51], v4 offset:8192
s_add_u32 m0, s23, 2048
s_add_u32 s31, s22, 90112
buffer_load_dwordx4 v1, s[4:7], s31 offen offset:0 sc1 lds
v_lshlrev_b32 v172, 7, v0
buffer_load_dword v174, v172, s[4:7], s43 offen sc1
v_mfma_f32_32x32x16_bf16 v[32:47], a[52:55], v[68:71], v[32:47]
ds_read_b128 v[52:55], v4 offset:25600
v_cvt_pk_bf16_f32 v112, v16, v17
v_cvt_pk_bf16_f32 v113, v18, v19
v_cvt_pk_bf16_f32 v114, v20, v21
v_cvt_pk_bf16_f32 v115, v22, v23
ds_read_b96 v[124:126], v6 offset:2560
s_waitcnt lgkmcnt(3)
v_mfma_f32_32x32x16_bf16 v[32:47], a[80:83], v[72:75], v[32:47]
ds_read_b128 v[56:59], v4 offset:43008
buffer_store_dwordx4 v[112:115], v119, s[4:7], s26 offen sc1
s_add_u32 s26, s26, 114688
v_mfma_f32_32x32x16_bf16 v[32:47], a[108:111], v[76:79], v[32:47]
ds_read_b128 v[60:63], v4 offset:60416
buffer_load_dwordx4 v1, s[4:7], s31 offen offset:1024 sc1 lds
s_waitcnt lgkmcnt(3)
v_mfma_f32_32x32x16_bf16 v[16:31], a[0:3], v[48:51], 0
ds_read_b128 v[64:67], v4 offset:9216
v_mfma_f32_32x32x16_bf16 v[16:31], a[28:31], v[52:55], v[16:31]
ds_read_b128 v[68:71], v4 offset:26624
s_waitcnt lgkmcnt(2)
v_mfma_f32_32x32x16_bf16 v[16:31], a[56:59], v[56:59], v[16:31]
ds_read_b128 v[72:75], v4 offset:44032
buffer_load_dwordx4 v1, s[4:7], s31 offen offset:2048 sc1 lds
s_nop 0
v_fma_f32 v32, -v124, v80, v32
v_fma_f32 v33, -v124, v81, v33
v_fma_f32 v34, -v124, v82, v34
v_fma_f32 v35, -v124, v83, v35
v_mfma_f32_32x32x16_bf16 v[16:31], a[84:87], v[60:63], v[16:31]
ds_read_b128 v[76:79], v4 offset:61440
s_add_u32 s3, s32, 4
s_waitcnt vmcnt(3)
v_subrev_u32 v174, s3, v174
v_cmp_le_u32 vcc, 12, v174
s_nop 0
s_and_b64 vcc, vcc, s[48:49]
s_cbranch_scc0 L_chk_24_ok
s_mov_b32 s15, 0
L_chk_24:
buffer_load_dword v174, v172, s[4:7], s43 offen sc1
s_waitcnt vmcnt(0)
s_add_u32 s3, s32, 4
v_subrev_u32 v174, s3, v174
v_cmp_le_u32 vcc, 12, v174
s_nop 0
s_and_b64 vcc, vcc, s[48:49]
s_cbranch_scc0 L_chk_24_ok
s_add_u32 s15, s15, 1
s_cmp_lt_u32 s15, 131072
s_cbranch_scc1 L_chk_24
L_chk_24_ok:
s_waitcnt lgkmcnt(2)
v_mfma_f32_32x32x16_bf16 v[16:31], a[4:7], v[64:67], v[16:31]
ds_read_b128 v[48:51], v4 offset:10240
buffer_load_dwordx4 v[128:131], v1, s[4:7], s20 offen offset:0 sc1
v_fma_f32 v36, -v124, v84, v36
v_fma_f32 v37, -v124, v85, v37
v_fma_f32 v38, -v124, v86, v38
v_fma_f32 v39, -v124, v87, v39
v_mfma_f32_32x32x16_bf16 v[16:31], a[32:35], v[68:71], v[16:31]
ds_read_b128 v[52:55], v4 offset:27648
v_fma_f32 v40, -v124, v88, v40
v_fma_f32 v41, -v124, v89, v41
v_fma_f32 v42, -v124, v90, v42
v_fma_f32 v43, -v124, v91, v43
s_waitcnt lgkmcnt(2)
v_mfma_f32_32x32x16_bf16 v[16:31], a[60:63], v[72:75], v[16:31]
ds_read_b128 v[56:59], v4 offset:45056
buffer_load_dwordx4 v[132:135], v1, s[4:7], s68 offen offset:0 sc1
v_fma_f32 v44, -v124, v92, v44
v_fma_f32 v45, -v124, v93, v45
v_fma_f32 v46, -v124, v94, v46
v_fma_f32 v47, -v124, v95, v47
v_mfma_f32_32x32x16_bf16 v[16:31], a[88:91], v[76:79], v[16:31]
ds_read_b128 v[60:63], v4 offset:62464
v_mul_f32 v96, v32, v125
v_mul_f32 v97, v33, v125
v_mul_f32 v98, v34, v125
v_mul_f32 v99, v35, v125
s_waitcnt lgkmcnt(2)
v_mfma_f32_32x32x16_bf16 v[16:31], a[8:11], v[48:51], v[16:31]
ds_read_b128 v[64:67], v4 offset:11264
buffer_load_dwordx4 v[136:139], v1, s[4:7], s20 offen offset:1024 sc1
v_mul_f32 v100, v36, v125
v_mul_f32 v101, v37, v125
v_mul_f32 v102, v38, v125
v_mul_f32 v103, v39, v125
v_mfma_f32_32x32x16_bf16 v[16:31], a[36:39], v[52:55], v[16:31]
s_barrier
ds_read_b128 v[68:71], v4 offset:28672
v_exp_f32 v96, v96
v_mul_f32 v32, v32, v40
s_waitcnt lgkmcnt(2)
v_mfma_f32_32x32x16_bf16 v[16:31], a[64:67], v[56:59], v[16:31]
ds_read_b128 v[72:75], v4 offset:46080
buffer_load_dwordx4 v[140:143], v1, s[4:7], s68 offen offset:1024 sc1
v_exp_f32 v97, v97
v_mul_f32 v33, v33, v41
v_mfma_f32_32x32x16_bf16 v[16:31], a[92:95], v[60:63], v[16:31]
ds_read_b128 v[76:79], v4 offset:63488
v_exp_f32 v98, v98
v_mul_f32 v34, v34, v42
s_waitcnt lgkmcnt(2)
v_mfma_f32_32x32x16_bf16 v[16:31], a[12:15], v[64:67], v[16:31]
ds_read_b128 v[48:51], v4 offset:12288
buffer_load_dwordx4 v[144:147], v1, s[4:7], s20 offen offset:2048 sc1
v_exp_f32 v99, v99
v_mul_f32 v35, v35, v43
v_mfma_f32_32x32x16_bf16 v[16:31], a[40:43], v[68:71], v[16:31]
ds_read_b128 v[52:55], v4 offset:29696
v_exp_f32 v100, v100
v_mul_f32 v36, v36, v44
s_waitcnt lgkmcnt(2)
v_mfma_f32_32x32x16_bf16 v[16:31], a[68:71], v[72:75], v[16:31]
ds_read_b128 v[56:59], v4 offset:47104
buffer_load_dwordx4 v[148:151], v1, s[4:7], s68 offen offset:2048 sc1
v_exp_f32 v101, v101
v_mul_f32 v37, v37, v45
v_mfma_f32_32x32x16_bf16 v[16:31], a[96:99], v[76:79], v[16:31]
ds_read_b128 v[60:63], v4 offset:64512
v_exp_f32 v102, v102
v_mul_f32 v38, v38, v46
s_waitcnt lgkmcnt(2)
v_mfma_f32_32x32x16_bf16 v[16:31], a[16:19], v[48:51], v[16:31]
ds_read_b128 v[64:67], v4 offset:13312
buffer_load_dwordx4 v[152:155], v1, s[4:7], s20 offen offset:3072 sc1
v_exp_f32 v103, v103
v_mul_f32 v39, v39, v47
v_fma_f32 v96, v96, v126, v126
v_mfma_f32_32x32x16_bf16 v[16:31], a[44:47], v[52:55], v[16:31]
ds_read_b128 v[68:71], v4 offset:30720
v_fma_f32 v97, v97, v126, v126
v_fma_f32 v98, v98, v126, v126
v_fma_f32 v99, v99, v126, v126
v_fma_f32 v100, v100, v126, v126
s_waitcnt lgkmcnt(2)
v_mfma_f32_32x32x16_bf16 v[16:31], a[72:75], v[56:59], v[16:31]
ds_read_b128 v[72:75], v4 offset:48128
buffer_load_dwordx4 v[156:159], v1, s[4:7], s68 offen offset:3072 sc1
v_fma_f32 v101, v101, v126, v126
v_fma_f32 v102, v102, v126, v126
v_fma_f32 v103, v103, v126, v126
v_mfma_f32_32x32x16_bf16 v[16:31], a[100:103], v[60:63], v[16:31]
ds_read_b128 v[76:79], v5 offset:0
v_rcp_f32 v96, v96
v_rcp_f32 v97, v97
s_waitcnt lgkmcnt(2)
v_mfma_f32_32x32x16_bf16 v[16:31], a[20:23], v[64:67], v[16:31]
ds_read_b128 v[48:51], v4 offset:14336
s_add_u32 s20, s20, 4096
buffer_load_dwordx4 v[160:163], v1, s[4:7], s20 offen offset:0 sc1
v_rcp_f32 v98, v98
v_mul_f32 v32, v32, v96
v_mfma_f32_32x32x16_bf16 v[16:31], a[48:51], v[68:71], v[16:31]
ds_read_b128 v[52:55], v4 offset:31744
v_rcp_f32 v99, v99
v_mul_f32 v33, v33, v97
s_waitcnt lgkmcnt(2)
v_mfma_f32_32x32x16_bf16 v[16:31], a[76:79], v[72:75], v[16:31]
ds_read_b128 v[56:59], v4 offset:49152
s_add_u32 s68, s68, 4096
buffer_load_dwordx4 v[164:167], v1, s[4:7], s68 offen offset:0 sc1
v_rcp_f32 v100, v100
v_mul_f32 v34, v34, v98
v_mfma_f32_32x32x16_bf16 v[16:31], a[104:107], v[76:79], v[16:31]
s_barrier
ds_read_b128 v[60:63], v5 offset:1024
v_rcp_f32 v101, v101
v_mul_f32 v35, v35, v99
s_waitcnt lgkmcnt(2)
v_mfma_f32_32x32x16_bf16 v[16:31], a[24:27], v[48:51], v[16:31]
ds_read_b128 v[64:67], v4 offset:15360
buffer_load_dwordx4 v[168:171], v1, s[4:7], s20 offen offset:1024 sc1
v_rcp_f32 v102, v102
v_mul_f32 v36, v36, v100
v_mfma_f32_32x32x16_bf16 v[16:31], a[52:55], v[52:55], v[16:31]
ds_read_b128 v[68:71], v4 offset:32768
v_rcp_f32 v103, v103
v_mul_f32 v37, v37, v101
v_mul_f32 v38, v38, v102
ds_read_b96 v[120:122], v6 offset:3072
s_waitcnt lgkmcnt(3)
v_mfma_f32_32x32x16_bf16 v[16:31], a[80:83], v[56:59], v[16:31]
ds_read_b128 v[72:75], v4 offset:50176
buffer_load_dwordx4 v[172:175], v1, s[4:7], s68 offen offset:1024 sc1
v_mul_f32 v39, v39, v103
v_cvt_pk_bf16_f32 v112, v32, v33
v_cvt_pk_bf16_f32 v113, v34, v35
v_cvt_pk_bf16_f32 v114, v36, v37
v_mfma_f32_32x32x16_bf16 v[16:31], a[108:111], v[60:63], v[16:31]
ds_read_b128 v[76:79], v5 offset:2048
v_cvt_pk_bf16_f32 v115, v38, v39
buffer_store_dwordx4 v[112:115], v119, s[4:7], s26 offen sc1
s_add_u32 s26, s26, 114688
s_waitcnt lgkmcnt(3)
v_mfma_f32_32x32x16_bf16 v[32:47], a[0:3], v[64:67], 0
ds_read_b128 v[48:51], v4 offset:16384
s_add_u32 m0, s27, 7168
s_nop 0
buffer_load_dwordx4 v1, s[4:7], s20 offen offset:2048 sc1 lds
v_mfma_f32_32x32x16_bf16 v[32:47], a[28:31], v[68:71], v[32:47]
ds_read_b128 v[52:55], v4 offset:33792
s_waitcnt lgkmcnt(2)
v_mfma_f32_32x32x16_bf16 v[32:47], a[56:59], v[72:75], v[32:47]
ds_read_b128 v[56:59], v4 offset:51200
s_add_u32 m0, s27, 8192
s_nop 0
buffer_load_dwordx4 v1, s[4:7], s68 offen offset:2048 sc1 lds
v_fma_f32 v16, -v120, v80, v16
v_fma_f32 v17, -v120, v81, v17
v_fma_f32 v18, -v120, v82, v18
v_mfma_f32_32x32x16_bf16 v[32:47], a[84:87], v[76:79], v[32:47]
ds_read_b128 v[60:63], v5 offset:3072
v_fma_f32 v19, -v120, v83, v19
v_fma_f32 v20, -v120, v84, v20
v_fma_f32 v21, -v120, v85, v21
v_fma_f32 v22, -v120, v86, v22
s_waitcnt lgkmcnt(2)
v_mfma_f32_32x32x16_bf16 v[32:47], a[4:7], v[48:51], v[32:47]
ds_read_b128 v[64:67], v4 offset:0
s_add_u32 m0, s27, 8192
s_nop 0
buffer_load_dwordx4 v1, s[4:7], s20 offen offset:3072 sc1 lds
v_fma_f32 v23, -v120, v87, v23
v_fma_f32 v24, -v120, v88, v24
v_fma_f32 v25, -v120, v89, v25
v_mfma_f32_32x32x16_bf16 v[32:47], a[32:35], v[52:55], v[32:47]
ds_read_b128 v[68:71], v4 offset:17408
v_fma_f32 v26, -v120, v90, v26
v_fma_f32 v27, -v120, v91, v27
v_fma_f32 v28, -v120, v92, v28
v_fma_f32 v29, -v120, v93, v29
s_waitcnt lgkmcnt(2)
v_mfma_f32_32x32x16_bf16 v[32:47], a[60:63], v[56:59], v[32:47]
ds_read_b128 v[72:75], v4 offset:34816
s_add_u32 m0, s27, 9216
s_nop 0
buffer_load_dwordx4 v1, s[4:7], s68 offen offset:3072 sc1 lds
v_fma_f32 v30, -v120, v94, v30
v_fma_f32 v31, -v120, v95, v31
v_mul_f32 v96, v16, v121
v_mfma_f32_32x32x16_bf16 v[32:47], a[88:91], v[60:63], v[32:47]
ds_read_b128 v[76:79], v4 offset:52224
v_mul_f32 v97, v17, v121
v_mul_f32 v98, v18, v121
v_mul_f32 v99, v19, v121
v_mul_f32 v100, v20, v121
s_waitcnt lgkmcnt(2)
v_mfma_f32_32x32x16_bf16 v[32:47], a[8:11], v[64:67], v[32:47]
ds_read_b128 v[48:51], v4 offset:1024
s_add_u32 s20, s20, 4096
s_add_u32 m0, s27, 13312
s_nop 0
buffer_load_dwordx4 v1, s[4:7], s20 offen offset:0 sc1 lds
v_mul_f32 v101, v21, v121
v_mul_f32 v102, v22, v121
v_mfma_f32_32x32x16_bf16 v[32:47], a[36:39], v[68:71], v[32:47]
s_waitcnt vmcnt(18)
s_barrier
ds_read_b128 v[52:55], v4 offset:18432
v_mul_f32 v103, v23, v121
v_exp_f32 v96, v96
s_waitcnt lgkmcnt(2)
v_mfma_f32_32x32x16_bf16 v[32:47], a[64:67], v[72:75], v[32:47]
ds_read_b128 v[56:59], v4 offset:35840
s_add_u32 s68, s68, 4096
s_add_u32 m0, s27, 14336
s_nop 0
buffer_load_dwordx4 v1, s[4:7], s68 offen offset:0 sc1 lds
v_mul_f32 v16, v16, v24
v_mfma_f32_32x32x16_bf16 v[32:47], a[92:95], v[76:79], v[32:47]
ds_read_b128 v[60:63], v4 offset:53248
v_exp_f32 v97, v97
v_mul_f32 v17, v17, v25
s_waitcnt lgkmcnt(2)
v_mfma_f32_32x32x16_bf16 v[32:47], a[12:15], v[48:51], v[32:47]
ds_read_b128 v[64:67], v4 offset:2048
s_add_u32 m0, s27, 14336
s_nop 0
buffer_load_dwordx4 v1, s[4:7], s20 offen offset:1024 sc1 lds
v_exp_f32 v98, v98
v_mul_f32 v18, v18, v26
v_mfma_f32_32x32x16_bf16 v[32:47], a[40:43], v[52:55], v[32:47]
ds_read_b128 v[68:71], v4 offset:19456
v_exp_f32 v99, v99
v_mul_f32 v19, v19, v27
s_waitcnt lgkmcnt(2)
v_mfma_f32_32x32x16_bf16 v[32:47], a[68:71], v[56:59], v[32:47]
ds_read_b128 v[72:75], v4 offset:36864
s_add_u32 m0, s27, 15360
s_nop 0
buffer_load_dwordx4 v1, s[4:7], s68 offen offset:1024 sc1 lds
v_exp_f32 v100, v100
v_mul_f32 v20, v20, v28
v_mfma_f32_32x32x16_bf16 v[32:47], a[96:99], v[60:63], v[32:47]
ds_read_b128 v[76:79], v4 offset:54272
v_exp_f32 v101, v101
v_mul_f32 v21, v21, v29
s_waitcnt lgkmcnt(2)
v_mfma_f32_32x32x16_bf16 v[32:47], a[16:19], v[64:67], v[32:47]
ds_read_b128 v[48:51], v4 offset:3072
s_add_u32 m0, s27, 15360
s_nop 0
buffer_load_dwordx4 v1, s[4:7], s20 offen offset:2048 sc1 lds
v_exp_f32 v102, v102
v_mul_f32 v22, v22, v30
v_mfma_f32_32x32x16_bf16 v[32:47], a[44:47], v[68:71], v[32:47]
ds_read_b128 v[52:55], v4 offset:20480
v_exp_f32 v103, v103
v_mul_f32 v23, v23, v31
v_fma_f32 v96, v96, v122, v122
s_waitcnt lgkmcnt(2)
v_mfma_f32_32x32x16_bf16 v[32:47], a[72:75], v[72:75], v[32:47]
ds_read_b128 v[56:59], v4 offset:37888
s_add_u32 m0, s27, 16384
s_nop 0
buffer_load_dwordx4 v1, s[4:7], s68 offen offset:2048 sc1 lds
v_fma_f32 v97, v97, v122, v122
v_fma_f32 v98, v98, v122, v122
v_fma_f32 v99, v99, v122, v122
v_mfma_f32_32x32x16_bf16 v[32:47], a[100:103], v[76:79], v[32:47]
ds_read_b128 v[60:63], v4 offset:55296
v_fma_f32 v100, v100, v122, v122
v_fma_f32 v101, v101, v122, v122
v_fma_f32 v102, v102, v122, v122
v_fma_f32 v103, v103, v122, v122
s_waitcnt lgkmcnt(2)
v_mfma_f32_32x32x16_bf16 v[32:47], a[20:23], v[48:51], v[32:47]
ds_read_b128 v[64:67], v4 offset:4096
v_rcp_f32 v96, v96
v_rcp_f32 v97, v97
v_mfma_f32_32x32x16_bf16 v[32:47], a[48:51], v[52:55], v[32:47]
ds_read_b128 v[68:71], v4 offset:21504
v_rcp_f32 v98, v98
v_mul_f32 v16, v16, v96
s_waitcnt lgkmcnt(2)
v_mfma_f32_32x32x16_bf16 v[32:47], a[76:79], v[56:59], v[32:47]
ds_read_b128 v[72:75], v4 offset:38912
v_rcp_f32 v99, v99
v_mul_f32 v17, v17, v97
v_rcp_f32 v100, v100
v_mfma_f32_32x32x16_bf16 v[32:47], a[104:107], v[60:63], v[32:47]
ds_read_b128 v[76:79], v4 offset:56320
v_mul_f32 v18, v18, v98
v_rcp_f32 v101, v101
v_mul_f32 v19, v19, v99
s_waitcnt lgkmcnt(2)
v_mfma_f32_32x32x16_bf16 v[32:47], a[24:27], v[64:67], v[32:47]
v_rcp_f32 v102, v102
v_mul_f32 v20, v20, v100
v_rcp_f32 v103, v103
v_mul_f32 v21, v21, v101
v_mfma_f32_32x32x16_bf16 v[32:47], a[52:55], v[68:71], v[32:47]
v_mul_f32 v22, v22, v102
v_mul_f32 v23, v23, v103
v_cvt_pk_bf16_f32 v112, v16, v17
v_cvt_pk_bf16_f32 v113, v18, v19
v_cvt_pk_bf16_f32 v114, v20, v21
ds_read_b96 v[124:126], v6 offset:3584
s_waitcnt lgkmcnt(1)
v_mfma_f32_32x32x16_bf16 v[32:47], a[80:83], v[72:75], v[32:47]
v_cvt_pk_bf16_f32 v115, v22, v23
buffer_store_dwordx4 v[112:115], v119, s[4:7], s26 offen sc1
s_add_u32 s26, s26, 114688
v_mfma_f32_32x32x16_bf16 v[32:47], a[108:111], v[76:79], v[32:47]
s_waitcnt vmcnt(23)
v_mfma_f32_16x16x32_bf16 v[16:19], a[112:115], v[128:131], 0
buffer_load_dwordx4 v[216:219], v1, s[4:7], s29 offen offset:2048 sc1
v_mfma_f32_16x16x32_bf16 v[24:27], a[116:119], v[128:131], 0
v_mfma_f32_16x16x32_bf16 v[48:51], a[120:123], v[128:131], 0
v_mfma_f32_16x16x32_bf16 v[56:59], a[124:127], v[128:131], 0
s_waitcnt vmcnt(23)
v_mfma_f32_16x16x32_bf16 v[20:23], a[112:115], v[132:135], 0
s_waitcnt lgkmcnt(0)
s_nop 2
v_fma_f32 v32, -v124, v80, v32
v_fma_f32 v33, -v124, v81, v33
v_fma_f32 v34, -v124, v82, v34
v_fma_f32 v35, -v124, v83, v35
v_mfma_f32_16x16x32_bf16 v[28:31], a[116:119], v[132:135], 0
v_fma_f32 v36, -v124, v84, v36
v_fma_f32 v37, -v124, v85, v37
buffer_load_dwordx4 v[220:223], v1, s[4:7], s29 offen offset:3072 sc1
v_mfma_f32_16x16x32_bf16 v[52:55], a[120:123], v[132:135], 0
v_fma_f32 v38, -v124, v86, v38
v_fma_f32 v39, -v124, v87, v39
v_fma_f32 v40, -v124, v88, v40
v_mfma_f32_16x16x32_bf16 v[60:63], a[124:127], v[132:135], 0
v_fma_f32 v41, -v124, v89, v41
v_fma_f32 v42, -v124, v90, v42
v_fma_f32 v43, -v124, v91, v43
s_waitcnt vmcnt(23)
v_mfma_f32_16x16x32_bf16 v[16:19], a[128:131], v[136:139], v[16:19]
v_fma_f32 v44, -v124, v92, v44
v_fma_f32 v45, -v124, v93, v45
v_fma_f32 v46, -v124, v94, v46
v_fma_f32 v47, -v124, v95, v47
v_mfma_f32_16x16x32_bf16 v[24:27], a[132:135], v[136:139], v[24:27]
v_mul_f32 v96, v32, v125
v_mul_f32 v97, v33, v125
s_add_u32 s29, s30, 49152
buffer_load_dwordx4 v[224:227], v1, s[4:7], s29 offen offset:0 sc1
v_mfma_f32_16x16x32_bf16 v[48:51], a[136:139], v[136:139], v[48:51]
v_mul_f32 v98, v34, v125
v_mul_f32 v99, v35, v125
v_mul_f32 v100, v36, v125
v_mfma_f32_16x16x32_bf16 v[56:59], a[140:143], v[136:139], v[56:59]
v_mul_f32 v101, v37, v125
v_mul_f32 v102, v38, v125
v_mul_f32 v103, v39, v125
s_waitcnt vmcnt(23)
v_mfma_f32_16x16x32_bf16 v[20:23], a[128:131], v[140:143], v[20:23]
v_exp_f32 v96, v96
v_mul_f32 v32, v32, v40
v_mfma_f32_16x16x32_bf16 v[28:31], a[132:135], v[140:143], v[28:31]
v_exp_f32 v97, v97
v_mul_f32 v33, v33, v41
buffer_load_dwordx4 v[228:231], v1, s[4:7], s29 offen offset:1024 sc1
v_mfma_f32_16x16x32_bf16 v[52:55], a[136:139], v[140:143], v[52:55]
v_exp_f32 v98, v98
v_mul_f32 v34, v34, v42
v_mfma_f32_16x16x32_bf16 v[60:63], a[140:143], v[140:143], v[60:63]
v_exp_f32 v99, v99
v_mul_f32 v35, v35, v43
s_waitcnt vmcnt(23)
v_mfma_f32_16x16x32_bf16 v[16:19], a[144:147], v[144:147], v[16:19]
v_exp_f32 v100, v100
v_mul_f32 v36, v36, v44
v_mfma_f32_16x16x32_bf16 v[24:27], a[148:151], v[144:147], v[24:27]
v_exp_f32 v101, v101
v_mul_f32 v37, v37, v45
buffer_load_dwordx4 v[232:235], v1, s[4:7], s29 offen offset:2048 sc1
v_mfma_f32_16x16x32_bf16 v[48:51], a[152:155], v[144:147], v[48:51]
v_exp_f32 v102, v102
v_mul_f32 v38, v38, v46
v_mfma_f32_16x16x32_bf16 v[56:59], a[156:159], v[144:147], v[56:59]
v_exp_f32 v103, v103
v_mul_f32 v39, v39, v47
s_waitcnt vmcnt(23)
v_mfma_f32_16x16x32_bf16 v[20:23], a[144:147], v[148:151], v[20:23]
v_fma_f32 v96, v96, v126, v126
v_fma_f32 v97, v97, v126, v126
v_fma_f32 v98, v98, v126, v126
v_fma_f32 v99, v99, v126, v126
v_mfma_f32_16x16x32_bf16 v[28:31], a[148:151], v[148:151], v[28:31]
v_fma_f32 v100, v100, v126, v126
v_fma_f32 v101, v101, v126, v126
buffer_load_dwordx4 v[236:239], v1, s[4:7], s29 offen offset:3072 sc1
v_mfma_f32_16x16x32_bf16 v[52:55], a[152:155], v[148:151], v[52:55]
v_fma_f32 v102, v102, v126, v126
v_fma_f32 v103, v103, v126, v126
v_rcp_f32 v96, v96
v_mfma_f32_16x16x32_bf16 v[60:63], a[156:159], v[148:151], v[60:63]
v_rcp_f32 v97, v97
s_waitcnt vmcnt(23)
v_mfma_f32_16x16x32_bf16 v[16:19], a[160:163], v[152:155], v[16:19]
v_rcp_f32 v98, v98
v_mul_f32 v32, v32, v96
v_rcp_f32 v99, v99
v_mfma_f32_16x16x32_bf16 v[24:27], a[164:167], v[152:155], v[24:27]
v_mul_f32 v33, v33, v97
s_add_u32 s29, s30, 53248
buffer_load_dwordx4 v[240:243], v1, s[4:7], s29 offen offset:0 sc1
v_mfma_f32_16x16x32_bf16 v[48:51], a[168:171], v[152:155], v[48:51]
v_rcp_f32 v100, v100
v_mul_f32 v34, v34, v98
v_mfma_f32_16x16x32_bf16 v[56:59], a[172:175], v[152:155], v[56:59]
v_rcp_f32 v101, v101
v_mul_f32 v35, v35, v99
s_waitcnt vmcnt(23)
v_mfma_f32_16x16x32_bf16 v[20:23], a[160:163], v[156:159], v[20:23]
v_rcp_f32 v102, v102
v_mul_f32 v36, v36, v100
v_mfma_f32_16x16x32_bf16 v[28:31], a[164:167], v[156:159], v[28:31]
v_rcp_f32 v103, v103
v_mul_f32 v37, v37, v101
buffer_load_dwordx4 v[244:247], v1, s[4:7], s29 offen offset:1024 sc1
v_mfma_f32_16x16x32_bf16 v[52:55], a[168:171], v[156:159], v[52:55]
v_mul_f32 v38, v38, v102
v_mul_f32 v39, v39, v103
v_cvt_pk_bf16_f32 v112, v32, v33
v_mfma_f32_16x16x32_bf16 v[60:63], a[172:175], v[156:159], v[60:63]
v_cvt_pk_bf16_f32 v113, v34, v35
v_cvt_pk_bf16_f32 v114, v36, v37
v_cvt_pk_bf16_f32 v115, v38, v39
s_waitcnt vmcnt(23)
v_mfma_f32_16x16x32_bf16 v[16:19], a[176:179], v[160:163], v[16:19]
buffer_store_dwordx4 v[112:115], v119, s[4:7], s26 offen sc1
s_add_u32 s26, s26, 114688
v_mfma_f32_16x16x32_bf16 v[24:27], a[180:183], v[160:163], v[24:27]
v_add_u32 v47, s23, v1
buffer_load_dwordx4 v[248:251], v1, s[4:7], s29 offen offset:2048 sc1
v_mfma_f32_16x16x32_bf16 v[48:51], a[184:187], v[160:163], v[48:51]
v_add_u32 v4, s65, v1
v_xor_b32 v5, 128, v4
s_waitcnt vmcnt(20)
v_mfma_f32_16x16x32_bf16 v[56:59], a[188:191], v[160:163], v[56:59]
ds_read_b128 v[80:83], v47 offset:5120
buffer_load_dwordx4 v[120:123], v1, s[4:7], s20 offen offset:3072 sc1
v_mfma_f32_16x16x32_bf16 v[20:23], a[176:179], v[164:167], v[20:23]
s_waitcnt vmcnt(20)
ds_read_b128 v[84:87], v47 offset:6144
v_mfma_f32_16x16x32_bf16 v[28:31], a[180:183], v[164:167], v[28:31]
buffer_load_dwordx4 v[252:255], v1, s[4:7], s29 offen offset:3072 sc1
v_mfma_f32_16x16x32_bf16 v[52:55], a[184:187], v[164:167], v[52:55]
s_waitcnt vmcnt(20)
ds_read_b128 v[88:91], v47 offset:7168
v_mfma_f32_16x16x32_bf16 v[60:63], a[188:191], v[164:167], v[60:63]
buffer_load_dwordx4 v[124:127], v1, s[4:7], s68 offen offset:3072 sc1
v_mfma_f32_16x16x32_bf16 v[16:19], a[192:195], v[168:171], v[16:19]
s_waitcnt vmcnt(20)
ds_read_b128 v[92:95], v47 offset:8192
v_mfma_f32_16x16x32_bf16 v[24:27], a[196:199], v[168:171], v[24:27]
v_mfma_f32_16x16x32_bf16 v[48:51], a[200:203], v[168:171], v[48:51]
s_waitcnt vmcnt(19)
ds_read_b128 v[96:99], v47 offset:9216
s_add_u32 s20, s20, 4096
v_mfma_f32_16x16x32_bf16 v[56:59], a[204:207], v[168:171], v[56:59]
buffer_load_dwordx4 v[128:131], v1, s[4:7], s20 offen offset:0 sc1
v_mfma_f32_16x16x32_bf16 v[20:23], a[192:195], v[172:175], v[20:23]
s_waitcnt vmcnt(19)
ds_read_b128 v[100:103], v47 offset:10240
v_mfma_f32_16x16x32_bf16 v[28:31], a[196:199], v[172:175], v[28:31]
v_mfma_f32_16x16x32_bf16 v[52:55], a[200:203], v[172:175], v[52:55]
s_waitcnt vmcnt(18)
ds_read_b128 v[104:107], v47 offset:11264
s_add_u32 s68, s68, 4096
v_mfma_f32_16x16x32_bf16 v[60:63], a[204:207], v[172:175], v[60:63]
buffer_load_dwordx4 v[132:135], v1, s[4:7], s68 offen offset:0 sc1
s_waitcnt lgkmcnt(6)
v_mfma_f32_16x16x32_bf16 v[16:19], a[208:211], v[80:83], v[16:19]
s_waitcnt vmcnt(6)
s_barrier
s_add_u32 s3, s32, 5
v_bfrev_b32 v40, 1
v_mov_b32 v41, s3
v_mfma_f32_16x16x32_bf16 v[24:27], a[212:215], v[80:83], v[24:27]
v_writelane_b32 v40, s50, 0
buffer_store_dword v41, v40, s[4:7], s46 offen sc1
ds_read_b128 v[108:111], v47 offset:12288
v_mfma_f32_16x16x32_bf16 v[48:51], a[216:219], v[80:83], v[48:51]
ds_read_b128 v[112:115], v47 offset:13312
v_mfma_f32_16x16x32_bf16 v[56:59], a[220:223], v[80:83], v[56:59]
buffer_load_dwordx4 v[136:139], v1, s[4:7], s20 offen offset:1024 sc1
s_waitcnt lgkmcnt(7)
v_mfma_f32_16x16x32_bf16 v[20:23], a[208:211], v[84:87], v[20:23]
ds_read_b128 v[116:119], v47 offset:14336
v_mfma_f32_16x16x32_bf16 v[28:31], a[212:215], v[84:87], v[28:31]
v_mfma_f32_16x16x32_bf16 v[52:55], a[216:219], v[84:87], v[52:55]
buffer_load_dwordx4 v[140:143], v1, s[4:7], s68 offen offset:1024 sc1
v_mfma_f32_16x16x32_bf16 v[60:63], a[220:223], v[84:87], v[60:63]
s_waitcnt lgkmcnt(7)
v_mfma_f32_16x16x32_bf16 v[16:19], a[224:227], v[88:91], v[16:19]
v_mfma_f32_16x16x32_bf16 v[24:27], a[228:231], v[88:91], v[24:27]
v_mfma_f32_16x16x32_bf16 v[48:51], a[232:235], v[88:91], v[48:51]
v_mfma_f32_16x16x32_bf16 v[56:59], a[236:239], v[88:91], v[56:59]
s_waitcnt lgkmcnt(6)
v_mfma_f32_16x16x32_bf16 v[20:23], a[224:227], v[92:95], v[20:23]
v_mfma_f32_16x16x32_bf16 v[28:31], a[228:231], v[92:95], v[28:31]
v_mfma_f32_16x16x32_bf16 v[52:55], a[232:235], v[92:95], v[52:55]
v_mfma_f32_16x16x32_bf16 v[60:63], a[236:239], v[92:95], v[60:63]
s_waitcnt lgkmcnt(5)
v_mfma_f32_16x16x32_bf16 v[16:19], a[240:243], v[96:99], v[16:19]
v_mfma_f32_16x16x32_bf16 v[24:27], a[244:247], v[96:99], v[24:27]
v_mfma_f32_16x16x32_bf16 v[48:51], a[248:251], v[96:99], v[48:51]
v_mfma_f32_16x16x32_bf16 v[56:59], a[252:255], v[96:99], v[56:59]
s_waitcnt lgkmcnt(4)
v_mfma_f32_16x16x32_bf16 v[20:23], a[240:243], v[100:103], v[20:23]
v_lshlrev_b32 v42, 7, v0
v_mfma_f32_16x16x32_bf16 v[28:31], a[244:247], v[100:103], v[28:31]
buffer_load_dword v44, v42, s[4:7], s43 offen sc1
v_mfma_f32_16x16x32_bf16 v[52:55], a[248:251], v[100:103], v[52:55]
v_mfma_f32_16x16x32_bf16 v[60:63], a[252:255], v[100:103], v[60:63]
s_waitcnt lgkmcnt(3)
v_mfma_f32_16x16x32_bf16 v[16:19], v[176:179], v[104:107], v[16:19]
v_mfma_f32_16x16x32_bf16 v[24:27], v[180:183], v[104:107], v[24:27]
v_mfma_f32_16x16x32_bf16 v[48:51], v[184:187], v[104:107], v[48:51]
v_mfma_f32_16x16x32_bf16 v[56:59], v[188:191], v[104:107], v[56:59]
s_waitcnt lgkmcnt(2)
v_mfma_f32_16x16x32_bf16 v[20:23], v[176:179], v[108:111], v[20:23]
v_mfma_f32_16x16x32_bf16 v[28:31], v[180:183], v[108:111], v[28:31]
v_mfma_f32_16x16x32_bf16 v[52:55], v[184:187], v[108:111], v[52:55]
s_add_u32 s3, s32, 5
s_waitcnt vmcnt(0)
v_subrev_u32 v44, s3, v44
v_cmp_le_u32 vcc, 11, v44
s_nop 0
s_and_b64 vcc, vcc, s[48:49]
v_mfma_f32_16x16x32_bf16 v[60:63], v[188:191], v[108:111], v[60:63]
s_cbranch_scc0 L_chk_25_ok
s_mov_b32 s15, 0
L_chk_25:
buffer_load_dword v44, v42, s[4:7], s43 offen sc1
s_waitcnt vmcnt(0)
s_add_u32 s3, s32, 5
v_subrev_u32 v44, s3, v44
v_cmp_le_u32 vcc, 11, v44
s_nop 0
s_and_b64 vcc, vcc, s[48:49]
s_cbranch_scc0 L_chk_25_ok
s_add_u32 s15, s15, 1
s_cmp_lt_u32 s15, 131072
s_cbranch_scc1 L_chk_25
L_chk_25_ok:
s_waitcnt lgkmcnt(1)
v_mfma_f32_16x16x32_bf16 v[16:19], v[192:195], v[112:115], v[16:19]
buffer_load_dwordx4 v[144:147], v1, s[4:7], s21 offen offset:0 sc1
v_mfma_f32_16x16x32_bf16 v[24:27], v[196:199], v[112:115], v[24:27]
v_mfma_f32_16x16x32_bf16 v[48:51], v[200:203], v[112:115], v[48:51]
buffer_load_dwordx4 v[148:151], v1, s[4:7], s69 offen offset:0 sc1
v_mfma_f32_16x16x32_bf16 v[56:59], v[204:207], v[112:115], v[56:59]
s_waitcnt lgkmcnt(0)
v_mfma_f32_16x16x32_bf16 v[20:23], v[192:195], v[116:119], v[20:23]
buffer_load_dwordx4 v[152:155], v1, s[4:7], s21 offen offset:1024 sc1
v_mfma_f32_16x16x32_bf16 v[28:31], v[196:199], v[116:119], v[28:31]
v_mfma_f32_16x16x32_bf16 v[52:55], v[200:203], v[116:119], v[52:55]
buffer_load_dwordx4 v[156:159], v1, s[4:7], s69 offen offset:1024 sc1
v_mfma_f32_16x16x32_bf16 v[60:63], v[204:207], v[116:119], v[60:63]
v_mfma_f32_16x16x32_bf16 v[16:19], v[208:211], v[120:123], v[16:19]
buffer_load_dwordx4 v[160:163], v1, s[4:7], s21 offen offset:2048 sc1
v_mfma_f32_16x16x32_bf16 v[24:27], v[212:215], v[120:123], v[24:27]
v_mfma_f32_16x16x32_bf16 v[48:51], v[216:219], v[120:123], v[48:51]
buffer_load_dwordx4 v[164:167], v1, s[4:7], s69 offen offset:2048 sc1
v_mfma_f32_16x16x32_bf16 v[56:59], v[220:223], v[120:123], v[56:59]
v_mfma_f32_16x16x32_bf16 v[20:23], v[208:211], v[124:127], v[20:23]
buffer_load_dwordx4 v[168:171], v1, s[4:7], s21 offen offset:3072 sc1
v_mfma_f32_16x16x32_bf16 v[28:31], v[212:215], v[124:127], v[28:31]
v_mfma_f32_16x16x32_bf16 v[52:55], v[216:219], v[124:127], v[52:55]
buffer_load_dwordx4 v[172:175], v1, s[4:7], s69 offen offset:3072 sc1
v_mfma_f32_16x16x32_bf16 v[60:63], v[220:223], v[124:127], v[60:63]
v_mfma_f32_16x16x32_bf16 v[16:19], v[224:227], v[128:131], v[16:19]
s_add_u32 s21, s21, 4096
v_mfma_f32_16x16x32_bf16 v[24:27], v[228:231], v[128:131], v[24:27]
buffer_load_dwordx4 v[80:83], v1, s[4:7], s21 offen offset:0 sc1
v_mfma_f32_16x16x32_bf16 v[48:51], v[232:235], v[128:131], v[48:51]
s_add_u32 s69, s69, 4096
v_mfma_f32_16x16x32_bf16 v[56:59], v[236:239], v[128:131], v[56:59]
buffer_load_dwordx4 v[84:87], v1, s[4:7], s69 offen offset:0 sc1
v_mfma_f32_16x16x32_bf16 v[20:23], v[224:227], v[132:135], v[20:23]
buffer_load_dwordx4 v[88:91], v1, s[4:7], s21 offen offset:1024 sc1
v_mfma_f32_16x16x32_bf16 v[28:31], v[228:231], v[132:135], v[28:31]
v_mfma_f32_16x16x32_bf16 v[52:55], v[232:235], v[132:135], v[52:55]
buffer_load_dwordx4 v[92:95], v1, s[4:7], s69 offen offset:1024 sc1
v_mfma_f32_16x16x32_bf16 v[60:63], v[236:239], v[132:135], v[60:63]
v_mfma_f32_16x16x32_bf16 v[16:19], v[240:243], v[136:139], v[16:19]
buffer_load_dwordx4 v[96:99], v1, s[4:7], s21 offen offset:2048 sc1
v_mfma_f32_16x16x32_bf16 v[24:27], v[244:247], v[136:139], v[24:27]
v_mfma_f32_16x16x32_bf16 v[48:51], v[248:251], v[136:139], v[48:51]
buffer_load_dwordx4 v[100:103], v1, s[4:7], s69 offen offset:2048 sc1
v_mfma_f32_16x16x32_bf16 v[56:59], v[252:255], v[136:139], v[56:59]
v_mfma_f32_16x16x32_bf16 v[20:23], v[240:243], v[140:143], v[20:23]
buffer_load_dwordx4 v[104:107], v1, s[4:7], s21 offen offset:3072 sc1
v_mfma_f32_16x16x32_bf16 v[28:31], v[244:247], v[140:143], v[28:31]
v_mfma_f32_16x16x32_bf16 v[52:55], v[248:251], v[140:143], v[52:55]
buffer_load_dwordx4 v[108:111], v1, s[4:7], s69 offen offset:3072 sc1
v_mfma_f32_16x16x32_bf16 v[60:63], v[252:255], v[140:143], v[60:63]
s_waitcnt vmcnt(15)
v_mfma_f32_16x16x32_bf16 v[32:35], a[112:115], v[144:147], 0
v_mfma_f32_16x16x32_bf16 v[40:43], a[116:119], v[144:147], 0
v_mfma_f32_16x16x32_bf16 v[64:67], a[120:123], v[144:147], 0
s_add_u32 s21, s21, 4096
v_mfma_f32_16x16x32_bf16 v[72:75], a[124:127], v[144:147], 0
buffer_load_dwordx4 v[112:115], v1, s[4:7], s21 offen offset:0 sc1
s_waitcnt vmcnt(15)
v_mfma_f32_16x16x32_bf16 v[36:39], a[112:115], v[148:151], 0
ds_write_b128 v4, v[16:19] offset:0
v_mfma_f32_16x16x32_bf16 v[44:47], a[116:119], v[148:151], 0
v_mfma_f32_16x16x32_bf16 v[68:71], a[120:123], v[148:151], 0
s_add_u32 s69, s69, 4096
v_mfma_f32_16x16x32_bf16 v[76:79], a[124:127], v[148:151], 0
buffer_load_dwordx4 v[116:119], v1, s[4:7], s69 offen offset:0 sc1
s_waitcnt vmcnt(15)
v_mfma_f32_16x16x32_bf16 v[32:35], a[128:131], v[152:155], v[32:35]
ds_write_b128 v4, v[20:23] offset:1024
v_mfma_f32_16x16x32_bf16 v[40:43], a[132:135], v[152:155], v[40:43]
v_mfma_f32_16x16x32_bf16 v[64:67], a[136:139], v[152:155], v[64:67]
buffer_load_dwordx4 v[120:123], v1, s[4:7], s21 offen offset:1024 sc1
v_mfma_f32_16x16x32_bf16 v[72:75], a[140:143], v[152:155], v[72:75]
s_waitcnt vmcnt(15)
v_mfma_f32_16x16x32_bf16 v[36:39], a[128:131], v[156:159], v[36:39]
ds_write_b128 v5, v[24:27] offset:2048
v_mfma_f32_16x16x32_bf16 v[44:47], a[132:135], v[156:159], v[44:47]
v_mfma_f32_16x16x32_bf16 v[68:71], a[136:139], v[156:159], v[68:71]
buffer_load_dwordx4 v[124:127], v1, s[4:7], s69 offen offset:1024 sc1
v_mfma_f32_16x16x32_bf16 v[76:79], a[140:143], v[156:159], v[76:79]
s_waitcnt vmcnt(15)
v_mfma_f32_16x16x32_bf16 v[32:35], a[144:147], v[160:163], v[32:35]
ds_write_b128 v5, v[28:31] offset:3072
v_mfma_f32_16x16x32_bf16 v[40:43], a[148:151], v[160:163], v[40:43]
v_mfma_f32_16x16x32_bf16 v[64:67], a[152:155], v[160:163], v[64:67]
buffer_load_dwordx4 v[128:131], v1, s[4:7], s21 offen offset:2048 sc1
v_mfma_f32_16x16x32_bf16 v[72:75], a[156:159], v[160:163], v[72:75]
s_waitcnt vmcnt(15)
v_mfma_f32_16x16x32_bf16 v[36:39], a[144:147], v[164:167], v[36:39]
ds_write_b128 v4, v[48:51] offset:4096
v_mfma_f32_16x16x32_bf16 v[44:47], a[148:151], v[164:167], v[44:47]
v_mfma_f32_16x16x32_bf16 v[68:71], a[152:155], v[164:167], v[68:71]
buffer_load_dwordx4 v[132:135], v1, s[4:7], s69 offen offset:2048 sc1
v_mfma_f32_16x16x32_bf16 v[76:79], a[156:159], v[164:167], v[76:79]
s_waitcnt vmcnt(15)
v_mfma_f32_16x16x32_bf16 v[32:35], a[160:163], v[168:171], v[32:35]
ds_write_b128 v4, v[52:55] offset:5120
v_mfma_f32_16x16x32_bf16 v[40:43], a[164:167], v[168:171], v[40:43]
v_mfma_f32_16x16x32_bf16 v[64:67], a[168:171], v[168:171], v[64:67]
buffer_load_dwordx4 v[136:139], v1, s[4:7], s21 offen offset:3072 sc1
v_mfma_f32_16x16x32_bf16 v[72:75], a[172:175], v[168:171], v[72:75]
s_waitcnt vmcnt(15)
v_mfma_f32_16x16x32_bf16 v[36:39], a[160:163], v[172:175], v[36:39]
ds_write_b128 v5, v[56:59] offset:6144
v_mfma_f32_16x16x32_bf16 v[44:47], a[164:167], v[172:175], v[44:47]
v_mfma_f32_16x16x32_bf16 v[68:71], a[168:171], v[172:175], v[68:71]
buffer_load_dwordx4 v[140:143], v1, s[4:7], s69 offen offset:3072 sc1
v_mfma_f32_16x16x32_bf16 v[76:79], a[172:175], v[172:175], v[76:79]
s_waitcnt vmcnt(15)
v_mfma_f32_16x16x32_bf16 v[32:35], a[176:179], v[80:83], v[32:35]
ds_write_b128 v5, v[60:63] offset:7168
v_mfma_f32_16x16x32_bf16 v[40:43], a[180:183], v[80:83], v[40:43]
v_mfma_f32_16x16x32_bf16 v[64:67], a[184:187], v[80:83], v[64:67]
s_add_u32 s21, s21, 4096
v_mfma_f32_16x16x32_bf16 v[72:75], a[188:191], v[80:83], v[72:75]
buffer_load_dwordx4 v[144:147], v1, s[4:7], s21 offen offset:0 sc1
s_waitcnt vmcnt(15)
v_mfma_f32_16x16x32_bf16 v[36:39], a[176:179], v[84:87], v[36:39]
v_mfma_f32_16x16x32_bf16 v[44:47], a[180:183], v[84:87], v[44:47]
v_mfma_f32_16x16x32_bf16 v[68:71], a[184:187], v[84:87], v[68:71]
s_add_u32 s69, s69, 4096
v_mfma_f32_16x16x32_bf16 v[76:79], a[188:191], v[84:87], v[76:79]
buffer_load_dwordx4 v[148:151], v1, s[4:7], s69 offen offset:0 sc1
s_waitcnt vmcnt(15)
v_mfma_f32_16x16x32_bf16 v[32:35], a[192:195], v[88:91], v[32:35]
s_waitcnt lgkmcnt(0)
s_barrier
v_mfma_f32_16x16x32_bf16 v[40:43], a[196:199], v[88:91], v[40:43]
ds_read_b128 v[16:19], v2 offset:0
ds_read_b128 v[20:23], v2 offset:512
v_mfma_f32_16x16x32_bf16 v[64:67], a[200:203], v[88:91], v[64:67]
buffer_load_dwordx4 v[152:155], v1, s[4:7], s21 offen offset:1024 sc1
ds_read_b128 v[24:27], v2 offset:8192
v_mfma_f32_16x16x32_bf16 v[72:75], a[204:207], v[88:91], v[72:75]
ds_read_b128 v[28:31], v2 offset:8704
s_waitcnt vmcnt(15)
v_mfma_f32_16x16x32_bf16 v[36:39], a[192:195], v[92:95], v[36:39]
ds_read_b128 v[48:51], v2 offset:16384
v_mfma_f32_16x16x32_bf16 v[44:47], a[196:199], v[92:95], v[44:47]
ds_read_b128 v[52:55], v2 offset:16896
v_mfma_f32_16x16x32_bf16 v[68:71], a[200:203], v[92:95], v[68:71]
buffer_load_dwordx4 v[156:159], v1, s[4:7], s69 offen offset:1024 sc1
ds_read_b128 v[56:59], v2 offset:24576
v_mfma_f32_16x16x32_bf16 v[76:79], a[204:207], v[92:95], v[76:79]
ds_read_b128 v[60:63], v2 offset:25088
s_waitcnt vmcnt(15)
v_mfma_f32_16x16x32_bf16 v[32:35], a[208:211], v[96:99], v[32:35]
v_mfma_f32_16x16x32_bf16 v[40:43], a[212:215], v[96:99], v[40:43]
v_mfma_f32_16x16x32_bf16 v[64:67], a[216:219], v[96:99], v[64:67]
s_waitcnt lgkmcnt(5)
v_add_f32 v24, v24, v16
v_add_f32 v25, v25, v17
v_mfma_f32_16x16x32_bf16 v[72:75], a[220:223], v[96:99], v[72:75]
v_add_f32 v26, v26, v18
v_add_f32 v27, v27, v19
s_waitcnt vmcnt(14)
v_mfma_f32_16x16x32_bf16 v[36:39], a[208:211], v[100:103], v[36:39]
s_waitcnt lgkmcnt(4)
v_add_f32 v28, v28, v20
v_add_f32 v29, v29, v21
v_mfma_f32_16x16x32_bf16 v[44:47], a[212:215], v[100:103], v[44:47]
v_add_f32 v30, v30, v22
v_add_f32 v31, v31, v23
v_mfma_f32_16x16x32_bf16 v[68:71], a[216:219], v[100:103], v[68:71]
v_lshlrev_b32 v16, 16, v8
v_and_b32 v17, 0xffff0000, v8
v_mfma_f32_16x16x32_bf16 v[76:79], a[220:223], v[100:103], v[76:79]
v_lshlrev_b32 v18, 16, v9
v_and_b32 v19, 0xffff0000, v9
s_waitcnt vmcnt(13)
v_mfma_f32_16x16x32_bf16 v[32:35], a[224:227], v[104:107], v[32:35]
v_lshlrev_b32 v20, 16, v10
v_and_b32 v21, 0xffff0000, v10
v_mfma_f32_16x16x32_bf16 v[40:43], a[228:231], v[104:107], v[40:43]
v_lshlrev_b32 v22, 16, v11
v_and_b32 v23, 0xffff0000, v11
v_mfma_f32_16x16x32_bf16 v[64:67], a[232:235], v[104:107], v[64:67]
v_add_f32 v24, v24, v16
v_add_f32 v25, v25, v17
v_mfma_f32_16x16x32_bf16 v[72:75], a[236:239], v[104:107], v[72:75]
v_add_f32 v26, v26, v18
v_add_f32 v27, v27, v19
s_waitcnt vmcnt(12)
v_mfma_f32_16x16x32_bf16 v[36:39], a[224:227], v[108:111], v[36:39]
v_add_f32 v28, v28, v20
v_add_f32 v29, v29, v21
v_mfma_f32_16x16x32_bf16 v[44:47], a[228:231], v[108:111], v[44:47]
v_add_f32 v30, v30, v22
v_add_f32 v31, v31, v23
v_mfma_f32_16x16x32_bf16 v[68:71], a[232:235], v[108:111], v[68:71]
s_waitcnt lgkmcnt(1)
v_add_f32 v48, v48, v56
v_add_f32 v49, v49, v57
v_mfma_f32_16x16x32_bf16 v[76:79], a[236:239], v[108:111], v[76:79]
v_add_f32 v50, v50, v58
v_add_f32 v51, v51, v59
s_waitcnt vmcnt(11)
v_mfma_f32_16x16x32_bf16 v[32:35], a[240:243], v[112:115], v[32:35]
s_waitcnt lgkmcnt(0)
v_add_f32 v52, v52, v60
v_add_f32 v53, v53, v61
v_mfma_f32_16x16x32_bf16 v[40:43], a[244:247], v[112:115], v[40:43]
v_add_f32 v54, v54, v62
v_add_f32 v55, v55, v63
v_mfma_f32_16x16x32_bf16 v[64:67], a[248:251], v[112:115], v[64:67]
v_add_f32 v24, v24, v48
v_add_f32 v25, v25, v49
v_mfma_f32_16x16x32_bf16 v[72:75], a[252:255], v[112:115], v[72:75]
v_add_f32 v26, v26, v50
v_add_f32 v27, v27, v51
s_waitcnt vmcnt(10)
v_mfma_f32_16x16x32_bf16 v[36:39], a[240:243], v[116:119], v[36:39]
v_add_f32 v28, v28, v52
v_add_f32 v29, v29, v53
v_mfma_f32_16x16x32_bf16 v[44:47], a[244:247], v[116:119], v[44:47]
v_add_f32 v30, v30, v54
v_add_f32 v31, v31, v55
v_mfma_f32_16x16x32_bf16 v[68:71], a[248:251], v[116:119], v[68:71]
v_cvt_pk_bf16_f32 v8, v24, v25
v_cvt_pk_bf16_f32 v9, v26, v27
v_mfma_f32_16x16x32_bf16 v[76:79], a[252:255], v[116:119], v[76:79]
v_cvt_pk_bf16_f32 v10, v28, v29
v_cvt_pk_bf16_f32 v11, v30, v31
s_waitcnt vmcnt(9)
v_mfma_f32_16x16x32_bf16 v[32:35], v[176:179], v[120:123], v[32:35]
buffer_store_dwordx4 v[8:11], v3, s[4:7], s18 offen sc1
v_add_f32 v16, v24, v25
v_mfma_f32_16x16x32_bf16 v[40:43], v[180:183], v[120:123], v[40:43]
v_mul_f32 v17, v24, v24
v_add_f32 v18, v26, v27
v_mfma_f32_16x16x32_bf16 v[64:67], v[184:187], v[120:123], v[64:67]
v_mul_f32 v19, v25, v25
v_fmac_f32 v17, v26, v26
v_mfma_f32_16x16x32_bf16 v[72:75], v[188:191], v[120:123], v[72:75]
v_fmac_f32 v19, v27, v27
v_add_f32 v16, v16, v28
s_waitcnt vmcnt(9)
v_mfma_f32_16x16x32_bf16 v[36:39], v[176:179], v[124:127], v[36:39]
v_fmac_f32 v17, v28, v28
v_add_f32 v18, v18, v29
v_mfma_f32_16x16x32_bf16 v[44:47], v[180:183], v[124:127], v[44:47]
v_fmac_f32 v19, v29, v29
v_add_f32 v16, v16, v30
v_mfma_f32_16x16x32_bf16 v[68:71], v[184:187], v[124:127], v[68:71]
v_fmac_f32 v17, v30, v30
v_add_f32 v18, v18, v31
v_mfma_f32_16x16x32_bf16 v[76:79], v[188:191], v[124:127], v[76:79]
v_fmac_f32 v19, v31, v31
v_add_f32 v16, v16, v18
s_waitcnt vmcnt(8)
v_mfma_f32_16x16x32_bf16 v[32:35], v[192:195], v[128:131], v[32:35]
v_add_f32 v17, v17, v19
s_nop 1
v_permlane32_swap_b32 v16, v17
v_mfma_f32_16x16x32_bf16 v[40:43], v[196:199], v[128:131], v[40:43]
v_add_f32 v16, v16, v17
v_mov_b32 v17, v16
v_mfma_f32_16x16x32_bf16 v[64:67], v[200:203], v[128:131], v[64:67]
s_nop 0
v_permlane16_swap_b32 v16, v17
v_add_f32 v16, v16, v17
v_mfma_f32_16x16x32_bf16 v[72:75], v[204:207], v[128:131], v[72:75]
s_nop 0
v_add_f32_dpp v17, v16, v16 row_ror:8 row_mask:0xf bank_mask:0xf
buffer_store_dword v17, v7, s[4:7], s19 offen sc1
s_waitcnt vmcnt(8)
v_mfma_f32_16x16x32_bf16 v[36:39], v[192:195], v[132:135], v[36:39]
v_mfma_f32_16x16x32_bf16 v[44:47], v[196:199], v[132:135], v[44:47]
v_mfma_f32_16x16x32_bf16 v[68:71], v[200:203], v[132:135], v[68:71]
v_mfma_f32_16x16x32_bf16 v[76:79], v[204:207], v[132:135], v[76:79]
s_waitcnt vmcnt(7)
v_mfma_f32_16x16x32_bf16 v[32:35], v[208:211], v[136:139], v[32:35]
v_mfma_f32_16x16x32_bf16 v[40:43], v[212:215], v[136:139], v[40:43]
s_waitcnt vmcnt(6)
v_mfma_f32_16x16x32_bf16 v[36:39], v[208:211], v[140:143], v[36:39]
v_mfma_f32_16x16x32_bf16 v[44:47], v[212:215], v[140:143], v[44:47]
s_waitcnt vmcnt(5)
v_mfma_f32_16x16x32_bf16 v[32:35], v[224:227], v[144:147], v[32:35]
v_mfma_f32_16x16x32_bf16 v[40:43], v[228:231], v[144:147], v[40:43]
s_waitcnt vmcnt(4)
v_mfma_f32_16x16x32_bf16 v[36:39], v[224:227], v[148:151], v[36:39]
v_mfma_f32_16x16x32_bf16 v[44:47], v[228:231], v[148:151], v[44:47]
s_waitcnt vmcnt(3)
v_mfma_f32_16x16x32_bf16 v[32:35], v[240:243], v[152:155], v[32:35]
v_mfma_f32_16x16x32_bf16 v[40:43], v[244:247], v[152:155], v[40:43]
s_waitcnt vmcnt(2)
v_mfma_f32_16x16x32_bf16 v[36:39], v[240:243], v[156:159], v[36:39]
v_mfma_f32_16x16x32_bf16 v[44:47], v[244:247], v[156:159], v[44:47]
v_mfma_f32_16x16x32_bf16 v[64:67], v[216:219], v[136:139], v[64:67]
v_mfma_f32_16x16x32_bf16 v[72:75], v[220:223], v[136:139], v[72:75]
v_mfma_f32_16x16x32_bf16 v[68:71], v[216:219], v[140:143], v[68:71]
v_mfma_f32_16x16x32_bf16 v[76:79], v[220:223], v[140:143], v[76:79]
v_mfma_f32_16x16x32_bf16 v[64:67], v[232:235], v[144:147], v[64:67]
ds_write_b128 v4, v[32:35] offset:32768
v_mfma_f32_16x16x32_bf16 v[72:75], v[236:239], v[144:147], v[72:75]
v_mfma_f32_16x16x32_bf16 v[68:71], v[232:235], v[148:151], v[68:71]
ds_write_b128 v4, v[36:39] offset:33792
v_mfma_f32_16x16x32_bf16 v[76:79], v[236:239], v[148:151], v[76:79]
v_mfma_f32_16x16x32_bf16 v[64:67], v[248:251], v[152:155], v[64:67]
ds_write_b128 v5, v[40:43] offset:34816
v_mfma_f32_16x16x32_bf16 v[72:75], v[252:255], v[152:155], v[72:75]
v_mfma_f32_16x16x32_bf16 v[68:71], v[248:251], v[156:159], v[68:71]
ds_write_b128 v5, v[44:47] offset:35840
v_mfma_f32_16x16x32_bf16 v[76:79], v[252:255], v[156:159], v[76:79]
v_lshlrev_b32 v128, 16, v12
v_and_b32 v129, 0xffff0000, v12
v_lshlrev_b32 v130, 16, v13
v_and_b32 v131, 0xffff0000, v13
v_lshlrev_b32 v132, 16, v14
v_and_b32 v133, 0xffff0000, v14
v_lshlrev_b32 v134, 16, v15
v_and_b32 v135, 0xffff0000, v15
ds_write_b128 v4, v[64:67] offset:36864
ds_write_b128 v4, v[68:71] offset:37888
ds_write_b128 v5, v[72:75] offset:38912
ds_write_b128 v5, v[76:79] offset:39936
s_waitcnt vmcnt(0)
s_waitcnt lgkmcnt(0)
s_barrier
ds_read_b128 v[32:35], v2 offset:32768
ds_read_b128 v[36:39], v2 offset:33280
ds_read_b128 v[40:43], v2 offset:40960
ds_read_b128 v[44:47], v2 offset:41472
ds_read_b128 v[64:67], v2 offset:49152
ds_read_b128 v[68:71], v2 offset:49664
ds_read_b128 v[72:75], v2 offset:57344
ds_read_b128 v[76:79], v2 offset:57856
v_bfrev_b32 v136, 1
v_writelane_b32 v136, s50, 0
v_mov_b32 v137, s33
s_cmp_eq_u32 s41, 3
s_cselect_b32 s16, s51, 0x40000000
buffer_store_dword v137, v136, s[4:7], s16 offen sc1
s_waitcnt lgkmcnt(7)
v_add_f32 v128, v128, v32
v_add_f32 v129, v129, v33
v_add_f32 v130, v130, v34
v_add_f32 v131, v131, v35
s_waitcnt lgkmcnt(6)
v_add_f32 v132, v132, v36
v_add_f32 v133, v133, v37
v_add_f32 v134, v134, v38
v_add_f32 v135, v135, v39
s_waitcnt lgkmcnt(5)
v_add_f32 v128, v128, v40
v_add_f32 v129, v129, v41
v_add_f32 v130, v130, v42
v_add_f32 v131, v131, v43
s_waitcnt lgkmcnt(4)
v_add_f32 v132, v132, v44
v_add_f32 v133, v133, v45
v_add_f32 v134, v134, v46
v_add_f32 v135, v135, v47
s_waitcnt lgkmcnt(1)
v_add_f32 v64, v64, v72
v_add_f32 v65, v65, v73
v_add_f32 v66, v66, v74
v_add_f32 v67, v67, v75
s_waitcnt lgkmcnt(0)
v_add_f32 v68, v68, v76
v_add_f32 v69, v69, v77
v_add_f32 v70, v70, v78
v_add_f32 v71, v71, v79
v_add_f32 v128, v128, v64
v_add_f32 v129, v129, v65
v_add_f32 v130, v130, v66
v_add_f32 v131, v131, v67
v_add_f32 v132, v132, v68
v_add_f32 v133, v133, v69
v_add_f32 v134, v134, v70
v_add_f32 v135, v135, v71
v_cvt_pk_bf16_f32 v12, v128, v129
v_cvt_pk_bf16_f32 v13, v130, v131
v_cvt_pk_bf16_f32 v14, v132, v133
v_cvt_pk_bf16_f32 v15, v134, v135
s_sub_u32 s18, s18, 114688
buffer_store_dwordx4 v[12:15], v3, s[4:7], s18 offen sc1
v_add_f32 v32, v128, v129
v_mul_f32 v33, v128, v128
v_add_f32 v34, v130, v131
v_mul_f32 v35, v129, v129
v_fmac_f32 v33, v130, v130
v_fmac_f32 v35, v131, v131
v_add_f32 v32, v32, v132
v_fmac_f32 v33, v132, v132
v_add_f32 v34, v34, v133
v_fmac_f32 v35, v133, v133
v_add_f32 v32, v32, v134
v_fmac_f32 v33, v134, v134
v_add_f32 v34, v34, v135
v_fmac_f32 v35, v135, v135
v_add_f32 v32, v32, v34
v_add_f32 v33, v33, v35
s_sub_u32 s19, s19, 8192
s_nop 0
v_permlane32_swap_b32 v32, v33
v_add_f32 v32, v32, v33
v_mov_b32 v33, v32
s_nop 1
v_permlane16_swap_b32 v32, v33
v_add_f32 v32, v32, v33
s_nop 1
v_add_f32_dpp v33, v32, v32 row_ror:8 row_mask:0xf bank_mask:0xf
buffer_store_dword v33, v7, s[4:7], s19 offen sc1
s_lshl_b32 s29, s12, 12
s_add_u32 s29, s29, 16878208
v_min_u32 v138, 6, v0
v_lshlrev_b32 v138, 7, v138
buffer_load_dword v140, v138, s[4:7], s29 offen sc1
s_lshl_b32 s20, s12, 4
s_lshr_b32 s16, s13, 4
s_lshl_b32 s16, s16, 3
s_add_u32 s20, s20, s16
s_lshl_b32 s16, s14, 1
s_add_u32 s20, s20, s16
s_and_b32 s16, s20, 63
s_cmp_eq_u32 s16, 0
s_cselect_b32 s21, 0, 1
s_sub_u32 s22, s20, s21
s_sub_u32 s17, s20, s14
s_sub_u32 s17, s17, 1
s_mul_i32 s24, s17, 14336
s_add_u32 s24, s24, 3440640
s_add_u32 s25, s24, 57344
s_mul_i32 s16, s14, 13312
s_sub_u32 s23, s25, s16
s_add_u32 s23, s23, 57344
s_cmp_lt_u32 s14, 2
s_cselect_b32 s23, s23, 0x40000000
s_xor_b32 s16, s21, 1
s_mul_i32 s16, s16, 14336
s_add_u32 s24, s24, s16
s_lshl_b32 s22, s14, 11
s_add_u32 s22, s22, 86016
s_lshl_b32 s19, s14, 10
s_add_u32 s19, s19, 102400
s_lshl_b32 s16, s14, 12
s_add_u32 s16, s16, 86016
v_add_u32 v152, s16, v1
s_lshl_b32 s27, s20, 10
s_add_u32 s27, s27, 16678912
s_lshl_b32 s16, s21, 11
s_sub_u32 s26, s27, s16
v_cmp_gt_u32 vcc, 48, v0
v_bfrev_b32 v207, 1
s_nop 0
v_cndmask_b32 v207, v207, v1, vcc
s_mul_i32 s18, s42, 28
s_lshl_b32 s16, s40, 1
s_add_u32 s18, s18, s16
s_lshr_b32 s16, s14, 1
s_add_u32 s18, s18, s16
s_lshl_b32 s18, s18, 10
s_and_b32 s16, s14, 1
s_lshl_b32 s16, s16, 9
s_add_u32 s18, s18, s16
s_add_u32 s18, s18, 3440640
v_and_b32 v153, 31, v0
v_lshlrev_b32 v153, 4, v153
v_lshrrev_b32 v154, 5, v0
v_lshl_add_u32 v153, v154, 3, v153
s_lshl_b32 s28, s20, 14
s_and_b32 s17, s13, 15
s_lshl_b32 s17, s17, 10
s_add_u32 s28, s28, s17
s_add_u32 s28, s28, 5275648
s_waitcnt vmcnt(1)
s_barrier
s_add_u32 s3, s32, 6
v_bfrev_b32 v76, 1
v_mov_b32 v77, s3
v_writelane_b32 v76, s50, 0
buffer_store_dword v77, v76, s[4:7], s46 offen sc1
s_branch interleave_layers__sliding_local_dilated__glu_gated_swiglu__prompt_kernel_jG
interleave_layers__sliding_local_dilated__glu_gated_swiglu__prompt_kernel_h0G:
s_cmp_lg_u32 s2, 255
s_cbranch_scc1 interleave_layers__sliding_local_dilated__glu_gated_swiglu__prompt_kernel_h1G
s_lshl_b32 s16, s14, 13
s_add_u32 s16, s16, 16846848
v_lshlrev_b32 v16, 7, v0
s_mov_b64 s[18:19], -1
s_mov_b32 s15, 0
L_epG:
buffer_load_dword v18, v16, s[4:7], s16 offen sc1
s_waitcnt vmcnt(0)
s_add_u32 s3, s33, 0
v_subrev_u32 v18, s3, v18
v_cmp_le_u32 vcc, 16, v18
s_nop 0
s_and_b64 vcc, vcc, s[18:19]
s_cbranch_scc0 L_epG_ok
s_add_u32 s15, s15, 1
s_cmp_lt_u32 s15, 131072
s_cbranch_scc1 L_epG
L_epG_ok:
s_barrier
s_mov_b32 s16, 17043456
v_bfrev_b32 v16, 1
v_mov_b32 v17, s33
v_writelane_b32 v16, s50, 0
buffer_store_dword v17, v16, s[4:7], s16 offen sc1
interleave_layers__sliding_local_dilated__glu_gated_swiglu__prompt_kernel_h1G:
s_lshl_b32 s20, s12, 4
s_lshr_b32 s16, s13, 4
s_lshl_b32 s16, s16, 3
s_add_u32 s20, s20, s16
s_lshl_b32 s16, s14, 1
s_add_u32 s20, s20, s16
s_and_b32 s16, s20, 63
s_cmp_eq_u32 s16, 0
s_cselect_b32 s21, 0, 1
s_sub_u32 s22, s20, s21
s_sub_u32 s17, s20, s14
s_sub_u32 s17, s17, 1
s_mul_i32 s24, s17, 14336
s_add_u32 s24, s24, 3440640
s_add_u32 s25, s24, 57344
s_mul_i32 s16, s14, 13312
s_sub_u32 s23, s25, s16
s_add_u32 s23, s23, 57344
s_cmp_lt_u32 s14, 2
s_cselect_b32 s23, s23, 0x40000000
s_xor_b32 s16, s21, 1
s_mul_i32 s16, s16, 14336
s_add_u32 s24, s24, s16
s_lshl_b32 s22, s14, 11
s_add_u32 s22, s22, 86016
s_lshl_b32 s19, s14, 10
s_add_u32 s19, s19, 102400
s_lshl_b32 s16, s14, 12
s_add_u32 s16, s16, 86016
v_add_u32 v152, s16, v1
s_lshl_b32 s27, s20, 10
s_add_u32 s27, s27, 16678912
s_lshl_b32 s16, s21, 11
s_sub_u32 s26, s27, s16
v_cmp_gt_u32 vcc, 48, v0
v_bfrev_b32 v207, 1
s_nop 0
v_cndmask_b32 v207, v207, v1, vcc
s_mul_i32 s18, s42, 28
s_lshl_b32 s16, s40, 1
s_add_u32 s18, s18, s16
s_lshr_b32 s16, s14, 1
s_add_u32 s18, s18, s16
s_lshl_b32 s18, s18, 10
s_and_b32 s16, s14, 1
s_lshl_b32 s16, s16, 9
s_add_u32 s18, s18, s16
s_add_u32 s18, s18, 3440640
v_and_b32 v153, 31, v0
v_lshlrev_b32 v153, 4, v153
v_lshrrev_b32 v154, 5, v0
v_lshl_add_u32 v153, v154, 3, v153
s_lshl_b32 s28, s20, 14
s_and_b32 s17, s13, 15
s_lshl_b32 s17, s17, 10
s_add_u32 s28, s28, s17
s_add_u32 s28, s28, 5275648
s_cmp_lg_u32 s14, 0
s_cbranch_scc1 L_hs_27_ok
v_lshlrev_b32 v72, 7, v0
s_mov_b32 s15, 0
L_hs_27:
s_sleep 32
buffer_load_dword v74, v72, s[4:7], s43 offen sc1
s_waitcnt vmcnt(0)
s_add_u32 s3, s32, 5
v_subrev_u32 v74, s3, v74
v_cmp_le_u32 vcc, 11, v74
s_nop 0
s_and_b64 vcc, vcc, s[48:49]
s_cbranch_scc0 L_hs_27_ok
s_add_u32 s15, s15, 1
s_cmp_lt_u32 s15, 16384
s_cbranch_scc1 L_hs_27
L_hs_27_ok:
interleave_layers__sliding_local_dilated__glu_gated_swiglu__prompt_kernel_jG:
v_lshrrev_b32 v59, 4, v0
v_and_b32 v61, 15, v0
v_lshlrev_b32 v60, 2, v59
v_sub_u32 v60, v60, v61
v_mov_b32 v62, 0xf149f2ca
v_cmp_le_i32 vcc, 9, v60
s_nop 1
v_cndmask_b32 v216, v62, 0, vcc
v_add_u32 v63, 7, v60
v_cmp_gt_u32 vcc, 8, v63
s_nop 1
v_cndmask_b32 v220, v62, 0, vcc
v_cmp_le_i32 vcc, 8, v60
s_nop 1
v_cndmask_b32 v217, v62, 0, vcc
v_add_u32 v63, 8, v60
v_cmp_gt_u32 vcc, 8, v63
s_nop 1
v_cndmask_b32 v221, v62, 0, vcc
v_cmp_le_i32 vcc, 7, v60
s_nop 1
v_cndmask_b32 v218, v62, 0, vcc
v_add_u32 v63, 9, v60
v_cmp_gt_u32 vcc, 8, v63
s_nop 1
v_cndmask_b32 v222, v62, 0, vcc
v_cmp_le_i32 vcc, 6, v60
s_nop 1
v_cndmask_b32 v219, v62, 0, vcc
v_add_u32 v63, 10, v60
v_cmp_gt_u32 vcc, 8, v63
s_nop 1
v_cndmask_b32 v223, v62, 0, vcc
v_add_u32 v252, 49152, v1
v_lshlrev_b32 v62, 4, v59
v_lshlrev_b32 v63, 2, v61
v_add_u32 v62, 159744, v62
v_add_u32 v63, 159744, v63
ds_read_b128 v[224:227], v62 offset:0
ds_read_b128 v[228:231], v62 offset:64
ds_read_b128 v[232:235], v62 offset:128
ds_read_b128 v[236:239], v62 offset:192
ds_read_b32 v5, v63 offset:256
ds_read_b32 v6, v63 offset:320
s_waitcnt lgkmcnt(0)
s_and_b32 s16, s20, 15
s_cmp_eq_u32 s16, 0
s_cselect_b32 s30, s21, 0
s_mov_b32 s31, 0
s_mul_i32 s30, s30, 0x7f
s_waitcnt vmcnt(1)
s_add_u32 s3, s33, 0
v_subrev_u32 v140, s3, v140
v_cmp_le_u32 vcc, 16, v140
s_nop 0
s_and_b64 vcc, vcc, s[30:31]
s_cbranch_scc0 L_chk_26_ok
s_mov_b32 s15, 0
L_chk_26:
buffer_load_dword v140, v138, s[4:7], s29 offen sc1
s_waitcnt vmcnt(0)
s_add_u32 s3, s33, 0
v_subrev_u32 v140, s3, v140
v_cmp_le_u32 vcc, 16, v140
s_nop 0
s_and_b64 vcc, vcc, s[30:31]
s_cbranch_scc0 L_chk_26_ok
s_add_u32 s15, s15, 1
s_cmp_lt_u32 s15, 131072
s_cbranch_scc1 L_chk_26
L_chk_26_ok:
s_cmp_lg_u32 s14, 0
s_cbranch_scc1 L_wt_28
v_lshlrev_b32 v72, 7, v0
s_add_u32 s3, s32, 6
s_mov_b32 s15, 0
buffer_load_dword v73, v72, s[4:7], s43 offen sc1
s_sleep 1
buffer_load_dword v74, v72, s[4:7], s43 offen sc1
s_sleep 1
L_wt_28_p:
buffer_load_dword v75, v72, s[4:7], s43 offen sc1
s_waitcnt vmcnt(2)
v_subrev_u32 v73, s3, v73
v_cmp_le_u32 vcc, 10, v73
s_nop 0
s_and_b64 vcc, vcc, s[48:49]
s_cbranch_scc0 L_wt_28
buffer_load_dword v73, v72, s[4:7], s43 offen sc1
s_waitcnt vmcnt(2)
v_subrev_u32 v74, s3, v74
v_cmp_le_u32 vcc, 10, v74
s_nop 0
s_and_b64 vcc, vcc, s[48:49]
s_cbranch_scc0 L_wt_28
buffer_load_dword v74, v72, s[4:7], s43 offen sc1
s_waitcnt vmcnt(2)
v_subrev_u32 v75, s3, v75
v_cmp_le_u32 vcc, 10, v75
s_nop 0
s_and_b64 vcc, vcc, s[48:49]
s_cbranch_scc0 L_wt_28
s_add_u32 s15, s15, 1
s_cmp_lt_u32 s15, 131072
s_cbranch_scc1 L_wt_28_p
L_wt_28:
s_barrier
s_add_u32 m0, s22, 0
s_add_u32 s31, s24, 0
buffer_load_dwordx4 v1, s[4:7], s31 offen offset:0 sc1 lds
buffer_load_dwordx4 v1, s[4:7], s31 offen offset:1024 sc1 lds
s_add_u32 m0, s22, 8192
s_add_u32 s31, s25, 0
buffer_load_dwordx4 v1, s[4:7], s31 offen offset:0 sc1 lds
buffer_load_dwordx4 v1, s[4:7], s31 offen offset:1024 sc1 lds
s_add_u32 m0, s19, 0
s_add_u32 s31, s23, 0
buffer_load_dwordx4 v1, s[4:7], s31 offen sc1 lds
s_add_u32 m0, s22, 20480
s_add_u32 s31, s24, 2048
buffer_load_dwordx4 v1, s[4:7], s31 offen offset:0 sc1 lds
buffer_load_dwordx4 v1, s[4:7], s31 offen offset:1024 sc1 lds
s_add_u32 m0, s22, 28672
s_add_u32 s31, s25, 2048
buffer_load_dwordx4 v1, s[4:7], s31 offen offset:0 sc1 lds
buffer_load_dwordx4 v1, s[4:7], s31 offen offset:1024 sc1 lds
s_add_u32 m0, s19, 20480
s_add_u32 s31, s23, 2048
buffer_load_dwordx4 v1, s[4:7], s31 offen sc1 lds
s_waitcnt vmcnt(5)
s_barrier
ds_read_b128 v[136:139], v152 offset:4096
ds_read_b128 v[132:135], v152 offset:2048
ds_read_b128 v[128:131], v152 offset:0
ds_read_b128 v[88:91], v1 offset:2048
ds_read_b128 v[92:95], v1 offset:3072
ds_read_b128 v[80:83], v1 offset:0
ds_read_b128 v[84:87], v1 offset:1024
ds_read_b128 v[96:99], v1 offset:4096
ds_read_b128 v[100:103], v1 offset:5120
s_waitcnt lgkmcnt(0)
v_mfma_f32_16x16x32_bf16 v[48:51], v[88:91], v[136:139], 0
ds_read_b128 v[112:115], v1 offset:8192
buffer_load_dwordx4 v[188:191], v1, s[4:7], s27 offen sc1
v_mfma_f32_16x16x32_bf16 v[40:43], v[88:91], v[132:135], 0
ds_read_b128 v[116:119], v1 offset:9216
buffer_load_dwordx4 v[192:195], v207, s[4:7], s27 offen offset:1024 sc1
v_mfma_f32_16x16x32_bf16 v[32:35], v[88:91], v[128:131], 0
ds_read_b128 v[148:151], v152 offset:5120
buffer_load_dwordx4 v[196:199], v1, s[4:7], s26 offen sc1
v_mfma_f32_16x16x32_bf16 v[52:55], v[92:95], v[136:139], 0
ds_read_b128 v[144:147], v152 offset:3072
buffer_load_dwordx4 v[200:203], v207, s[4:7], s26 offen offset:1024 sc1
v_mfma_f32_16x16x32_bf16 v[44:47], v[92:95], v[132:135], 0
ds_read_b128 v[140:143], v152 offset:1024
s_add_u32 m0, s22, 40960
v_mfma_f32_16x16x32_bf16 v[36:39], v[92:95], v[128:131], 0
ds_read_b128 v[104:107], v1 offset:6144
s_add_u32 s31, s24, 4096
v_mfma_f32_16x16x32_bf16 v[16:19], v[80:83], v[132:135], 0
ds_read_b128 v[108:111], v1 offset:7168
buffer_load_dwordx4 v1, s[4:7], s31 offen offset:0 sc1 lds
v_mfma_f32_16x16x32_bf16 v[24:27], v[80:83], v[136:139], 0
ds_read_b128 v[120:123], v1 offset:10240
buffer_load_dwordx4 v1, s[4:7], s31 offen offset:1024 sc1 lds
v_mfma_f32_16x16x32_bf16 v[20:23], v[84:87], v[132:135], 0
ds_read_b128 v[124:127], v1 offset:11264
s_add_u32 m0, s22, 49152
v_mfma_f32_16x16x32_bf16 v[28:31], v[84:87], v[136:139], 0
s_add_u32 s31, s25, 4096
buffer_load_dwordx4 v1, s[4:7], s31 offen offset:0 sc1 lds
v_mfma_f32_16x16x32_bf16 v[56:59], v[128:131], v[96:99], 0
buffer_load_dwordx4 v1, s[4:7], s31 offen offset:1024 sc1 lds
v_mfma_f32_16x16x32_bf16 v[64:67], v[132:135], v[96:99], 0
s_add_u32 m0, s19, 40960
s_add_u32 s31, s23, 4096
v_mfma_f32_16x16x32_bf16 v[72:75], v[136:139], v[96:99], 0
buffer_load_dwordx4 v1, s[4:7], s31 offen sc1 lds
v_mfma_f32_16x16x32_bf16 v[60:63], v[128:131], v[100:103], 0
v_mfma_f32_16x16x32_bf16 v[68:71], v[132:135], v[100:103], 0
v_mfma_f32_16x16x32_bf16 v[76:79], v[136:139], v[100:103], 0
s_waitcnt lgkmcnt(0)
v_mfma_f32_16x16x32_bf16 v[48:51], v[112:115], v[148:151], v[48:51]
s_waitcnt vmcnt(9)
s_barrier
v_mfma_f32_16x16x32_bf16 v[40:43], v[112:115], v[144:147], v[40:43]
ds_read_b128 v[88:91], v1 offset:14336
s_add_u32 m0, s22, 0
v_mfma_f32_16x16x32_bf16 v[32:35], v[112:115], v[140:143], v[32:35]
ds_read_b128 v[92:95], v1 offset:15360
s_add_u32 s31, s24, 6144
v_mfma_f32_16x16x32_bf16 v[52:55], v[116:119], v[148:151], v[52:55]
ds_read_b128 v[136:139], v152 offset:24576
buffer_load_dwordx4 v1, s[4:7], s31 offen offset:0 sc1 lds
v_mfma_f32_16x16x32_bf16 v[44:47], v[116:119], v[144:147], v[44:47]
ds_read_b128 v[132:135], v152 offset:22528
v_mfma_f32_16x16x32_bf16 v[36:39], v[116:119], v[140:143], v[36:39]
ds_read_b128 v[128:131], v152 offset:20480
v_mfma_f32_16x16x32_bf16 v[16:19], v[104:107], v[144:147], v[16:19]
ds_read_b128 v[80:83], v1 offset:12288
s_lshl_b32 s16, s14, 9
v_mfma_f32_16x16x32_bf16 v[24:27], v[104:107], v[148:151], v[24:27]
ds_read_b128 v[84:87], v1 offset:13312
buffer_load_dwordx4 v1, s[4:7], s31 offen offset:1024 sc1 lds
v_mfma_f32_16x16x32_bf16 v[20:23], v[108:111], v[144:147], v[20:23]
ds_read_b128 v[96:99], v1 offset:16384
s_add_u32 s16, s16, 160768
v_mfma_f32_16x16x32_bf16 v[28:31], v[108:111], v[148:151], v[28:31]
ds_read_b128 v[100:103], v1 offset:17408
v_and_b32 v254, 7, v0
v_mfma_f32_16x16x32_bf16 v[56:59], v[140:143], v[120:123], v[56:59]
v_lshrrev_b32 v255, 4, v0
v_lshl_add_u32 v254, v254, 2, v255
v_mfma_f32_16x16x32_bf16 v[64:67], v[144:147], v[120:123], v[64:67]
s_add_u32 m0, s22, 8192
s_add_u32 s31, s25, 6144
v_mfma_f32_16x16x32_bf16 v[72:75], v[148:151], v[120:123], v[72:75]
buffer_load_dwordx4 v1, s[4:7], s31 offen offset:0 sc1 lds
v_lshl_add_u32 v254, v254, 2, s16
v_mfma_f32_16x16x32_bf16 v[60:63], v[140:143], v[124:127], v[60:63]
s_waitcnt vmcnt(10)
v_add_f32 v188, v188, v192
s_waitcnt vmcnt(8)
v_add_f32 v196, v196, v200
v_mfma_f32_16x16x32_bf16 v[68:71], v[144:147], v[124:127], v[68:71]
v_add_f32 v189, v189, v193
v_add_f32 v197, v197, v201
v_mfma_f32_16x16x32_bf16 v[76:79], v[148:151], v[124:127], v[76:79]
v_add_f32 v190, v190, v194
s_waitcnt lgkmcnt(0)
v_mfma_f32_16x16x32_bf16 v[48:51], v[88:91], v[136:139], v[48:51]
ds_read_b128 v[112:115], v1 offset:20480
buffer_load_dwordx4 v1, s[4:7], s31 offen offset:1024 sc1 lds
v_mfma_f32_16x16x32_bf16 v[40:43], v[88:91], v[132:135], v[40:43]
ds_read_b128 v[116:119], v1 offset:21504
v_add_f32 v198, v198, v202
v_mfma_f32_16x16x32_bf16 v[32:35], v[88:91], v[128:131], v[32:35]
ds_read_b128 v[148:151], v152 offset:25600
v_add_f32 v191, v191, v195
v_mfma_f32_16x16x32_bf16 v[52:55], v[92:95], v[136:139], v[52:55]
ds_read_b128 v[144:147], v152 offset:23552
v_add_f32 v199, v199, v203
v_mfma_f32_16x16x32_bf16 v[44:47], v[92:95], v[132:135], v[44:47]
ds_read_b128 v[140:143], v152 offset:21504
s_add_u32 m0, s19, 0
v_mfma_f32_16x16x32_bf16 v[36:39], v[92:95], v[128:131], v[36:39]
ds_read_b128 v[104:107], v1 offset:18432
s_add_u32 s31, s23, 6144
v_mfma_f32_16x16x32_bf16 v[16:19], v[80:83], v[132:135], v[16:19]
ds_read_b128 v[108:111], v1 offset:19456
buffer_load_dwordx4 v1, s[4:7], s31 offen sc1 lds
v_mfma_f32_16x16x32_bf16 v[24:27], v[80:83], v[136:139], v[24:27]
ds_read_b128 v[120:123], v1 offset:22528
v_permlane32_swap_b32 v188, v190
v_mfma_f32_16x16x32_bf16 v[20:23], v[84:87], v[132:135], v[20:23]
ds_read_b128 v[124:127], v1 offset:23552
v_permlane32_swap_b32 v196, v198
v_mfma_f32_16x16x32_bf16 v[28:31], v[84:87], v[136:139], v[28:31]
v_permlane32_swap_b32 v189, v191
v_permlane32_swap_b32 v197, v199
v_mfma_f32_16x16x32_bf16 v[56:59], v[128:131], v[96:99], v[56:59]
v_add_f32 v188, v188, v190
v_add_f32 v196, v196, v198
v_mfma_f32_16x16x32_bf16 v[64:67], v[132:135], v[96:99], v[64:67]
v_add_f32 v189, v189, v191
v_add_f32 v197, v197, v199
v_mfma_f32_16x16x32_bf16 v[72:75], v[136:139], v[96:99], v[72:75]
v_permlane16_swap_b32 v188, v189
v_permlane16_swap_b32 v196, v197
v_mfma_f32_16x16x32_bf16 v[60:63], v[128:131], v[100:103], v[60:63]
v_add_f32 v188, v188, v189
v_add_f32 v196, v196, v197
v_mfma_f32_16x16x32_bf16 v[68:71], v[132:135], v[100:103], v[68:71]
v_mul_f32 v188, 0x3b124925, v188
v_mul_f32 v196, 0x3b124925, v196
v_mfma_f32_16x16x32_bf16 v[76:79], v[136:139], v[100:103], v[76:79]
v_mov_b32_dpp v189, v188 row_ror:8 row_mask:0xf bank_mask:0xf
s_waitcnt lgkmcnt(0)
v_mfma_f32_16x16x32_bf16 v[48:51], v[112:115], v[148:151], v[48:51]
s_waitcnt vmcnt(5)
s_barrier
v_mfma_f32_16x16x32_bf16 v[40:43], v[112:115], v[144:147], v[40:43]
ds_read_b128 v[88:91], v1 offset:26624
s_add_u32 m0, s22, 20480
v_mfma_f32_16x16x32_bf16 v[32:35], v[112:115], v[140:143], v[32:35]
ds_read_b128 v[92:95], v1 offset:27648
s_add_u32 s31, s24, 8192
v_mfma_f32_16x16x32_bf16 v[52:55], v[116:119], v[148:151], v[52:55]
ds_read_b128 v[136:139], v152 offset:45056
buffer_load_dwordx4 v1, s[4:7], s31 offen offset:0 sc1 lds
v_mfma_f32_16x16x32_bf16 v[44:47], v[116:119], v[144:147], v[44:47]
ds_read_b128 v[132:135], v152 offset:43008
v_mov_b32_dpp v197, v196 row_ror:8 row_mask:0xf bank_mask:0xf
v_mfma_f32_16x16x32_bf16 v[36:39], v[116:119], v[140:143], v[36:39]
ds_read_b128 v[128:131], v152 offset:40960
v_fma_f32 v189, -v188, v188, v189
v_mfma_f32_16x16x32_bf16 v[16:19], v[104:107], v[144:147], v[16:19]
ds_read_b128 v[80:83], v1 offset:24576
v_fma_f32 v197, -v196, v196, v197
v_mfma_f32_16x16x32_bf16 v[24:27], v[104:107], v[148:151], v[24:27]
ds_read_b128 v[84:87], v1 offset:25600
buffer_load_dwordx4 v1, s[4:7], s31 offen offset:1024 sc1 lds
v_mfma_f32_16x16x32_bf16 v[20:23], v[108:111], v[144:147], v[20:23]
ds_read_b128 v[96:99], v1 offset:28672
v_max_f32 v189, 0, v189
v_mfma_f32_16x16x32_bf16 v[28:31], v[108:111], v[148:151], v[28:31]
ds_read_b128 v[100:103], v1 offset:29696
v_max_f32 v197, 0, v197
v_mfma_f32_16x16x32_bf16 v[56:59], v[140:143], v[120:123], v[56:59]
v_add_f32 v189, 0x3727c5ac, v189
v_add_f32 v197, 0x3727c5ac, v197
v_mfma_f32_16x16x32_bf16 v[64:67], v[144:147], v[120:123], v[64:67]
s_add_u32 m0, s22, 28672
s_add_u32 s31, s25, 8192
v_mfma_f32_16x16x32_bf16 v[72:75], v[148:151], v[120:123], v[72:75]
buffer_load_dwordx4 v1, s[4:7], s31 offen offset:0 sc1 lds
v_mfma_f32_16x16x32_bf16 v[60:63], v[140:143], v[124:127], v[60:63]
v_rsq_f32 v189, v189
v_mfma_f32_16x16x32_bf16 v[68:71], v[144:147], v[124:127], v[68:71]
v_rsq_f32 v197, v197
v_mfma_f32_16x16x32_bf16 v[76:79], v[148:151], v[124:127], v[76:79]
s_mov_b32 exec_lo, 0x00ff00ff
s_mov_b32 exec_hi, 0x00ff00ff
ds_write2_b32 v254, v188, v189 offset0:32 offset1:96
ds_write2_b32 v254, v196, v197 offset0:0 offset1:64
s_mov_b64 exec, -1
s_waitcnt lgkmcnt(0)
v_mfma_f32_16x16x32_bf16 v[48:51], v[88:91], v[136:139], v[48:51]
ds_read_b128 v[112:115], v1 offset:32768
buffer_load_dwordx4 v1, s[4:7], s31 offen offset:1024 sc1 lds
v_mfma_f32_16x16x32_bf16 v[40:43], v[88:91], v[132:135], v[40:43]
ds_read_b128 v[116:119], v1 offset:33792
v_and_b32 v254, 15, v0
v_mfma_f32_16x16x32_bf16 v[32:35], v[88:91], v[128:131], v[32:35]
ds_read_b128 v[148:151], v152 offset:46080
v_lshl_add_u32 v254, v254, 2, s16
v_mfma_f32_16x16x32_bf16 v[52:55], v[92:95], v[136:139], v[52:55]
ds_read_b128 v[144:147], v152 offset:44032
v_lshl_add_u32 v255, v255, 4, s16
v_mfma_f32_16x16x32_bf16 v[44:47], v[92:95], v[132:135], v[44:47]
ds_read_b128 v[140:143], v152 offset:41984
s_add_u32 m0, s19, 20480
v_mfma_f32_16x16x32_bf16 v[36:39], v[92:95], v[128:131], v[36:39]
ds_read_b128 v[104:107], v1 offset:30720
s_add_u32 s31, s23, 8192
v_mfma_f32_16x16x32_bf16 v[16:19], v[80:83], v[132:135], v[16:19]
ds_read_b128 v[108:111], v1 offset:31744
buffer_load_dwordx4 v1, s[4:7], s31 offen sc1 lds
v_mfma_f32_16x16x32_bf16 v[24:27], v[80:83], v[136:139], v[24:27]
ds_read_b128 v[120:123], v1 offset:34816
v_mfma_f32_16x16x32_bf16 v[20:23], v[84:87], v[132:135], v[20:23]
ds_read_b128 v[124:127], v1 offset:35840
v_mfma_f32_16x16x32_bf16 v[28:31], v[84:87], v[136:139], v[28:31]
v_mfma_f32_16x16x32_bf16 v[56:59], v[128:131], v[96:99], v[56:59]
v_mfma_f32_16x16x32_bf16 v[64:67], v[132:135], v[96:99], v[64:67]
v_mfma_f32_16x16x32_bf16 v[72:75], v[136:139], v[96:99], v[72:75]
v_mfma_f32_16x16x32_bf16 v[60:63], v[128:131], v[100:103], v[60:63]
v_mfma_f32_16x16x32_bf16 v[68:71], v[132:135], v[100:103], v[68:71]
v_mfma_f32_16x16x32_bf16 v[76:79], v[136:139], v[100:103], v[76:79]
s_waitcnt lgkmcnt(0)
v_mfma_f32_16x16x32_bf16 v[48:51], v[112:115], v[148:151], v[48:51]
s_waitcnt vmcnt(5)
s_barrier
v_mfma_f32_16x16x32_bf16 v[40:43], v[112:115], v[144:147], v[40:43]
ds_read_b128 v[88:91], v1 offset:38912
s_add_u32 m0, s22, 40960
v_mfma_f32_16x16x32_bf16 v[32:35], v[112:115], v[140:143], v[32:35]
ds_read_b128 v[92:95], v1 offset:39936
s_add_u32 s31, s24, 10240
v_mfma_f32_16x16x32_bf16 v[52:55], v[116:119], v[148:151], v[52:55]
ds_read_b128 v[136:139], v152 offset:4096
buffer_load_dwordx4 v1, s[4:7], s31 offen offset:0 sc1 lds
v_mfma_f32_16x16x32_bf16 v[44:47], v[116:119], v[144:147], v[44:47]
ds_read_b128 v[132:135], v152 offset:2048
v_mfma_f32_16x16x32_bf16 v[36:39], v[116:119], v[140:143], v[36:39]
ds_read_b128 v[128:131], v152 offset:0
v_mfma_f32_16x16x32_bf16 v[16:19], v[104:107], v[144:147], v[16:19]
ds_read_b128 v[80:83], v1 offset:36864
v_mfma_f32_16x16x32_bf16 v[24:27], v[104:107], v[148:151], v[24:27]
ds_read_b128 v[84:87], v1 offset:37888
buffer_load_dwordx4 v1, s[4:7], s31 offen offset:1024 sc1 lds
v_mfma_f32_16x16x32_bf16 v[20:23], v[108:111], v[144:147], v[20:23]
ds_read_b128 v[96:99], v1 offset:40960
ds_read_b32 v2, v254 offset:64
v_mfma_f32_16x16x32_bf16 v[28:31], v[108:111], v[148:151], v[28:31]
ds_read_b128 v[100:103], v1 offset:41984
ds_read_b32 v3, v254 offset:128
v_mfma_f32_16x16x32_bf16 v[56:59], v[140:143], v[120:123], v[56:59]
ds_read_b32 v4, v254 offset:192
ds_read_b128 v[240:243], v255 offset:64
v_mfma_f32_16x16x32_bf16 v[64:67], v[144:147], v[120:123], v[64:67]
s_add_u32 m0, s22, 49152
s_add_u32 s31, s25, 10240
v_mfma_f32_16x16x32_bf16 v[72:75], v[148:151], v[120:123], v[72:75]
buffer_load_dwordx4 v1, s[4:7], s31 offen offset:0 sc1 lds
ds_read_b128 v[244:247], v255 offset:128
v_mfma_f32_16x16x32_bf16 v[60:63], v[140:143], v[124:127], v[60:63]
ds_read_b128 v[248:251], v255 offset:192
v_mfma_f32_16x16x32_bf16 v[68:71], v[144:147], v[124:127], v[68:71]
v_mfma_f32_16x16x32_bf16 v[76:79], v[148:151], v[124:127], v[76:79]
s_waitcnt lgkmcnt(0)
v_mfma_f32_16x16x32_bf16 v[48:51], v[88:91], v[136:139], v[48:51]
ds_read_b128 v[112:115], v1 offset:45056
buffer_load_dwordx4 v1, s[4:7], s31 offen offset:1024 sc1 lds
v_mfma_f32_16x16x32_bf16 v[40:43], v[88:91], v[132:135], v[40:43]
ds_read_b128 v[116:119], v1 offset:46080
v_fma_f32 v44, -v3, v236, v44
v_mfma_f32_16x16x32_bf16 v[32:35], v[88:91], v[128:131], v[32:35]
ds_read_b128 v[148:151], v152 offset:5120
v_fma_f32 v36, -v2, v236, v36
v_mfma_f32_16x16x32_bf16 v[52:55], v[92:95], v[136:139], v[52:55]
ds_read_b128 v[144:147], v152 offset:3072
v_fma_f32 v16, -v3, v224, v16
v_mfma_f32_16x16x32_bf16 v[44:47], v[92:95], v[132:135], v[44:47]
ds_read_b128 v[140:143], v152 offset:1024
s_add_u32 m0, s19, 40960
v_mfma_f32_16x16x32_bf16 v[36:39], v[92:95], v[128:131], v[36:39]
ds_read_b128 v[104:107], v1 offset:43008
s_add_u32 s31, s23, 10240
v_mfma_f32_16x16x32_bf16 v[16:19], v[80:83], v[132:135], v[16:19]
ds_read_b128 v[108:111], v1 offset:44032
buffer_load_dwordx4 v1, s[4:7], s31 offen sc1 lds
v_mfma_f32_16x16x32_bf16 v[24:27], v[80:83], v[136:139], v[24:27]
ds_read_b128 v[120:123], v1 offset:47104
v_fma_f32 v48, -v4, v232, v48
v_mfma_f32_16x16x32_bf16 v[20:23], v[84:87], v[132:135], v[20:23]
ds_read_b128 v[124:127], v1 offset:48128
v_fma_f32 v49, -v4, v233, v49
v_mfma_f32_16x16x32_bf16 v[28:31], v[84:87], v[136:139], v[28:31]
v_fma_f32 v50, -v4, v234, v50
v_fma_f32 v51, -v4, v235, v51
v_mfma_f32_16x16x32_bf16 v[56:59], v[128:131], v[96:99], v[56:59]
v_fma_f32 v40, -v3, v232, v40
v_fma_f32 v41, -v3, v233, v41
v_mfma_f32_16x16x32_bf16 v[64:67], v[132:135], v[96:99], v[64:67]
v_fma_f32 v42, -v3, v234, v42
v_fma_f32 v43, -v3, v235, v43
v_mfma_f32_16x16x32_bf16 v[72:75], v[136:139], v[96:99], v[72:75]
v_fma_f32 v32, -v2, v232, v32
v_fma_f32 v33, -v2, v233, v33
v_mfma_f32_16x16x32_bf16 v[60:63], v[128:131], v[100:103], v[60:63]
v_fma_f32 v34, -v2, v234, v34
v_fma_f32 v35, -v2, v235, v35
v_mfma_f32_16x16x32_bf16 v[68:71], v[132:135], v[100:103], v[68:71]
v_fma_f32 v52, -v4, v236, v52
v_fma_f32 v53, -v4, v237, v53
v_mfma_f32_16x16x32_bf16 v[76:79], v[136:139], v[100:103], v[76:79]
v_fma_f32 v54, -v4, v238, v54
s_waitcnt lgkmcnt(0)
v_mfma_f32_16x16x32_bf16 v[48:51], v[112:115], v[148:151], v[48:51]
s_waitcnt vmcnt(5)
s_barrier
v_mfma_f32_16x16x32_bf16 v[40:43], v[112:115], v[144:147], v[40:43]
ds_read_b128 v[88:91], v252 offset:2048
s_add_u32 m0, s22, 0
v_mfma_f32_16x16x32_bf16 v[32:35], v[112:115], v[140:143], v[32:35]
ds_read_b128 v[92:95], v252 offset:3072
s_add_u32 s31, s24, 12288
v_mfma_f32_16x16x32_bf16 v[52:55], v[116:119], v[148:151], v[52:55]
ds_read_b128 v[136:139], v152 offset:24576
buffer_load_dwordx4 v1, s[4:7], s31 offen offset:0 sc1 lds
v_mfma_f32_16x16x32_bf16 v[44:47], v[116:119], v[144:147], v[44:47]
ds_read_b128 v[132:135], v152 offset:22528
v_fma_f32 v24, -v4, v224, v24
v_mfma_f32_16x16x32_bf16 v[36:39], v[116:119], v[140:143], v[36:39]
ds_read_b128 v[128:131], v152 offset:20480
v_fma_f32 v20, -v3, v228, v20
v_mfma_f32_16x16x32_bf16 v[16:19], v[104:107], v[144:147], v[16:19]
ds_read_b128 v[80:83], v252 offset:0
v_fma_f32 v28, -v4, v228, v28
v_mfma_f32_16x16x32_bf16 v[24:27], v[104:107], v[148:151], v[24:27]
ds_read_b128 v[84:87], v252 offset:1024
buffer_load_dwordx4 v1, s[4:7], s31 offen offset:1024 sc1 lds
v_mfma_f32_16x16x32_bf16 v[20:23], v[108:111], v[144:147], v[20:23]
ds_read_b128 v[96:99], v252 offset:4096
v_fma_f32 v64, -v244, v5, v64
v_mfma_f32_16x16x32_bf16 v[28:31], v[108:111], v[148:151], v[28:31]
ds_read_b128 v[100:103], v252 offset:5120
v_fma_f32 v55, -v4, v239, v55
v_mfma_f32_16x16x32_bf16 v[56:59], v[140:143], v[120:123], v[56:59]
v_fma_f32 v45, -v3, v237, v45
v_fma_f32 v46, -v3, v238, v46
v_mfma_f32_16x16x32_bf16 v[64:67], v[144:147], v[120:123], v[64:67]
s_add_u32 m0, s22, 8192
s_add_u32 s31, s25, 12288
v_mfma_f32_16x16x32_bf16 v[72:75], v[148:151], v[120:123], v[72:75]
buffer_load_dwordx4 v1, s[4:7], s31 offen offset:0 sc1 lds
v_fma_f32 v47, -v3, v239, v47
v_mfma_f32_16x16x32_bf16 v[60:63], v[140:143], v[124:127], v[60:63]
v_fma_f32 v37, -v2, v237, v37
v_fma_f32 v38, -v2, v238, v38
v_mfma_f32_16x16x32_bf16 v[68:71], v[144:147], v[124:127], v[68:71]
v_fma_f32 v39, -v2, v239, v39
v_fma_f32 v17, -v3, v225, v17
v_mfma_f32_16x16x32_bf16 v[76:79], v[148:151], v[124:127], v[76:79]
v_fma_f32 v18, -v3, v226, v18
s_waitcnt lgkmcnt(0)
v_mfma_f32_16x16x32_bf16 v[48:51], v[88:91], v[136:139], v[48:51]
ds_read_b128 v[112:115], v252 offset:8192
buffer_load_dwordx4 v1, s[4:7], s31 offen offset:1024 sc1 lds
v_mfma_f32_16x16x32_bf16 v[40:43], v[88:91], v[132:135], v[40:43]
ds_read_b128 v[116:119], v252 offset:9216
v_fma_f32 v19, -v3, v227, v19
v_mfma_f32_16x16x32_bf16 v[32:35], v[88:91], v[128:131], v[32:35]
ds_read_b128 v[148:151], v152 offset:25600
v_fma_f32 v25, -v4, v225, v25
v_mfma_f32_16x16x32_bf16 v[52:55], v[92:95], v[136:139], v[52:55]
ds_read_b128 v[144:147], v152 offset:23552
v_fma_f32 v26, -v4, v226, v26
v_mfma_f32_16x16x32_bf16 v[44:47], v[92:95], v[132:135], v[44:47]
ds_read_b128 v[140:143], v152 offset:21504
s_add_u32 m0, s19, 0
v_mfma_f32_16x16x32_bf16 v[36:39], v[92:95], v[128:131], v[36:39]
ds_read_b128 v[104:107], v252 offset:6144
s_add_u32 s31, s23, 12288
v_mfma_f32_16x16x32_bf16 v[16:19], v[80:83], v[132:135], v[16:19]
ds_read_b128 v[108:111], v252 offset:7168
buffer_load_dwordx4 v1, s[4:7], s31 offen sc1 lds
v_mfma_f32_16x16x32_bf16 v[24:27], v[80:83], v[136:139], v[24:27]
ds_read_b128 v[120:123], v252 offset:10240
v_fma_f32 v56, -v240, v5, v56
v_mfma_f32_16x16x32_bf16 v[20:23], v[84:87], v[132:135], v[20:23]
ds_read_b128 v[124:127], v252 offset:11264
buffer_load_dwordx2 v[8:9], v153, s[4:7], s18 offen sc1
v_mfma_f32_16x16x32_bf16 v[28:31], v[84:87], v[136:139], v[28:31]
v_fma_f32 v72, -v248, v5, v72
v_fma_f32 v73, -v249, v5, v73
v_mfma_f32_16x16x32_bf16 v[56:59], v[128:131], v[96:99], v[56:59]
s_add_u32 s18, s18, 14336
buffer_load_dwordx2 v[10:11], v153, s[4:7], s18 offen sc1
v_mfma_f32_16x16x32_bf16 v[64:67], v[132:135], v[96:99], v[64:67]
v_fma_f32 v68, -v244, v6, v68
v_fma_f32 v69, -v245, v6, v69
v_mfma_f32_16x16x32_bf16 v[72:75], v[136:139], v[96:99], v[72:75]
s_add_u32 s18, s18, 100352
buffer_load_dwordx2 v[12:13], v153, s[4:7], s18 offen sc1
v_mfma_f32_16x16x32_bf16 v[60:63], v[128:131], v[100:103], v[60:63]
v_fma_f32 v27, -v4, v227, v27
v_mfma_f32_16x16x32_bf16 v[68:71], v[132:135], v[100:103], v[68:71]
s_add_u32 s18, s18, 14336
buffer_load_dwordx2 v[14:15], v153, s[4:7], s18 offen sc1
v_mfma_f32_16x16x32_bf16 v[76:79], v[136:139], v[100:103], v[76:79]
v_fma_f32 v21, -v3, v229, v21
s_waitcnt lgkmcnt(0)
v_mfma_f32_16x16x32_bf16 v[48:51], v[112:115], v[148:151], v[48:51]
s_waitcnt vmcnt(9)
s_barrier
v_mfma_f32_16x16x32_bf16 v[40:43], v[112:115], v[144:147], v[40:43]
ds_read_b128 v[88:91], v252 offset:14336
v_fma_f32 v22, -v3, v230, v22
v_mfma_f32_16x16x32_bf16 v[32:35], v[112:115], v[140:143], v[32:35]
ds_read_b128 v[92:95], v252 offset:15360
s_lshl_b32 s30, s40, 16
v_mfma_f32_16x16x32_bf16 v[52:55], v[116:119], v[148:151], v[52:55]
ds_read_b128 v[136:139], v152 offset:45056
s_lshl_b32 s29, s14, 14
v_mfma_f32_16x16x32_bf16 v[44:47], v[116:119], v[144:147], v[44:47]
ds_read_b128 v[132:135], v152 offset:43008
s_add_u32 s30, s30, s29
v_mfma_f32_16x16x32_bf16 v[36:39], v[116:119], v[140:143], v[36:39]
ds_read_b128 v[128:131], v152 offset:40960
s_add_u32 s30, s30, 1605632
v_mfma_f32_16x16x32_bf16 v[16:19], v[104:107], v[144:147], v[16:19]
ds_read_b128 v[80:83], v252 offset:12288
s_add_u32 s29, s30, 0
v_mfma_f32_16x16x32_bf16 v[24:27], v[104:107], v[148:151], v[24:27]
ds_read_b128 v[84:87], v252 offset:13312
buffer_load_dwordx4 v[156:159], v1, s[4:7], s29 offen offset:3072 sc1
v_mfma_f32_16x16x32_bf16 v[20:23], v[108:111], v[144:147], v[20:23]
ds_read_b128 v[96:99], v252 offset:16384
v_fma_f32 v65, -v245, v5, v65
v_mfma_f32_16x16x32_bf16 v[28:31], v[108:111], v[148:151], v[28:31]
ds_read_b128 v[100:103], v252 offset:17408
v_fma_f32 v74, -v250, v5, v74
v_mfma_f32_16x16x32_bf16 v[56:59], v[140:143], v[120:123], v[56:59]
v_fma_f32 v60, -v240, v6, v60
v_fma_f32 v61, -v241, v6, v61
v_mfma_f32_16x16x32_bf16 v[64:67], v[144:147], v[120:123], v[64:67]
v_fma_f32 v70, -v246, v6, v70
v_fma_f32 v71, -v247, v6, v71
v_mfma_f32_16x16x32_bf16 v[72:75], v[148:151], v[120:123], v[72:75]
s_add_u32 s29, s30, 4096
buffer_load_dwordx4 v[160:163], v1, s[4:7], s29 offen offset:0 sc1
v_mfma_f32_16x16x32_bf16 v[60:63], v[140:143], v[124:127], v[60:63]
v_mfma_f32_16x16x32_bf16 v[68:71], v[144:147], v[124:127], v[68:71]
v_fma_f32 v23, -v3, v231, v23
v_mfma_f32_16x16x32_bf16 v[76:79], v[148:151], v[124:127], v[76:79]
v_fma_f32 v29, -v4, v229, v29
s_waitcnt lgkmcnt(0)
v_mfma_f32_16x16x32_bf16 v[48:51], v[88:91], v[136:139], v[48:51]
ds_read_b128 v[112:115], v252 offset:20480
v_fma_f32 v30, -v4, v230, v30
v_mfma_f32_16x16x32_bf16 v[40:43], v[88:91], v[132:135], v[40:43]
ds_read_b128 v[116:119], v252 offset:21504
v_fma_f32 v31, -v4, v231, v31
v_mfma_f32_16x16x32_bf16 v[32:35], v[88:91], v[128:131], v[32:35]
ds_read_b128 v[148:151], v152 offset:46080
buffer_load_dwordx4 v[164:167], v1, s[4:7], s29 offen offset:1024 sc1
v_mfma_f32_16x16x32_bf16 v[52:55], v[92:95], v[136:139], v[52:55]
ds_read_b128 v[144:147], v152 offset:44032
v_fma_f32 v57, -v241, v5, v57
v_mfma_f32_16x16x32_bf16 v[44:47], v[92:95], v[132:135], v[44:47]
ds_read_b128 v[140:143], v152 offset:41984
v_fma_f32 v58, -v242, v5, v58
v_mfma_f32_16x16x32_bf16 v[36:39], v[92:95], v[128:131], v[36:39]
ds_read_b128 v[104:107], v252 offset:18432
buffer_load_dwordx4 v[168:171], v1, s[4:7], s29 offen offset:2048 sc1
v_mfma_f32_16x16x32_bf16 v[16:19], v[80:83], v[132:135], v[16:19]
ds_read_b128 v[108:111], v252 offset:19456
v_fma_f32 v59, -v243, v5, v59
v_mfma_f32_16x16x32_bf16 v[24:27], v[80:83], v[136:139], v[24:27]
ds_read_b128 v[120:123], v252 offset:22528
v_fma_f32 v66, -v246, v5, v66
v_mfma_f32_16x16x32_bf16 v[20:23], v[84:87], v[132:135], v[20:23]
ds_read_b128 v[124:127], v252 offset:23552
buffer_load_dwordx4 v[172:175], v1, s[4:7], s29 offen offset:3072 sc1
v_mfma_f32_16x16x32_bf16 v[28:31], v[84:87], v[136:139], v[28:31]
v_fma_f32 v75, -v251, v5, v75
v_fma_f32 v62, -v242, v6, v62
v_mfma_f32_16x16x32_bf16 v[56:59], v[128:131], v[96:99], v[56:59]
v_fma_f32 v63, -v243, v6, v63
v_fma_f32 v76, -v248, v6, v76
v_mfma_f32_16x16x32_bf16 v[64:67], v[132:135], v[96:99], v[64:67]
v_fma_f32 v77, -v249, v6, v77
v_fma_f32 v78, -v250, v6, v78
v_mfma_f32_16x16x32_bf16 v[72:75], v[136:139], v[96:99], v[72:75]
v_fma_f32 v79, -v251, v6, v79
v_mfma_f32_16x16x32_bf16 v[60:63], v[128:131], v[100:103], v[60:63]
v_mfma_f32_16x16x32_bf16 v[68:71], v[132:135], v[100:103], v[68:71]
v_mfma_f32_16x16x32_bf16 v[76:79], v[136:139], v[100:103], v[76:79]
s_waitcnt lgkmcnt(0)
v_mfma_f32_16x16x32_bf16 v[48:51], v[112:115], v[148:151], v[48:51]
s_waitcnt vmcnt(9)
s_barrier
v_mfma_f32_16x16x32_bf16 v[40:43], v[112:115], v[144:147], v[40:43]
ds_read_b128 v[88:91], v252 offset:26624
v_fma_f32 v67, -v247, v5, v67
v_mfma_f32_16x16x32_bf16 v[32:35], v[112:115], v[140:143], v[32:35]
ds_read_b128 v[92:95], v252 offset:27648
s_add_u32 s29, s30, 8192
v_mfma_f32_16x16x32_bf16 v[52:55], v[116:119], v[148:151], v[52:55]
ds_read_b128 v[136:139], v152 offset:4096
buffer_load_dwordx4 v[176:179], v1, s[4:7], s29 offen offset:0 sc1
v_mfma_f32_16x16x32_bf16 v[44:47], v[116:119], v[144:147], v[44:47]
ds_read_b128 v[132:135], v152 offset:2048
v_mfma_f32_16x16x32_bf16 v[36:39], v[116:119], v[140:143], v[36:39]
ds_read_b128 v[128:131], v152 offset:0
v_mfma_f32_16x16x32_bf16 v[16:19], v[104:107], v[144:147], v[16:19]
ds_read_b128 v[80:83], v252 offset:24576
buffer_load_dwordx4 v[180:183], v1, s[4:7], s29 offen offset:1024 sc1
v_mfma_f32_16x16x32_bf16 v[24:27], v[104:107], v[148:151], v[24:27]
ds_read_b128 v[84:87], v252 offset:25600
v_mfma_f32_16x16x32_bf16 v[20:23], v[108:111], v[144:147], v[20:23]
ds_read_b128 v[96:99], v252 offset:28672
v_mfma_f32_16x16x32_bf16 v[28:31], v[108:111], v[148:151], v[28:31]
ds_read_b128 v[100:103], v252 offset:29696
buffer_load_dwordx4 v[184:187], v1, s[4:7], s29 offen offset:2048 sc1
v_mfma_f32_16x16x32_bf16 v[56:59], v[140:143], v[120:123], v[56:59]
v_mfma_f32_16x16x32_bf16 v[64:67], v[144:147], v[120:123], v[64:67]
v_mfma_f32_16x16x32_bf16 v[72:75], v[148:151], v[120:123], v[72:75]
v_mfma_f32_16x16x32_bf16 v[60:63], v[140:143], v[124:127], v[60:63]
v_mfma_f32_16x16x32_bf16 v[68:71], v[144:147], v[124:127], v[68:71]
v_mfma_f32_16x16x32_bf16 v[76:79], v[148:151], v[124:127], v[76:79]
s_waitcnt lgkmcnt(0)
v_mfma_f32_16x16x32_bf16 v[48:51], v[88:91], v[136:139], v[48:51]
ds_read_b128 v[112:115], v252 offset:32768
v_mfma_f32_16x16x32_bf16 v[40:43], v[88:91], v[132:135], v[40:43]
ds_read_b128 v[116:119], v252 offset:33792
v_mfma_f32_16x16x32_bf16 v[32:35], v[88:91], v[128:131], v[32:35]
ds_read_b128 v[148:151], v152 offset:5120
buffer_load_dwordx4 v[188:191], v1, s[4:7], s29 offen offset:3072 sc1
v_mfma_f32_16x16x32_bf16 v[52:55], v[92:95], v[136:139], v[52:55]
ds_read_b128 v[144:147], v152 offset:3072
v_mfma_f32_16x16x32_bf16 v[44:47], v[92:95], v[132:135], v[44:47]
ds_read_b128 v[140:143], v152 offset:1024
v_mfma_f32_16x16x32_bf16 v[36:39], v[92:95], v[128:131], v[36:39]
ds_read_b128 v[104:107], v252 offset:30720
s_add_u32 s29, s30, 12288
v_mfma_f32_16x16x32_bf16 v[16:19], v[80:83], v[132:135], v[16:19]
ds_read_b128 v[108:111], v252 offset:31744
buffer_load_dwordx4 v[192:195], v1, s[4:7], s29 offen offset:0 sc1
v_mfma_f32_16x16x32_bf16 v[24:27], v[80:83], v[136:139], v[24:27]
ds_read_b128 v[120:123], v252 offset:34816
v_mfma_f32_16x16x32_bf16 v[20:23], v[84:87], v[132:135], v[20:23]
ds_read_b128 v[124:127], v252 offset:35840
v_mfma_f32_16x16x32_bf16 v[28:31], v[84:87], v[136:139], v[28:31]
buffer_load_dwordx4 v[196:199], v1, s[4:7], s29 offen offset:1024 sc1
v_mfma_f32_16x16x32_bf16 v[56:59], v[128:131], v[96:99], v[56:59]
v_mfma_f32_16x16x32_bf16 v[64:67], v[132:135], v[96:99], v[64:67]
v_mfma_f32_16x16x32_bf16 v[72:75], v[136:139], v[96:99], v[72:75]
v_mfma_f32_16x16x32_bf16 v[60:63], v[128:131], v[100:103], v[60:63]
v_mfma_f32_16x16x32_bf16 v[68:71], v[132:135], v[100:103], v[68:71]
v_mfma_f32_16x16x32_bf16 v[76:79], v[136:139], v[100:103], v[76:79]
s_waitcnt lgkmcnt(0)
v_mfma_f32_16x16x32_bf16 v[48:51], v[112:115], v[148:151], v[48:51]
v_mfma_f32_16x16x32_bf16 v[40:43], v[112:115], v[144:147], v[40:43]
v_mfma_f32_16x16x32_bf16 v[32:35], v[112:115], v[140:143], v[32:35]
buffer_load_dwordx4 v[200:203], v1, s[4:7], s29 offen offset:2048 sc1
v_mfma_f32_16x16x32_bf16 v[52:55], v[116:119], v[148:151], v[52:55]
v_mfma_f32_16x16x32_bf16 v[44:47], v[116:119], v[144:147], v[44:47]
v_mfma_f32_16x16x32_bf16 v[36:39], v[116:119], v[140:143], v[36:39]
v_mfma_f32_16x16x32_bf16 v[16:19], v[104:107], v[144:147], v[16:19]
v_mfma_f32_16x16x32_bf16 v[24:27], v[104:107], v[148:151], v[24:27]
buffer_load_dwordx4 v[204:207], v1, s[4:7], s29 offen offset:3072 sc1
v_mfma_f32_16x16x32_bf16 v[20:23], v[108:111], v[144:147], v[20:23]
v_mfma_f32_16x16x32_bf16 v[28:31], v[108:111], v[148:151], v[28:31]
v_mfma_f32_16x16x32_bf16 v[56:59], v[140:143], v[120:123], v[56:59]
v_mfma_f32_16x16x32_bf16 v[64:67], v[144:147], v[120:123], v[64:67]
v_mfma_f32_16x16x32_bf16 v[72:75], v[148:151], v[120:123], v[72:75]
v_mfma_f32_16x16x32_bf16 v[60:63], v[140:143], v[124:127], v[60:63]
v_mfma_f32_16x16x32_bf16 v[68:71], v[144:147], v[124:127], v[68:71]
v_mfma_f32_16x16x32_bf16 v[76:79], v[148:151], v[124:127], v[76:79]
s_lshl_b32 s30, s40, 16
s_lshl_b32 s29, s14, 14
s_add_u32 s30, s30, s29
s_add_u32 s30, s30, 1605632
s_add_u32 s29, s30, 0
buffer_load_dwordx4 v[144:147], v1, s[4:7], s29 offen offset:0 sc1
buffer_load_dwordx4 v[148:151], v1, s[4:7], s29 offen offset:1024 sc1
buffer_load_dwordx4 v[152:155], v1, s[4:7], s29 offen offset:2048 sc1
s_lshl_b32 s16, s14, 9
s_add_u32 s16, s16, 160768
v_and_b32 v130, 15, v0
v_lshrrev_b32 v131, 4, v0
v_lshl_add_u32 v132, v130, 2, s16
v_lshl_add_u32 v133, v131, 4, s16
ds_read_b32 v112, v132 offset:320
ds_read_b32 v113, v132 offset:384
ds_read_b32 v114, v132 offset:448
ds_read_b128 v[116:119], v133 offset:320
ds_read_b128 v[120:123], v133 offset:384
ds_read_b128 v[124:127], v133 offset:448
v_cvt_pk_bf16_f32 v92, v16, v17
v_cvt_pk_bf16_f32 v93, v18, v19
v_cvt_pk_bf16_f32 v94, v20, v21
v_cvt_pk_bf16_f32 v95, v22, v23
v_cvt_pk_bf16_f32 v96, v24, v25
v_cvt_pk_bf16_f32 v97, v26, v27
v_cvt_pk_bf16_f32 v98, v28, v29
v_cvt_pk_bf16_f32 v99, v30, v31
s_cmp_eq_u32 s21, 1
s_cselect_b64 vcc, -1, 0
v_mov_b32 v140, 0xf149f2ca
s_waitcnt lgkmcnt(5)
v_mul_f32 v32, v32, v112
v_mul_f32 v33, v33, v112
v_mul_f32 v34, v34, v112
v_mul_f32 v35, v35, v112
v_cvt_pk_bf16_f32 v80, v32, v33
v_cvt_pk_bf16_f32 v81, v34, v35
v_mul_f32 v36, v36, v112
v_mul_f32 v37, v37, v112
v_mul_f32 v38, v38, v112
v_mul_f32 v39, v39, v112
v_cvt_pk_bf16_f32 v82, v36, v37
v_cvt_pk_bf16_f32 v83, v38, v39
s_waitcnt lgkmcnt(4)
v_mul_f32 v40, v40, v113
v_mul_f32 v41, v41, v113
v_mul_f32 v42, v42, v113
v_mul_f32 v43, v43, v113
v_cvt_pk_bf16_f32 v84, v40, v41
v_cvt_pk_bf16_f32 v85, v42, v43
v_mul_f32 v44, v44, v113
v_mul_f32 v45, v45, v113
v_mul_f32 v46, v46, v113
v_mul_f32 v47, v47, v113
v_cvt_pk_bf16_f32 v86, v44, v45
v_cvt_pk_bf16_f32 v87, v46, v47
s_waitcnt lgkmcnt(3)
v_mul_f32 v48, v48, v114
v_mul_f32 v49, v49, v114
v_mul_f32 v50, v50, v114
v_mul_f32 v51, v51, v114
v_cvt_pk_bf16_f32 v88, v48, v49
v_cvt_pk_bf16_f32 v89, v50, v51
v_mul_f32 v52, v52, v114
v_mul_f32 v53, v53, v114
v_mul_f32 v54, v54, v114
v_mul_f32 v55, v55, v114
v_cvt_pk_bf16_f32 v90, v52, v53
v_cvt_pk_bf16_f32 v91, v54, v55
v_cndmask_b32 v136, v140, v216, vcc
v_cndmask_b32 v137, v140, v217, vcc
v_cndmask_b32 v138, v140, v218, vcc
v_cndmask_b32 v139, v140, v219, vcc
v_mul_f32 v141, 0x3e8b97f6, v113
v_mul_f32 v142, 0x3e8b97f6, v114
v_mfma_f32_16x16x32_bf16 v[16:19], v[80:83], v[92:95], v[136:139]
v_mfma_f32_16x16x32_bf16 v[20:23], v[84:87], v[92:95], v[220:223]
v_mfma_f32_16x16x32_bf16 v[24:27], v[84:87], v[96:99], v[216:219]
v_mfma_f32_16x16x32_bf16 v[28:31], v[88:91], v[96:99], v[220:223]
s_waitcnt lgkmcnt(2)
v_mul_f32 v56, v56, v116
v_mul_f32 v57, v57, v117
v_mul_f32 v58, v58, v118
v_mul_f32 v59, v59, v119
v_cvt_pk_bf16_f32 v100, v56, v57
v_cvt_pk_bf16_f32 v101, v58, v59
v_mul_f32 v60, v60, v116
v_mul_f32 v61, v61, v117
v_max3_f32 v40, v16, v17, v18
v_max3_f32 v41, v19, v20, v21
v_max3_f32 v40, v40, v22, v23
v_max_f32 v40, v40, v41
v_max3_f32 v44, v24, v25, v26
v_max3_f32 v45, v27, v28, v29
v_max3_f32 v44, v44, v30, v31
v_max_f32 v44, v44, v45
v_mov_b32 v41, v40
v_mov_b32 v45, v44
v_mul_f32 v62, v62, v118
v_mul_f32 v63, v63, v119
v_permlane16_swap_b32 v40, v41
v_permlane16_swap_b32 v44, v45
v_max_f32 v40, v40, v41
v_max_f32 v44, v44, v45
v_mov_b32 v41, v40
v_mov_b32 v45, v44
v_cvt_pk_bf16_f32 v106, v60, v61
v_cvt_pk_bf16_f32 v107, v62, v63
v_permlane32_swap_b32 v40, v41
v_permlane32_swap_b32 v44, v45
v_max_f32 v40, v40, v41
v_max_f32 v44, v44, v45
v_mul_f32 v40, v40, v141
v_mul_f32 v44, v44, v142
v_fma_f32 v16, v16, v141, -v40
v_fma_f32 v17, v17, v141, -v40
v_fma_f32 v18, v18, v141, -v40
v_fma_f32 v19, v19, v141, -v40
v_fma_f32 v20, v20, v141, -v40
v_fma_f32 v21, v21, v141, -v40
v_fma_f32 v22, v22, v141, -v40
v_fma_f32 v23, v23, v141, -v40
v_fma_f32 v24, v24, v142, -v44
v_fma_f32 v25, v25, v142, -v44
v_fma_f32 v26, v26, v142, -v44
v_fma_f32 v27, v27, v142, -v44
v_fma_f32 v28, v28, v142, -v44
v_fma_f32 v29, v29, v142, -v44
v_fma_f32 v30, v30, v142, -v44
v_fma_f32 v31, v31, v142, -v44
v_exp_f32 v16, v16
v_exp_f32 v17, v17
v_exp_f32 v18, v18
v_exp_f32 v19, v19
v_exp_f32 v20, v20
v_exp_f32 v21, v21
v_exp_f32 v22, v22
v_exp_f32 v23, v23
v_exp_f32 v24, v24
v_exp_f32 v25, v25
v_exp_f32 v26, v26
v_exp_f32 v27, v27
v_exp_f32 v28, v28
v_exp_f32 v29, v29
v_exp_f32 v30, v30
v_exp_f32 v31, v31
s_waitcnt lgkmcnt(1)
v_mul_f32 v64, v64, v120
v_add_f32 v40, v16, v17
v_add_f32 v41, v18, v19
v_add_f32 v42, v20, v21
v_add_f32 v43, v22, v23
v_add_f32 v40, v40, v41
v_add_f32 v42, v42, v43
v_add_f32 v40, v40, v42
v_add_f32 v44, v24, v25
v_add_f32 v45, v26, v27
v_add_f32 v46, v28, v29
v_add_f32 v47, v30, v31
v_add_f32 v44, v44, v45
v_add_f32 v46, v46, v47
v_add_f32 v44, v44, v46
v_mov_b32 v41, v40
v_mov_b32 v45, v44
v_mul_f32 v65, v65, v121
v_mul_f32 v66, v66, v122
v_permlane16_swap_b32 v40, v41
v_permlane16_swap_b32 v44, v45
v_add_f32 v40, v40, v41
v_add_f32 v44, v44, v45
v_mov_b32 v41, v40
v_mov_b32 v45, v44
v_mul_f32 v67, v67, v123
v_cvt_pk_bf16_f32 v102, v64, v65
v_permlane32_swap_b32 v40, v41
v_permlane32_swap_b32 v44, v45
v_add_f32 v40, v40, v41
v_add_f32 v44, v44, v45
v_rcp_f32 v40, v40
v_rcp_f32 v44, v44
v_cvt_pk_bf16_f32 v103, v66, v67
v_mul_f32 v68, v68, v120
v_mul_f32 v69, v69, v121
v_mul_f32 v70, v70, v122
v_mul_f32 v71, v71, v123
v_cvt_pk_bf16_f32 v108, v68, v69
v_cvt_pk_bf16_f32 v109, v70, v71
s_waitcnt lgkmcnt(0)
v_mul_f32 v72, v72, v124
v_mul_f32 v73, v73, v125
v_mul_f32 v74, v74, v126
v_mul_f32 v75, v75, v127
v_cvt_pk_bf16_f32 v104, v72, v73
v_cvt_pk_bf16_f32 v105, v74, v75
v_mul_f32 v76, v76, v124
v_mul_f32 v77, v77, v125
v_mul_f32 v78, v78, v126
v_mul_f32 v79, v79, v127
v_cvt_pk_bf16_f32 v110, v76, v77
v_cvt_pk_bf16_f32 v111, v78, v79
v_mul_f32 v16, v16, v40
v_mul_f32 v17, v17, v40
v_mul_f32 v18, v18, v40
v_mul_f32 v19, v19, v40
v_mul_f32 v20, v20, v40
v_mul_f32 v21, v21, v40
v_mul_f32 v22, v22, v40
v_mul_f32 v23, v23, v40
v_cvt_pk_bf16_f32 v32, v16, v17
v_cvt_pk_bf16_f32 v33, v18, v19
v_cvt_pk_bf16_f32 v34, v20, v21
v_cvt_pk_bf16_f32 v35, v22, v23
s_nop 1
v_mfma_f32_16x16x32_bf16 v[48:51], v[100:103], v[32:35], 0
v_mfma_f32_16x16x32_bf16 v[52:55], v[106:109], v[32:35], 0
v_mul_f32 v24, v24, v44
v_mul_f32 v25, v25, v44
v_mul_f32 v26, v26, v44
v_mul_f32 v27, v27, v44
v_mul_f32 v28, v28, v44
v_mul_f32 v29, v29, v44
v_mul_f32 v30, v30, v44
v_mul_f32 v31, v31, v44
v_cvt_pk_bf16_f32 v36, v24, v25
v_cvt_pk_bf16_f32 v37, v26, v27
v_cvt_pk_bf16_f32 v38, v28, v29
v_cvt_pk_bf16_f32 v39, v30, v31
s_nop 1
v_mfma_f32_16x16x32_bf16 v[56:59], v[102:105], v[36:39], 0
v_mfma_f32_16x16x32_bf16 v[60:63], v[108:111], v[36:39], 0
v_cvt_pk_bf16_f32 v64, v48, v49
v_cvt_pk_bf16_f32 v65, v50, v51
v_cvt_pk_bf16_f32 v66, v52, v53
v_cvt_pk_bf16_f32 v67, v54, v55
buffer_store_dwordx4 v[64:67], v1, s[4:7], s28 offen sc1
s_nop 1
v_cvt_pk_bf16_f32 v68, v56, v57
v_cvt_pk_bf16_f32 v69, v58, v59
v_cvt_pk_bf16_f32 v70, v60, v61
v_cvt_pk_bf16_f32 v71, v62, v63
s_add_u32 s28, s28, 16384
buffer_store_dwordx4 v[68:71], v1, s[4:7], s28 offen sc1
s_add_u32 s16, s42, 4
s_lshl_b32 s19, s16, 11
s_mul_i32 s18, s16, 28
s_lshl_b32 s16, s16, 1
s_lshr_b32 s17, s14, 1
s_add_u32 s16, s16, s17
s_lshl_b32 s20, s16, 14
s_and_b32 s17, s14, 1
s_lshl_b32 s17, s17, 12
s_add_u32 s20, s20, s17
s_add_u32 s20, s20, 5275648
s_lshl_b32 s17, s40, 8
s_add_u32 s19, s19, s17
s_add_u32 s19, s19, 16547840
s_lshr_b32 s17, s50, 1
s_add_u32 s19, s19, s17
s_lshl_b32 s21, s14, 12
s_add_u32 s21, s21, 86016
s_lshl_b32 s16, s40, 2
s_add_u32 s18, s18, s16
s_add_u32 s18, s18, s14
s_lshl_b32 s18, s18, 10
s_add_u32 s18, s18, 7372800
v_add_u32 v2, 86016, v1
v_and_b32 v3, 15, v0
v_lshrrev_b32 v4, 5, v0
v_lshl_add_u32 v3, v4, 4, v3
v_lshlrev_b32 v3, 4, v3
v_bfe_u32 v4, v0, 4, 1
v_lshl_add_u32 v3, v4, 9, v3
v_lshlrev_b32 v6, 2, v0
v_add_u32 v5, 160768, v6
s_lshl_b32 s16, s14, 8
v_add_u32 v4, s16, v5
s_waitcnt vmcnt(0)
s_barrier
s_add_u32 s3, s32, 7
v_bfrev_b32 v76, 1
v_mov_b32 v77, s3
v_writelane_b32 v76, s50, 0
buffer_store_dword v77, v76, s[4:7], s46 offen sc1
s_cmp_ge_u32 s13, 28
s_cbranch_scc1 interleave_layers__sliding_local_dilated__glu_gated_swiglu__prompt_kernel_h2G
s_cmp_lg_u32 s14, 0
s_cbranch_scc1 L_wt_29
v_lshlrev_b32 v72, 7, v0
s_add_u32 s3, s32, 7
s_mov_b32 s15, 0
buffer_load_dword v73, v72, s[4:7], s43 offen sc1
s_sleep 1
buffer_load_dword v74, v72, s[4:7], s43 offen sc1
s_sleep 1
L_wt_29_p:
buffer_load_dword v75, v72, s[4:7], s43 offen sc1
s_waitcnt vmcnt(2)
v_subrev_u32 v73, s3, v73
v_cmp_le_u32 vcc, 9, v73
s_nop 0
s_and_b64 vcc, vcc, s[38:39]
s_cbranch_scc0 L_wt_29
buffer_load_dword v73, v72, s[4:7], s43 offen sc1
s_waitcnt vmcnt(2)
v_subrev_u32 v74, s3, v74
v_cmp_le_u32 vcc, 9, v74
s_nop 0
s_and_b64 vcc, vcc, s[38:39]
s_cbranch_scc0 L_wt_29
buffer_load_dword v74, v72, s[4:7], s43 offen sc1
s_waitcnt vmcnt(2)
v_subrev_u32 v75, s3, v75
v_cmp_le_u32 vcc, 9, v75
s_nop 0
s_and_b64 vcc, vcc, s[38:39]
s_cbranch_scc0 L_wt_29
s_add_u32 s15, s15, 1
s_cmp_lt_u32 s15, 131072
s_cbranch_scc1 L_wt_29_p
L_wt_29:
s_barrier
s_add_u32 m0, s21, 0
s_add_u32 s31, s20, 0x0
buffer_load_dwordx4 v1, s[4:7], s31 offen offset:0 sc1 lds
buffer_load_dwordx4 v1, s[4:7], s31 offen offset:1024 sc1 lds
buffer_load_dwordx4 v1, s[4:7], s31 offen offset:2048 sc1 lds
buffer_load_dwordx4 v1, s[4:7], s31 offen offset:3072 sc1 lds
s_add_u32 m0, s21, 16384
s_add_u32 s31, s20, 0x2000
buffer_load_dwordx4 v1, s[4:7], s31 offen offset:0 sc1 lds
buffer_load_dwordx4 v1, s[4:7], s31 offen offset:1024 sc1 lds
buffer_load_dwordx4 v1, s[4:7], s31 offen offset:2048 sc1 lds
buffer_load_dwordx4 v1, s[4:7], s31 offen offset:3072 sc1 lds
v_lshlrev_b32 v32, 16, v8
v_and_b32 v33, 0xffff0000, v8
v_lshlrev_b32 v34, 16, v9
v_and_b32 v35, 0xffff0000, v9
v_lshlrev_b32 v36, 16, v10
v_and_b32 v37, 0xffff0000, v10
v_lshlrev_b32 v38, 16, v11
v_and_b32 v39, 0xffff0000, v11
v_lshlrev_b32 v40, 16, v12
v_and_b32 v41, 0xffff0000, v12
v_lshlrev_b32 v42, 16, v13
v_and_b32 v43, 0xffff0000, v13
v_lshlrev_b32 v44, 16, v14
v_and_b32 v45, 0xffff0000, v14
v_lshlrev_b32 v46, 16, v15
v_and_b32 v47, 0xffff0000, v15
s_waitcnt vmcnt(4)
s_barrier
ds_read_b128 v[48:51], v2 offset:0
s_add_u32 m0, s21, 32768
ds_read_b128 v[52:55], v2 offset:8192
s_add_u32 s31, s20, 0xfffe0000
ds_read_b128 v[56:59], v2 offset:1024
buffer_load_dwordx4 v1, s[4:7], s31 offen offset:0 sc1 lds
ds_read_b128 v[60:63], v2 offset:9216
buffer_load_dwordx4 v1, s[4:7], s31 offen offset:1024 sc1 lds
ds_read_b128 v[64:67], v2 offset:2048
buffer_load_dwordx4 v1, s[4:7], s31 offen offset:2048 sc1 lds
ds_read_b128 v[68:71], v2 offset:10240
buffer_load_dwordx4 v1, s[4:7], s31 offen offset:3072 sc1 lds
ds_read_b128 v[72:75], v2 offset:3072
s_add_u32 m0, s21, 49152
ds_read_b128 v[76:79], v2 offset:11264
s_add_u32 s31, s20, 0xfffe2000
s_waitcnt lgkmcnt(7)
v_mfma_f32_16x16x32_bf16 v[24:27], v[144:147], v[48:51], v[40:43]
ds_read_b128 v[80:83], v2 offset:4096
buffer_load_dwordx4 v1, s[4:7], s31 offen offset:0 sc1 lds
s_waitcnt lgkmcnt(7)
v_mfma_f32_16x16x32_bf16 v[28:31], v[144:147], v[52:55], v[44:47]
ds_read_b128 v[84:87], v2 offset:12288
buffer_load_dwordx4 v1, s[4:7], s31 offen offset:1024 sc1 lds
s_waitcnt lgkmcnt(7)
v_mfma_f32_16x16x32_bf16 v[24:27], v[148:151], v[56:59], v[24:27]
ds_read_b128 v[88:91], v2 offset:5120
buffer_load_dwordx4 v1, s[4:7], s31 offen offset:2048 sc1 lds
s_waitcnt lgkmcnt(7)
v_mfma_f32_16x16x32_bf16 v[28:31], v[148:151], v[60:63], v[28:31]
ds_read_b128 v[92:95], v2 offset:13312
buffer_load_dwordx4 v1, s[4:7], s31 offen offset:3072 sc1 lds
s_waitcnt lgkmcnt(7)
v_mfma_f32_16x16x32_bf16 v[24:27], v[152:155], v[64:67], v[24:27]
ds_read_b128 v[96:99], v2 offset:6144
s_waitcnt lgkmcnt(7)
v_mfma_f32_16x16x32_bf16 v[28:31], v[152:155], v[68:71], v[28:31]
ds_read_b128 v[100:103], v2 offset:14336
s_waitcnt lgkmcnt(7)
v_mfma_f32_16x16x32_bf16 v[24:27], v[156:159], v[72:75], v[24:27]
ds_read_b128 v[104:107], v2 offset:7168
s_waitcnt lgkmcnt(7)
v_mfma_f32_16x16x32_bf16 v[28:31], v[156:159], v[76:79], v[28:31]
ds_read_b128 v[108:111], v2 offset:15360
s_waitcnt vmcnt(8)
s_barrier
s_waitcnt lgkmcnt(7)
v_mfma_f32_16x16x32_bf16 v[24:27], v[160:163], v[80:83], v[24:27]
ds_read_b128 v[48:51], v2 offset:16384
s_mul_i32 s30, s40, 229376
s_waitcnt lgkmcnt(7)
v_mfma_f32_16x16x32_bf16 v[28:31], v[160:163], v[84:87], v[28:31]
ds_read_b128 v[52:55], v2 offset:24576
s_mul_i32 s29, s14, 57344
s_waitcnt lgkmcnt(7)
v_mfma_f32_16x16x32_bf16 v[24:27], v[164:167], v[88:91], v[24:27]
ds_read_b128 v[56:59], v2 offset:17408
s_add_u32 s30, s30, s29
s_waitcnt lgkmcnt(7)
v_mfma_f32_16x16x32_bf16 v[28:31], v[164:167], v[92:95], v[28:31]
ds_read_b128 v[60:63], v2 offset:25600
s_add_u32 s30, s30, 0
s_waitcnt lgkmcnt(7)
v_mfma_f32_16x16x32_bf16 v[24:27], v[168:171], v[96:99], v[24:27]
ds_read_b128 v[64:67], v2 offset:18432
s_add_u32 s29, s30, 49152
s_waitcnt lgkmcnt(7)
v_mfma_f32_16x16x32_bf16 v[28:31], v[168:171], v[100:103], v[28:31]
ds_read_b128 v[68:71], v2 offset:26624
buffer_load_dwordx4 v[232:235], v1, s[4:7], s29 offen offset:2048 sc1
s_waitcnt lgkmcnt(7)
v_mfma_f32_16x16x32_bf16 v[24:27], v[172:175], v[104:107], v[24:27]
ds_read_b128 v[72:75], v2 offset:19456
buffer_load_dwordx4 v[236:239], v1, s[4:7], s29 offen offset:3072 sc1
s_waitcnt lgkmcnt(7)
v_mfma_f32_16x16x32_bf16 v[28:31], v[172:175], v[108:111], v[28:31]
ds_read_b128 v[76:79], v2 offset:27648
s_add_u32 s29, s30, 53248
s_waitcnt lgkmcnt(7)
v_mfma_f32_16x16x32_bf16 v[24:27], v[176:179], v[48:51], v[24:27]
ds_read_b128 v[80:83], v2 offset:20480
buffer_load_dwordx4 v[240:243], v1, s[4:7], s29 offen offset:0 sc1
s_waitcnt lgkmcnt(7)
v_mfma_f32_16x16x32_bf16 v[28:31], v[176:179], v[52:55], v[28:31]
ds_read_b128 v[84:87], v2 offset:28672
buffer_load_dwordx4 v[244:247], v1, s[4:7], s29 offen offset:1024 sc1
s_waitcnt lgkmcnt(7)
v_mfma_f32_16x16x32_bf16 v[24:27], v[180:183], v[56:59], v[24:27]
ds_read_b128 v[88:91], v2 offset:21504
buffer_load_dwordx4 v[248:251], v1, s[4:7], s29 offen offset:2048 sc1
s_waitcnt lgkmcnt(7)
v_mfma_f32_16x16x32_bf16 v[28:31], v[180:183], v[60:63], v[28:31]
ds_read_b128 v[92:95], v2 offset:29696
buffer_load_dwordx4 v[252:255], v1, s[4:7], s29 offen offset:3072 sc1
s_waitcnt lgkmcnt(7)
v_mfma_f32_16x16x32_bf16 v[24:27], v[184:187], v[64:67], v[24:27]
ds_read_b128 v[96:99], v2 offset:22528
s_waitcnt lgkmcnt(7)
v_mfma_f32_16x16x32_bf16 v[28:31], v[184:187], v[68:71], v[28:31]
ds_read_b128 v[100:103], v2 offset:30720
s_waitcnt lgkmcnt(7)
v_mfma_f32_16x16x32_bf16 v[24:27], v[188:191], v[72:75], v[24:27]
ds_read_b128 v[104:107], v2 offset:23552
s_waitcnt lgkmcnt(7)
v_mfma_f32_16x16x32_bf16 v[28:31], v[188:191], v[76:79], v[28:31]
ds_read_b128 v[108:111], v2 offset:31744
s_waitcnt vmcnt(10)
s_barrier
s_waitcnt lgkmcnt(7)
v_mfma_f32_16x16x32_bf16 v[24:27], v[192:195], v[80:83], v[24:27]
ds_read_b128 v[48:51], v2 offset:32768
s_waitcnt lgkmcnt(7)
v_mfma_f32_16x16x32_bf16 v[28:31], v[192:195], v[84:87], v[28:31]
ds_read_b128 v[52:55], v2 offset:40960
s_waitcnt lgkmcnt(7)
v_mfma_f32_16x16x32_bf16 v[24:27], v[196:199], v[88:91], v[24:27]
ds_read_b128 v[56:59], v2 offset:33792
s_waitcnt lgkmcnt(7)
v_mfma_f32_16x16x32_bf16 v[28:31], v[196:199], v[92:95], v[28:31]
ds_read_b128 v[60:63], v2 offset:41984
s_waitcnt lgkmcnt(7)
v_mfma_f32_16x16x32_bf16 v[24:27], v[200:203], v[96:99], v[24:27]
ds_read_b128 v[64:67], v2 offset:34816
s_waitcnt lgkmcnt(7)
v_mfma_f32_16x16x32_bf16 v[28:31], v[200:203], v[100:103], v[28:31]
ds_read_b128 v[68:71], v2 offset:43008
s_waitcnt lgkmcnt(7)
v_mfma_f32_16x16x32_bf16 v[24:27], v[204:207], v[104:107], v[24:27]
ds_read_b128 v[72:75], v2 offset:35840
s_waitcnt lgkmcnt(7)
v_mfma_f32_16x16x32_bf16 v[28:31], v[204:207], v[108:111], v[28:31]
ds_read_b128 v[76:79], v2 offset:44032
s_waitcnt lgkmcnt(7)
v_mfma_f32_16x16x32_bf16 v[16:19], v[144:147], v[48:51], v[32:35]
ds_read_b128 v[80:83], v2 offset:36864
s_waitcnt lgkmcnt(7)
v_mfma_f32_16x16x32_bf16 v[20:23], v[144:147], v[52:55], v[36:39]
ds_read_b128 v[84:87], v2 offset:45056
s_waitcnt lgkmcnt(7)
v_mfma_f32_16x16x32_bf16 v[16:19], v[148:151], v[56:59], v[16:19]
ds_read_b128 v[88:91], v2 offset:37888
v_cvt_pk_bf16_f32 v112, v24, v25
s_waitcnt lgkmcnt(7)
v_mfma_f32_16x16x32_bf16 v[20:23], v[148:151], v[60:63], v[20:23]
ds_read_b128 v[92:95], v2 offset:46080
v_cvt_pk_bf16_f32 v113, v26, v27
v_cvt_pk_bf16_f32 v114, v28, v29
s_waitcnt lgkmcnt(7)
v_mfma_f32_16x16x32_bf16 v[16:19], v[152:155], v[64:67], v[16:19]
ds_read_b128 v[96:99], v2 offset:38912
v_cvt_pk_bf16_f32 v115, v30, v31
s_waitcnt lgkmcnt(7)
v_mfma_f32_16x16x32_bf16 v[20:23], v[152:155], v[68:71], v[20:23]
ds_read_b128 v[100:103], v2 offset:47104
v_add_f32 v116, v24, v25
v_mul_f32 v117, v24, v24
s_waitcnt lgkmcnt(7)
v_mfma_f32_16x16x32_bf16 v[16:19], v[156:159], v[72:75], v[16:19]
ds_read_b128 v[104:107], v2 offset:39936
v_add_f32 v118, v28, v29
s_waitcnt lgkmcnt(7)
v_mfma_f32_16x16x32_bf16 v[20:23], v[156:159], v[76:79], v[20:23]
ds_read_b128 v[108:111], v2 offset:48128
v_mul_f32 v119, v28, v28
v_permlane32_swap_b32 v112, v114
s_waitcnt vmcnt(6)
s_barrier
s_waitcnt lgkmcnt(7)
v_mfma_f32_16x16x32_bf16 v[16:19], v[160:163], v[80:83], v[16:19]
ds_read_b128 v[48:51], v2 offset:49152
v_permlane32_swap_b32 v113, v115
s_waitcnt lgkmcnt(7)
v_mfma_f32_16x16x32_bf16 v[20:23], v[160:163], v[84:87], v[20:23]
ds_read_b128 v[52:55], v2 offset:57344
buffer_store_dwordx4 v[112:115], v3, s[4:7], s18 offen sc1
v_fmac_f32 v117, v25, v25
s_waitcnt lgkmcnt(7)
v_mfma_f32_16x16x32_bf16 v[16:19], v[164:167], v[88:91], v[16:19]
ds_read_b128 v[56:59], v2 offset:50176
v_fmac_f32 v119, v29, v29
s_waitcnt lgkmcnt(7)
v_mfma_f32_16x16x32_bf16 v[20:23], v[164:167], v[92:95], v[20:23]
ds_read_b128 v[60:63], v2 offset:58368
v_add_f32 v116, v116, v26
v_fmac_f32 v117, v26, v26
s_waitcnt lgkmcnt(7)
v_mfma_f32_16x16x32_bf16 v[16:19], v[168:171], v[96:99], v[16:19]
ds_read_b128 v[64:67], v2 offset:51200
v_add_f32 v118, v118, v30
s_waitcnt lgkmcnt(7)
v_mfma_f32_16x16x32_bf16 v[20:23], v[168:171], v[100:103], v[20:23]
ds_read_b128 v[68:71], v2 offset:59392
v_fmac_f32 v119, v30, v30
v_add_f32 v116, v116, v27
s_waitcnt lgkmcnt(7)
v_mfma_f32_16x16x32_bf16 v[16:19], v[172:175], v[104:107], v[16:19]
ds_read_b128 v[72:75], v2 offset:52224
v_fmac_f32 v117, v27, v27
s_waitcnt lgkmcnt(7)
v_mfma_f32_16x16x32_bf16 v[20:23], v[172:175], v[108:111], v[20:23]
ds_read_b128 v[76:79], v2 offset:60416
v_add_f32 v118, v118, v31
v_fmac_f32 v119, v31, v31
s_waitcnt lgkmcnt(7)
v_mfma_f32_16x16x32_bf16 v[16:19], v[176:179], v[48:51], v[16:19]
ds_read_b128 v[80:83], v2 offset:53248
v_permlane32_swap_b32 v116, v117
s_waitcnt lgkmcnt(7)
v_mfma_f32_16x16x32_bf16 v[20:23], v[176:179], v[52:55], v[20:23]
ds_read_b128 v[84:87], v2 offset:61440
v_permlane32_swap_b32 v118, v119
v_add_f32 v116, v116, v117
s_waitcnt lgkmcnt(7)
v_mfma_f32_16x16x32_bf16 v[16:19], v[180:183], v[56:59], v[16:19]
ds_read_b128 v[88:91], v2 offset:54272
v_add_f32 v118, v118, v119
s_waitcnt lgkmcnt(7)
v_mfma_f32_16x16x32_bf16 v[20:23], v[180:183], v[60:63], v[20:23]
ds_read_b128 v[92:95], v2 offset:62464
v_permlane16_swap_b32 v116, v118
v_add_f32 v116, v116, v118
s_waitcnt lgkmcnt(7)
v_mfma_f32_16x16x32_bf16 v[16:19], v[184:187], v[64:67], v[16:19]
ds_read_b128 v[96:99], v2 offset:55296
ds_write_b32 v4, v116 offset:1024
s_waitcnt lgkmcnt(8)
v_mfma_f32_16x16x32_bf16 v[20:23], v[184:187], v[68:71], v[20:23]
ds_read_b128 v[100:103], v2 offset:63488
s_waitcnt lgkmcnt(8)
v_mfma_f32_16x16x32_bf16 v[16:19], v[188:191], v[72:75], v[16:19]
ds_read_b128 v[104:107], v2 offset:56320
s_waitcnt lgkmcnt(8)
v_mfma_f32_16x16x32_bf16 v[20:23], v[188:191], v[76:79], v[20:23]
ds_read_b128 v[108:111], v2 offset:64512
s_waitcnt lgkmcnt(3)
s_barrier
v_mfma_f32_16x16x32_bf16 v[16:19], v[192:195], v[80:83], v[16:19]
ds_read2st64_b32 v[120:121], v5 offset0:4 offset1:5
ds_read2st64_b32 v[122:123], v5 offset0:6 offset1:7
v_mfma_f32_16x16x32_bf16 v[20:23], v[192:195], v[84:87], v[20:23]
s_waitcnt lgkmcnt(1)
v_add_f32 v120, v120, v121
s_waitcnt lgkmcnt(0)
v_add_f32 v122, v122, v123
v_mfma_f32_16x16x32_bf16 v[16:19], v[196:199], v[88:91], v[16:19]
v_add_f32 v120, v120, v122
buffer_store_dword v120, v6, s[4:7], s19 offen sc1
v_mfma_f32_16x16x32_bf16 v[20:23], v[196:199], v[92:95], v[20:23]
v_mfma_f32_16x16x32_bf16 v[16:19], v[200:203], v[96:99], v[16:19]
v_mfma_f32_16x16x32_bf16 v[20:23], v[200:203], v[100:103], v[20:23]
v_mfma_f32_16x16x32_bf16 v[16:19], v[204:207], v[104:107], v[16:19]
v_mfma_f32_16x16x32_bf16 v[20:23], v[204:207], v[108:111], v[20:23]
s_nop 6
v_cvt_pk_bf16_f32 v124, v16, v17
v_cvt_pk_bf16_f32 v125, v18, v19
v_cvt_pk_bf16_f32 v126, v20, v21
v_cvt_pk_bf16_f32 v127, v22, v23
v_add_f32 v48, v16, v17
v_mul_f32 v49, v16, v16
v_add_f32 v50, v20, v21
v_mul_f32 v51, v20, v20
v_permlane32_swap_b32 v124, v126
v_permlane32_swap_b32 v125, v127
s_sub_u32 s18, s18, 114688
buffer_store_dwordx4 v[124:127], v3, s[4:7], s18 offen sc1
v_fmac_f32 v49, v17, v17
v_fmac_f32 v51, v21, v21
v_add_f32 v48, v48, v18
v_fmac_f32 v49, v18, v18
v_add_f32 v50, v50, v22
v_fmac_f32 v51, v22, v22
v_add_f32 v48, v48, v19
v_fmac_f32 v49, v19, v19
v_add_f32 v50, v50, v23
v_fmac_f32 v51, v23, v23
v_permlane32_swap_b32 v48, v49
s_nop 0
v_permlane32_swap_b32 v50, v51
v_add_f32 v48, v48, v49
v_add_f32 v50, v50, v51
s_nop 1
v_permlane16_swap_b32 v48, v50
v_add_f32 v48, v48, v50
ds_write_b32 v4, v48 offset:0
s_waitcnt vmcnt(1)
s_waitcnt lgkmcnt(0)
s_barrier
ds_read2st64_b32 v[60:61], v5 offset0:0 offset1:1
ds_read2st64_b32 v[62:63], v5 offset0:2 offset1:3
s_add_u32 s3, s32, 8
v_bfrev_b32 v128, 1
v_mov_b32 v129, s3
v_writelane_b32 v128, s50, 0
buffer_store_dword v129, v128, s[4:7], s46 offen sc1
s_waitcnt lgkmcnt(1)
v_add_f32 v60, v60, v61
s_waitcnt lgkmcnt(0)
v_add_f32 v62, v62, v63
v_add_f32 v60, v60, v62
s_sub_u32 s19, s19, 8192
buffer_store_dword v60, v6, s[4:7], s19 offen sc1
v_lshlrev_b32 v130, 7, v0
buffer_load_dword v132, v130, s[4:7], s43 offen sc1
s_load_dwordx2 s[8:9], s[0:1], 56
s_mov_b32 s10, 1835008
s_mov_b32 s11, 0x20000
s_waitcnt lgkmcnt(0)
s_and_b32 s9, s9, 0xffff
s_lshl_b32 s16, s14, 7
s_add_u32 s16, s16, 160256
v_lshrrev_b32 v148, 5, v0
v_lshl_add_u32 v148, v148, 6, s16
ds_read_b128 v[80:83], v148 offset:0
ds_read_b128 v[84:87], v148 offset:16
ds_read_b128 v[88:91], v148 offset:32
ds_read_b128 v[92:95], v148 offset:48
s_lshl_b32 s16, s13, 2
s_add_u32 s16, s16, s14
s_lshl_b32 s20, s12, 3
s_mul_i32 s26, s20, 224
s_add_u32 s26, s26, s16
s_lshl_b32 s26, s26, 9
s_add_u32 s26, s26, 9666560
v_bfe_u32 v119, v0, 4, 1
v_mul_u32_u24 v119, 57344, v119
v_lshrrev_b32 v6, 5, v0
v_lshl_add_u32 v119, v6, 8, v119
v_and_b32 v6, 15, v0
v_lshl_add_u32 v119, v6, 4, v119
s_add_u32 s16, s14, s20
s_lshl_b32 s25, s16, 11
s_add_u32 s25, s25, 16547840
s_add_u32 s24, s25, 8192
s_mul_i32 s22, s20, 28672
s_mul_i32 s16, s14, 7168
s_add_u32 s22, s22, s16
s_add_u32 s22, s22, 7372800
s_mul_i32 s23, s14, 17408
s_add_u32 s23, s23, 86016
v_add_u32 v4, 86016, v1
v_add_u32 v5, 151552, v1
v_and_b32 v6, 31, v0
v_lshlrev_b32 v6, 4, v6
v_add_u32 v6, 155648, v6
v_and_b32 v145, 7, v0
v_lshrrev_b32 v144, 4, v0
v_lshl_add_u32 v145, v145, 2, v144
s_lshl_b32 s16, s14, 9
s_add_u32 s16, s16, 155648
v_lshl_add_u32 v145, v145, 4, s16
v_cmp_gt_u32 vcc, 48, v0
v_bfrev_b32 v144, 1
s_nop 0
v_cndmask_b32 v144, v144, v1, vcc
s_waitcnt lgkmcnt(0)
s_add_u32 s3, s32, 8
s_waitcnt vmcnt(0)
v_subrev_u32 v132, s3, v132
v_cmp_le_u32 vcc, 8, v132
s_nop 0
s_and_b64 vcc, vcc, s[48:49]
s_cbranch_scc0 L_chk_30_ok
s_mov_b32 s15, 0
L_chk_30:
buffer_load_dword v132, v130, s[4:7], s43 offen sc1
s_waitcnt vmcnt(0)
s_add_u32 s3, s32, 8
v_subrev_u32 v132, s3, v132
v_cmp_le_u32 vcc, 8, v132
s_nop 0
s_and_b64 vcc, vcc, s[48:49]
s_cbranch_scc0 L_chk_30_ok
s_add_u32 s15, s15, 1
s_cmp_lt_u32 s15, 131072
s_cbranch_scc1 L_chk_30
L_chk_30_ok:
s_add_u32 m0, s23, 0
s_add_u32 s31, s22, 114688
buffer_load_dwordx4 v1, s[4:7], s31 offen offset:0 sc1 lds
buffer_load_dwordx4 v1, s[4:7], s31 offen offset:1024 sc1 lds
buffer_load_dwordx4 v1, s[4:7], s31 offen offset:2048 sc1 lds
buffer_load_dwordx4 v1, s[4:7], s31 offen offset:3072 sc1 lds
s_add_u32 m0, s23, 4096
s_add_u32 s31, s22, 118784
buffer_load_dwordx4 v1, s[4:7], s31 offen offset:0 sc1 lds
buffer_load_dwordx4 v1, s[4:7], s31 offen offset:1024 sc1 lds
buffer_load_dwordx4 v1, s[4:7], s31 offen offset:2048 sc1 lds
s_barrier
s_add_u32 s3, s32, 9
v_bfrev_b32 v76, 1
v_mov_b32 v77, s3
v_writelane_b32 v76, s50, 0
buffer_store_dword v77, v76, s[4:7], s46 offen sc1
s_add_u32 s44, s42, 4
s_mul_i32 s16, s14, 14
s_mul_i32 s20, s44, 112
s_add_u32 s20, s20, s16
s_lshl_b32 s20, s20, 10
s_add_u32 s20, s20, 9207808
s_sub_u32 s21, s20, 458752
s_add_u32 s68, s20, 57344
s_add_u32 s69, s21, 57344
s_lshl_b32 s65, s14, 13
s_add_u32 s65, s65, 86016
v_and_b32 v3, 7, v0
v_lshlrev_b32 v3, 4, v3
s_and_b32 s16, s14, 1
s_lshl_b32 s16, s16, 7
s_lshr_b32 s17, s14, 1
s_lshl_b32 s17, s17, 10
s_add_u32 s16, s16, s17
v_add_u32 v2, s16, v3
v_bfe_u32 v146, v0, 3, 1
v_lshl_add_u32 v2, v146, 8, v2
v_bfe_u32 v7, v0, 4, 1
v_lshlrev_b32 v7, 7, v7
v_xor_b32 v2, v2, v7
v_lshrrev_b32 v7, 4, v0
v_lshl_add_u32 v2, v7, 11, v2
v_add_u32 v2, 86016, v2
s_and_b32 s16, s44, 31
s_lshl_b32 s16, s16, 6
s_lshr_b32 s17, s44, 5
s_add_u32 s16, s16, s17
s_lshl_b32 s17, s14, 4
s_add_u32 s16, s16, s17
s_mul_i32 s18, s16, 896
s_lshl_b32 s16, s40, 7
s_add_u32 s18, s18, s16
v_mul_u32_u24 v3, 112, v3
v_lshl_add_u32 v3, v7, 5, v3
v_lshl_add_u32 v3, v146, 3, v3
s_mul_i32 s64, s44, 28
s_lshl_b32 s16, s40, 2
s_add_u32 s64, s64, s16
s_lshl_b32 s64, s64, 10
s_lshl_b32 s16, s14, 7
s_add_u32 s64, s64, s16
s_add_u32 s64, s64, 7372800
v_and_b32 v147, 7, v0
v_lshrrev_b32 v146, 3, v0
v_lshlrev_b32 v147, 4, v147
v_lshl_add_u32 v147, v146, 9, v147
s_sub_u32 s27, s23, 4096
s_sub_u32 s66, s64, 114688
s_waitcnt vmcnt(4)
s_barrier
ds_read_b128 v[48:51], v4 offset:0
ds_read_b128 v[52:55], v4 offset:17408
ds_read_b128 v[56:59], v4 offset:34816
ds_read_b128 v[60:63], v4 offset:52224
s_waitcnt lgkmcnt(2)
v_mfma_f32_32x32x16_bf16 v[16:31], a[0:3], v[48:51], 0
ds_read_b128 v[64:67], v4 offset:1024
buffer_load_dwordx4 v[128:131], v1, s[4:7], s24 offen sc1
v_mfma_f32_32x32x16_bf16 v[16:31], a[28:31], v[52:55], v[16:31]
ds_read_b128 v[68:71], v4 offset:18432
s_waitcnt lgkmcnt(2)
v_mfma_f32_32x32x16_bf16 v[16:31], a[56:59], v[56:59], v[16:31]
ds_read_b128 v[72:75], v4 offset:35840
buffer_load_dwordx4 v[132:135], v144, s[4:7], s24 offen offset:1024 sc1
v_mfma_f32_32x32x16_bf16 v[16:31], a[84:87], v[60:63], v[16:31]
ds_read_b128 v[76:79], v4 offset:53248
s_waitcnt lgkmcnt(2)
v_mfma_f32_32x32x16_bf16 v[16:31], a[4:7], v[64:67], v[16:31]
ds_read_b128 v[48:51], v4 offset:2048
s_add_u32 m0, s23, 7168
s_add_u32 s31, s22, 143360
buffer_load_dwordx4 v1, s[4:7], s31 offen offset:0 sc1 lds
v_mfma_f32_32x32x16_bf16 v[16:31], a[32:35], v[68:71], v[16:31]
ds_read_b128 v[52:55], v4 offset:19456
s_waitcnt lgkmcnt(2)
v_mfma_f32_32x32x16_bf16 v[16:31], a[60:63], v[72:75], v[16:31]
ds_read_b128 v[56:59], v4 offset:36864
buffer_load_dwordx4 v1, s[4:7], s31 offen offset:1024 sc1 lds
v_mfma_f32_32x32x16_bf16 v[16:31], a[88:91], v[76:79], v[16:31]
ds_read_b128 v[60:63], v4 offset:54272
s_waitcnt lgkmcnt(2)
v_mfma_f32_32x32x16_bf16 v[16:31], a[8:11], v[48:51], v[16:31]
ds_read_b128 v[64:67], v4 offset:3072
buffer_load_dwordx4 v1, s[4:7], s31 offen offset:2048 sc1 lds
v_mfma_f32_32x32x16_bf16 v[16:31], a[36:39], v[52:55], v[16:31]
s_waitcnt vmcnt(6)
s_barrier
ds_read_b128 v[68:71], v4 offset:20480
s_waitcnt lgkmcnt(2)
v_mfma_f32_32x32x16_bf16 v[16:31], a[64:67], v[56:59], v[16:31]
ds_read_b128 v[72:75], v4 offset:37888
buffer_load_dwordx4 v1, s[4:7], s31 offen offset:3072 sc1 lds
v_mfma_f32_32x32x16_bf16 v[16:31], a[92:95], v[60:63], v[16:31]
ds_read_b128 v[76:79], v4 offset:55296
s_waitcnt lgkmcnt(2)
v_mfma_f32_32x32x16_bf16 v[16:31], a[12:15], v[64:67], v[16:31]
ds_read_b128 v[48:51], v4 offset:4096
s_add_u32 m0, s23, 11264
s_add_u32 s31, s22, 147456
buffer_load_dwordx4 v1, s[4:7], s31 offen offset:0 sc1 lds
s_waitcnt vmcnt(5)
v_add_f32 v128, v128, v132
v_add_f32 v129, v129, v133
v_mfma_f32_32x32x16_bf16 v[16:31], a[40:43], v[68:71], v[16:31]
ds_read_b128 v[52:55], v4 offset:21504
v_add_f32 v130, v130, v134
v_add_f32 v131, v131, v135
s_nop 0
v_permlane32_swap_b32 v128, v130
v_permlane32_swap_b32 v129, v131
s_waitcnt lgkmcnt(2)
v_mfma_f32_32x32x16_bf16 v[16:31], a[68:71], v[72:75], v[16:31]
ds_read_b128 v[56:59], v4 offset:38912
buffer_load_dwordx4 v1, s[4:7], s31 offen offset:1024 sc1 lds
v_add_f32 v128, v128, v130
v_add_f32 v129, v129, v131
s_nop 1
v_permlane16_swap_b32 v128, v129
v_add_f32 v128, v128, v129
s_mul_i32 s30, s40, 229376
s_mul_i32 s29, s14, 57344
s_add_u32 s30, s30, s29
s_add_u32 s30, s30, 0
s_add_u32 s29, s30, 36864
buffer_load_dwordx4 v[176:179], v1, s[4:7], s29 offen offset:0 sc1
v_mfma_f32_32x32x16_bf16 v[16:31], a[96:99], v[76:79], v[16:31]
ds_read_b128 v[60:63], v4 offset:56320
v_mul_f32 v128, 0x3b124925, v128
s_nop 1
v_mov_b32_dpp v129, v128 row_ror:8 row_mask:0xf bank_mask:0xf
v_fma_f32 v129, -v128, v128, v129
v_max_f32 v129, 0, v129
s_waitcnt lgkmcnt(2)
v_mfma_f32_32x32x16_bf16 v[16:31], a[16:19], v[48:51], v[16:31]
ds_read_b128 v[64:67], v4 offset:5120
buffer_load_dwordx4 v1, s[4:7], s31 offen offset:2048 sc1 lds
v_add_f32 v129, 0x3727c5ac, v129
v_rsq_f32 v131, v129
v_mov_b32 v130, v129
v_mfma_f32_32x32x16_bf16 v[16:31], a[44:47], v[52:55], v[16:31]
ds_read_b128 v[68:71], v4 offset:22528
v_mul_f32 v129, 0xbfb8aa3b, v131
s_waitcnt lgkmcnt(2)
v_mfma_f32_32x32x16_bf16 v[16:31], a[72:75], v[56:59], v[16:31]
ds_read_b128 v[72:75], v4 offset:39936
s_add_u32 m0, s23, 14336
s_add_u32 s31, s22, 172032
buffer_load_dwordx4 v1, s[4:7], s31 offen offset:0 sc1 lds
s_mov_b32 exec_lo, 0x00ff00ff
s_mov_b32 exec_hi, 0x00ff00ff
ds_write_b96 v145, v[128:130] offset:0
s_mov_b64 exec, -1
v_mfma_f32_32x32x16_bf16 v[16:31], a[100:103], v[60:63], v[16:31]
ds_read_b128 v[76:79], v4 offset:57344
s_waitcnt lgkmcnt(3)
v_mfma_f32_32x32x16_bf16 v[16:31], a[20:23], v[64:67], v[16:31]
ds_read_b128 v[48:51], v4 offset:6144
buffer_load_dwordx4 v1, s[4:7], s31 offen offset:1024 sc1 lds
v_lshlrev_b32 v168, 7, v0
buffer_load_dword v170, v168, s[4:7], s43 offen sc1
v_mfma_f32_32x32x16_bf16 v[16:31], a[48:51], v[68:71], v[16:31]
ds_read_b128 v[52:55], v4 offset:23552
s_waitcnt lgkmcnt(2)
v_mfma_f32_32x32x16_bf16 v[16:31], a[76:79], v[72:75], v[16:31]
ds_read_b128 v[56:59], v4 offset:40960
buffer_load_dwordx4 v1, s[4:7], s31 offen offset:2048 sc1 lds
v_mfma_f32_32x32x16_bf16 v[16:31], a[104:107], v[76:79], v[16:31]
s_waitcnt vmcnt(4)
s_barrier
ds_read_b128 v[60:63], v4 offset:58368
s_waitcnt lgkmcnt(2)
v_mfma_f32_32x32x16_bf16 v[16:31], a[24:27], v[48:51], v[16:31]
ds_read_b128 v[64:67], v4 offset:7168
s_add_u32 m0, s23, 0
s_add_u32 s31, s22, 175104
buffer_load_dwordx4 v1, s[4:7], s31 offen offset:0 sc1 lds
v_mfma_f32_32x32x16_bf16 v[16:31], a[52:55], v[52:55], v[16:31]
ds_read_b128 v[68:71], v4 offset:24576
ds_read_b96 v[120:122], v6 offset:0
s_waitcnt lgkmcnt(3)
v_mfma_f32_32x32x16_bf16 v[16:31], a[80:83], v[56:59], v[16:31]
ds_read_b128 v[72:75], v4 offset:41984
s_add_u32 m0, s23, 1024
s_add_u32 s31, s22, 176128
buffer_load_dwordx4 v1, s[4:7], s31 offen offset:0 sc1 lds
v_mfma_f32_32x32x16_bf16 v[16:31], a[108:111], v[60:63], v[16:31]
ds_read_b128 v[76:79], v4 offset:59392
s_add_u32 s3, s32, 9
s_waitcnt vmcnt(3)
v_subrev_u32 v170, s3, v170
v_cmp_le_u32 vcc, 7, v170
s_nop 0
s_and_b64 vcc, vcc, s[48:49]
s_cbranch_scc0 L_chk_31_ok
s_mov_b32 s15, 0
L_chk_31:
buffer_load_dword v170, v168, s[4:7], s43 offen sc1
s_waitcnt vmcnt(0)
s_add_u32 s3, s32, 9
v_subrev_u32 v170, s3, v170
v_cmp_le_u32 vcc, 7, v170
s_nop 0
s_and_b64 vcc, vcc, s[48:49]
s_cbranch_scc0 L_chk_31_ok
s_add_u32 s15, s15, 1
s_cmp_lt_u32 s15, 131072
s_cbranch_scc1 L_chk_31
L_chk_31_ok:
s_waitcnt lgkmcnt(3)
v_mfma_f32_32x32x16_bf16 v[32:47], a[0:3], v[64:67], 0
ds_read_b128 v[48:51], v4 offset:8192
buffer_load_dwordx4 v[136:139], v1, s[4:7], s25 offen sc1
v_mfma_f32_32x32x16_bf16 v[32:47], a[28:31], v[68:71], v[32:47]
ds_read_b128 v[52:55], v4 offset:25600
buffer_load_dwordx4 v1, s[4:7], s31 offen offset:1024 sc1 lds
s_waitcnt lgkmcnt(2)
v_mfma_f32_32x32x16_bf16 v[32:47], a[56:59], v[72:75], v[32:47]
ds_read_b128 v[56:59], v4 offset:43008
buffer_load_dwordx4 v[140:143], v144, s[4:7], s25 offen offset:1024 sc1
v_fma_f32 v16, -v120, v80, v16
v_fma_f32 v17, -v120, v81, v17
v_fma_f32 v18, -v120, v82, v18
v_fma_f32 v19, -v120, v83, v19
v_mfma_f32_32x32x16_bf16 v[32:47], a[84:87], v[76:79], v[32:47]
ds_read_b128 v[60:63], v4 offset:60416
v_fma_f32 v20, -v120, v84, v20
v_fma_f32 v21, -v120, v85, v21
v_fma_f32 v22, -v120, v86, v22
v_fma_f32 v23, -v120, v87, v23
s_waitcnt lgkmcnt(2)
v_mfma_f32_32x32x16_bf16 v[32:47], a[4:7], v[48:51], v[32:47]
ds_read_b128 v[64:67], v4 offset:9216
buffer_load_dwordx4 v1, s[4:7], s31 offen offset:2048 sc1 lds
v_fma_f32 v24, -v120, v88, v24
v_fma_f32 v25, -v120, v89, v25
v_fma_f32 v26, -v120, v90, v26
v_fma_f32 v27, -v120, v91, v27
v_mfma_f32_32x32x16_bf16 v[32:47], a[32:35], v[52:55], v[32:47]
ds_read_b128 v[68:71], v4 offset:26624
v_fma_f32 v28, -v120, v92, v28
v_fma_f32 v29, -v120, v93, v29
v_fma_f32 v30, -v120, v94, v30
v_fma_f32 v31, -v120, v95, v31
s_waitcnt lgkmcnt(2)
v_mfma_f32_32x32x16_bf16 v[32:47], a[60:63], v[56:59], v[32:47]
ds_read_b128 v[72:75], v4 offset:44032
v_mul_f32 v96, v16, v121
v_mul_f32 v97, v17, v121
v_mul_f32 v98, v18, v121
v_mul_f32 v99, v19, v121
v_mul_f32 v100, v20, v121
v_mfma_f32_32x32x16_bf16 v[32:47], a[88:91], v[60:63], v[32:47]
ds_read_b128 v[76:79], v4 offset:61440
v_mul_f32 v101, v21, v121
v_mul_f32 v102, v22, v121
v_mul_f32 v103, v23, v121
s_waitcnt lgkmcnt(2)
v_mfma_f32_32x32x16_bf16 v[32:47], a[8:11], v[64:67], v[32:47]
ds_read_b128 v[48:51], v4 offset:10240
v_exp_f32 v96, v96
v_mul_f32 v16, v16, v24
v_exp_f32 v97, v97
v_mfma_f32_32x32x16_bf16 v[32:47], a[36:39], v[68:71], v[32:47]
ds_read_b128 v[52:55], v4 offset:27648
v_mul_f32 v17, v17, v25
v_exp_f32 v98, v98
v_mul_f32 v18, v18, v26
s_waitcnt lgkmcnt(2)
v_mfma_f32_32x32x16_bf16 v[32:47], a[64:67], v[72:75], v[32:47]
ds_read_b128 v[56:59], v4 offset:45056
v_exp_f32 v99, v99
v_mul_f32 v19, v19, v27
v_exp_f32 v100, v100
v_mfma_f32_32x32x16_bf16 v[32:47], a[92:95], v[76:79], v[32:47]
ds_read_b128 v[60:63], v4 offset:62464
v_mul_f32 v20, v20, v28
v_exp_f32 v101, v101
v_mul_f32 v21, v21, v29
s_waitcnt lgkmcnt(2)
v_mfma_f32_32x32x16_bf16 v[32:47], a[12:15], v[48:51], v[32:47]
ds_read_b128 v[64:67], v4 offset:11264
v_exp_f32 v102, v102
v_mul_f32 v22, v22, v30
v_exp_f32 v103, v103
v_mfma_f32_32x32x16_bf16 v[32:47], a[40:43], v[52:55], v[32:47]
ds_read_b128 v[68:71], v4 offset:28672
v_mul_f32 v23, v23, v31
v_fma_f32 v96, v96, v122, v122
v_fma_f32 v97, v97, v122, v122
v_fma_f32 v98, v98, v122, v122
s_waitcnt lgkmcnt(2)
v_mfma_f32_32x32x16_bf16 v[32:47], a[68:71], v[56:59], v[32:47]
ds_read_b128 v[72:75], v4 offset:46080
v_fma_f32 v99, v99, v122, v122
v_fma_f32 v100, v100, v122, v122
v_fma_f32 v101, v101, v122, v122
v_fma_f32 v102, v102, v122, v122
v_fma_f32 v103, v103, v122, v122
v_mfma_f32_32x32x16_bf16 v[32:47], a[96:99], v[60:63], v[32:47]
ds_read_b128 v[76:79], v4 offset:63488
v_rcp_f32 v96, v96
v_rcp_f32 v97, v97
s_waitcnt lgkmcnt(2)
v_mfma_f32_32x32x16_bf16 v[32:47], a[16:19], v[64:67], v[32:47]
ds_read_b128 v[48:51], v4 offset:12288
v_rcp_f32 v98, v98
v_mul_f32 v16, v16, v96
v_rcp_f32 v99, v99
v_mfma_f32_32x32x16_bf16 v[32:47], a[44:47], v[68:71], v[32:47]
ds_read_b128 v[52:55], v4 offset:29696
v_mul_f32 v17, v17, v97
v_rcp_f32 v100, v100
v_mul_f32 v18, v18, v98
s_waitcnt lgkmcnt(2)
v_mfma_f32_32x32x16_bf16 v[32:47], a[72:75], v[72:75], v[32:47]
ds_read_b128 v[56:59], v4 offset:47104
v_rcp_f32 v101, v101
v_mul_f32 v19, v19, v99
v_rcp_f32 v102, v102
v_mfma_f32_32x32x16_bf16 v[32:47], a[100:103], v[76:79], v[32:47]
ds_read_b128 v[60:63], v4 offset:64512
v_mul_f32 v20, v20, v100
v_rcp_f32 v103, v103
v_mul_f32 v21, v21, v101
s_waitcnt lgkmcnt(2)
v_mfma_f32_32x32x16_bf16 v[32:47], a[20:23], v[48:51], v[32:47]
ds_read_b128 v[64:67], v4 offset:13312
buffer_load_dwordx4 v[180:183], v1, s[4:7], s29 offen offset:1024 sc1
v_mul_f32 v22, v22, v102
v_mul_f32 v23, v23, v103
v_cvt_pk_bf16_f32 v112, v16, v17
v_cvt_pk_bf16_f32 v113, v18, v19
v_mfma_f32_32x32x16_bf16 v[32:47], a[48:51], v[52:55], v[32:47]
ds_read_b128 v[68:71], v4 offset:30720
v_cvt_pk_bf16_f32 v114, v20, v21
v_cvt_pk_bf16_f32 v115, v22, v23
buffer_store_dwordx4 v[112:115], v119, s[4:7], s26 offen sc1
s_add_u32 s26, s26, 114688
s_waitcnt lgkmcnt(2)
v_mfma_f32_32x32x16_bf16 v[32:47], a[76:79], v[56:59], v[32:47]
ds_read_b128 v[72:75], v4 offset:48128
v_mfma_f32_32x32x16_bf16 v[32:47], a[104:107], v[60:63], v[32:47]
s_waitcnt vmcnt(2)
s_barrier
ds_read_b128 v[76:79], v5 offset:0
s_waitcnt lgkmcnt(2)
v_mfma_f32_32x32x16_bf16 v[32:47], a[24:27], v[64:67], v[32:47]
ds_read_b128 v[48:51], v4 offset:14336
s_add_u32 m0, s23, 4096
s_add_u32 s31, s22, 200704
buffer_load_dwordx4 v1, s[4:7], s31 offen offset:0 sc1 lds
v_mfma_f32_32x32x16_bf16 v[32:47], a[52:55], v[68:71], v[32:47]
ds_read_b128 v[52:55], v4 offset:31744
ds_read_b96 v[124:126], v6 offset:512
s_waitcnt lgkmcnt(3)
v_mfma_f32_32x32x16_bf16 v[32:47], a[80:83], v[72:75], v[32:47]
ds_read_b128 v[56:59], v4 offset:49152
buffer_load_dwordx4 v1, s[4:7], s31 offen offset:1024 sc1 lds
v_mfma_f32_32x32x16_bf16 v[32:47], a[108:111], v[76:79], v[32:47]
ds_read_b128 v[60:63], v5 offset:1024
s_waitcnt lgkmcnt(3)
v_mfma_f32_32x32x16_bf16 v[16:31], a[0:3], v[48:51], 0
ds_read_b128 v[64:67], v4 offset:15360
buffer_load_dwordx4 v1, s[4:7], s31 offen offset:2048 sc1 lds
v_mfma_f32_32x32x16_bf16 v[16:31], a[28:31], v[52:55], v[16:31]
ds_read_b128 v[68:71], v4 offset:32768
s_waitcnt lgkmcnt(2)
v_mfma_f32_32x32x16_bf16 v[16:31], a[56:59], v[56:59], v[16:31]
ds_read_b128 v[72:75], v4 offset:50176
buffer_load_dwordx4 v1, s[4:7], s31 offen offset:3072 sc1 lds
s_nop 0
v_fma_f32 v32, -v124, v80, v32
v_fma_f32 v33, -v124, v81, v33
v_fma_f32 v34, -v124, v82, v34
v_fma_f32 v35, -v124, v83, v35
v_mfma_f32_32x32x16_bf16 v[16:31], a[84:87], v[60:63], v[16:31]
ds_read_b128 v[76:79], v5 offset:2048
v_fma_f32 v36, -v124, v84, v36
v_fma_f32 v37, -v124, v85, v37
v_fma_f32 v38, -v124, v86, v38
v_fma_f32 v39, -v124, v87, v39
s_waitcnt lgkmcnt(2)
v_mfma_f32_32x32x16_bf16 v[16:31], a[4:7], v[64:67], v[16:31]
ds_read_b128 v[48:51], v4 offset:16384
s_add_u32 m0, s23, 8192
s_add_u32 s31, s22, 204800
buffer_load_dwordx4 v1, s[4:7], s31 offen offset:0 sc1 lds
v_fma_f32 v40, -v124, v88, v40
v_fma_f32 v41, -v124, v89, v41
v_mfma_f32_32x32x16_bf16 v[16:31], a[32:35], v[68:71], v[16:31]
ds_read_b128 v[52:55], v4 offset:33792
v_fma_f32 v42, -v124, v90, v42
v_fma_f32 v43, -v124, v91, v43
v_fma_f32 v44, -v124, v92, v44
v_fma_f32 v45, -v124, v93, v45
s_waitcnt lgkmcnt(2)
v_mfma_f32_32x32x16_bf16 v[16:31], a[60:63], v[72:75], v[16:31]
ds_read_b128 v[56:59], v4 offset:51200
buffer_load_dwordx4 v1, s[4:7], s31 offen offset:1024 sc1 lds
v_fma_f32 v46, -v124, v94, v46
v_fma_f32 v47, -v124, v95, v47
v_mul_f32 v96, v32, v125
v_mul_f32 v97, v33, v125
v_mfma_f32_32x32x16_bf16 v[16:31], a[88:91], v[76:79], v[16:31]
ds_read_b128 v[60:63], v5 offset:3072
v_mul_f32 v98, v34, v125
v_mul_f32 v99, v35, v125
v_mul_f32 v100, v36, v125
v_mul_f32 v101, v37, v125
s_waitcnt lgkmcnt(2)
v_mfma_f32_32x32x16_bf16 v[16:31], a[8:11], v[48:51], v[16:31]
ds_read_b128 v[64:67], v4 offset:0
buffer_load_dwordx4 v1, s[4:7], s31 offen offset:2048 sc1 lds
v_mul_f32 v102, v38, v125
v_mul_f32 v103, v39, v125
v_exp_f32 v96, v96
v_mfma_f32_32x32x16_bf16 v[16:31], a[36:39], v[52:55], v[16:31]
ds_read_b128 v[68:71], v4 offset:17408
v_mul_f32 v32, v32, v40
v_exp_f32 v97, v97
v_mul_f32 v33, v33, v41
s_waitcnt lgkmcnt(2)
v_mfma_f32_32x32x16_bf16 v[16:31], a[64:67], v[56:59], v[16:31]
ds_read_b128 v[72:75], v4 offset:34816
v_exp_f32 v98, v98
v_mul_f32 v34, v34, v42
v_exp_f32 v99, v99
v_mfma_f32_32x32x16_bf16 v[16:31], a[92:95], v[60:63], v[16:31]
ds_read_b128 v[76:79], v4 offset:52224
v_mul_f32 v35, v35, v43
v_exp_f32 v100, v100
v_mul_f32 v36, v36, v44
s_waitcnt lgkmcnt(2)
v_mfma_f32_32x32x16_bf16 v[16:31], a[12:15], v[64:67], v[16:31]
ds_read_b128 v[48:51], v4 offset:1024
v_exp_f32 v101, v101
v_mul_f32 v37, v37, v45
v_exp_f32 v102, v102
v_mfma_f32_32x32x16_bf16 v[16:31], a[40:43], v[68:71], v[16:31]
ds_read_b128 v[52:55], v4 offset:18432
v_mul_f32 v38, v38, v46
v_exp_f32 v103, v103
v_mul_f32 v39, v39, v47
s_waitcnt lgkmcnt(2)
v_mfma_f32_32x32x16_bf16 v[16:31], a[68:71], v[72:75], v[16:31]
ds_read_b128 v[56:59], v4 offset:35840
v_fma_f32 v96, v96, v126, v126
v_fma_f32 v97, v97, v126, v126
v_fma_f32 v98, v98, v126, v126
v_fma_f32 v99, v99, v126, v126
v_fma_f32 v100, v100, v126, v126
v_mfma_f32_32x32x16_bf16 v[16:31], a[96:99], v[76:79], v[16:31]
ds_read_b128 v[60:63], v4 offset:53248
v_fma_f32 v101, v101, v126, v126
v_fma_f32 v102, v102, v126, v126
v_fma_f32 v103, v103, v126, v126
s_waitcnt lgkmcnt(2)
v_mfma_f32_32x32x16_bf16 v[16:31], a[16:19], v[48:51], v[16:31]
ds_read_b128 v[64:67], v4 offset:2048
v_rcp_f32 v96, v96
v_rcp_f32 v97, v97
v_mfma_f32_32x32x16_bf16 v[16:31], a[44:47], v[52:55], v[16:31]
ds_read_b128 v[68:71], v4 offset:19456
v_rcp_f32 v98, v98
v_mul_f32 v32, v32, v96
s_waitcnt lgkmcnt(2)
v_mfma_f32_32x32x16_bf16 v[16:31], a[72:75], v[56:59], v[16:31]
ds_read_b128 v[72:75], v4 offset:36864
v_rcp_f32 v99, v99
v_mul_f32 v33, v33, v97
v_rcp_f32 v100, v100
v_mfma_f32_32x32x16_bf16 v[16:31], a[100:103], v[60:63], v[16:31]
ds_read_b128 v[76:79], v4 offset:54272
v_mul_f32 v34, v34, v98
v_rcp_f32 v101, v101
v_mul_f32 v35, v35, v99
s_waitcnt lgkmcnt(2)
v_mfma_f32_32x32x16_bf16 v[16:31], a[20:23], v[64:67], v[16:31]
ds_read_b128 v[48:51], v4 offset:3072
v_rcp_f32 v102, v102
v_mul_f32 v36, v36, v100
v_rcp_f32 v103, v103
v_mfma_f32_32x32x16_bf16 v[16:31], a[48:51], v[68:71], v[16:31]
ds_read_b128 v[52:55], v4 offset:20480
v_mul_f32 v37, v37, v101
v_mul_f32 v38, v38, v102
v_mul_f32 v39, v39, v103
v_cvt_pk_bf16_f32 v112, v32, v33
s_waitcnt lgkmcnt(2)
v_mfma_f32_32x32x16_bf16 v[16:31], a[76:79], v[72:75], v[16:31]
ds_read_b128 v[56:59], v4 offset:37888
v_cvt_pk_bf16_f32 v113, v34, v35
v_cvt_pk_bf16_f32 v114, v36, v37
v_cvt_pk_bf16_f32 v115, v38, v39
buffer_store_dwordx4 v[112:115], v119, s[4:7], s26 offen sc1
s_add_u32 s26, s26, 114688
v_mfma_f32_32x32x16_bf16 v[16:31], a[104:107], v[76:79], v[16:31]
s_waitcnt vmcnt(1)
s_barrier
ds_read_b128 v[60:63], v4 offset:55296
v_add_f32 v136, v136, v140
v_add_f32 v137, v137, v141
v_add_f32 v138, v138, v142
s_waitcnt lgkmcnt(2)
v_mfma_f32_32x32x16_bf16 v[16:31], a[24:27], v[48:51], v[16:31]
ds_read_b128 v[64:67], v4 offset:4096
s_add_u32 m0, s23, 11264
s_add_u32 s31, s22, 0
buffer_load_dwordx4 v1, s[4:7], s31 offen offset:0 sc1 lds
v_add_f32 v139, v139, v143
v_permlane32_swap_b32 v136, v138
v_mfma_f32_32x32x16_bf16 v[16:31], a[52:55], v[52:55], v[16:31]
ds_read_b128 v[68:71], v4 offset:21504
v_permlane32_swap_b32 v137, v139
v_add_f32 v136, v136, v138
v_add_f32 v137, v137, v139
s_nop 1
v_permlane16_swap_b32 v136, v137
ds_read_b96 v[120:122], v6 offset:1024
s_waitcnt lgkmcnt(3)
v_mfma_f32_32x32x16_bf16 v[16:31], a[80:83], v[56:59], v[16:31]
ds_read_b128 v[72:75], v4 offset:38912
buffer_load_dwordx4 v1, s[4:7], s31 offen offset:1024 sc1 lds
buffer_load_dwordx4 v[184:187], v1, s[4:7], s29 offen offset:2048 sc1
v_mfma_f32_32x32x16_bf16 v[16:31], a[108:111], v[60:63], v[16:31]
ds_read_b128 v[76:79], v4 offset:56320
s_waitcnt lgkmcnt(3)
v_mfma_f32_32x32x16_bf16 v[32:47], a[0:3], v[64:67], 0
ds_read_b128 v[48:51], v4 offset:5120
buffer_load_dwordx4 v1, s[4:7], s31 offen offset:2048 sc1 lds
v_mfma_f32_32x32x16_bf16 v[32:47], a[28:31], v[68:71], v[32:47]
ds_read_b128 v[52:55], v4 offset:22528
s_waitcnt lgkmcnt(2)
v_mfma_f32_32x32x16_bf16 v[32:47], a[56:59], v[72:75], v[32:47]
ds_read_b128 v[56:59], v4 offset:39936
buffer_load_dwordx4 v1, s[4:7], s31 offen offset:3072 sc1 lds
s_nop 0
v_fma_f32 v16, -v120, v80, v16
v_fma_f32 v17, -v120, v81, v17
v_fma_f32 v18, -v120, v82, v18
v_fma_f32 v19, -v120, v83, v19
v_mfma_f32_32x32x16_bf16 v[32:47], a[84:87], v[76:79], v[32:47]
ds_read_b128 v[60:63], v4 offset:57344
v_fma_f32 v20, -v120, v84, v20
v_fma_f32 v21, -v120, v85, v21
v_fma_f32 v22, -v120, v86, v22
v_fma_f32 v23, -v120, v87, v23
s_waitcnt lgkmcnt(2)
v_mfma_f32_32x32x16_bf16 v[32:47], a[4:7], v[48:51], v[32:47]
ds_read_b128 v[64:67], v4 offset:6144
s_add_u32 m0, s23, 15360
s_add_u32 s31, s22, 4096
buffer_load_dwordx4 v1, s[4:7], s31 offen offset:0 sc1 lds
v_fma_f32 v24, -v120, v88, v24
v_fma_f32 v25, -v120, v89, v25
v_mfma_f32_32x32x16_bf16 v[32:47], a[32:35], v[52:55], v[32:47]
ds_read_b128 v[68:71], v4 offset:23552
v_fma_f32 v26, -v120, v90, v26
v_fma_f32 v27, -v120, v91, v27
v_fma_f32 v28, -v120, v92, v28
v_fma_f32 v29, -v120, v93, v29
s_waitcnt lgkmcnt(2)
v_mfma_f32_32x32x16_bf16 v[32:47], a[60:63], v[56:59], v[32:47]
ds_read_b128 v[72:75], v4 offset:40960
buffer_load_dwordx4 v1, s[4:7], s31 offen offset:1024 sc1 lds
v_fma_f32 v30, -v120, v94, v30
v_fma_f32 v31, -v120, v95, v31
v_mul_f32 v96, v16, v121
v_mul_f32 v97, v17, v121
v_mfma_f32_32x32x16_bf16 v[32:47], a[88:91], v[60:63], v[32:47]
ds_read_b128 v[76:79], v4 offset:58368
v_mul_f32 v98, v18, v121
v_mul_f32 v99, v19, v121
v_mul_f32 v100, v20, v121
v_mul_f32 v101, v21, v121
s_waitcnt lgkmcnt(2)
v_mfma_f32_32x32x16_bf16 v[32:47], a[8:11], v[64:67], v[32:47]
ds_read_b128 v[48:51], v4 offset:7168
s_add_u32 m0, s23, 0
s_add_u32 s31, s22, 6144
buffer_load_dwordx4 v1, s[4:7], s31 offen offset:0 sc1 lds
v_mul_f32 v102, v22, v121
v_mul_f32 v103, v23, v121
v_mfma_f32_32x32x16_bf16 v[32:47], a[36:39], v[68:71], v[32:47]
ds_read_b128 v[52:55], v4 offset:24576
v_exp_f32 v96, v96
v_mul_f32 v16, v16, v24
s_waitcnt lgkmcnt(2)
v_mfma_f32_32x32x16_bf16 v[32:47], a[64:67], v[72:75], v[32:47]
ds_read_b128 v[56:59], v4 offset:41984
v_exp_f32 v97, v97
v_mul_f32 v17, v17, v25
v_exp_f32 v98, v98
v_mfma_f32_32x32x16_bf16 v[32:47], a[92:95], v[76:79], v[32:47]
ds_read_b128 v[60:63], v4 offset:59392
v_mul_f32 v18, v18, v26
v_exp_f32 v99, v99
v_mul_f32 v19, v19, v27
s_waitcnt lgkmcnt(2)
v_mfma_f32_32x32x16_bf16 v[32:47], a[12:15], v[48:51], v[32:47]
ds_read_b128 v[64:67], v4 offset:8192
v_exp_f32 v100, v100
v_mul_f32 v20, v20, v28
v_exp_f32 v101, v101
v_mfma_f32_32x32x16_bf16 v[32:47], a[40:43], v[52:55], v[32:47]
ds_read_b128 v[68:71], v4 offset:25600
v_mul_f32 v21, v21, v29
v_exp_f32 v102, v102
v_mul_f32 v22, v22, v30
s_waitcnt lgkmcnt(2)
v_mfma_f32_32x32x16_bf16 v[32:47], a[68:71], v[56:59], v[32:47]
ds_read_b128 v[72:75], v4 offset:43008
v_exp_f32 v103, v103
v_mul_f32 v23, v23, v31
v_fma_f32 v96, v96, v122, v122
v_fma_f32 v97, v97, v122, v122
v_mfma_f32_32x32x16_bf16 v[32:47], a[96:99], v[60:63], v[32:47]
ds_read_b128 v[76:79], v4 offset:60416
v_fma_f32 v98, v98, v122, v122
v_fma_f32 v99, v99, v122, v122
v_fma_f32 v100, v100, v122, v122
v_fma_f32 v101, v101, v122, v122
s_waitcnt lgkmcnt(2)
v_mfma_f32_32x32x16_bf16 v[32:47], a[16:19], v[64:67], v[32:47]
ds_read_b128 v[48:51], v4 offset:9216
v_fma_f32 v102, v102, v122, v122
v_fma_f32 v103, v103, v122, v122
v_rcp_f32 v96, v96
v_mfma_f32_32x32x16_bf16 v[32:47], a[44:47], v[68:71], v[32:47]
ds_read_b128 v[52:55], v4 offset:26624
v_rcp_f32 v97, v97
v_rcp_f32 v98, v98
s_waitcnt lgkmcnt(2)
v_mfma_f32_32x32x16_bf16 v[32:47], a[72:75], v[72:75], v[32:47]
ds_read_b128 v[56:59], v4 offset:44032
v_mul_f32 v16, v16, v96
v_rcp_f32 v99, v99
v_mul_f32 v17, v17, v97
v_mfma_f32_32x32x16_bf16 v[32:47], a[100:103], v[76:79], v[32:47]
ds_read_b128 v[60:63], v4 offset:61440
v_rcp_f32 v100, v100
v_mul_f32 v18, v18, v98
s_waitcnt lgkmcnt(2)
v_mfma_f32_32x32x16_bf16 v[32:47], a[20:23], v[48:51], v[32:47]
ds_read_b128 v[64:67], v4 offset:10240
v_rcp_f32 v101, v101
v_mul_f32 v19, v19, v99
v_rcp_f32 v102, v102
v_mfma_f32_32x32x16_bf16 v[32:47], a[48:51], v[52:55], v[32:47]
ds_read_b128 v[68:71], v4 offset:27648
v_mul_f32 v20, v20, v100
v_rcp_f32 v103, v103
v_mul_f32 v21, v21, v101
s_waitcnt lgkmcnt(2)
v_mfma_f32_32x32x16_bf16 v[32:47], a[76:79], v[56:59], v[32:47]
ds_read_b128 v[72:75], v4 offset:45056
v_mul_f32 v22, v22, v102
v_mul_f32 v23, v23, v103
v_cvt_pk_bf16_f32 v112, v16, v17
v_cvt_pk_bf16_f32 v113, v18, v19
v_cvt_pk_bf16_f32 v114, v20, v21
v_mfma_f32_32x32x16_bf16 v[32:47], a[104:107], v[60:63], v[32:47]
s_waitcnt vmcnt(0)
s_barrier
ds_read_b128 v[76:79], v4 offset:62464
v_cvt_pk_bf16_f32 v115, v22, v23
buffer_store_dwordx4 v[112:115], v119, s[4:7], s26 offen sc1
s_add_u32 s26, s26, 114688
s_waitcnt lgkmcnt(2)
v_mfma_f32_32x32x16_bf16 v[32:47], a[24:27], v[64:67], v[32:47]
ds_read_b128 v[48:51], v4 offset:11264
s_add_u32 m0, s23, 1024
s_add_u32 s31, s22, 28672
buffer_load_dwordx4 v1, s[4:7], s31 offen offset:0 sc1 lds
v_add_f32 v136, v136, v137
v_mul_f32 v136, 0x3b124925, v136
v_mfma_f32_32x32x16_bf16 v[32:47], a[52:55], v[68:71], v[32:47]
ds_read_b128 v[52:55], v4 offset:28672
v_mov_b32_dpp v137, v136 row_ror:8 row_mask:0xf bank_mask:0xf
v_fma_f32 v137, -v136, v136, v137
v_max_f32 v137, 0, v137
v_add_f32 v137, 0x3727c5ac, v137
ds_read_b96 v[124:126], v6 offset:1536
s_waitcnt lgkmcnt(3)
v_mfma_f32_32x32x16_bf16 v[32:47], a[80:83], v[72:75], v[32:47]
ds_read_b128 v[56:59], v4 offset:46080
buffer_load_dwordx4 v1, s[4:7], s31 offen offset:1024 sc1 lds
v_rsq_f32 v139, v137
v_mov_b32 v138, v137
v_mul_f32 v137, 0xbfb8aa3b, v139
v_mfma_f32_32x32x16_bf16 v[32:47], a[108:111], v[76:79], v[32:47]
ds_read_b128 v[60:63], v4 offset:63488
s_mov_b32 exec_lo, 0x00ff00ff
s_mov_b32 exec_hi, 0x00ff00ff
ds_write_b96 v145, v[136:138] offset:2048
s_mov_b64 exec, -1
s_waitcnt lgkmcnt(4)
v_mfma_f32_32x32x16_bf16 v[16:31], a[0:3], v[48:51], 0
ds_read_b128 v[64:67], v4 offset:12288
buffer_load_dwordx4 v1, s[4:7], s31 offen offset:2048 sc1 lds
v_mfma_f32_32x32x16_bf16 v[16:31], a[28:31], v[52:55], v[16:31]
ds_read_b128 v[68:71], v4 offset:29696
s_waitcnt lgkmcnt(3)
v_mfma_f32_32x32x16_bf16 v[16:31], a[56:59], v[56:59], v[16:31]
ds_read_b128 v[72:75], v4 offset:47104
buffer_load_dwordx4 v1, s[4:7], s31 offen offset:3072 sc1 lds
v_fma_f32 v32, -v124, v80, v32
v_fma_f32 v33, -v124, v81, v33
v_fma_f32 v34, -v124, v82, v34
v_fma_f32 v35, -v124, v83, v35
v_mfma_f32_32x32x16_bf16 v[16:31], a[84:87], v[60:63], v[16:31]
ds_read_b128 v[76:79], v4 offset:64512
v_fma_f32 v36, -v124, v84, v36
v_fma_f32 v37, -v124, v85, v37
v_fma_f32 v38, -v124, v86, v38
v_fma_f32 v39, -v124, v87, v39
s_waitcnt lgkmcnt(2)
v_mfma_f32_32x32x16_bf16 v[16:31], a[4:7], v[64:67], v[16:31]
ds_read_b128 v[48:51], v4 offset:13312
s_add_u32 m0, s23, 5120
s_add_u32 s31, s22, 32768
buffer_load_dwordx4 v1, s[4:7], s31 offen offset:0 sc1 lds
v_fma_f32 v40, -v124, v88, v40
v_fma_f32 v41, -v124, v89, v41
v_mfma_f32_32x32x16_bf16 v[16:31], a[32:35], v[68:71], v[16:31]
ds_read_b128 v[52:55], v4 offset:30720
buffer_load_dwordx4 v[188:191], v1, s[4:7], s29 offen offset:3072 sc1
v_fma_f32 v42, -v124, v90, v42
v_fma_f32 v43, -v124, v91, v43
v_fma_f32 v44, -v124, v92, v44
s_waitcnt lgkmcnt(2)
v_mfma_f32_32x32x16_bf16 v[16:31], a[60:63], v[72:75], v[16:31]
ds_read_b128 v[56:59], v4 offset:48128
buffer_load_dwordx4 v1, s[4:7], s31 offen offset:1024 sc1 lds
v_fma_f32 v45, -v124, v93, v45
v_fma_f32 v46, -v124, v94, v46
v_fma_f32 v47, -v124, v95, v47
v_mul_f32 v96, v32, v125
v_mfma_f32_32x32x16_bf16 v[16:31], a[88:91], v[76:79], v[16:31]
ds_read_b128 v[60:63], v5 offset:0
v_mul_f32 v97, v33, v125
v_mul_f32 v98, v34, v125
v_mul_f32 v99, v35, v125
v_mul_f32 v100, v36, v125
s_waitcnt lgkmcnt(2)
v_mfma_f32_32x32x16_bf16 v[16:31], a[8:11], v[48:51], v[16:31]
ds_read_b128 v[64:67], v4 offset:14336
buffer_load_dwordx4 v1, s[4:7], s31 offen offset:2048 sc1 lds
v_mul_f32 v101, v37, v125
v_mul_f32 v102, v38, v125
v_mul_f32 v103, v39, v125
v_mfma_f32_32x32x16_bf16 v[16:31], a[36:39], v[52:55], v[16:31]
ds_read_b128 v[68:71], v4 offset:31744
v_exp_f32 v96, v96
v_mul_f32 v32, v32, v40
s_waitcnt lgkmcnt(2)
v_mfma_f32_32x32x16_bf16 v[16:31], a[64:67], v[56:59], v[16:31]
ds_read_b128 v[72:75], v4 offset:49152
v_exp_f32 v97, v97
v_mul_f32 v33, v33, v41
v_exp_f32 v98, v98
v_mfma_f32_32x32x16_bf16 v[16:31], a[92:95], v[60:63], v[16:31]
ds_read_b128 v[76:79], v5 offset:1024
v_mul_f32 v34, v34, v42
v_exp_f32 v99, v99
v_mul_f32 v35, v35, v43
s_waitcnt lgkmcnt(2)
v_mfma_f32_32x32x16_bf16 v[16:31], a[12:15], v[64:67], v[16:31]
ds_read_b128 v[48:51], v4 offset:15360
v_exp_f32 v100, v100
v_mul_f32 v36, v36, v44
v_exp_f32 v101, v101
v_mfma_f32_32x32x16_bf16 v[16:31], a[40:43], v[68:71], v[16:31]
ds_read_b128 v[52:55], v4 offset:32768
v_mul_f32 v37, v37, v45
v_exp_f32 v102, v102
v_mul_f32 v38, v38, v46
s_waitcnt lgkmcnt(2)
v_mfma_f32_32x32x16_bf16 v[16:31], a[68:71], v[72:75], v[16:31]
ds_read_b128 v[56:59], v4 offset:50176
buffer_load_dwordx4 v[8:11], v147, s[4:7], s64 offen sc1
v_exp_f32 v103, v103
v_mul_f32 v39, v39, v47
v_fma_f32 v96, v96, v126, v126
v_mfma_f32_32x32x16_bf16 v[16:31], a[96:99], v[76:79], v[16:31]
ds_read_b128 v[60:63], v5 offset:2048
v_fma_f32 v97, v97, v126, v126
v_fma_f32 v98, v98, v126, v126
v_fma_f32 v99, v99, v126, v126
v_fma_f32 v100, v100, v126, v126
s_waitcnt lgkmcnt(2)
v_mfma_f32_32x32x16_bf16 v[16:31], a[16:19], v[48:51], v[16:31]
ds_read_b128 v[64:67], v4 offset:16384
v_fma_f32 v101, v101, v126, v126
v_fma_f32 v102, v102, v126, v126
v_fma_f32 v103, v103, v126, v126
v_rcp_f32 v96, v96
v_mfma_f32_32x32x16_bf16 v[16:31], a[44:47], v[52:55], v[16:31]
ds_read_b128 v[68:71], v4 offset:33792
v_rcp_f32 v97, v97
v_rcp_f32 v98, v98
s_waitcnt lgkmcnt(2)
v_mfma_f32_32x32x16_bf16 v[16:31], a[72:75], v[56:59], v[16:31]
ds_read_b128 v[72:75], v4 offset:51200
buffer_load_dwordx4 v[12:15], v147, s[4:7], s66 offen sc1
v_mul_f32 v32, v32, v96
v_rcp_f32 v99, v99
v_mul_f32 v33, v33, v97
v_mfma_f32_32x32x16_bf16 v[16:31], a[100:103], v[60:63], v[16:31]
ds_read_b128 v[76:79], v5 offset:3072
v_rcp_f32 v100, v100
v_mul_f32 v34, v34, v98
s_waitcnt lgkmcnt(2)
v_mfma_f32_32x32x16_bf16 v[16:31], a[20:23], v[64:67], v[16:31]
ds_read_b128 v[48:51], v4 offset:0
v_rcp_f32 v101, v101
v_mul_f32 v35, v35, v99
v_rcp_f32 v102, v102
v_mfma_f32_32x32x16_bf16 v[16:31], a[48:51], v[68:71], v[16:31]
ds_read_b128 v[52:55], v4 offset:17408
v_mul_f32 v36, v36, v100
v_rcp_f32 v103, v103
v_mul_f32 v37, v37, v101
s_waitcnt lgkmcnt(2)
v_mfma_f32_32x32x16_bf16 v[16:31], a[76:79], v[72:75], v[16:31]
ds_read_b128 v[56:59], v4 offset:34816
v_mul_f32 v38, v38, v102
v_mul_f32 v39, v39, v103
v_cvt_pk_bf16_f32 v112, v32, v33
v_cvt_pk_bf16_f32 v113, v34, v35
v_cvt_pk_bf16_f32 v114, v36, v37
v_mfma_f32_32x32x16_bf16 v[16:31], a[104:107], v[76:79], v[16:31]
s_waitcnt vmcnt(6)
s_barrier
ds_read_b128 v[60:63], v4 offset:52224
v_cvt_pk_bf16_f32 v115, v38, v39
buffer_store_dwordx4 v[112:115], v119, s[4:7], s26 offen sc1
s_sub_u32 s26, s26, 802816
s_waitcnt lgkmcnt(2)
v_mfma_f32_32x32x16_bf16 v[16:31], a[24:27], v[48:51], v[16:31]
ds_read_b128 v[64:67], v4 offset:1024
s_add_u32 m0, s23, 8192
s_add_u32 s31, s22, 57344
buffer_load_dwordx4 v1, s[4:7], s31 offen offset:0 sc1 lds
v_mfma_f32_32x32x16_bf16 v[16:31], a[52:55], v[52:55], v[16:31]
ds_read_b128 v[68:71], v4 offset:18432
ds_read_b96 v[120:122], v6 offset:2048
s_waitcnt lgkmcnt(3)
v_mfma_f32_32x32x16_bf16 v[16:31], a[80:83], v[56:59], v[16:31]
ds_read_b128 v[72:75], v4 offset:35840
buffer_load_dwordx4 v1, s[4:7], s31 offen offset:1024 sc1 lds
v_mfma_f32_32x32x16_bf16 v[16:31], a[108:111], v[60:63], v[16:31]
ds_read_b128 v[76:79], v4 offset:53248
s_waitcnt lgkmcnt(3)
v_mfma_f32_32x32x16_bf16 v[32:47], a[0:3], v[64:67], 0
ds_read_b128 v[48:51], v4 offset:2048
buffer_load_dwordx4 v1, s[4:7], s31 offen offset:2048 sc1 lds
v_mfma_f32_32x32x16_bf16 v[32:47], a[28:31], v[68:71], v[32:47]
ds_read_b128 v[52:55], v4 offset:19456
s_waitcnt lgkmcnt(2)
v_mfma_f32_32x32x16_bf16 v[32:47], a[56:59], v[72:75], v[32:47]
ds_read_b128 v[56:59], v4 offset:36864
buffer_load_dwordx4 v1, s[4:7], s31 offen offset:3072 sc1 lds
s_nop 0
v_fma_f32 v16, -v120, v80, v16
v_fma_f32 v17, -v120, v81, v17
v_fma_f32 v18, -v120, v82, v18
v_fma_f32 v19, -v120, v83, v19
v_mfma_f32_32x32x16_bf16 v[32:47], a[84:87], v[76:79], v[32:47]
ds_read_b128 v[60:63], v4 offset:54272
v_fma_f32 v20, -v120, v84, v20
v_fma_f32 v21, -v120, v85, v21
v_fma_f32 v22, -v120, v86, v22
v_fma_f32 v23, -v120, v87, v23
s_waitcnt lgkmcnt(2)
v_mfma_f32_32x32x16_bf16 v[32:47], a[4:7], v[48:51], v[32:47]
ds_read_b128 v[64:67], v4 offset:3072
s_add_u32 m0, s23, 12288
s_add_u32 s31, s22, 61440
buffer_load_dwordx4 v1, s[4:7], s31 offen offset:0 sc1 lds
v_fma_f32 v24, -v120, v88, v24
v_fma_f32 v25, -v120, v89, v25
v_mfma_f32_32x32x16_bf16 v[32:47], a[32:35], v[52:55], v[32:47]
ds_read_b128 v[68:71], v4 offset:20480
v_fma_f32 v26, -v120, v90, v26
v_fma_f32 v27, -v120, v91, v27
v_fma_f32 v28, -v120, v92, v28
v_fma_f32 v29, -v120, v93, v29
s_waitcnt lgkmcnt(2)
v_mfma_f32_32x32x16_bf16 v[32:47], a[60:63], v[56:59], v[32:47]
ds_read_b128 v[72:75], v4 offset:37888
buffer_load_dwordx4 v1, s[4:7], s31 offen offset:1024 sc1 lds
v_fma_f32 v30, -v120, v94, v30
v_fma_f32 v31, -v120, v95, v31
v_mul_f32 v96, v16, v121
v_mul_f32 v97, v17, v121
v_mfma_f32_32x32x16_bf16 v[32:47], a[88:91], v[60:63], v[32:47]
ds_read_b128 v[76:79], v4 offset:55296
v_mul_f32 v98, v18, v121
v_mul_f32 v99, v19, v121
v_mul_f32 v100, v20, v121
v_mul_f32 v101, v21, v121
s_waitcnt lgkmcnt(2)
v_mfma_f32_32x32x16_bf16 v[32:47], a[8:11], v[64:67], v[32:47]
ds_read_b128 v[48:51], v4 offset:4096
buffer_load_dwordx4 v1, s[4:7], s31 offen offset:2048 sc1 lds
v_mul_f32 v102, v22, v121
v_mul_f32 v103, v23, v121
v_exp_f32 v96, v96
v_mfma_f32_32x32x16_bf16 v[32:47], a[36:39], v[68:71], v[32:47]
s_waitcnt vmcnt(7)
s_barrier
ds_read_b128 v[52:55], v4 offset:21504
v_mul_f32 v16, v16, v24
v_exp_f32 v97, v97
s_waitcnt lgkmcnt(2)
v_mfma_f32_32x32x16_bf16 v[32:47], a[64:67], v[72:75], v[32:47]
ds_read_b128 v[56:59], v4 offset:38912
s_add_u32 m0, s23, 15360
s_add_u32 s31, s22, 86016
buffer_load_dwordx4 v1, s[4:7], s31 offen offset:0 sc1 lds
v_mul_f32 v17, v17, v25
v_mfma_f32_32x32x16_bf16 v[32:47], a[92:95], v[76:79], v[32:47]
ds_read_b128 v[60:63], v4 offset:56320
s_add_u32 s3, s32, 10
v_bfrev_b32 v116, 1
v_mov_b32 v117, s3
v_writelane_b32 v116, s50, 0
buffer_store_dword v117, v116, s[4:7], s46 offen sc1
s_waitcnt lgkmcnt(2)
v_mfma_f32_32x32x16_bf16 v[32:47], a[12:15], v[48:51], v[32:47]
ds_read_b128 v[64:67], v4 offset:5120
v_exp_f32 v98, v98
v_mul_f32 v18, v18, v26
v_exp_f32 v99, v99
v_mfma_f32_32x32x16_bf16 v[32:47], a[40:43], v[52:55], v[32:47]
ds_read_b128 v[68:71], v4 offset:22528
buffer_load_dwordx4 v1, s[4:7], s31 offen offset:1024 sc1 lds
v_mul_f32 v19, v19, v27
v_exp_f32 v100, v100
s_waitcnt lgkmcnt(2)
v_mfma_f32_32x32x16_bf16 v[32:47], a[68:71], v[56:59], v[32:47]
ds_read_b128 v[72:75], v4 offset:39936
v_mul_f32 v20, v20, v28
v_exp_f32 v101, v101
v_mul_f32 v21, v21, v29
v_mfma_f32_32x32x16_bf16 v[32:47], a[96:99], v[60:63], v[32:47]
ds_read_b128 v[76:79], v4 offset:57344
v_exp_f32 v102, v102
v_mul_f32 v22, v22, v30
s_waitcnt lgkmcnt(2)
v_mfma_f32_32x32x16_bf16 v[32:47], a[16:19], v[64:67], v[32:47]
ds_read_b128 v[48:51], v4 offset:6144
s_add_u32 m0, s23, 0
s_add_u32 s31, s22, 88064
buffer_load_dwordx4 v1, s[4:7], s31 offen offset:0 sc1 lds
v_exp_f32 v103, v103
v_mfma_f32_32x32x16_bf16 v[32:47], a[44:47], v[68:71], v[32:47]
ds_read_b128 v[52:55], v4 offset:23552
v_mul_f32 v23, v23, v31
v_fma_f32 v96, v96, v122, v122
v_fma_f32 v97, v97, v122, v122
v_fma_f32 v98, v98, v122, v122
s_waitcnt lgkmcnt(2)
v_mfma_f32_32x32x16_bf16 v[32:47], a[72:75], v[72:75], v[32:47]
ds_read_b128 v[56:59], v4 offset:40960
v_fma_f32 v99, v99, v122, v122
v_fma_f32 v100, v100, v122, v122
v_fma_f32 v101, v101, v122, v122
v_fma_f32 v102, v102, v122, v122
v_fma_f32 v103, v103, v122, v122
v_mfma_f32_32x32x16_bf16 v[32:47], a[100:103], v[76:79], v[32:47]
ds_read_b128 v[60:63], v4 offset:58368
buffer_load_dwordx4 v1, s[4:7], s31 offen offset:1024 sc1 lds
v_rcp_f32 v96, v96
s_waitcnt lgkmcnt(2)
v_mfma_f32_32x32x16_bf16 v[32:47], a[20:23], v[48:51], v[32:47]
ds_read_b128 v[64:67], v4 offset:7168
v_rcp_f32 v97, v97
v_rcp_f32 v98, v98
v_mul_f32 v16, v16, v96
v_mfma_f32_32x32x16_bf16 v[32:47], a[48:51], v[52:55], v[32:47]
ds_read_b128 v[68:71], v4 offset:24576
v_rcp_f32 v99, v99
v_mul_f32 v17, v17, v97
s_waitcnt lgkmcnt(2)
v_mfma_f32_32x32x16_bf16 v[32:47], a[76:79], v[56:59], v[32:47]
ds_read_b128 v[72:75], v4 offset:41984
v_rcp_f32 v100, v100
v_mul_f32 v18, v18, v98
v_rcp_f32 v101, v101
v_mfma_f32_32x32x16_bf16 v[32:47], a[104:107], v[60:63], v[32:47]
s_waitcnt vmcnt(8)
s_barrier
ds_read_b128 v[76:79], v4 offset:59392
v_mul_f32 v19, v19, v99
v_rcp_f32 v102, v102
s_waitcnt lgkmcnt(2)
v_mfma_f32_32x32x16_bf16 v[32:47], a[24:27], v[64:67], v[32:47]
ds_read_b128 v[48:51], v4 offset:8192
s_add_u32 m0, s23, 2048
s_add_u32 s31, s22, 90112
buffer_load_dwordx4 v1, s[4:7], s31 offen offset:0 sc1 lds
v_lshlrev_b32 v172, 7, v0
buffer_load_dword v174, v172, s[4:7], s43 offen sc1
v_mfma_f32_32x32x16_bf16 v[32:47], a[52:55], v[68:71], v[32:47]
ds_read_b128 v[52:55], v4 offset:25600
v_mul_f32 v20, v20, v100
v_rcp_f32 v103, v103
v_mul_f32 v21, v21, v101
ds_read_b96 v[124:126], v6 offset:2560
s_waitcnt lgkmcnt(3)
v_mfma_f32_32x32x16_bf16 v[32:47], a[80:83], v[72:75], v[32:47]
ds_read_b128 v[56:59], v4 offset:43008
v_mul_f32 v22, v22, v102
v_mul_f32 v23, v23, v103
v_cvt_pk_bf16_f32 v112, v16, v17
v_cvt_pk_bf16_f32 v113, v18, v19
v_cvt_pk_bf16_f32 v114, v20, v21
v_mfma_f32_32x32x16_bf16 v[32:47], a[108:111], v[76:79], v[32:47]
ds_read_b128 v[60:63], v4 offset:60416
buffer_load_dwordx4 v1, s[4:7], s31 offen offset:1024 sc1 lds
v_cvt_pk_bf16_f32 v115, v22, v23
buffer_store_dwordx4 v[112:115], v119, s[4:7], s26 offen sc1
s_add_u32 s26, s26, 114688
s_waitcnt lgkmcnt(3)
v_mfma_f32_32x32x16_bf16 v[16:31], a[0:3], v[48:51], 0
ds_read_b128 v[64:67], v4 offset:9216
v_mfma_f32_32x32x16_bf16 v[16:31], a[28:31], v[52:55], v[16:31]
ds_read_b128 v[68:71], v4 offset:26624
s_waitcnt lgkmcnt(2)
v_mfma_f32_32x32x16_bf16 v[16:31], a[56:59], v[56:59], v[16:31]
ds_read_b128 v[72:75], v4 offset:44032
buffer_load_dwordx4 v1, s[4:7], s31 offen offset:2048 sc1 lds
v_fma_f32 v32, -v124, v80, v32
v_fma_f32 v33, -v124, v81, v33
v_fma_f32 v34, -v124, v82, v34
v_fma_f32 v35, -v124, v83, v35
v_mfma_f32_32x32x16_bf16 v[16:31], a[84:87], v[60:63], v[16:31]
ds_read_b128 v[76:79], v4 offset:61440
s_add_u32 s3, s32, 10
s_waitcnt vmcnt(3)
v_subrev_u32 v174, s3, v174
v_cmp_le_u32 vcc, 6, v174
s_nop 0
s_and_b64 vcc, vcc, s[48:49]
s_cbranch_scc0 L_chk_32_ok
s_mov_b32 s15, 0
L_chk_32:
buffer_load_dword v174, v172, s[4:7], s43 offen sc1
s_waitcnt vmcnt(0)
s_add_u32 s3, s32, 10
v_subrev_u32 v174, s3, v174
v_cmp_le_u32 vcc, 6, v174
s_nop 0
s_and_b64 vcc, vcc, s[48:49]
s_cbranch_scc0 L_chk_32_ok
s_add_u32 s15, s15, 1
s_cmp_lt_u32 s15, 131072
s_cbranch_scc1 L_chk_32
L_chk_32_ok:
s_waitcnt lgkmcnt(2)
v_mfma_f32_32x32x16_bf16 v[16:31], a[4:7], v[64:67], v[16:31]
ds_read_b128 v[48:51], v4 offset:10240
buffer_load_dwordx4 v[128:131], v1, s[4:7], s20 offen offset:0 sc1
v_fma_f32 v36, -v124, v84, v36
v_fma_f32 v37, -v124, v85, v37
v_fma_f32 v38, -v124, v86, v38
v_fma_f32 v39, -v124, v87, v39
v_mfma_f32_32x32x16_bf16 v[16:31], a[32:35], v[68:71], v[16:31]
ds_read_b128 v[52:55], v4 offset:27648
v_fma_f32 v40, -v124, v88, v40
v_fma_f32 v41, -v124, v89, v41
v_fma_f32 v42, -v124, v90, v42
v_fma_f32 v43, -v124, v91, v43
s_waitcnt lgkmcnt(2)
v_mfma_f32_32x32x16_bf16 v[16:31], a[60:63], v[72:75], v[16:31]
ds_read_b128 v[56:59], v4 offset:45056
buffer_load_dwordx4 v[132:135], v1, s[4:7], s68 offen offset:0 sc1
v_fma_f32 v44, -v124, v92, v44
v_fma_f32 v45, -v124, v93, v45
v_fma_f32 v46, -v124, v94, v46
v_fma_f32 v47, -v124, v95, v47
v_mfma_f32_32x32x16_bf16 v[16:31], a[88:91], v[76:79], v[16:31]
ds_read_b128 v[60:63], v4 offset:62464
v_mul_f32 v96, v32, v125
v_mul_f32 v97, v33, v125
v_mul_f32 v98, v34, v125
v_mul_f32 v99, v35, v125
s_waitcnt lgkmcnt(2)
v_mfma_f32_32x32x16_bf16 v[16:31], a[8:11], v[48:51], v[16:31]
ds_read_b128 v[64:67], v4 offset:11264
buffer_load_dwordx4 v[136:139], v1, s[4:7], s20 offen offset:1024 sc1
v_mul_f32 v100, v36, v125
v_mul_f32 v101, v37, v125
v_mul_f32 v102, v38, v125
v_mul_f32 v103, v39, v125
v_mfma_f32_32x32x16_bf16 v[16:31], a[36:39], v[52:55], v[16:31]
s_barrier
ds_read_b128 v[68:71], v4 offset:28672
v_exp_f32 v96, v96
v_mul_f32 v32, v32, v40
s_waitcnt lgkmcnt(2)
v_mfma_f32_32x32x16_bf16 v[16:31], a[64:67], v[56:59], v[16:31]
ds_read_b128 v[72:75], v4 offset:46080
buffer_load_dwordx4 v[140:143], v1, s[4:7], s68 offen offset:1024 sc1
v_exp_f32 v97, v97
v_mul_f32 v33, v33, v41
v_mfma_f32_32x32x16_bf16 v[16:31], a[92:95], v[60:63], v[16:31]
ds_read_b128 v[76:79], v4 offset:63488
v_exp_f32 v98, v98
v_mul_f32 v34, v34, v42
s_waitcnt lgkmcnt(2)
v_mfma_f32_32x32x16_bf16 v[16:31], a[12:15], v[64:67], v[16:31]
ds_read_b128 v[48:51], v4 offset:12288
buffer_load_dwordx4 v[144:147], v1, s[4:7], s20 offen offset:2048 sc1
v_exp_f32 v99, v99
v_mul_f32 v35, v35, v43
v_mfma_f32_32x32x16_bf16 v[16:31], a[40:43], v[68:71], v[16:31]
ds_read_b128 v[52:55], v4 offset:29696
v_exp_f32 v100, v100
v_mul_f32 v36, v36, v44
s_waitcnt lgkmcnt(2)
v_mfma_f32_32x32x16_bf16 v[16:31], a[68:71], v[72:75], v[16:31]
ds_read_b128 v[56:59], v4 offset:47104
buffer_load_dwordx4 v[148:151], v1, s[4:7], s68 offen offset:2048 sc1
v_exp_f32 v101, v101
v_mul_f32 v37, v37, v45
v_mfma_f32_32x32x16_bf16 v[16:31], a[96:99], v[76:79], v[16:31]
ds_read_b128 v[60:63], v4 offset:64512
v_exp_f32 v102, v102
v_mul_f32 v38, v38, v46
s_waitcnt lgkmcnt(2)
v_mfma_f32_32x32x16_bf16 v[16:31], a[16:19], v[48:51], v[16:31]
ds_read_b128 v[64:67], v4 offset:13312
buffer_load_dwordx4 v[152:155], v1, s[4:7], s20 offen offset:3072 sc1
v_exp_f32 v103, v103
v_mul_f32 v39, v39, v47
v_fma_f32 v96, v96, v126, v126
v_mfma_f32_32x32x16_bf16 v[16:31], a[44:47], v[52:55], v[16:31]
ds_read_b128 v[68:71], v4 offset:30720
v_fma_f32 v97, v97, v126, v126
v_fma_f32 v98, v98, v126, v126
v_fma_f32 v99, v99, v126, v126
v_fma_f32 v100, v100, v126, v126
s_waitcnt lgkmcnt(2)
v_mfma_f32_32x32x16_bf16 v[16:31], a[72:75], v[56:59], v[16:31]
ds_read_b128 v[72:75], v4 offset:48128
buffer_load_dwordx4 v[156:159], v1, s[4:7], s68 offen offset:3072 sc1
v_fma_f32 v101, v101, v126, v126
v_fma_f32 v102, v102, v126, v126
v_fma_f32 v103, v103, v126, v126
v_mfma_f32_32x32x16_bf16 v[16:31], a[100:103], v[60:63], v[16:31]
ds_read_b128 v[76:79], v5 offset:0
v_rcp_f32 v96, v96
v_rcp_f32 v97, v97
s_waitcnt lgkmcnt(2)
v_mfma_f32_32x32x16_bf16 v[16:31], a[20:23], v[64:67], v[16:31]
ds_read_b128 v[48:51], v4 offset:14336
s_add_u32 s20, s20, 4096
buffer_load_dwordx4 v[160:163], v1, s[4:7], s20 offen offset:0 sc1
v_rcp_f32 v98, v98
v_mul_f32 v32, v32, v96
v_mfma_f32_32x32x16_bf16 v[16:31], a[48:51], v[68:71], v[16:31]
ds_read_b128 v[52:55], v4 offset:31744
v_rcp_f32 v99, v99
v_mul_f32 v33, v33, v97
s_waitcnt lgkmcnt(2)
v_mfma_f32_32x32x16_bf16 v[16:31], a[76:79], v[72:75], v[16:31]
ds_read_b128 v[56:59], v4 offset:49152
s_add_u32 s68, s68, 4096
buffer_load_dwordx4 v[164:167], v1, s[4:7], s68 offen offset:0 sc1
v_rcp_f32 v100, v100
v_mul_f32 v34, v34, v98
v_mfma_f32_32x32x16_bf16 v[16:31], a[104:107], v[76:79], v[16:31]
s_barrier
ds_read_b128 v[60:63], v5 offset:1024
v_rcp_f32 v101, v101
v_mul_f32 v35, v35, v99
s_waitcnt lgkmcnt(2)
v_mfma_f32_32x32x16_bf16 v[16:31], a[24:27], v[48:51], v[16:31]
ds_read_b128 v[64:67], v4 offset:15360
buffer_load_dwordx4 v[168:171], v1, s[4:7], s20 offen offset:1024 sc1
v_rcp_f32 v102, v102
v_mul_f32 v36, v36, v100
v_mfma_f32_32x32x16_bf16 v[16:31], a[52:55], v[52:55], v[16:31]
ds_read_b128 v[68:71], v4 offset:32768
v_rcp_f32 v103, v103
v_mul_f32 v37, v37, v101
v_mul_f32 v38, v38, v102
ds_read_b96 v[120:122], v6 offset:3072
s_waitcnt lgkmcnt(3)
v_mfma_f32_32x32x16_bf16 v[16:31], a[80:83], v[56:59], v[16:31]
ds_read_b128 v[72:75], v4 offset:50176
buffer_load_dwordx4 v[172:175], v1, s[4:7], s68 offen offset:1024 sc1
v_mul_f32 v39, v39, v103
v_cvt_pk_bf16_f32 v112, v32, v33
v_cvt_pk_bf16_f32 v113, v34, v35
v_cvt_pk_bf16_f32 v114, v36, v37
v_mfma_f32_32x32x16_bf16 v[16:31], a[108:111], v[60:63], v[16:31]
ds_read_b128 v[76:79], v5 offset:2048
v_cvt_pk_bf16_f32 v115, v38, v39
buffer_store_dwordx4 v[112:115], v119, s[4:7], s26 offen sc1
s_add_u32 s26, s26, 114688
s_waitcnt lgkmcnt(3)
v_mfma_f32_32x32x16_bf16 v[32:47], a[0:3], v[64:67], 0
ds_read_b128 v[48:51], v4 offset:16384
s_add_u32 m0, s27, 7168
s_nop 0
buffer_load_dwordx4 v1, s[4:7], s20 offen offset:2048 sc1 lds
v_mfma_f32_32x32x16_bf16 v[32:47], a[28:31], v[68:71], v[32:47]
ds_read_b128 v[52:55], v4 offset:33792
s_waitcnt lgkmcnt(2)
v_mfma_f32_32x32x16_bf16 v[32:47], a[56:59], v[72:75], v[32:47]
ds_read_b128 v[56:59], v4 offset:51200
s_add_u32 m0, s27, 8192
s_nop 0
buffer_load_dwordx4 v1, s[4:7], s68 offen offset:2048 sc1 lds
v_fma_f32 v16, -v120, v80, v16
v_fma_f32 v17, -v120, v81, v17
v_fma_f32 v18, -v120, v82, v18
v_mfma_f32_32x32x16_bf16 v[32:47], a[84:87], v[76:79], v[32:47]
ds_read_b128 v[60:63], v5 offset:3072
v_fma_f32 v19, -v120, v83, v19
v_fma_f32 v20, -v120, v84, v20
v_fma_f32 v21, -v120, v85, v21
v_fma_f32 v22, -v120, v86, v22
s_waitcnt lgkmcnt(2)
v_mfma_f32_32x32x16_bf16 v[32:47], a[4:7], v[48:51], v[32:47]
ds_read_b128 v[64:67], v4 offset:0
s_add_u32 m0, s27, 8192
s_nop 0
buffer_load_dwordx4 v1, s[4:7], s20 offen offset:3072 sc1 lds
v_fma_f32 v23, -v120, v87, v23
v_fma_f32 v24, -v120, v88, v24
v_fma_f32 v25, -v120, v89, v25
v_mfma_f32_32x32x16_bf16 v[32:47], a[32:35], v[52:55], v[32:47]
ds_read_b128 v[68:71], v4 offset:17408
v_fma_f32 v26, -v120, v90, v26
v_fma_f32 v27, -v120, v91, v27
v_fma_f32 v28, -v120, v92, v28
v_fma_f32 v29, -v120, v93, v29
s_waitcnt lgkmcnt(2)
v_mfma_f32_32x32x16_bf16 v[32:47], a[60:63], v[56:59], v[32:47]
ds_read_b128 v[72:75], v4 offset:34816
s_add_u32 m0, s27, 9216
s_nop 0
buffer_load_dwordx4 v1, s[4:7], s68 offen offset:3072 sc1 lds
v_fma_f32 v30, -v120, v94, v30
v_fma_f32 v31, -v120, v95, v31
v_mul_f32 v96, v16, v121
v_mfma_f32_32x32x16_bf16 v[32:47], a[88:91], v[60:63], v[32:47]
ds_read_b128 v[76:79], v4 offset:52224
v_mul_f32 v97, v17, v121
v_mul_f32 v98, v18, v121
v_mul_f32 v99, v19, v121
v_mul_f32 v100, v20, v121
s_waitcnt lgkmcnt(2)
v_mfma_f32_32x32x16_bf16 v[32:47], a[8:11], v[64:67], v[32:47]
ds_read_b128 v[48:51], v4 offset:1024
s_add_u32 s20, s20, 4096
s_add_u32 m0, s27, 13312
s_nop 0
buffer_load_dwordx4 v1, s[4:7], s20 offen offset:0 sc1 lds
v_mul_f32 v101, v21, v121
v_mul_f32 v102, v22, v121
v_mfma_f32_32x32x16_bf16 v[32:47], a[36:39], v[68:71], v[32:47]
s_waitcnt vmcnt(18)
s_barrier
ds_read_b128 v[52:55], v4 offset:18432
v_mul_f32 v103, v23, v121
v_exp_f32 v96, v96
s_waitcnt lgkmcnt(2)
v_mfma_f32_32x32x16_bf16 v[32:47], a[64:67], v[72:75], v[32:47]
ds_read_b128 v[56:59], v4 offset:35840
s_add_u32 s68, s68, 4096
s_add_u32 m0, s27, 14336
s_nop 0
buffer_load_dwordx4 v1, s[4:7], s68 offen offset:0 sc1 lds
v_mul_f32 v16, v16, v24
v_mfma_f32_32x32x16_bf16 v[32:47], a[92:95], v[76:79], v[32:47]
ds_read_b128 v[60:63], v4 offset:53248
v_exp_f32 v97, v97
v_mul_f32 v17, v17, v25
s_waitcnt lgkmcnt(2)
v_mfma_f32_32x32x16_bf16 v[32:47], a[12:15], v[48:51], v[32:47]
ds_read_b128 v[64:67], v4 offset:2048
s_add_u32 m0, s27, 14336
s_nop 0
buffer_load_dwordx4 v1, s[4:7], s20 offen offset:1024 sc1 lds
v_exp_f32 v98, v98
v_mul_f32 v18, v18, v26
v_mfma_f32_32x32x16_bf16 v[32:47], a[40:43], v[52:55], v[32:47]
ds_read_b128 v[68:71], v4 offset:19456
v_exp_f32 v99, v99
v_mul_f32 v19, v19, v27
s_waitcnt lgkmcnt(2)
v_mfma_f32_32x32x16_bf16 v[32:47], a[68:71], v[56:59], v[32:47]
ds_read_b128 v[72:75], v4 offset:36864
s_add_u32 m0, s27, 15360
s_nop 0
buffer_load_dwordx4 v1, s[4:7], s68 offen offset:1024 sc1 lds
v_exp_f32 v100, v100
v_mul_f32 v20, v20, v28
v_mfma_f32_32x32x16_bf16 v[32:47], a[96:99], v[60:63], v[32:47]
ds_read_b128 v[76:79], v4 offset:54272
v_exp_f32 v101, v101
v_mul_f32 v21, v21, v29
s_waitcnt lgkmcnt(2)
v_mfma_f32_32x32x16_bf16 v[32:47], a[16:19], v[64:67], v[32:47]
ds_read_b128 v[48:51], v4 offset:3072
s_add_u32 m0, s27, 15360
s_nop 0
buffer_load_dwordx4 v1, s[4:7], s20 offen offset:2048 sc1 lds
v_exp_f32 v102, v102
v_mul_f32 v22, v22, v30
v_mfma_f32_32x32x16_bf16 v[32:47], a[44:47], v[68:71], v[32:47]
ds_read_b128 v[52:55], v4 offset:20480
v_exp_f32 v103, v103
v_mul_f32 v23, v23, v31
v_fma_f32 v96, v96, v122, v122
s_waitcnt lgkmcnt(2)
v_mfma_f32_32x32x16_bf16 v[32:47], a[72:75], v[72:75], v[32:47]
ds_read_b128 v[56:59], v4 offset:37888
s_add_u32 m0, s27, 16384
s_nop 0
buffer_load_dwordx4 v1, s[4:7], s68 offen offset:2048 sc1 lds
v_fma_f32 v97, v97, v122, v122
v_fma_f32 v98, v98, v122, v122
v_fma_f32 v99, v99, v122, v122
v_mfma_f32_32x32x16_bf16 v[32:47], a[100:103], v[76:79], v[32:47]
ds_read_b128 v[60:63], v4 offset:55296
v_fma_f32 v100, v100, v122, v122
v_fma_f32 v101, v101, v122, v122
v_fma_f32 v102, v102, v122, v122
v_fma_f32 v103, v103, v122, v122
s_waitcnt lgkmcnt(2)
v_mfma_f32_32x32x16_bf16 v[32:47], a[20:23], v[48:51], v[32:47]
ds_read_b128 v[64:67], v4 offset:4096
v_rcp_f32 v96, v96
v_rcp_f32 v97, v97
v_mfma_f32_32x32x16_bf16 v[32:47], a[48:51], v[52:55], v[32:47]
ds_read_b128 v[68:71], v4 offset:21504
v_rcp_f32 v98, v98
v_mul_f32 v16, v16, v96
s_waitcnt lgkmcnt(2)
v_mfma_f32_32x32x16_bf16 v[32:47], a[76:79], v[56:59], v[32:47]
ds_read_b128 v[72:75], v4 offset:38912
v_rcp_f32 v99, v99
v_mul_f32 v17, v17, v97
v_rcp_f32 v100, v100
v_mfma_f32_32x32x16_bf16 v[32:47], a[104:107], v[60:63], v[32:47]
ds_read_b128 v[76:79], v4 offset:56320
v_mul_f32 v18, v18, v98
v_rcp_f32 v101, v101
v_mul_f32 v19, v19, v99
s_waitcnt lgkmcnt(2)
v_mfma_f32_32x32x16_bf16 v[32:47], a[24:27], v[64:67], v[32:47]
v_rcp_f32 v102, v102
v_mul_f32 v20, v20, v100
v_rcp_f32 v103, v103
v_mul_f32 v21, v21, v101
v_mfma_f32_32x32x16_bf16 v[32:47], a[52:55], v[68:71], v[32:47]
v_mul_f32 v22, v22, v102
v_mul_f32 v23, v23, v103
v_cvt_pk_bf16_f32 v112, v16, v17
v_cvt_pk_bf16_f32 v113, v18, v19
v_cvt_pk_bf16_f32 v114, v20, v21
ds_read_b96 v[124:126], v6 offset:3584
s_waitcnt lgkmcnt(1)
v_mfma_f32_32x32x16_bf16 v[32:47], a[80:83], v[72:75], v[32:47]
v_cvt_pk_bf16_f32 v115, v22, v23
buffer_store_dwordx4 v[112:115], v119, s[4:7], s26 offen sc1
s_add_u32 s26, s26, 114688
v_mfma_f32_32x32x16_bf16 v[32:47], a[108:111], v[76:79], v[32:47]
s_waitcnt vmcnt(23)
v_mfma_f32_16x16x32_bf16 v[16:19], a[112:115], v[128:131], 0
s_add_u32 s29, s30, 40960
v_mfma_f32_16x16x32_bf16 v[24:27], a[116:119], v[128:131], 0
buffer_load_dwordx4 v[192:195], v1, s[4:7], s29 offen offset:0 sc1
v_mfma_f32_16x16x32_bf16 v[48:51], a[120:123], v[128:131], 0
v_mfma_f32_16x16x32_bf16 v[56:59], a[124:127], v[128:131], 0
s_waitcnt vmcnt(23)
v_mfma_f32_16x16x32_bf16 v[20:23], a[112:115], v[132:135], 0
s_waitcnt lgkmcnt(0)
s_nop 1
v_fma_f32 v32, -v124, v80, v32
v_fma_f32 v33, -v124, v81, v33
v_fma_f32 v34, -v124, v82, v34
v_fma_f32 v35, -v124, v83, v35
v_mfma_f32_16x16x32_bf16 v[28:31], a[116:119], v[132:135], 0
v_fma_f32 v36, -v124, v84, v36
v_fma_f32 v37, -v124, v85, v37
buffer_load_dwordx4 v[196:199], v1, s[4:7], s29 offen offset:1024 sc1
v_mfma_f32_16x16x32_bf16 v[52:55], a[120:123], v[132:135], 0
v_fma_f32 v38, -v124, v86, v38
v_fma_f32 v39, -v124, v87, v39
v_fma_f32 v40, -v124, v88, v40
v_mfma_f32_16x16x32_bf16 v[60:63], a[124:127], v[132:135], 0
v_fma_f32 v41, -v124, v89, v41
v_fma_f32 v42, -v124, v90, v42
v_fma_f32 v43, -v124, v91, v43
s_waitcnt vmcnt(23)
v_mfma_f32_16x16x32_bf16 v[16:19], a[128:131], v[136:139], v[16:19]
v_fma_f32 v44, -v124, v92, v44
v_fma_f32 v45, -v124, v93, v45
v_fma_f32 v46, -v124, v94, v46
v_fma_f32 v47, -v124, v95, v47
v_mfma_f32_16x16x32_bf16 v[24:27], a[132:135], v[136:139], v[24:27]
v_mul_f32 v96, v32, v125
v_mul_f32 v97, v33, v125
buffer_load_dwordx4 v[200:203], v1, s[4:7], s29 offen offset:2048 sc1
v_mfma_f32_16x16x32_bf16 v[48:51], a[136:139], v[136:139], v[48:51]
v_mul_f32 v98, v34, v125
v_mul_f32 v99, v35, v125
v_mul_f32 v100, v36, v125
v_mfma_f32_16x16x32_bf16 v[56:59], a[140:143], v[136:139], v[56:59]
v_mul_f32 v101, v37, v125
v_mul_f32 v102, v38, v125
v_mul_f32 v103, v39, v125
s_waitcnt vmcnt(23)
v_mfma_f32_16x16x32_bf16 v[20:23], a[128:131], v[140:143], v[20:23]
v_exp_f32 v96, v96
v_mul_f32 v32, v32, v40
v_mfma_f32_16x16x32_bf16 v[28:31], a[132:135], v[140:143], v[28:31]
v_exp_f32 v97, v97
v_mul_f32 v33, v33, v41
buffer_load_dwordx4 v[204:207], v1, s[4:7], s29 offen offset:3072 sc1
v_mfma_f32_16x16x32_bf16 v[52:55], a[136:139], v[140:143], v[52:55]
v_exp_f32 v98, v98
v_mul_f32 v34, v34, v42
v_mfma_f32_16x16x32_bf16 v[60:63], a[140:143], v[140:143], v[60:63]
v_exp_f32 v99, v99
v_mul_f32 v35, v35, v43
s_waitcnt vmcnt(23)
v_mfma_f32_16x16x32_bf16 v[16:19], a[144:147], v[144:147], v[16:19]
v_exp_f32 v100, v100
v_mul_f32 v36, v36, v44
v_exp_f32 v101, v101
v_mfma_f32_16x16x32_bf16 v[24:27], a[148:151], v[144:147], v[24:27]
v_mul_f32 v37, v37, v45
s_add_u32 s29, s30, 45056
buffer_load_dwordx4 v[208:211], v1, s[4:7], s29 offen offset:0 sc1
v_mfma_f32_16x16x32_bf16 v[48:51], a[152:155], v[144:147], v[48:51]
v_exp_f32 v102, v102
v_mul_f32 v38, v38, v46
v_mfma_f32_16x16x32_bf16 v[56:59], a[156:159], v[144:147], v[56:59]
v_exp_f32 v103, v103
v_mul_f32 v39, v39, v47
s_waitcnt vmcnt(23)
v_mfma_f32_16x16x32_bf16 v[20:23], a[144:147], v[148:151], v[20:23]
v_fma_f32 v96, v96, v126, v126
v_fma_f32 v97, v97, v126, v126
v_fma_f32 v98, v98, v126, v126
v_fma_f32 v99, v99, v126, v126
v_mfma_f32_16x16x32_bf16 v[28:31], a[148:151], v[148:151], v[28:31]
v_fma_f32 v100, v100, v126, v126
v_fma_f32 v101, v101, v126, v126
buffer_load_dwordx4 v[212:215], v1, s[4:7], s29 offen offset:1024 sc1
v_mfma_f32_16x16x32_bf16 v[52:55], a[152:155], v[148:151], v[52:55]
v_fma_f32 v102, v102, v126, v126
v_fma_f32 v103, v103, v126, v126
v_rcp_f32 v96, v96
v_mfma_f32_16x16x32_bf16 v[60:63], a[156:159], v[148:151], v[60:63]
v_rcp_f32 v97, v97
s_waitcnt vmcnt(23)
v_mfma_f32_16x16x32_bf16 v[16:19], a[160:163], v[152:155], v[16:19]
v_rcp_f32 v98, v98
v_mul_f32 v32, v32, v96
v_mfma_f32_16x16x32_bf16 v[24:27], a[164:167], v[152:155], v[24:27]
v_rcp_f32 v99, v99
v_mul_f32 v33, v33, v97
buffer_load_dwordx4 v[216:219], v1, s[4:7], s29 offen offset:2048 sc1
v_mfma_f32_16x16x32_bf16 v[48:51], a[168:171], v[152:155], v[48:51]
v_rcp_f32 v100, v100
v_mul_f32 v34, v34, v98
v_mfma_f32_16x16x32_bf16 v[56:59], a[172:175], v[152:155], v[56:59]
v_rcp_f32 v101, v101
v_mul_f32 v35, v35, v99
s_waitcnt vmcnt(23)
v_mfma_f32_16x16x32_bf16 v[20:23], a[160:163], v[156:159], v[20:23]
v_rcp_f32 v102, v102
v_mul_f32 v36, v36, v100
v_mfma_f32_16x16x32_bf16 v[28:31], a[164:167], v[156:159], v[28:31]
v_rcp_f32 v103, v103
v_mul_f32 v37, v37, v101
buffer_load_dwordx4 v[220:223], v1, s[4:7], s29 offen offset:3072 sc1
v_mfma_f32_16x16x32_bf16 v[52:55], a[168:171], v[156:159], v[52:55]
v_mul_f32 v38, v38, v102
v_mul_f32 v39, v39, v103
v_cvt_pk_bf16_f32 v112, v32, v33
v_mfma_f32_16x16x32_bf16 v[60:63], a[172:175], v[156:159], v[60:63]
v_cvt_pk_bf16_f32 v113, v34, v35
v_cvt_pk_bf16_f32 v114, v36, v37
v_cvt_pk_bf16_f32 v115, v38, v39
s_waitcnt vmcnt(23)
v_mfma_f32_16x16x32_bf16 v[16:19], a[176:179], v[160:163], v[16:19]
buffer_store_dwordx4 v[112:115], v119, s[4:7], s26 offen sc1
s_add_u32 s26, s26, 114688
v_add_u32 v47, s23, v1
v_mfma_f32_16x16x32_bf16 v[24:27], a[180:183], v[160:163], v[24:27]
s_add_u32 s29, s30, 49152
buffer_load_dwordx4 v[224:227], v1, s[4:7], s29 offen offset:0 sc1
v_mfma_f32_16x16x32_bf16 v[48:51], a[184:187], v[160:163], v[48:51]
v_add_u32 v4, s65, v1
v_xor_b32 v5, 128, v4
s_waitcnt vmcnt(20)
v_mfma_f32_16x16x32_bf16 v[56:59], a[188:191], v[160:163], v[56:59]
ds_read_b128 v[80:83], v47 offset:5120
buffer_load_dwordx4 v[120:123], v1, s[4:7], s20 offen offset:3072 sc1
v_mfma_f32_16x16x32_bf16 v[20:23], a[176:179], v[164:167], v[20:23]
s_waitcnt vmcnt(20)
ds_read_b128 v[84:87], v47 offset:6144
v_mfma_f32_16x16x32_bf16 v[28:31], a[180:183], v[164:167], v[28:31]
buffer_load_dwordx4 v[228:231], v1, s[4:7], s29 offen offset:1024 sc1
v_mfma_f32_16x16x32_bf16 v[52:55], a[184:187], v[164:167], v[52:55]
s_waitcnt vmcnt(20)
ds_read_b128 v[88:91], v47 offset:7168
v_mfma_f32_16x16x32_bf16 v[60:63], a[188:191], v[164:167], v[60:63]
buffer_load_dwordx4 v[124:127], v1, s[4:7], s68 offen offset:3072 sc1
v_mfma_f32_16x16x32_bf16 v[16:19], a[192:195], v[168:171], v[16:19]
s_waitcnt vmcnt(20)
ds_read_b128 v[92:95], v47 offset:8192
v_mfma_f32_16x16x32_bf16 v[24:27], a[196:199], v[168:171], v[24:27]
v_mfma_f32_16x16x32_bf16 v[48:51], a[200:203], v[168:171], v[48:51]
s_waitcnt vmcnt(19)
ds_read_b128 v[96:99], v47 offset:9216
s_add_u32 s20, s20, 4096
v_mfma_f32_16x16x32_bf16 v[56:59], a[204:207], v[168:171], v[56:59]
buffer_load_dwordx4 v[128:131], v1, s[4:7], s20 offen offset:0 sc1
v_mfma_f32_16x16x32_bf16 v[20:23], a[192:195], v[172:175], v[20:23]
s_waitcnt vmcnt(19)
ds_read_b128 v[100:103], v47 offset:10240
v_mfma_f32_16x16x32_bf16 v[28:31], a[196:199], v[172:175], v[28:31]
v_mfma_f32_16x16x32_bf16 v[52:55], a[200:203], v[172:175], v[52:55]
s_waitcnt vmcnt(18)
ds_read_b128 v[104:107], v47 offset:11264
s_add_u32 s68, s68, 4096
v_mfma_f32_16x16x32_bf16 v[60:63], a[204:207], v[172:175], v[60:63]
buffer_load_dwordx4 v[132:135], v1, s[4:7], s68 offen offset:0 sc1
s_waitcnt lgkmcnt(6)
v_mfma_f32_16x16x32_bf16 v[16:19], a[208:211], v[80:83], v[16:19]
s_waitcnt vmcnt(6)
s_barrier
s_add_u32 s3, s32, 11
v_bfrev_b32 v40, 1
v_mov_b32 v41, s3
v_mfma_f32_16x16x32_bf16 v[24:27], a[212:215], v[80:83], v[24:27]
v_writelane_b32 v40, s50, 0
buffer_store_dword v41, v40, s[4:7], s46 offen sc1
ds_read_b128 v[108:111], v47 offset:12288
v_mfma_f32_16x16x32_bf16 v[48:51], a[216:219], v[80:83], v[48:51]
ds_read_b128 v[112:115], v47 offset:13312
v_mfma_f32_16x16x32_bf16 v[56:59], a[220:223], v[80:83], v[56:59]
buffer_load_dwordx4 v[136:139], v1, s[4:7], s20 offen offset:1024 sc1
s_waitcnt lgkmcnt(7)
v_mfma_f32_16x16x32_bf16 v[20:23], a[208:211], v[84:87], v[20:23]
ds_read_b128 v[116:119], v47 offset:14336
v_mfma_f32_16x16x32_bf16 v[28:31], a[212:215], v[84:87], v[28:31]
v_mfma_f32_16x16x32_bf16 v[52:55], a[216:219], v[84:87], v[52:55]
buffer_load_dwordx4 v[140:143], v1, s[4:7], s68 offen offset:1024 sc1
v_mfma_f32_16x16x32_bf16 v[60:63], a[220:223], v[84:87], v[60:63]
s_waitcnt lgkmcnt(7)
v_mfma_f32_16x16x32_bf16 v[16:19], a[224:227], v[88:91], v[16:19]
v_mfma_f32_16x16x32_bf16 v[24:27], a[228:231], v[88:91], v[24:27]
v_mfma_f32_16x16x32_bf16 v[48:51], a[232:235], v[88:91], v[48:51]
v_mfma_f32_16x16x32_bf16 v[56:59], a[236:239], v[88:91], v[56:59]
s_waitcnt lgkmcnt(6)
v_mfma_f32_16x16x32_bf16 v[20:23], a[224:227], v[92:95], v[20:23]
v_mfma_f32_16x16x32_bf16 v[28:31], a[228:231], v[92:95], v[28:31]
v_mfma_f32_16x16x32_bf16 v[52:55], a[232:235], v[92:95], v[52:55]
v_mfma_f32_16x16x32_bf16 v[60:63], a[236:239], v[92:95], v[60:63]
s_waitcnt lgkmcnt(5)
v_mfma_f32_16x16x32_bf16 v[16:19], a[240:243], v[96:99], v[16:19]
v_mfma_f32_16x16x32_bf16 v[24:27], a[244:247], v[96:99], v[24:27]
v_mfma_f32_16x16x32_bf16 v[48:51], a[248:251], v[96:99], v[48:51]
v_mfma_f32_16x16x32_bf16 v[56:59], a[252:255], v[96:99], v[56:59]
s_waitcnt lgkmcnt(4)
v_mfma_f32_16x16x32_bf16 v[20:23], a[240:243], v[100:103], v[20:23]
v_lshlrev_b32 v42, 7, v0
v_mfma_f32_16x16x32_bf16 v[28:31], a[244:247], v[100:103], v[28:31]
buffer_load_dword v44, v42, s[4:7], s43 offen sc1
v_mfma_f32_16x16x32_bf16 v[52:55], a[248:251], v[100:103], v[52:55]
v_mfma_f32_16x16x32_bf16 v[60:63], a[252:255], v[100:103], v[60:63]
s_waitcnt lgkmcnt(3)
v_mfma_f32_16x16x32_bf16 v[16:19], v[176:179], v[104:107], v[16:19]
v_mfma_f32_16x16x32_bf16 v[24:27], v[180:183], v[104:107], v[24:27]
v_mfma_f32_16x16x32_bf16 v[48:51], v[184:187], v[104:107], v[48:51]
v_mfma_f32_16x16x32_bf16 v[56:59], v[188:191], v[104:107], v[56:59]
s_waitcnt lgkmcnt(2)
v_mfma_f32_16x16x32_bf16 v[20:23], v[176:179], v[108:111], v[20:23]
v_mfma_f32_16x16x32_bf16 v[28:31], v[180:183], v[108:111], v[28:31]
v_mfma_f32_16x16x32_bf16 v[52:55], v[184:187], v[108:111], v[52:55]
s_add_u32 s3, s32, 11
s_waitcnt vmcnt(0)
v_subrev_u32 v44, s3, v44
v_cmp_le_u32 vcc, 5, v44
s_nop 0
s_and_b64 vcc, vcc, s[48:49]
v_mfma_f32_16x16x32_bf16 v[60:63], v[188:191], v[108:111], v[60:63]
s_cbranch_scc0 L_chk_33_ok
s_mov_b32 s15, 0
L_chk_33:
buffer_load_dword v44, v42, s[4:7], s43 offen sc1
s_waitcnt vmcnt(0)
s_add_u32 s3, s32, 11
v_subrev_u32 v44, s3, v44
v_cmp_le_u32 vcc, 5, v44
s_nop 0
s_and_b64 vcc, vcc, s[48:49]
s_cbranch_scc0 L_chk_33_ok
s_add_u32 s15, s15, 1
s_cmp_lt_u32 s15, 131072
s_cbranch_scc1 L_chk_33
L_chk_33_ok:
s_waitcnt lgkmcnt(1)
v_mfma_f32_16x16x32_bf16 v[16:19], v[192:195], v[112:115], v[16:19]
buffer_load_dwordx4 v[144:147], v1, s[4:7], s21 offen offset:0 sc1
v_mfma_f32_16x16x32_bf16 v[24:27], v[196:199], v[112:115], v[24:27]
v_mfma_f32_16x16x32_bf16 v[48:51], v[200:203], v[112:115], v[48:51]
buffer_load_dwordx4 v[148:151], v1, s[4:7], s69 offen offset:0 sc1
v_mfma_f32_16x16x32_bf16 v[56:59], v[204:207], v[112:115], v[56:59]
s_waitcnt lgkmcnt(0)
v_mfma_f32_16x16x32_bf16 v[20:23], v[192:195], v[116:119], v[20:23]
buffer_load_dwordx4 v[152:155], v1, s[4:7], s21 offen offset:1024 sc1
v_mfma_f32_16x16x32_bf16 v[28:31], v[196:199], v[116:119], v[28:31]
v_mfma_f32_16x16x32_bf16 v[52:55], v[200:203], v[116:119], v[52:55]
buffer_load_dwordx4 v[156:159], v1, s[4:7], s69 offen offset:1024 sc1
v_mfma_f32_16x16x32_bf16 v[60:63], v[204:207], v[116:119], v[60:63]
v_mfma_f32_16x16x32_bf16 v[16:19], v[208:211], v[120:123], v[16:19]
buffer_load_dwordx4 v[160:163], v1, s[4:7], s21 offen offset:2048 sc1
v_mfma_f32_16x16x32_bf16 v[24:27], v[212:215], v[120:123], v[24:27]
v_mfma_f32_16x16x32_bf16 v[48:51], v[216:219], v[120:123], v[48:51]
buffer_load_dwordx4 v[164:167], v1, s[4:7], s69 offen offset:2048 sc1
v_mfma_f32_16x16x32_bf16 v[56:59], v[220:223], v[120:123], v[56:59]
v_mfma_f32_16x16x32_bf16 v[20:23], v[208:211], v[124:127], v[20:23]
buffer_load_dwordx4 v[168:171], v1, s[4:7], s21 offen offset:3072 sc1
v_mfma_f32_16x16x32_bf16 v[28:31], v[212:215], v[124:127], v[28:31]
v_mfma_f32_16x16x32_bf16 v[52:55], v[216:219], v[124:127], v[52:55]
buffer_load_dwordx4 v[172:175], v1, s[4:7], s69 offen offset:3072 sc1
v_mfma_f32_16x16x32_bf16 v[60:63], v[220:223], v[124:127], v[60:63]
v_mfma_f32_16x16x32_bf16 v[16:19], v[224:227], v[128:131], v[16:19]
s_add_u32 s21, s21, 4096
v_mfma_f32_16x16x32_bf16 v[24:27], v[228:231], v[128:131], v[24:27]
buffer_load_dwordx4 v[80:83], v1, s[4:7], s21 offen offset:0 sc1
v_mfma_f32_16x16x32_bf16 v[48:51], v[232:235], v[128:131], v[48:51]
s_add_u32 s69, s69, 4096
v_mfma_f32_16x16x32_bf16 v[56:59], v[236:239], v[128:131], v[56:59]
buffer_load_dwordx4 v[84:87], v1, s[4:7], s69 offen offset:0 sc1
v_mfma_f32_16x16x32_bf16 v[20:23], v[224:227], v[132:135], v[20:23]
buffer_load_dwordx4 v[88:91], v1, s[4:7], s21 offen offset:1024 sc1
v_mfma_f32_16x16x32_bf16 v[28:31], v[228:231], v[132:135], v[28:31]
v_mfma_f32_16x16x32_bf16 v[52:55], v[232:235], v[132:135], v[52:55]
buffer_load_dwordx4 v[92:95], v1, s[4:7], s69 offen offset:1024 sc1
v_mfma_f32_16x16x32_bf16 v[60:63], v[236:239], v[132:135], v[60:63]
v_mfma_f32_16x16x32_bf16 v[16:19], v[240:243], v[136:139], v[16:19]
buffer_load_dwordx4 v[96:99], v1, s[4:7], s21 offen offset:2048 sc1
v_mfma_f32_16x16x32_bf16 v[24:27], v[244:247], v[136:139], v[24:27]
v_mfma_f32_16x16x32_bf16 v[48:51], v[248:251], v[136:139], v[48:51]
buffer_load_dwordx4 v[100:103], v1, s[4:7], s69 offen offset:2048 sc1
v_mfma_f32_16x16x32_bf16 v[56:59], v[252:255], v[136:139], v[56:59]
v_mfma_f32_16x16x32_bf16 v[20:23], v[240:243], v[140:143], v[20:23]
buffer_load_dwordx4 v[104:107], v1, s[4:7], s21 offen offset:3072 sc1
v_mfma_f32_16x16x32_bf16 v[28:31], v[244:247], v[140:143], v[28:31]
v_mfma_f32_16x16x32_bf16 v[52:55], v[248:251], v[140:143], v[52:55]
buffer_load_dwordx4 v[108:111], v1, s[4:7], s69 offen offset:3072 sc1
v_mfma_f32_16x16x32_bf16 v[60:63], v[252:255], v[140:143], v[60:63]
s_waitcnt vmcnt(15)
v_mfma_f32_16x16x32_bf16 v[32:35], a[112:115], v[144:147], 0
v_mfma_f32_16x16x32_bf16 v[40:43], a[116:119], v[144:147], 0
v_mfma_f32_16x16x32_bf16 v[64:67], a[120:123], v[144:147], 0
s_add_u32 s21, s21, 4096
v_mfma_f32_16x16x32_bf16 v[72:75], a[124:127], v[144:147], 0
buffer_load_dwordx4 v[112:115], v1, s[4:7], s21 offen offset:0 sc1
s_waitcnt vmcnt(15)
v_mfma_f32_16x16x32_bf16 v[36:39], a[112:115], v[148:151], 0
ds_write_b128 v4, v[16:19] offset:0
v_mfma_f32_16x16x32_bf16 v[44:47], a[116:119], v[148:151], 0
v_mfma_f32_16x16x32_bf16 v[68:71], a[120:123], v[148:151], 0
s_add_u32 s69, s69, 4096
v_mfma_f32_16x16x32_bf16 v[76:79], a[124:127], v[148:151], 0
buffer_load_dwordx4 v[116:119], v1, s[4:7], s69 offen offset:0 sc1
s_waitcnt vmcnt(15)
v_mfma_f32_16x16x32_bf16 v[32:35], a[128:131], v[152:155], v[32:35]
ds_write_b128 v4, v[20:23] offset:1024
v_mfma_f32_16x16x32_bf16 v[40:43], a[132:135], v[152:155], v[40:43]
v_mfma_f32_16x16x32_bf16 v[64:67], a[136:139], v[152:155], v[64:67]
buffer_load_dwordx4 v[120:123], v1, s[4:7], s21 offen offset:1024 sc1
v_mfma_f32_16x16x32_bf16 v[72:75], a[140:143], v[152:155], v[72:75]
s_waitcnt vmcnt(15)
v_mfma_f32_16x16x32_bf16 v[36:39], a[128:131], v[156:159], v[36:39]
ds_write_b128 v5, v[24:27] offset:2048
v_mfma_f32_16x16x32_bf16 v[44:47], a[132:135], v[156:159], v[44:47]
v_mfma_f32_16x16x32_bf16 v[68:71], a[136:139], v[156:159], v[68:71]
buffer_load_dwordx4 v[124:127], v1, s[4:7], s69 offen offset:1024 sc1
v_mfma_f32_16x16x32_bf16 v[76:79], a[140:143], v[156:159], v[76:79]
s_waitcnt vmcnt(15)
v_mfma_f32_16x16x32_bf16 v[32:35], a[144:147], v[160:163], v[32:35]
ds_write_b128 v5, v[28:31] offset:3072
v_mfma_f32_16x16x32_bf16 v[40:43], a[148:151], v[160:163], v[40:43]
v_mfma_f32_16x16x32_bf16 v[64:67], a[152:155], v[160:163], v[64:67]
buffer_load_dwordx4 v[128:131], v1, s[4:7], s21 offen offset:2048 sc1
v_mfma_f32_16x16x32_bf16 v[72:75], a[156:159], v[160:163], v[72:75]
s_waitcnt vmcnt(15)
v_mfma_f32_16x16x32_bf16 v[36:39], a[144:147], v[164:167], v[36:39]
ds_write_b128 v4, v[48:51] offset:4096
v_mfma_f32_16x16x32_bf16 v[44:47], a[148:151], v[164:167], v[44:47]
v_mfma_f32_16x16x32_bf16 v[68:71], a[152:155], v[164:167], v[68:71]
buffer_load_dwordx4 v[132:135], v1, s[4:7], s69 offen offset:2048 sc1
v_mfma_f32_16x16x32_bf16 v[76:79], a[156:159], v[164:167], v[76:79]
s_waitcnt vmcnt(15)
v_mfma_f32_16x16x32_bf16 v[32:35], a[160:163], v[168:171], v[32:35]
ds_write_b128 v4, v[52:55] offset:5120
v_mfma_f32_16x16x32_bf16 v[40:43], a[164:167], v[168:171], v[40:43]
v_mfma_f32_16x16x32_bf16 v[64:67], a[168:171], v[168:171], v[64:67]
buffer_load_dwordx4 v[136:139], v1, s[4:7], s21 offen offset:3072 sc1
v_mfma_f32_16x16x32_bf16 v[72:75], a[172:175], v[168:171], v[72:75]
s_waitcnt vmcnt(15)
v_mfma_f32_16x16x32_bf16 v[36:39], a[160:163], v[172:175], v[36:39]
ds_write_b128 v5, v[56:59] offset:6144
v_mfma_f32_16x16x32_bf16 v[44:47], a[164:167], v[172:175], v[44:47]
v_mfma_f32_16x16x32_bf16 v[68:71], a[168:171], v[172:175], v[68:71]
buffer_load_dwordx4 v[140:143], v1, s[4:7], s69 offen offset:3072 sc1
v_mfma_f32_16x16x32_bf16 v[76:79], a[172:175], v[172:175], v[76:79]
s_waitcnt vmcnt(15)
v_mfma_f32_16x16x32_bf16 v[32:35], a[176:179], v[80:83], v[32:35]
ds_write_b128 v5, v[60:63] offset:7168
v_mfma_f32_16x16x32_bf16 v[40:43], a[180:183], v[80:83], v[40:43]
v_mfma_f32_16x16x32_bf16 v[64:67], a[184:187], v[80:83], v[64:67]
s_add_u32 s21, s21, 4096
v_mfma_f32_16x16x32_bf16 v[72:75], a[188:191], v[80:83], v[72:75]
buffer_load_dwordx4 v[144:147], v1, s[4:7], s21 offen offset:0 sc1
s_waitcnt vmcnt(15)
v_mfma_f32_16x16x32_bf16 v[36:39], a[176:179], v[84:87], v[36:39]
v_mfma_f32_16x16x32_bf16 v[44:47], a[180:183], v[84:87], v[44:47]
v_mfma_f32_16x16x32_bf16 v[68:71], a[184:187], v[84:87], v[68:71]
s_add_u32 s69, s69, 4096
v_mfma_f32_16x16x32_bf16 v[76:79], a[188:191], v[84:87], v[76:79]
buffer_load_dwordx4 v[148:151], v1, s[4:7], s69 offen offset:0 sc1
s_waitcnt vmcnt(15)
v_mfma_f32_16x16x32_bf16 v[32:35], a[192:195], v[88:91], v[32:35]
s_waitcnt lgkmcnt(0)
s_barrier
v_mfma_f32_16x16x32_bf16 v[40:43], a[196:199], v[88:91], v[40:43]
ds_read_b128 v[16:19], v2 offset:0
ds_read_b128 v[20:23], v2 offset:512
v_mfma_f32_16x16x32_bf16 v[64:67], a[200:203], v[88:91], v[64:67]
buffer_load_dwordx4 v[152:155], v1, s[4:7], s21 offen offset:1024 sc1
ds_read_b128 v[24:27], v2 offset:8192
v_mfma_f32_16x16x32_bf16 v[72:75], a[204:207], v[88:91], v[72:75]
ds_read_b128 v[28:31], v2 offset:8704
s_waitcnt vmcnt(15)
v_mfma_f32_16x16x32_bf16 v[36:39], a[192:195], v[92:95], v[36:39]
ds_read_b128 v[48:51], v2 offset:16384
v_mfma_f32_16x16x32_bf16 v[44:47], a[196:199], v[92:95], v[44:47]
ds_read_b128 v[52:55], v2 offset:16896
v_mfma_f32_16x16x32_bf16 v[68:71], a[200:203], v[92:95], v[68:71]
buffer_load_dwordx4 v[156:159], v1, s[4:7], s69 offen offset:1024 sc1
ds_read_b128 v[56:59], v2 offset:24576
v_mfma_f32_16x16x32_bf16 v[76:79], a[204:207], v[92:95], v[76:79]
ds_read_b128 v[60:63], v2 offset:25088
s_waitcnt vmcnt(15)
v_mfma_f32_16x16x32_bf16 v[32:35], a[208:211], v[96:99], v[32:35]
v_mfma_f32_16x16x32_bf16 v[40:43], a[212:215], v[96:99], v[40:43]
v_mfma_f32_16x16x32_bf16 v[64:67], a[216:219], v[96:99], v[64:67]
s_waitcnt lgkmcnt(5)
v_add_f32 v24, v24, v16
v_add_f32 v25, v25, v17
v_mfma_f32_16x16x32_bf16 v[72:75], a[220:223], v[96:99], v[72:75]
v_add_f32 v26, v26, v18
v_add_f32 v27, v27, v19
s_waitcnt vmcnt(14)
v_mfma_f32_16x16x32_bf16 v[36:39], a[208:211], v[100:103], v[36:39]
s_waitcnt lgkmcnt(4)
v_add_f32 v28, v28, v20
v_add_f32 v29, v29, v21
v_mfma_f32_16x16x32_bf16 v[44:47], a[212:215], v[100:103], v[44:47]
v_add_f32 v30, v30, v22
v_add_f32 v31, v31, v23
v_mfma_f32_16x16x32_bf16 v[68:71], a[216:219], v[100:103], v[68:71]
v_lshlrev_b32 v16, 16, v8
v_and_b32 v17, 0xffff0000, v8
v_mfma_f32_16x16x32_bf16 v[76:79], a[220:223], v[100:103], v[76:79]
v_lshlrev_b32 v18, 16, v9
v_and_b32 v19, 0xffff0000, v9
s_waitcnt vmcnt(13)
v_mfma_f32_16x16x32_bf16 v[32:35], a[224:227], v[104:107], v[32:35]
v_lshlrev_b32 v20, 16, v10
v_and_b32 v21, 0xffff0000, v10
v_mfma_f32_16x16x32_bf16 v[40:43], a[228:231], v[104:107], v[40:43]
v_lshlrev_b32 v22, 16, v11
v_and_b32 v23, 0xffff0000, v11
v_mfma_f32_16x16x32_bf16 v[64:67], a[232:235], v[104:107], v[64:67]
v_add_f32 v24, v24, v16
v_add_f32 v25, v25, v17
v_mfma_f32_16x16x32_bf16 v[72:75], a[236:239], v[104:107], v[72:75]
v_add_f32 v26, v26, v18
v_add_f32 v27, v27, v19
s_waitcnt vmcnt(12)
v_mfma_f32_16x16x32_bf16 v[36:39], a[224:227], v[108:111], v[36:39]
v_add_f32 v28, v28, v20
v_add_f32 v29, v29, v21
v_mfma_f32_16x16x32_bf16 v[44:47], a[228:231], v[108:111], v[44:47]
v_add_f32 v30, v30, v22
v_add_f32 v31, v31, v23
v_mfma_f32_16x16x32_bf16 v[68:71], a[232:235], v[108:111], v[68:71]
s_waitcnt lgkmcnt(1)
v_add_f32 v48, v48, v56
v_add_f32 v49, v49, v57
v_mfma_f32_16x16x32_bf16 v[76:79], a[236:239], v[108:111], v[76:79]
v_add_f32 v50, v50, v58
v_add_f32 v51, v51, v59
s_waitcnt vmcnt(11)
v_mfma_f32_16x16x32_bf16 v[32:35], a[240:243], v[112:115], v[32:35]
s_waitcnt lgkmcnt(0)
v_add_f32 v52, v52, v60
v_add_f32 v53, v53, v61
v_mfma_f32_16x16x32_bf16 v[40:43], a[244:247], v[112:115], v[40:43]
v_add_f32 v54, v54, v62
v_add_f32 v55, v55, v63
v_mfma_f32_16x16x32_bf16 v[64:67], a[248:251], v[112:115], v[64:67]
v_add_f32 v24, v24, v48
v_add_f32 v25, v25, v49
v_mfma_f32_16x16x32_bf16 v[72:75], a[252:255], v[112:115], v[72:75]
v_add_f32 v26, v26, v50
v_add_f32 v27, v27, v51
s_waitcnt vmcnt(10)
v_mfma_f32_16x16x32_bf16 v[36:39], a[240:243], v[116:119], v[36:39]
v_add_f32 v28, v28, v52
v_add_f32 v29, v29, v53
v_mfma_f32_16x16x32_bf16 v[44:47], a[244:247], v[116:119], v[44:47]
v_add_f32 v30, v30, v54
v_add_f32 v31, v31, v55
v_mfma_f32_16x16x32_bf16 v[68:71], a[248:251], v[116:119], v[68:71]
v_cvt_pk_bf16_f32 v8, v24, v25
v_cvt_pk_bf16_f32 v9, v26, v27
v_mfma_f32_16x16x32_bf16 v[76:79], a[252:255], v[116:119], v[76:79]
v_cvt_pk_bf16_f32 v10, v28, v29
v_cvt_pk_bf16_f32 v11, v30, v31
s_waitcnt vmcnt(9)
v_mfma_f32_16x16x32_bf16 v[32:35], v[176:179], v[120:123], v[32:35]
buffer_store_dwordx2 v[8:9], v3, s[8:11], s18 offen offset:0 nt
v_mfma_f32_16x16x32_bf16 v[40:43], v[180:183], v[120:123], v[40:43]
buffer_store_dwordx2 v[10:11], v3, s[8:11], s18 offen offset:16 nt
v_mfma_f32_16x16x32_bf16 v[64:67], v[184:187], v[120:123], v[64:67]
v_mfma_f32_16x16x32_bf16 v[72:75], v[188:191], v[120:123], v[72:75]
s_waitcnt vmcnt(10)
v_mfma_f32_16x16x32_bf16 v[36:39], v[176:179], v[124:127], v[36:39]
v_mfma_f32_16x16x32_bf16 v[44:47], v[180:183], v[124:127], v[44:47]
v_mfma_f32_16x16x32_bf16 v[68:71], v[184:187], v[124:127], v[68:71]
v_mfma_f32_16x16x32_bf16 v[76:79], v[188:191], v[124:127], v[76:79]
s_waitcnt vmcnt(9)
v_mfma_f32_16x16x32_bf16 v[32:35], v[192:195], v[128:131], v[32:35]
v_mfma_f32_16x16x32_bf16 v[40:43], v[196:199], v[128:131], v[40:43]
v_mfma_f32_16x16x32_bf16 v[64:67], v[200:203], v[128:131], v[64:67]
v_mfma_f32_16x16x32_bf16 v[72:75], v[204:207], v[128:131], v[72:75]
s_waitcnt vmcnt(8)
v_mfma_f32_16x16x32_bf16 v[36:39], v[192:195], v[132:135], v[36:39]
v_mfma_f32_16x16x32_bf16 v[44:47], v[196:199], v[132:135], v[44:47]
v_mfma_f32_16x16x32_bf16 v[68:71], v[200:203], v[132:135], v[68:71]
v_mfma_f32_16x16x32_bf16 v[76:79], v[204:207], v[132:135], v[76:79]
s_waitcnt vmcnt(7)
v_mfma_f32_16x16x32_bf16 v[32:35], v[208:211], v[136:139], v[32:35]
v_mfma_f32_16x16x32_bf16 v[40:43], v[212:215], v[136:139], v[40:43]
s_waitcnt vmcnt(6)
v_mfma_f32_16x16x32_bf16 v[36:39], v[208:211], v[140:143], v[36:39]
v_mfma_f32_16x16x32_bf16 v[44:47], v[212:215], v[140:143], v[44:47]
s_waitcnt vmcnt(5)
v_mfma_f32_16x16x32_bf16 v[32:35], v[224:227], v[144:147], v[32:35]
v_mfma_f32_16x16x32_bf16 v[40:43], v[228:231], v[144:147], v[40:43]
s_waitcnt vmcnt(4)
v_mfma_f32_16x16x32_bf16 v[36:39], v[224:227], v[148:151], v[36:39]
v_mfma_f32_16x16x32_bf16 v[44:47], v[228:231], v[148:151], v[44:47]
s_waitcnt vmcnt(3)
v_mfma_f32_16x16x32_bf16 v[32:35], v[240:243], v[152:155], v[32:35]
v_mfma_f32_16x16x32_bf16 v[40:43], v[244:247], v[152:155], v[40:43]
s_waitcnt vmcnt(2)
v_mfma_f32_16x16x32_bf16 v[36:39], v[240:243], v[156:159], v[36:39]
v_mfma_f32_16x16x32_bf16 v[44:47], v[244:247], v[156:159], v[44:47]
v_mfma_f32_16x16x32_bf16 v[64:67], v[216:219], v[136:139], v[64:67]
v_mfma_f32_16x16x32_bf16 v[72:75], v[220:223], v[136:139], v[72:75]
v_mfma_f32_16x16x32_bf16 v[68:71], v[216:219], v[140:143], v[68:71]
v_mfma_f32_16x16x32_bf16 v[76:79], v[220:223], v[140:143], v[76:79]
v_mfma_f32_16x16x32_bf16 v[64:67], v[232:235], v[144:147], v[64:67]
ds_write_b128 v4, v[32:35] offset:32768
v_mfma_f32_16x16x32_bf16 v[72:75], v[236:239], v[144:147], v[72:75]
v_mfma_f32_16x16x32_bf16 v[68:71], v[232:235], v[148:151], v[68:71]
ds_write_b128 v4, v[36:39] offset:33792
v_mfma_f32_16x16x32_bf16 v[76:79], v[236:239], v[148:151], v[76:79]
v_mfma_f32_16x16x32_bf16 v[64:67], v[248:251], v[152:155], v[64:67]
ds_write_b128 v5, v[40:43] offset:34816
v_mfma_f32_16x16x32_bf16 v[72:75], v[252:255], v[152:155], v[72:75]
v_mfma_f32_16x16x32_bf16 v[68:71], v[248:251], v[156:159], v[68:71]
ds_write_b128 v5, v[44:47] offset:35840
v_mfma_f32_16x16x32_bf16 v[76:79], v[252:255], v[156:159], v[76:79]
v_lshlrev_b32 v128, 16, v12
v_and_b32 v129, 0xffff0000, v12
v_lshlrev_b32 v130, 16, v13
v_and_b32 v131, 0xffff0000, v13
v_lshlrev_b32 v132, 16, v14
v_and_b32 v133, 0xffff0000, v14
v_lshlrev_b32 v134, 16, v15
v_and_b32 v135, 0xffff0000, v15
ds_write_b128 v4, v[64:67] offset:36864
ds_write_b128 v4, v[68:71] offset:37888
ds_write_b128 v5, v[72:75] offset:38912
ds_write_b128 v5, v[76:79] offset:39936
s_waitcnt lgkmcnt(0)
s_barrier
ds_read_b128 v[32:35], v2 offset:32768
ds_read_b128 v[36:39], v2 offset:33280
ds_read_b128 v[40:43], v2 offset:40960
ds_read_b128 v[44:47], v2 offset:41472
ds_read_b128 v[64:67], v2 offset:49152
ds_read_b128 v[68:71], v2 offset:49664
ds_read_b128 v[72:75], v2 offset:57344
ds_read_b128 v[76:79], v2 offset:57856
s_waitcnt lgkmcnt(7)
v_add_f32 v128, v128, v32
v_add_f32 v129, v129, v33
v_add_f32 v130, v130, v34
v_add_f32 v131, v131, v35
s_waitcnt lgkmcnt(6)
v_add_f32 v132, v132, v36
v_add_f32 v133, v133, v37
v_add_f32 v134, v134, v38
v_add_f32 v135, v135, v39
s_waitcnt lgkmcnt(5)
v_add_f32 v128, v128, v40
v_add_f32 v129, v129, v41
v_add_f32 v130, v130, v42
v_add_f32 v131, v131, v43
s_waitcnt lgkmcnt(4)
v_add_f32 v132, v132, v44
v_add_f32 v133, v133, v45
v_add_f32 v134, v134, v46
v_add_f32 v135, v135, v47
s_waitcnt lgkmcnt(1)
v_add_f32 v64, v64, v72
v_add_f32 v65, v65, v73
v_add_f32 v66, v66, v74
v_add_f32 v67, v67, v75
s_waitcnt lgkmcnt(0)
v_add_f32 v68, v68, v76
v_add_f32 v69, v69, v77
v_add_f32 v70, v70, v78
v_add_f32 v71, v71, v79
v_add_f32 v128, v128, v64
v_add_f32 v129, v129, v65
v_add_f32 v130, v130, v66
v_add_f32 v131, v131, v67
v_add_f32 v132, v132, v68
v_add_f32 v133, v133, v69
v_add_f32 v134, v134, v70
v_add_f32 v135, v135, v71
v_cvt_pk_bf16_f32 v12, v128, v129
v_cvt_pk_bf16_f32 v13, v130, v131
v_cvt_pk_bf16_f32 v14, v132, v133
v_cvt_pk_bf16_f32 v15, v134, v135
s_sub_u32 s18, s18, 229376
buffer_store_dwordx2 v[12:13], v3, s[8:11], s18 offen offset:0 nt
buffer_store_dwordx2 v[14:15], v3, s[8:11], s18 offen offset:16 nt
s_endpgm
interleave_layers__sliding_local_dilated__glu_gated_swiglu__prompt_kernel_h2G:
s_endpgm
interleave_layers__sliding_local_dilated__glu_gated_swiglu__prompt_kernel_end:
s_endpgm

.section .rodata,"a"
.p2align 6
.amdhsa_kernel interleave_layers__sliding_local_dilated__glu_gated_swiglu__prompt_kernel
  .amdhsa_next_free_vgpr 512
  .amdhsa_next_free_sgpr 102
  .amdhsa_accum_offset 256
  .amdhsa_group_segment_fixed_size 0
  .amdhsa_kernarg_size 80
  .amdhsa_user_sgpr_count 2
  .amdhsa_user_sgpr_kernarg_segment_ptr 1
  .amdhsa_system_sgpr_workgroup_id_x 1
.end_amdhsa_kernel
```
